```python
import torch

def _softmax(x, axis=-1):
    return torch.softmax(x, dim=axis)
def _gelu(x):
    return torch.nn.functional.gelu(x, approximate="tanh")
def _silu(x):
    return torch.nn.functional.silu(x)
def _sigmoid(x):
    return torch.sigmoid(x)
def _layernorm(x, axis=-1, eps=1e-5):
    m = x.mean(dim=axis, keepdim=True)
    v = x.var(dim=axis, keepdim=True, unbiased=False)
    return (x - m) / torch.sqrt(v + eps)
def _scatter_add(tgt, idx, src, axis=0):
    return tgt.clone().index_add_(axis, idx, src)
def _segment_sum(src, seg, n):
    out = torch.zeros((n,) + src.shape[1:], dtype=src.dtype)
    return out.index_add_(0, seg, src)
def _pad(x, pw):
    flat = tuple(v for pair in reversed(pw) for v in pair)
    return torch.nn.functional.pad(x, flat)

kernel_name = 'recurrent_scan__linear_attn_block__glu_gated_swiglu__prompt'

def setup_inputs():

    _w = (lambda a: (lambda t: t.to(torch.bfloat16) if t.is_floating_point() else t)(torch.as_tensor(a)))
    def _A_setup():
        B, S, D = 1, 2048, 1024
        return {
            "x": _w((lambda *s: torch.randn(*s, dtype=torch.bfloat16) * 0.05)(B, S, D)),
            "wqkv": _w((lambda *s: torch.randn(*s, dtype=torch.bfloat16) * 0.8)(D, 3 * D)),
            "wo": _w((lambda *s: torch.randn(*s, dtype=torch.bfloat16) * 0.8)(D, D)),
        }
    _A_in = _A_setup()

    def _B_setup():
        B, S, D, F = 1, 2048, 1024, 3584
        return {
            "x": _w((lambda *s: torch.randn(*s, dtype=torch.bfloat16) * 0.05)(B, S, D)),
            "w1": _w((lambda *s: torch.randn(*s, dtype=torch.bfloat16) * 0.2)(D, F) * (2.0 / D) ** 0.5),
            "w3": _w((lambda *s: torch.randn(*s, dtype=torch.bfloat16) * 0.2)(D, F) * (2.0 / D) ** 0.5),
            "w2": _w((lambda *s: torch.randn(*s, dtype=torch.bfloat16) * 0.2)(F, D) * (2.0 / F) ** 0.5),
        }
    _B_in = _B_setup()

    return {
        "A_x": _A_in["x"],
        "A_wqkv": _A_in["wqkv"],
        "A_wo": _A_in["wo"],
        "B_x": _B_in["x"],
        "B_w1": _B_in["w1"],
        "B_w3": _B_in["w3"],
        "B_w2": _B_in["w2"],
    }

def reference(A_x, A_wqkv, A_wo, B_x, B_w1, B_w3, B_w2):
    def _A_ref(x, wqkv, wo):
        B, S, D = x.shape
        H = 32; Dh = D // H
        qkv = (lambda x, *d: x.permute(*d))((x @ wqkv).reshape(B, S, 3, H, Dh), 2, 0, 3, 1, 4)
        q, k, v = qkv[0], qkv[1], qkv[2]
        phi = lambda t: torch.where(t > 0, t + 1, torch.exp(t)) + 1e-6
        pq, pk = phi(q), phi(k)
        kv = torch.einsum("bhsd,bhse->bhde", pk, v)
        z = torch.einsum("bhsd->bhd", pk)
        num = torch.einsum("bhqd,bhde->bhqe", pq, kv)
        den = torch.einsum("bhqd,bhd->bhq", pq, z)[..., None] + 1e-6
        o = num / den
        return (lambda x, *d: x.permute(*d))(o, 0, 2, 1, 3).reshape(B, S, D) @ wo

    def _B_ref(x, w1, w3, w2):
        gate = torch.einsum("bsd,df->bsf", x, w1)
        up = torch.einsum("bsd,df->bsf", x, w3)
        h = _silu(gate) * up
        out = torch.einsum("bsf,fd->bsd", h, w2)
        return out

    x = A_x
    xn = _layernorm(x, axis=-1)
    s = _A_ref(xn, A_wqkv, A_wo)
    g = _silu(_B_ref(xn, B_w1, B_w3, B_w2))
    return x + s * g
```

```asm
; @launch grid=(256,1,1) block=(256,1,1) lds=163840
.amdgcn_target "amdgcn-amd-amdhsa--gfx950"
.text
.globl recurrent_scan__linear_attn_block__glu_gated_swiglu__prompt_kernel
.p2align 8
.type recurrent_scan__linear_attn_block__glu_gated_swiglu__prompt_kernel,@function
recurrent_scan__linear_attn_block__glu_gated_swiglu__prompt_kernel:
    s_cmp_ge_u32 s2, 256
    s_cbranch_scc1 L_done
    s_load_dwordx2 s[4:5], s[0:1], 0
    s_load_dwordx4 s[72:75], s[0:1], 8
    s_load_dwordx4 s[76:79], s[0:1], 32
    s_load_dwordx4 s[80:83], s[0:1], 48
    s_load_dwordx2 s[6:7], s[0:1], 72
    s_getpc_b64 s[32:33]
L_pc0:
    s_and_b32 s33, s33, 0xffff
    s_mov_b32 s34, L_done-L_pc0
    s_mov_b32 s35, 0x20000
    s_bitcmp1_b32 s2, 2
    s_cselect_b32 s52, L_clsB-L_pc0, 0
    s_bfe_u32 s53, s2, 0x30003
    s_lshl_b32 s53, s53, 11
    s_add_u32 s52, s52, s53
    v_lshrrev_b32 v30, 4, v0
    v_lshlrev_b32 v30, 7, v30
    buffer_load_dword v30, v30, s[32:35], s52 offen
    v_lshrrev_b32 v1, 6, v0
    v_and_b32 v2, 63, v0
    v_readfirstlane_b32 s49, v1
    s_and_b32 s52, s2, 7
    s_bfe_u32 s50, s2, 0x30003
    s_lshr_b32 s51, s2, 6
    s_lshl_b32 s52, s52, 2
    s_add_u32 s56, s51, s52
    s_and_b32 s51, s56, 15
    s_and_b32 s54, s49, 1
    s_lshr_b32 s55, s49, 1
    s_mov_b32 s57, 0xbfb8aa3b
    v_lshlrev_b32 v12, 4, v2
    v_lshlrev_b32 v31, 22, v2
    s_lshr_b32 s52, s50, 2
    s_lshl_b32 s62, s52, 4
    s_lshl_b32 s63, s52, 10
    s_mul_i32 s42, s62, 196608
    s_mul_i32 s43, s62, 229376
    s_lshl_b32 s53, s50, 19
    s_lshl_b32 s64, s49, 17
    s_add_u32 s64, s64, s53
    s_add_u32 s40, s64, s63
    s_add_u32 s41, s40, 0x10000
    s_lshl_b32 s58, s49, 13
    s_and_b32 s65, s50, 3
    s_sub_u32 s65, 5, s65
    s_lshl_b32 s52, s56, 2
    s_add_u32 s52, s52, s49
    s_lshl_b32 s52, s52, 1
    v_lshrrev_b32 v32, 5, v2
    v_add_u32 v32, s52, v32
    v_and_b32 v33, 31, v2
    v_lshlrev_b32 v34, 11, v32
    v_lshl_add_u32 v34, v33, 4, v34
    v_lshrrev_b32 v96, 4, v2
    v_and_b32 v97, 7, v2
    v_xor_b32 v97, v97, v96
    v_lshrrev_b32 v98, 3, v2
    v_lshlrev_b32 v99, 11, v98
    v_lshl_add_u32 v21, v97, 4, v99
    v_xor_b32 v22, 64, v21
    v_add_u32 v23, 30720, v21
    v_add_u32 v24, 46080, v22
    v_add_u32 v22, 15360, v22
    v_mov_b32 v19, 0x1ec000
    s_waitcnt lgkmcnt(0)
    s_mov_b32 s8, s4
    s_and_b32 s9, s5, 0xffff
    s_mov_b32 s10, 0x400000
    s_mov_b32 s11, 0x20000
    buffer_load_dwordx4 v[40:43], v34, s[8:11], s53 offen offset:0
    buffer_load_dwordx4 v[44:47], v34, s[8:11], s53 offen offset:512
    buffer_load_dwordx4 v[48:51], v34, s[8:11], s53 offen offset:1024
    buffer_load_dwordx4 v[52:55], v34, s[8:11], s53 offen offset:1536
    s_add_u32 m0, s58, 0x0
    s_nop 0
    buffer_load_dwordx4 v21, s[8:11], s40 offen offset:0 lds
    buffer_load_dwordx4 v22, s[8:11], s40 offen offset:1024 lds
    buffer_load_dwordx4 v23, s[8:11], s40 offen offset:2048 lds
    buffer_load_dwordx4 v24, s[8:11], s40 offen offset:3072 lds
    s_mov_b32 s44, s6
    s_and_b32 s45, s7, 0xffff
    s_mov_b32 s46, 0x200000
    s_mov_b32 s47, 0x20000
    buffer_load_dword v3, v19, s[44:47], 0 offen sc1
    s_lshl_b32 s52, s50, 8
    v_add_u32 v100, s52, v32
    v_lshlrev_b32 v101, 5, v100
    v_lshlrev_b32 v100, 2, v100
    v_add_u32 v100, 0x10000, v100
    v_cmp_gt_u32 vcc, 32, v2
    s_mov_b32 s52, 0x1c0000
    s_nop 0
    v_cndmask_b32 v100, v100, v101, vcc
    buffer_load_dword v29, v100, s[44:47], s52 offen
    s_bitcmp1_b32 s2, 2
    s_cbranch_scc1 L_clsB
    s_lshl_b32 s52, s49, 3
    v_add_u32 v104, s52, v98
    v_bfe_u32 v105, v2, 4, 1
    v_lshlrev_b32 v105, 1, v105
    s_lshl_b32 s52, s54, 2
    v_or_b32 v105, s52, v105
    v_and_b32 v106, 7, v2
    v_xor_b32 v105, v105, v106
    v_lshlrev_b32 v105, 4, v105
    v_mul_u32_u24 v106, 6144, v104
    v_add_u32 v13, v106, v105
    v_mul_u32_u24 v106, 7168, v104
    v_add_u32 v14, v106, v105
    s_lshl_b32 s59, s49, 10
    s_and_b32 s52, s50, 3
    s_lshl_b32 s52, s52, 2
    s_add_u32 s52, s52, s49
    s_lshl_b32 s52, s52, 3
    v_and_b32 v104, 7, v2
    v_add_u32 v104, s52, v104
    v_mul_u32_u24 v16, 7168, v104
    v_mul_u32_u24 v104, 6144, v104
    v_min_u32 v105, 2, v98
    v_lshl_add_u32 v15, v105, 11, v104
    s_lshl_b32 s52, s51, 7
    s_add_u32 s52, s52, 2048
    s_add_u32 s12, s72, s52
    s_addc_u32 s13, s73, 0
    s_and_b32 s13, s13, 0xffff
    s_sub_u32 s14, 0x600000, s52
    s_mov_b32 s15, 0x20000
    s_lshl_b32 s52, s51, 7
    s_add_u32 s52, s52, 4096
    s_add_u32 s16, s72, s52
    s_addc_u32 s17, s73, 0
    s_and_b32 s17, s17, 0xffff
    s_sub_u32 s18, 0x600000, s52
    s_mov_b32 s19, 0x20000
    s_lshl_b32 s52, s51, 7
    s_add_u32 s20, s72, s52
    s_addc_u32 s21, s73, 0
    s_and_b32 s21, s21, 0xffff
    s_sub_u32 s22, 0x600000, s52
    s_mov_b32 s23, 0x20000
    s_xor_b32 s52, s52, 128
    s_add_u32 s24, s76, s52
    s_addc_u32 s25, s77, 0
    s_and_b32 s25, s25, 0xffff
    s_sub_u32 s26, 0x700000, s52
    s_mov_b32 s27, 0x20000
    s_add_u32 s28, s78, s52
    s_addc_u32 s29, s79, 0
    s_and_b32 s29, s29, 0xffff
    s_sub_u32 s30, 0x700000, s52
    s_mov_b32 s31, 0x20000
    s_add_u32 m0, s59, 0x10000
    s_nop 0
    buffer_load_dwordx4 v13, s[12:15], s42 offen nt lds
    s_add_u32 m0, s59, 0x11000
    s_nop 0
    buffer_load_dwordx4 v13, s[16:19], s42 offen nt lds
    s_add_u32 m0, s59, 0x12000
    s_nop 0
    buffer_load_dwordx4 v13, s[20:23], s42 offen nt lds
    s_add_u32 m0, s59, 0x13000
    s_nop 0
    buffer_load_dwordx4 v14, s[24:27], s43 offen nt lds
    s_add_u32 s62, s62, 1
    s_and_b32 s62, s62, 31
    s_add_u32 m0, s59, 0x14000
    s_nop 0
    buffer_load_dwordx4 v14, s[28:31], s43 offen nt lds
    s_mul_i32 s43, s62, 229376
    s_mul_i32 s42, s62, 196608
    s_add_u32 m0, s58, 0x1000
    s_nop 0
    buffer_load_dwordx4 v21, s[8:11], s41 offen offset:0 lds
    buffer_load_dwordx4 v22, s[8:11], s41 offen offset:1024 lds
    s_add_u32 s63, s63, 128
    s_and_b32 s63, s63, 2047
    buffer_load_dwordx4 v23, s[8:11], s41 offen offset:2048 lds
    s_add_u32 s40, s64, s63
    buffer_load_dwordx4 v24, s[8:11], s41 offen offset:3072 lds
    s_add_u32 s41, s40, 0x10000
    v_and_b32 v104, 15, v2
    v_lshrrev_b32 v105, 1, v104
    v_xor_b32 v105, v105, v96
    v_lshlrev_b32 v104, 7, v104
    v_lshl_add_u32 v104, v105, 4, v104
    s_lshl_b32 s52, s54, 14
    v_add_u32 v4, s52, v104
    v_xor_b32 v5, 64, v4
    v_bfe_u32 v100, v2, 2, 2
    v_and_b32 v101, 3, v2
    v_lshl_add_u32 v102, v96, 3, v100
    v_lshrrev_b32 v104, 1, v100
    v_and_b32 v105, 1, v96
    v_lshl_or_b32 v104, v105, 1, v104
    s_lshl_b32 s52, s55, 1
    v_xor_b32 v104, s52, v104
    v_lshlrev_b32 v104, 5, v104
    v_lshl_add_u32 v104, v102, 7, v104
    v_lshl_add_u32 v104, v101, 3, v104
    v_add_u32 v6, 0x10000, v104
    v_xor_b32 v8, 32, v6
    v_add_u32 v7, 0xa000, v6
    v_add_u32 v9, 0xa000, v8
    s_cmp_eq_u32 s49, 3
    s_cselect_b32 s36, s74, s80
    s_cselect_b32 s37, s75, s81
    s_mov_b32 s38, 0x700000
    s_cselect_b32 s38, 0x200000, s38
    s_mov_b32 s61, 0x138000
    s_cselect_b32 s61, 0x68000, s61
    s_cselect_b32 s60, 0, s49
    s_and_b32 s37, s37, 0xffff
    s_mov_b32 s39, 0x20000
    s_lshl_b32 s60, s60, 8
    s_add_u32 s60, s60, s2
    s_mul_i32 s60, s60, 1664
    v_min_u32 v18, 12, v2
    v_lshlrev_b32 v18, 7, v18
    s_cmp_eq_u32 s54, 0
    s_cselect_b32 s66, s65, 99
    s_cselect_b32 s67, 99, s65
    s_getpc_b64 s[32:33]
L_pcA:
    s_add_u32 s32, s32, L_tailA-L_pcA
    s_addc_u32 s33, s33, 0
    s_and_b32 s33, s33, 0xffff
    s_mov_b32 s34, L_endC-L_tailA
    s_mov_b32 s35, 0x20000
    s_lshr_b32 s65, s2, 3
    s_lshl_b32 s65, s65, 2
    s_add_u32 s65, s65, s49
    s_mul_i32 s65, s65, 1664
    v_mov_b32 v0, 0x3f803f80
    v_accvgpr_write_b32 a200, 0
    v_accvgpr_write_b32 a201, 0
    v_accvgpr_write_b32 a202, 0
    v_accvgpr_write_b32 a203, 0
    v_accvgpr_write_b32 a204, 0
    v_accvgpr_write_b32 a205, 0
    v_accvgpr_write_b32 a206, 0
    v_accvgpr_write_b32 a207, 0
    v_accvgpr_write_b32 a208, 0
    v_accvgpr_write_b32 a209, 0
    v_accvgpr_write_b32 a210, 0
    v_accvgpr_write_b32 a211, 0
    v_accvgpr_write_b32 a212, 0
    v_accvgpr_write_b32 a213, 0
    v_accvgpr_write_b32 a214, 0
    v_accvgpr_write_b32 a215, 0
    v_accvgpr_write_b32 a216, 0
    v_accvgpr_write_b32 a217, 0
    v_accvgpr_write_b32 a218, 0
    v_accvgpr_write_b32 a219, 0
    v_accvgpr_write_b32 a220, v0
    v_accvgpr_write_b32 a221, v0
    v_accvgpr_write_b32 a222, v0
    v_accvgpr_write_b32 a223, v0
    s_waitcnt vmcnt(15)
    v_lshlrev_b32 v56, 16, v40
    v_and_b32 v57, 0xffff0000, v40
    v_lshlrev_b32 v58, 16, v41
    v_and_b32 v59, 0xffff0000, v41
    v_lshlrev_b32 v60, 16, v42
    v_and_b32 v61, 0xffff0000, v42
    v_lshlrev_b32 v62, 16, v43
    v_and_b32 v63, 0xffff0000, v43
    v_lshlrev_b32 v64, 16, v44
    v_and_b32 v65, 0xffff0000, v44
    v_lshlrev_b32 v66, 16, v45
    v_and_b32 v67, 0xffff0000, v45
    v_lshlrev_b32 v68, 16, v46
    v_and_b32 v69, 0xffff0000, v46
    v_lshlrev_b32 v70, 16, v47
    v_and_b32 v71, 0xffff0000, v47
    v_lshlrev_b32 v72, 16, v48
    v_and_b32 v73, 0xffff0000, v48
    v_lshlrev_b32 v74, 16, v49
    v_and_b32 v75, 0xffff0000, v49
    v_lshlrev_b32 v76, 16, v50
    v_and_b32 v77, 0xffff0000, v50
    v_lshlrev_b32 v78, 16, v51
    v_and_b32 v79, 0xffff0000, v51
    v_lshlrev_b32 v80, 16, v52
    v_and_b32 v81, 0xffff0000, v52
    v_lshlrev_b32 v82, 16, v53
    v_and_b32 v83, 0xffff0000, v53
    v_lshlrev_b32 v84, 16, v54
    v_and_b32 v85, 0xffff0000, v54
    v_lshlrev_b32 v86, 16, v55
    v_and_b32 v87, 0xffff0000, v55
    v_add_f32 v88, v56, v57
    v_add_f32 v89, v58, v59
    v_add_f32 v88, v88, v60
    v_add_f32 v89, v89, v61
    v_add_f32 v88, v88, v62
    v_add_f32 v89, v89, v63
    v_add_f32 v88, v88, v64
    v_add_f32 v89, v89, v65
    v_add_f32 v88, v88, v66
    v_add_f32 v89, v89, v67
    v_add_f32 v88, v88, v68
    v_add_f32 v89, v89, v69
    v_add_f32 v88, v88, v70
    v_add_f32 v89, v89, v71
    v_add_f32 v88, v88, v72
    v_add_f32 v89, v89, v73
    v_add_f32 v88, v88, v74
    v_add_f32 v89, v89, v75
    v_add_f32 v88, v88, v76
    v_add_f32 v89, v89, v77
    v_add_f32 v88, v88, v78
    v_add_f32 v89, v89, v79
    v_add_f32 v88, v88, v80
    v_add_f32 v89, v89, v81
    v_add_f32 v88, v88, v82
    v_add_f32 v89, v89, v83
    v_add_f32 v88, v88, v84
    v_add_f32 v89, v89, v85
    v_add_f32 v88, v88, v86
    v_add_f32 v89, v89, v87
    v_add_f32 v88, v88, v89
    s_nop 1
    v_add_f32_dpp v88, v88, v88 quad_perm:[1,0,3,2] row_mask:0xf bank_mask:0xf
    s_nop 1
    v_add_f32_dpp v88, v88, v88 quad_perm:[2,3,0,1] row_mask:0xf bank_mask:0xf
    s_nop 1
    v_add_f32_dpp v88, v88, v88 row_half_mirror row_mask:0xf bank_mask:0xf
    s_nop 1
    v_add_f32_dpp v88, v88, v88 row_mirror row_mask:0xf bank_mask:0xf
    v_mov_b32 v90, v88
    s_nop 1
    v_permlane16_swap_b32 v90, v88
    s_nop 1
    v_add_f32 v88, v88, v90
    v_mul_f32 v88, 0x3a800000, v88
    v_sub_f32 v90, v56, v88
    v_sub_f32 v91, v57, v88
    v_mul_f32 v92, v90, v90
    v_mul_f32 v93, v91, v91
    v_sub_f32 v90, v58, v88
    v_sub_f32 v91, v59, v88
    v_fmac_f32 v92, v90, v90
    v_fmac_f32 v93, v91, v91
    v_sub_f32 v90, v60, v88
    v_sub_f32 v91, v61, v88
    v_fmac_f32 v92, v90, v90
    v_fmac_f32 v93, v91, v91
    v_sub_f32 v90, v62, v88
    v_sub_f32 v91, v63, v88
    v_fmac_f32 v92, v90, v90
    v_fmac_f32 v93, v91, v91
    v_sub_f32 v90, v64, v88
    v_sub_f32 v91, v65, v88
    v_fmac_f32 v92, v90, v90
    v_fmac_f32 v93, v91, v91
    v_sub_f32 v90, v66, v88
    v_sub_f32 v91, v67, v88
    v_fmac_f32 v92, v90, v90
    v_fmac_f32 v93, v91, v91
    v_sub_f32 v90, v68, v88
    v_sub_f32 v91, v69, v88
    v_fmac_f32 v92, v90, v90
    v_fmac_f32 v93, v91, v91
    v_sub_f32 v90, v70, v88
    v_sub_f32 v91, v71, v88
    v_fmac_f32 v92, v90, v90
    v_fmac_f32 v93, v91, v91
    v_sub_f32 v90, v72, v88
    v_sub_f32 v91, v73, v88
    v_fmac_f32 v92, v90, v90
    v_fmac_f32 v93, v91, v91
    v_sub_f32 v90, v74, v88
    v_sub_f32 v91, v75, v88
    v_fmac_f32 v92, v90, v90
    v_fmac_f32 v93, v91, v91
    v_sub_f32 v90, v76, v88
    v_sub_f32 v91, v77, v88
    v_fmac_f32 v92, v90, v90
    v_fmac_f32 v93, v91, v91
    v_sub_f32 v90, v78, v88
    v_sub_f32 v91, v79, v88
    v_fmac_f32 v92, v90, v90
    v_fmac_f32 v93, v91, v91
    v_sub_f32 v90, v80, v88
    v_sub_f32 v91, v81, v88
    v_fmac_f32 v92, v90, v90
    v_fmac_f32 v93, v91, v91
    v_sub_f32 v90, v82, v88
    v_sub_f32 v91, v83, v88
    v_fmac_f32 v92, v90, v90
    v_fmac_f32 v93, v91, v91
    v_sub_f32 v90, v84, v88
    v_sub_f32 v91, v85, v88
    v_fmac_f32 v92, v90, v90
    v_fmac_f32 v93, v91, v91
    v_sub_f32 v90, v86, v88
    v_sub_f32 v91, v87, v88
    v_fmac_f32 v92, v90, v90
    v_fmac_f32 v93, v91, v91
    v_add_f32 v92, v92, v93
    s_nop 1
    v_add_f32_dpp v92, v92, v92 quad_perm:[1,0,3,2] row_mask:0xf bank_mask:0xf
    s_nop 1
    v_add_f32_dpp v92, v92, v92 quad_perm:[2,3,0,1] row_mask:0xf bank_mask:0xf
    s_nop 1
    v_add_f32_dpp v92, v92, v92 row_half_mirror row_mask:0xf bank_mask:0xf
    s_nop 1
    v_add_f32_dpp v92, v92, v92 row_mirror row_mask:0xf bank_mask:0xf
    v_mov_b32 v90, v92
    s_nop 1
    v_permlane16_swap_b32 v90, v92
    s_nop 1
    v_add_f32 v92, v92, v90
    v_mul_f32 v92, 0x3a800000, v92
    v_cvt_pk_bf16_f32 v92, v92, v92
    v_lshlrev_b32 v92, 16, v92
    v_add_f32 v92, 0x3727c5ac, v92
    v_cvt_pk_bf16_f32 v92, v92, v92
    v_lshlrev_b32 v92, 16, v92
    v_sqrt_f32 v92, v92
    v_sub_f32 v88, 0, v88
    v_cvt_pk_bf16_f32 v40, v88, v88
    v_cvt_pk_bf16_f32 v92, v92, v92
    v_lshlrev_b32 v92, 16, v92
    v_rcp_f32 v46, v92
    v_mov_b32 v41, v40
    v_mov_b32 v42, v40
    v_mov_b32 v43, v40
    v_mul_f32 v45, v92, v92
    v_mul_f32 v44, s57, v46
    s_lshl_b32 s52, s50, 8
    v_add_u32 v32, s52, v32
    v_lshlrev_b32 v90, 5, v32
    v_lshlrev_b32 v91, 2, v32
    s_mov_b32 s52, 0x1c0000
    s_mov_b32 s53, 0x1d0000
    s_mov_b32 exec_lo, 1
    s_mov_b32 exec_hi, 1
    buffer_store_dwordx4 v[40:43], v90, s[44:47], s52 offen sc1
    buffer_store_dwordx2 v[44:45], v90, s[44:47], s52 offen offset:16 sc1
    buffer_store_dword v46, v91, s[44:47], s53 offen sc1
    s_mov_b64 exec, -1
    s_add_u32 m0, s59, 0x15000
    s_nop 0
    buffer_load_dwordx4 v13, s[12:15], s42 offen nt lds
    s_add_u32 m0, s59, 0x16000
    s_nop 0
    buffer_load_dwordx4 v13, s[16:19], s42 offen nt lds
    s_add_u32 m0, s59, 0x17000
    s_nop 0
    buffer_load_dwordx4 v13, s[20:23], s42 offen nt lds
    s_add_u32 m0, s59, 0x18000
    s_nop 0
    buffer_load_dwordx4 v14, s[24:27], s43 offen nt lds
    s_add_u32 s62, s62, 1
    s_and_b32 s62, s62, 31
    s_add_u32 m0, s59, 0x19000
    s_nop 0
    buffer_load_dwordx4 v14, s[28:31], s43 offen nt lds
    s_mul_i32 s43, s62, 229376
    s_mul_i32 s42, s62, 196608
    s_waitcnt vmcnt(8)
    s_barrier
    ds_read_b64_tr_b16 a[160:161], v6 offset:0
    ds_read_b64_tr_b16 a[162:163], v6 offset:512
    ds_read_b128 a[96:99], v4 offset:0
    ds_read_b128 a[100:103], v4 offset:2048
    ds_read_b128 a[104:107], v4 offset:4096
    ds_read_b128 a[108:111], v4 offset:6144
    ds_read_b128 a[112:115], v4 offset:8192
    ds_read_b128 a[116:119], v4 offset:10240
    ds_read_b128 a[120:123], v4 offset:12288
    ds_read_b128 a[124:127], v4 offset:14336
    ds_read_b64_tr_b16 a[164:165], v8 offset:0
    ds_read_b64_tr_b16 a[166:167], v8 offset:512
    ds_read_b64_tr_b16 a[168:169], v6 offset:4096
    ds_read_b64_tr_b16 a[170:171], v6 offset:4608
    ds_read_b64_tr_b16 a[172:173], v8 offset:4096
    ds_read_b64_tr_b16 a[174:175], v8 offset:4608
    ds_read_b64_tr_b16 a[176:177], v6 offset:8192
    ds_read_b64_tr_b16 a[178:179], v6 offset:8704
    s_mov_b32 s52, 1664525
    v_mul_lo_u32 v3, v3, s52
    v_add_u32 v3, 0x3c6ef35f, v3
    s_mov_b32 s48, 5
    s_waitcnt lgkmcnt(0)
    v_mfma_f32_16x16x32_bf16 v[32:35], a[96:99], a[160:163], 0
    ds_read_b64_tr_b16 a[180:181], v8 offset:8192
    v_mfma_f32_16x16x32_bf16 v[36:39], a[100:103], a[160:163], 0
    s_add_u32 m0, s58, 0x8000
    v_mfma_f32_16x16x32_bf16 v[40:43], a[104:107], a[160:163], 0
    v_mfma_f32_16x16x32_bf16 v[44:47], a[108:111], a[160:163], 0
    ds_read_b64_tr_b16 a[182:183], v8 offset:8704
    v_mfma_f32_16x16x32_bf16 v[48:51], a[112:115], a[160:163], 0
    buffer_load_dwordx4 v21, s[8:11], s40 offen offset:0 lds
    v_mfma_f32_16x16x32_bf16 v[52:55], a[116:119], a[160:163], 0
    v_mfma_f32_16x16x32_bf16 v[56:59], a[120:123], a[160:163], 0
    buffer_load_dwordx4 v22, s[8:11], s40 offen offset:1024 lds
    v_mfma_f32_16x16x32_bf16 v[60:63], a[124:127], a[160:163], 0
    ds_read_b64_tr_b16 a[184:185], v6 offset:12288
    v_mfma_f32_16x16x32_bf16 v[92:95], a[124:127], a[164:167], 0
    v_mfma_f32_16x16x32_bf16 v[88:91], a[120:123], a[164:167], 0
    buffer_load_dwordx4 v23, s[8:11], s40 offen offset:2048 lds
    v_mfma_f32_16x16x32_bf16 v[84:87], a[116:119], a[164:167], 0
    ds_read_b64_tr_b16 a[186:187], v6 offset:12800
    v_mfma_f32_16x16x32_bf16 v[80:83], a[112:115], a[164:167], 0
    v_mfma_f32_16x16x32_bf16 v[76:79], a[108:111], a[164:167], 0
    buffer_load_dwordx4 v24, s[8:11], s40 offen offset:3072 lds
    v_mfma_f32_16x16x32_bf16 v[72:75], a[104:107], a[164:167], 0
    ds_read_b64_tr_b16 a[188:189], v6 offset:16384
    v_mfma_f32_16x16x32_bf16 v[68:71], a[100:103], a[164:167], 0
    v_mfma_f32_16x16x32_bf16 v[64:67], a[96:99], a[164:167], 0
    s_add_u32 m0, s58, 0x9000
    v_mfma_f32_16x16x32_bf16 v[96:99], a[96:99], a[168:171], 0
    v_mfma_f32_16x16x32_bf16 v[100:103], a[100:103], a[168:171], 0
    ds_read_b64_tr_b16 a[190:191], v6 offset:16896
    v_mfma_f32_16x16x32_bf16 v[104:107], a[104:107], a[168:171], 0
    buffer_load_dwordx4 v21, s[8:11], s41 offen offset:0 lds
    v_mfma_f32_16x16x32_bf16 v[108:111], a[108:111], a[168:171], 0
    v_mfma_f32_16x16x32_bf16 v[112:115], a[112:115], a[168:171], 0
    ds_read_b64_tr_b16 a[192:193], v8 offset:12288
    v_mfma_f32_16x16x32_bf16 v[116:119], a[116:119], a[168:171], 0
    buffer_load_dwordx4 v22, s[8:11], s41 offen offset:1024 lds
    v_mfma_f32_16x16x32_bf16 v[120:123], a[120:123], a[168:171], 0
    v_mfma_f32_16x16x32_bf16 v[124:127], a[124:127], a[168:171], 0
    ds_read_b64_tr_b16 a[194:195], v8 offset:12800
    v_mfma_f32_16x16x32_bf16 v[156:159], a[124:127], a[172:175], 0
    s_add_u32 s63, s63, 128
    v_mfma_f32_16x16x32_bf16 v[152:155], a[120:123], a[172:175], 0
    v_mfma_f32_16x16x32_bf16 v[148:151], a[116:119], a[172:175], 0
    s_and_b32 s63, s63, 2047
    v_mfma_f32_16x16x32_bf16 v[144:147], a[112:115], a[172:175], 0
    ds_read_b64_tr_b16 a[196:197], v8 offset:16384
    v_mfma_f32_16x16x32_bf16 v[140:143], a[108:111], a[172:175], 0
    v_mfma_f32_16x16x32_bf16 v[136:139], a[104:107], a[172:175], 0
    buffer_load_dwordx4 v23, s[8:11], s41 offen offset:2048 lds
    v_mfma_f32_16x16x32_bf16 v[132:135], a[100:103], a[172:175], 0
    ds_read_b64_tr_b16 a[198:199], v8 offset:16896
    v_mfma_f32_16x16x32_bf16 v[128:131], a[96:99], a[172:175], 0
    v_mfma_f32_16x16x32_bf16 v[160:163], a[176:179], a[96:99], 0
    s_add_u32 s40, s64, s63
    v_mfma_f32_16x16x32_bf16 v[164:167], a[176:179], a[100:103], 0
    v_mfma_f32_16x16x32_bf16 v[168:171], a[176:179], a[104:107], 0
    buffer_load_dwordx4 v24, s[8:11], s41 offen offset:3072 lds
    v_mfma_f32_16x16x32_bf16 v[172:175], a[176:179], a[108:111], 0
    v_mfma_f32_16x16x32_bf16 v[176:179], a[176:179], a[112:115], 0
    s_cmp_eq_u32 s48, s66
    s_cbranch_scc1 L_cs0Ap0
    L_cs0Ap0b:
    v_mfma_f32_16x16x32_bf16 v[180:183], a[176:179], a[116:119], 0
    s_add_u32 s41, s40, 0x10000
    v_mfma_f32_16x16x32_bf16 v[184:187], a[176:179], a[120:123], 0
    v_mfma_f32_16x16x32_bf16 v[188:191], a[176:179], a[124:127], 0
    s_waitcnt vmcnt(8) lgkmcnt(0)
    s_barrier
    v_mfma_f32_16x16x32_bf16 v[192:195], a[180:183], a[96:99], 0
    ds_read_b64_tr_b16 a[160:161], v6 offset:20480
    s_add_u32 m0, s59, 0x1a000
    v_mfma_f32_16x16x32_bf16 v[196:199], a[180:183], a[100:103], 0
    buffer_load_dwordx4 v13, s[12:15], s42 offen nt lds
    v_mfma_f32_16x16x32_bf16 v[200:203], a[180:183], a[104:107], 0
    ds_read_b64_tr_b16 a[162:163], v6 offset:20992
    s_add_u32 m0, s59, 0x1b000
    v_mfma_f32_16x16x32_bf16 v[204:207], a[180:183], a[108:111], 0
    v_mfma_f32_16x16x32_bf16 v[208:211], a[180:183], a[112:115], 0
    ds_read_b128 a[128:131], v5 offset:0
    buffer_load_dwordx4 v13, s[16:19], s42 offen nt lds
    v_mfma_f32_16x16x32_bf16 v[212:215], a[180:183], a[116:119], 0
    ds_read_b128 a[132:135], v5 offset:2048
    s_add_u32 m0, s59, 0x1c000
    v_mfma_f32_16x16x32_bf16 v[216:219], a[180:183], a[120:123], 0
    v_mfma_f32_16x16x32_bf16 v[220:223], a[180:183], a[124:127], 0
    ds_read_b128 a[136:139], v5 offset:4096
    buffer_load_dwordx4 v13, s[20:23], s42 offen nt lds
    v_mfma_f32_16x16x32_bf16 v[252:255], a[184:187], a[124:127], 0
    s_add_u32 m0, s59, 0x1d000
    v_mfma_f32_16x16x32_bf16 v[248:251], a[184:187], a[120:123], 0
    ds_read_b128 a[140:143], v5 offset:6144
    v_mfma_f32_16x16x32_bf16 v[244:247], a[184:187], a[116:119], 0
    buffer_load_dwordx4 v14, s[24:27], s43 offen nt lds
    v_mfma_f32_16x16x32_bf16 v[240:243], a[184:187], a[112:115], 0
    ds_read_b128 a[144:147], v5 offset:8192
    s_add_u32 s62, s62, 1
    v_mfma_f32_16x16x32_bf16 v[236:239], a[184:187], a[108:111], 0
    ds_read_b128 a[148:151], v5 offset:10240
    s_and_b32 s62, s62, 31
    v_mfma_f32_16x16x32_bf16 v[232:235], a[184:187], a[104:107], 0
    v_mfma_f32_16x16x32_bf16 v[228:231], a[184:187], a[100:103], 0
    ds_read_b128 a[152:155], v5 offset:12288
    s_add_u32 m0, s59, 0x1e000
    v_mfma_f32_16x16x32_bf16 v[224:227], a[184:187], a[96:99], 0
    buffer_load_dwordx4 v14, s[28:31], s43 offen nt lds
    v_mfma_f32_16x16x32_bf16 a[0:3], a[188:191], a[96:99], 0
    ds_read_b128 a[156:159], v5 offset:14336
    v_mfma_f32_16x16x32_bf16 a[4:7], a[188:191], a[100:103], 0
    s_mul_i32 s43, s62, 229376
    v_mfma_f32_16x16x32_bf16 a[8:11], a[188:191], a[104:107], 0
    ds_read_b64_tr_b16 a[164:165], v8 offset:20480
    s_mul_i32 s42, s62, 196608
    v_mfma_f32_16x16x32_bf16 a[12:15], a[188:191], a[108:111], 0
    ds_read_b64_tr_b16 a[166:167], v8 offset:20992
    v_mfma_f32_16x16x32_bf16 a[16:19], a[188:191], a[112:115], 0
    s_add_u32 m0, s59, 0x1f000
    v_mfma_f32_16x16x32_bf16 a[20:23], a[188:191], a[116:119], 0
    ds_read_b64_tr_b16 a[168:169], v6 offset:24576
    buffer_load_dwordx4 v13, s[12:15], s42 offen nt lds
    v_mfma_f32_16x16x32_bf16 a[24:27], a[188:191], a[120:123], 0
    s_add_u32 m0, s59, 0x20000
    v_mfma_f32_16x16x32_bf16 a[28:31], a[188:191], a[124:127], 0
    ds_read_b64_tr_b16 a[170:171], v6 offset:25088
    v_mfma_f32_16x16x32_bf16 a[60:63], a[192:195], a[124:127], 0
    buffer_load_dwordx4 v13, s[16:19], s42 offen nt lds
    v_mfma_f32_16x16x32_bf16 a[56:59], a[192:195], a[120:123], 0
    ds_read_b64_tr_b16 a[172:173], v8 offset:24576
    s_add_u32 m0, s59, 0x21000
    v_mfma_f32_16x16x32_bf16 a[52:55], a[192:195], a[116:119], 0
    ds_read_b64_tr_b16 a[174:175], v8 offset:25088
    v_mfma_f32_16x16x32_bf16 a[48:51], a[192:195], a[112:115], 0
    buffer_load_dwordx4 v13, s[20:23], s42 offen nt lds
    v_mfma_f32_16x16x32_bf16 a[44:47], a[192:195], a[108:111], 0
    ds_read_b64_tr_b16 a[176:177], v6 offset:28672
    s_add_u32 m0, s59, 0x22000
    v_mfma_f32_16x16x32_bf16 a[40:43], a[192:195], a[104:107], 0
    v_mfma_f32_16x16x32_bf16 a[36:39], a[192:195], a[100:103], 0
    ds_read_b64_tr_b16 a[178:179], v6 offset:29184
    buffer_load_dwordx4 v14, s[24:27], s43 offen nt lds
    v_mfma_f32_16x16x32_bf16 a[32:35], a[192:195], a[96:99], 0
    s_add_u32 s62, s62, 1
    v_mfma_f32_16x16x32_bf16 a[64:67], a[196:199], a[96:99], 0
    s_and_b32 s62, s62, 31
    v_mfma_f32_16x16x32_bf16 a[68:71], a[196:199], a[100:103], 0
    v_mfma_f32_16x16x32_bf16 a[72:75], a[196:199], a[104:107], 0
    s_add_u32 m0, s59, 0x23000
    v_mfma_f32_16x16x32_bf16 a[76:79], a[196:199], a[108:111], 0
    buffer_load_dwordx4 v14, s[28:31], s43 offen nt lds
    v_mfma_f32_16x16x32_bf16 a[80:83], a[196:199], a[112:115], 0
    s_cmp_eq_u32 s48, s67
    s_cbranch_scc1 L_cs1Ap0
    L_cs1Ap0b:
    v_mfma_f32_16x16x32_bf16 a[84:87], a[196:199], a[116:119], 0
    s_mul_i32 s43, s62, 229376
    v_mfma_f32_16x16x32_bf16 a[88:91], a[196:199], a[120:123], 0
    s_mul_i32 s42, s62, 196608
    v_mfma_f32_16x16x32_bf16 a[92:95], a[196:199], a[124:127], 0
    s_waitcnt lgkmcnt(0)
    v_mfma_f32_16x16x32_bf16 v[32:35], a[128:131], a[160:163], v[32:35]
    ds_read_b64_tr_b16 a[180:181], v8 offset:28672
    v_mfma_f32_16x16x32_bf16 v[36:39], a[132:135], a[160:163], v[36:39]
    s_add_u32 m0, s59, 0x10000
    v_mfma_f32_16x16x32_bf16 v[40:43], a[136:139], a[160:163], v[40:43]
    buffer_load_dwordx4 v13, s[12:15], s42 offen nt lds
    v_mfma_f32_16x16x32_bf16 v[44:47], a[140:143], a[160:163], v[44:47]
    ds_read_b64_tr_b16 a[182:183], v8 offset:29184
    v_mfma_f32_16x16x32_bf16 v[48:51], a[144:147], a[160:163], v[48:51]
    v_mfma_f32_16x16x32_bf16 v[52:55], a[148:151], a[160:163], v[52:55]
    s_add_u32 m0, s59, 0x11000
    v_mfma_f32_16x16x32_bf16 v[56:59], a[152:155], a[160:163], v[56:59]
    buffer_load_dwordx4 v13, s[16:19], s42 offen nt lds
    v_mfma_f32_16x16x32_bf16 v[60:63], a[156:159], a[160:163], v[60:63]
    ds_read_b64_tr_b16 a[184:185], v6 offset:32768
    v_mfma_f32_16x16x32_bf16 v[92:95], a[156:159], a[164:167], v[92:95]
    v_mfma_f32_16x16x32_bf16 v[88:91], a[152:155], a[164:167], v[88:91]
    s_add_u32 m0, s59, 0x12000
    v_mfma_f32_16x16x32_bf16 v[84:87], a[148:151], a[164:167], v[84:87]
    ds_read_b64_tr_b16 a[186:187], v6 offset:33280
    v_mfma_f32_16x16x32_bf16 v[80:83], a[144:147], a[164:167], v[80:83]
    buffer_load_dwordx4 v13, s[20:23], s42 offen nt lds
    v_mfma_f32_16x16x32_bf16 v[76:79], a[140:143], a[164:167], v[76:79]
    v_mfma_f32_16x16x32_bf16 v[72:75], a[136:139], a[164:167], v[72:75]
    ds_read_b64_tr_b16 a[188:189], v6 offset:36864
    v_mfma_f32_16x16x32_bf16 v[68:71], a[132:135], a[164:167], v[68:71]
    s_add_u32 m0, s59, 0x13000
    v_mfma_f32_16x16x32_bf16 v[64:67], a[128:131], a[164:167], v[64:67]
    buffer_load_dwordx4 v14, s[24:27], s43 offen nt lds
    v_mfma_f32_16x16x32_bf16 v[96:99], a[128:131], a[168:171], v[96:99]
    v_mfma_f32_16x16x32_bf16 v[100:103], a[132:135], a[168:171], v[100:103]
    ds_read_b64_tr_b16 a[190:191], v6 offset:37376
    v_mfma_f32_16x16x32_bf16 v[104:107], a[136:139], a[168:171], v[104:107]
    s_add_u32 s62, s62, 1
    v_mfma_f32_16x16x32_bf16 v[108:111], a[140:143], a[168:171], v[108:111]
    s_and_b32 s62, s62, 31
    v_mfma_f32_16x16x32_bf16 v[112:115], a[144:147], a[168:171], v[112:115]
    ds_read_b64_tr_b16 a[192:193], v8 offset:32768
    v_mfma_f32_16x16x32_bf16 v[116:119], a[148:151], a[168:171], v[116:119]
    v_mfma_f32_16x16x32_bf16 v[120:123], a[152:155], a[168:171], v[120:123]
    s_add_u32 m0, s59, 0x14000
    v_mfma_f32_16x16x32_bf16 v[124:127], a[156:159], a[168:171], v[124:127]
    ds_read_b64_tr_b16 a[194:195], v8 offset:33280
    v_mfma_f32_16x16x32_bf16 v[156:159], a[156:159], a[172:175], v[156:159]
    buffer_load_dwordx4 v14, s[28:31], s43 offen nt lds
    v_mfma_f32_16x16x32_bf16 v[152:155], a[152:155], a[172:175], v[152:155]
    v_mfma_f32_16x16x32_bf16 v[148:151], a[148:151], a[172:175], v[148:151]
    s_mul_i32 s43, s62, 229376
    v_mfma_f32_16x16x32_bf16 v[144:147], a[144:147], a[172:175], v[144:147]
    ds_read_b64_tr_b16 a[196:197], v8 offset:36864
    v_mfma_f32_16x16x32_bf16 v[140:143], a[140:143], a[172:175], v[140:143]
    s_mul_i32 s42, s62, 196608
    v_mfma_f32_16x16x32_bf16 v[136:139], a[136:139], a[172:175], v[136:139]
    v_mfma_f32_16x16x32_bf16 v[132:135], a[132:135], a[172:175], v[132:135]
    ds_read_b64_tr_b16 a[198:199], v8 offset:37376
    v_mfma_f32_16x16x32_bf16 v[128:131], a[128:131], a[172:175], v[128:131]
    s_lshl_b32 s52, s2, 2
    v_mfma_f32_16x16x32_bf16 v[160:163], a[176:179], a[128:131], v[160:163]
    s_add_u32 s52, s52, s49
    v_mfma_f32_16x16x32_bf16 v[164:167], a[176:179], a[132:135], v[164:167]
    v_mfma_f32_16x16x32_bf16 v[168:171], a[176:179], a[136:139], v[168:171]
    s_lshl_b32 s52, s52, 10
    v_mfma_f32_16x16x32_bf16 v[172:175], a[176:179], a[140:143], v[172:175]
    s_add_u32 s52, s52, 0x100000
    v_mfma_f32_16x16x32_bf16 v[176:179], a[176:179], a[144:147], v[176:179]
    s_cmp_eq_u32 s48, s66
    s_cbranch_scc1 L_cs0Ap1
    L_cs0Ap1b:
    v_mfma_f32_16x16x32_bf16 v[180:183], a[176:179], a[148:151], v[180:183]
    v_mfma_f32_16x16x32_bf16 v[184:187], a[176:179], a[152:155], v[184:187]
    buffer_load_dword v19, v18, s[44:47], s52 offen
    v_mfma_f32_16x16x32_bf16 v[188:191], a[176:179], a[156:159], v[188:191]
    s_waitcnt vmcnt(11) lgkmcnt(0)
    s_barrier
    v_mfma_f32_16x16x32_bf16 v[192:195], a[180:183], a[128:131], v[192:195]
    ds_read_b64_tr_b16 a[160:161], v7 offset:0
    v_mfma_f32_16x16x32_bf16 v[196:199], a[180:183], a[132:135], v[196:199]
    s_add_u32 m0, s58, 0x0
    v_mfma_f32_16x16x32_bf16 v[200:203], a[180:183], a[136:139], v[200:203]
    ds_read_b64_tr_b16 a[162:163], v7 offset:512
    v_mfma_f32_16x16x32_bf16 v[204:207], a[180:183], a[140:143], v[204:207]
    v_mfma_f32_16x16x32_bf16 v[208:211], a[180:183], a[144:147], v[208:211]
    ds_read_b128 a[96:99], v4 offset:32768
    v_mfma_f32_16x16x32_bf16 v[212:215], a[180:183], a[148:151], v[212:215]
    ds_read_b128 a[100:103], v4 offset:34816
    v_mfma_f32_16x16x32_bf16 v[216:219], a[180:183], a[152:155], v[216:219]
    v_mfma_f32_16x16x32_bf16 v[220:223], a[180:183], a[156:159], v[220:223]
    ds_read_b128 a[104:107], v4 offset:36864
    v_mfma_f32_16x16x32_bf16 v[252:255], a[184:187], a[156:159], v[252:255]
    v_mfma_f32_16x16x32_bf16 v[248:251], a[184:187], a[152:155], v[248:251]
    ds_read_b128 a[108:111], v4 offset:38912
    v_mfma_f32_16x16x32_bf16 v[244:247], a[184:187], a[148:151], v[244:247]
    buffer_load_dwordx4 v21, s[8:11], s40 offen offset:0 lds
    v_mfma_f32_16x16x32_bf16 v[240:243], a[184:187], a[144:147], v[240:243]
    ds_read_b128 a[112:115], v4 offset:40960
    v_mfma_f32_16x16x32_bf16 v[236:239], a[184:187], a[140:143], v[236:239]
    ds_read_b128 a[116:119], v4 offset:43008
    v_mfma_f32_16x16x32_bf16 v[232:235], a[184:187], a[136:139], v[232:235]
    v_mfma_f32_16x16x32_bf16 v[228:231], a[184:187], a[132:135], v[228:231]
    ds_read_b128 a[120:123], v4 offset:45056
    v_mfma_f32_16x16x32_bf16 v[224:227], a[184:187], a[128:131], v[224:227]
    v_mfma_f32_16x16x32_bf16 a[0:3], a[188:191], a[128:131], a[0:3]
    ds_read_b128 a[124:127], v4 offset:47104
    v_mfma_f32_16x16x32_bf16 a[4:7], a[188:191], a[132:135], a[4:7]
    v_mfma_f32_16x16x32_bf16 a[8:11], a[188:191], a[136:139], a[8:11]
    ds_read_b64_tr_b16 a[164:165], v9 offset:0
    v_mfma_f32_16x16x32_bf16 a[12:15], a[188:191], a[140:143], a[12:15]
    ds_read_b64_tr_b16 a[166:167], v9 offset:512
    v_mfma_f32_16x16x32_bf16 a[16:19], a[188:191], a[144:147], a[16:19]
    buffer_load_dwordx4 v22, s[8:11], s40 offen offset:1024 lds
    v_mfma_f32_16x16x32_bf16 a[20:23], a[188:191], a[148:151], a[20:23]
    ds_read_b64_tr_b16 a[168:169], v7 offset:4096
    v_mfma_f32_16x16x32_bf16 a[24:27], a[188:191], a[152:155], a[24:27]
    v_mfma_f32_16x16x32_bf16 a[28:31], a[188:191], a[156:159], a[28:31]
    ds_read_b64_tr_b16 a[170:171], v7 offset:4608
    v_mfma_f32_16x16x32_bf16 a[60:63], a[192:195], a[156:159], a[60:63]
    v_mfma_f32_16x16x32_bf16 a[56:59], a[192:195], a[152:155], a[56:59]
    ds_read_b64_tr_b16 a[172:173], v9 offset:4096
    v_mfma_f32_16x16x32_bf16 a[52:55], a[192:195], a[148:151], a[52:55]
    ds_read_b64_tr_b16 a[174:175], v9 offset:4608
    v_mfma_f32_16x16x32_bf16 a[48:51], a[192:195], a[144:147], a[48:51]
    v_mfma_f32_16x16x32_bf16 a[44:47], a[192:195], a[140:143], a[44:47]
    ds_read_b64_tr_b16 a[176:177], v7 offset:8192
    v_mfma_f32_16x16x32_bf16 a[40:43], a[192:195], a[136:139], a[40:43]
    buffer_load_dwordx4 v23, s[8:11], s40 offen offset:2048 lds
    v_mfma_f32_16x16x32_bf16 a[36:39], a[192:195], a[132:135], a[36:39]
    ds_read_b64_tr_b16 a[178:179], v7 offset:8704
    v_mfma_f32_16x16x32_bf16 a[32:35], a[192:195], a[128:131], a[32:35]
    v_mfma_f32_16x16x32_bf16 a[64:67], a[196:199], a[128:131], a[64:67]
    v_mfma_f32_16x16x32_bf16 a[68:71], a[196:199], a[132:135], a[68:71]
    v_mfma_f32_16x16x32_bf16 a[72:75], a[196:199], a[136:139], a[72:75]
    buffer_load_dwordx4 v24, s[8:11], s40 offen offset:3072 lds
    v_mfma_f32_16x16x32_bf16 a[76:79], a[196:199], a[140:143], a[76:79]
    v_mfma_f32_16x16x32_bf16 a[80:83], a[196:199], a[144:147], a[80:83]
    s_cmp_eq_u32 s48, s67
    s_cbranch_scc1 L_cs1Ap1
    L_cs1Ap1b:
    v_mfma_f32_16x16x32_bf16 a[84:87], a[196:199], a[148:151], a[84:87]
    v_mfma_f32_16x16x32_bf16 a[88:91], a[196:199], a[152:155], a[88:91]
    v_mfma_f32_16x16x32_bf16 a[92:95], a[196:199], a[156:159], a[92:95]
    s_waitcnt lgkmcnt(0)
    s_branch L_loopA_2
L_cs0Ap0:
    v_mfma_f32_16x16x32_bf16 a[200:203], a[220:223], a[160:163], a[200:203]
    v_mfma_f32_16x16x32_bf16 a[204:207], a[220:223], a[164:167], a[204:207]
    v_mfma_f32_16x16x32_bf16 a[208:211], a[220:223], a[168:171], a[208:211]
    v_mfma_f32_16x16x32_bf16 a[212:215], a[220:223], a[172:175], a[212:215]
    v_mfma_f32_16x16x32_bf16 a[216:219], a[220:223], a[176:179], a[216:219]
    s_branch L_cs0Ap0b
L_cs1Ap0:
    v_mfma_f32_16x16x32_bf16 a[200:203], a[220:223], a[180:183], a[200:203]
    v_mfma_f32_16x16x32_bf16 a[204:207], a[220:223], a[184:187], a[204:207]
    v_mfma_f32_16x16x32_bf16 a[208:211], a[220:223], a[188:191], a[208:211]
    v_mfma_f32_16x16x32_bf16 a[212:215], a[220:223], a[192:195], a[212:215]
    v_mfma_f32_16x16x32_bf16 a[216:219], a[220:223], a[196:199], a[216:219]
    s_branch L_cs1Ap0b
L_cs0Ap1:
    v_mfma_f32_16x16x32_bf16 a[200:203], a[220:223], a[160:163], a[200:203]
    v_mfma_f32_16x16x32_bf16 a[204:207], a[220:223], a[164:167], a[204:207]
    v_mfma_f32_16x16x32_bf16 a[208:211], a[220:223], a[168:171], a[208:211]
    v_mfma_f32_16x16x32_bf16 a[212:215], a[220:223], a[172:175], a[212:215]
    v_mfma_f32_16x16x32_bf16 a[216:219], a[220:223], a[176:179], a[216:219]
    s_branch L_cs0Ap1b
L_cs1Ap1:
    v_mfma_f32_16x16x32_bf16 a[200:203], a[220:223], a[180:183], a[200:203]
    v_mfma_f32_16x16x32_bf16 a[204:207], a[220:223], a[184:187], a[204:207]
    v_mfma_f32_16x16x32_bf16 a[208:211], a[220:223], a[188:191], a[208:211]
    v_mfma_f32_16x16x32_bf16 a[212:215], a[220:223], a[192:195], a[212:215]
    v_mfma_f32_16x16x32_bf16 a[216:219], a[220:223], a[196:199], a[216:219]
    s_branch L_cs1Ap1b
L_cs0A4:
    v_mfma_f32_16x16x32_bf16 a[200:203], a[220:223], a[160:163], a[200:203]
    v_mfma_f32_16x16x32_bf16 a[204:207], a[220:223], a[164:167], a[204:207]
    v_mfma_f32_16x16x32_bf16 a[208:211], a[220:223], a[168:171], a[208:211]
    v_mfma_f32_16x16x32_bf16 a[212:215], a[220:223], a[172:175], a[212:215]
    v_mfma_f32_16x16x32_bf16 a[216:219], a[220:223], a[176:179], a[216:219]
    s_branch L_cs0A4b
L_cs1A4:
    v_mfma_f32_16x16x32_bf16 a[200:203], a[220:223], a[180:183], a[200:203]
    v_mfma_f32_16x16x32_bf16 a[204:207], a[220:223], a[184:187], a[204:207]
    v_mfma_f32_16x16x32_bf16 a[208:211], a[220:223], a[188:191], a[208:211]
    v_mfma_f32_16x16x32_bf16 a[212:215], a[220:223], a[192:195], a[212:215]
    v_mfma_f32_16x16x32_bf16 a[216:219], a[220:223], a[196:199], a[216:219]
    s_branch L_cs1A4b
L_cs0A5:
    v_mfma_f32_16x16x32_bf16 a[200:203], a[220:223], a[160:163], a[200:203]
    v_mfma_f32_16x16x32_bf16 a[204:207], a[220:223], a[164:167], a[204:207]
    v_mfma_f32_16x16x32_bf16 a[208:211], a[220:223], a[168:171], a[208:211]
    v_mfma_f32_16x16x32_bf16 a[212:215], a[220:223], a[172:175], a[212:215]
    v_mfma_f32_16x16x32_bf16 a[216:219], a[220:223], a[176:179], a[216:219]
    s_branch L_cs0A5b
L_cs1A5:
    v_mfma_f32_16x16x32_bf16 a[200:203], a[220:223], a[180:183], a[200:203]
    v_mfma_f32_16x16x32_bf16 a[204:207], a[220:223], a[184:187], a[204:207]
    v_mfma_f32_16x16x32_bf16 a[208:211], a[220:223], a[188:191], a[208:211]
    v_mfma_f32_16x16x32_bf16 a[212:215], a[220:223], a[192:195], a[212:215]
    v_mfma_f32_16x16x32_bf16 a[216:219], a[220:223], a[196:199], a[216:219]
    s_branch L_cs1A5b
L_cs0A6:
    v_mfma_f32_16x16x32_bf16 a[200:203], a[220:223], a[160:163], a[200:203]
    v_mfma_f32_16x16x32_bf16 a[204:207], a[220:223], a[164:167], a[204:207]
    v_mfma_f32_16x16x32_bf16 a[208:211], a[220:223], a[168:171], a[208:211]
    v_mfma_f32_16x16x32_bf16 a[212:215], a[220:223], a[172:175], a[212:215]
    v_mfma_f32_16x16x32_bf16 a[216:219], a[220:223], a[176:179], a[216:219]
    s_branch L_cs0A6b
L_cs1A6:
    v_mfma_f32_16x16x32_bf16 a[200:203], a[220:223], a[180:183], a[200:203]
    v_mfma_f32_16x16x32_bf16 a[204:207], a[220:223], a[184:187], a[204:207]
    v_mfma_f32_16x16x32_bf16 a[208:211], a[220:223], a[188:191], a[208:211]
    v_mfma_f32_16x16x32_bf16 a[212:215], a[220:223], a[192:195], a[212:215]
    v_mfma_f32_16x16x32_bf16 a[216:219], a[220:223], a[196:199], a[216:219]
    s_branch L_cs1A6b
L_cs0A7:
    v_mfma_f32_16x16x32_bf16 a[200:203], a[220:223], a[160:163], a[200:203]
    v_mfma_f32_16x16x32_bf16 a[204:207], a[220:223], a[164:167], a[204:207]
    v_mfma_f32_16x16x32_bf16 a[208:211], a[220:223], a[168:171], a[208:211]
    v_mfma_f32_16x16x32_bf16 a[212:215], a[220:223], a[172:175], a[212:215]
    v_mfma_f32_16x16x32_bf16 a[216:219], a[220:223], a[176:179], a[216:219]
    s_branch L_cs0A7b
L_cs1A7:
    v_mfma_f32_16x16x32_bf16 a[200:203], a[220:223], a[180:183], a[200:203]
    v_mfma_f32_16x16x32_bf16 a[204:207], a[220:223], a[184:187], a[204:207]
    v_mfma_f32_16x16x32_bf16 a[208:211], a[220:223], a[188:191], a[208:211]
    v_mfma_f32_16x16x32_bf16 a[212:215], a[220:223], a[192:195], a[212:215]
    v_mfma_f32_16x16x32_bf16 a[216:219], a[220:223], a[196:199], a[216:219]
    s_branch L_cs1A7b
.p2align 6
L_loopA:
    v_mfma_f32_16x16x32_bf16 v[32:35], a[96:99], a[160:163], v[32:35]
    ds_read_b64_tr_b16 a[180:181], v8 offset:8192
    v_mfma_f32_16x16x32_bf16 v[36:39], a[100:103], a[160:163], v[36:39]
    s_add_u32 m0, s58, 0x9000
    v_mfma_f32_16x16x32_bf16 v[40:43], a[104:107], a[160:163], v[40:43]
    v_mfma_f32_16x16x32_bf16 v[44:47], a[108:111], a[160:163], v[44:47]
    ds_read_b64_tr_b16 a[182:183], v8 offset:8704
    v_mfma_f32_16x16x32_bf16 v[48:51], a[112:115], a[160:163], v[48:51]
    buffer_load_dwordx4 v21, s[8:11], s41 offen offset:0 lds
    v_mfma_f32_16x16x32_bf16 v[52:55], a[116:119], a[160:163], v[52:55]
    v_mfma_f32_16x16x32_bf16 v[56:59], a[120:123], a[160:163], v[56:59]
    v_mfma_f32_16x16x32_bf16 v[60:63], a[124:127], a[160:163], v[60:63]
    ds_read_b64_tr_b16 a[184:185], v6 offset:12288
    v_mfma_f32_16x16x32_bf16 v[92:95], a[124:127], a[164:167], v[92:95]
    buffer_load_dwordx4 v22, s[8:11], s41 offen offset:1024 lds
    v_mfma_f32_16x16x32_bf16 v[88:91], a[120:123], a[164:167], v[88:91]
    v_mfma_f32_16x16x32_bf16 v[84:87], a[116:119], a[164:167], v[84:87]
    ds_read_b64_tr_b16 a[186:187], v6 offset:12800
    v_mfma_f32_16x16x32_bf16 v[80:83], a[112:115], a[164:167], v[80:83]
    v_mfma_f32_16x16x32_bf16 v[76:79], a[108:111], a[164:167], v[76:79]
    s_add_u32 s63, s63, 128
    v_mfma_f32_16x16x32_bf16 v[72:75], a[104:107], a[164:167], v[72:75]
    ds_read_b64_tr_b16 a[188:189], v6 offset:16384
    v_mfma_f32_16x16x32_bf16 v[68:71], a[100:103], a[164:167], v[68:71]
    v_mfma_f32_16x16x32_bf16 v[64:67], a[96:99], a[164:167], v[64:67]
    v_mfma_f32_16x16x32_bf16 v[96:99], a[96:99], a[168:171], v[96:99]
    s_and_b32 s63, s63, 2047
    v_mfma_f32_16x16x32_bf16 v[100:103], a[100:103], a[168:171], v[100:103]
    ds_read_b64_tr_b16 a[190:191], v6 offset:16896
    v_mfma_f32_16x16x32_bf16 v[104:107], a[104:107], a[168:171], v[104:107]
    v_mfma_f32_16x16x32_bf16 v[108:111], a[108:111], a[168:171], v[108:111]
    v_mfma_f32_16x16x32_bf16 v[112:115], a[112:115], a[168:171], v[112:115]
    ds_read_b64_tr_b16 a[192:193], v8 offset:12288
    v_mfma_f32_16x16x32_bf16 v[116:119], a[116:119], a[168:171], v[116:119]
    buffer_load_dwordx4 v23, s[8:11], s41 offen offset:2048 lds
    v_mfma_f32_16x16x32_bf16 v[120:123], a[120:123], a[168:171], v[120:123]
    v_mfma_f32_16x16x32_bf16 v[124:127], a[124:127], a[168:171], v[124:127]
    ds_read_b64_tr_b16 a[194:195], v8 offset:12800
    v_mfma_f32_16x16x32_bf16 v[156:159], a[124:127], a[172:175], v[156:159]
    v_mfma_f32_16x16x32_bf16 v[152:155], a[120:123], a[172:175], v[152:155]
    s_add_u32 s40, s64, s63
    v_mfma_f32_16x16x32_bf16 v[148:151], a[116:119], a[172:175], v[148:151]
    v_mfma_f32_16x16x32_bf16 v[144:147], a[112:115], a[172:175], v[144:147]
    ds_read_b64_tr_b16 a[196:197], v8 offset:16384
    v_mfma_f32_16x16x32_bf16 v[140:143], a[108:111], a[172:175], v[140:143]
    v_mfma_f32_16x16x32_bf16 v[136:139], a[104:107], a[172:175], v[136:139]
    buffer_load_dwordx4 v24, s[8:11], s41 offen offset:3072 lds
    v_mfma_f32_16x16x32_bf16 v[132:135], a[100:103], a[172:175], v[132:135]
    ds_read_b64_tr_b16 a[198:199], v8 offset:16896
    v_mfma_f32_16x16x32_bf16 v[128:131], a[96:99], a[172:175], v[128:131]
    v_mfma_f32_16x16x32_bf16 v[160:163], a[176:179], a[96:99], v[160:163]
    v_mfma_f32_16x16x32_bf16 v[164:167], a[176:179], a[100:103], v[164:167]
    s_add_u32 s41, s40, 0x10000
    v_mfma_f32_16x16x32_bf16 v[168:171], a[176:179], a[104:107], v[168:171]
    v_mfma_f32_16x16x32_bf16 v[172:175], a[176:179], a[108:111], v[172:175]
    v_mfma_f32_16x16x32_bf16 v[176:179], a[176:179], a[112:115], v[176:179]
    s_cmp_eq_u32 s48, s66
    s_cbranch_scc1 L_cs0A4
    L_cs0A4b:
    v_mfma_f32_16x16x32_bf16 v[180:183], a[176:179], a[116:119], v[180:183]
    buffer_load_dword v19, v18, s[32:35], s65 offen
    v_mfma_f32_16x16x32_bf16 v[184:187], a[176:179], a[120:123], v[184:187]
    v_mfma_f32_16x16x32_bf16 v[188:191], a[176:179], a[124:127], v[188:191]
    s_waitcnt vmcnt(13) lgkmcnt(0)
    s_barrier
    v_mfma_f32_16x16x32_bf16 v[192:195], a[180:183], a[96:99], v[192:195]
    ds_read_b64_tr_b16 a[160:161], v6 offset:20480
    v_mfma_f32_16x16x32_bf16 v[196:199], a[180:183], a[100:103], v[196:199]
    s_add_u32 m0, s59, 0x1f000
    v_mfma_f32_16x16x32_bf16 v[200:203], a[180:183], a[104:107], v[200:203]
    ds_read_b64_tr_b16 a[162:163], v6 offset:20992
    v_mfma_f32_16x16x32_bf16 v[204:207], a[180:183], a[108:111], v[204:207]
    buffer_load_dwordx4 v13, s[12:15], s42 offen nt lds
    v_mfma_f32_16x16x32_bf16 v[208:211], a[180:183], a[112:115], v[208:211]
    ds_read_b128 a[128:131], v5 offset:0
    v_mfma_f32_16x16x32_bf16 v[212:215], a[180:183], a[116:119], v[212:215]
    ds_read_b128 a[132:135], v5 offset:2048
    v_mfma_f32_16x16x32_bf16 v[216:219], a[180:183], a[120:123], v[216:219]
    v_mfma_f32_16x16x32_bf16 v[220:223], a[180:183], a[124:127], v[220:223]
    ds_read_b128 a[136:139], v5 offset:4096
    v_mfma_f32_16x16x32_bf16 v[252:255], a[184:187], a[124:127], v[252:255]
    s_add_u32 m0, s59, 0x20000
    v_mfma_f32_16x16x32_bf16 v[248:251], a[184:187], a[120:123], v[248:251]
    ds_read_b128 a[140:143], v5 offset:6144
    v_mfma_f32_16x16x32_bf16 v[244:247], a[184:187], a[116:119], v[244:247]
    buffer_load_dwordx4 v13, s[16:19], s42 offen nt lds
    v_mfma_f32_16x16x32_bf16 v[240:243], a[184:187], a[112:115], v[240:243]
    ds_read_b128 a[144:147], v5 offset:8192
    v_mfma_f32_16x16x32_bf16 v[236:239], a[184:187], a[108:111], v[236:239]
    ds_read_b128 a[148:151], v5 offset:10240
    v_mfma_f32_16x16x32_bf16 v[232:235], a[184:187], a[104:107], v[232:235]
    v_mfma_f32_16x16x32_bf16 v[228:231], a[184:187], a[100:103], v[228:231]
    ds_read_b128 a[152:155], v5 offset:12288
    v_mfma_f32_16x16x32_bf16 v[224:227], a[184:187], a[96:99], v[224:227]
    s_add_u32 m0, s59, 0x21000
    v_mfma_f32_16x16x32_bf16 a[0:3], a[188:191], a[96:99], a[0:3]
    ds_read_b128 a[156:159], v5 offset:14336
    v_mfma_f32_16x16x32_bf16 a[4:7], a[188:191], a[100:103], a[4:7]
    buffer_load_dwordx4 v13, s[20:23], s42 offen nt lds
    v_mfma_f32_16x16x32_bf16 a[8:11], a[188:191], a[104:107], a[8:11]
    ds_read_b64_tr_b16 a[164:165], v8 offset:20480
    v_mfma_f32_16x16x32_bf16 a[12:15], a[188:191], a[108:111], a[12:15]
    ds_read_b64_tr_b16 a[166:167], v8 offset:20992
    v_mfma_f32_16x16x32_bf16 a[16:19], a[188:191], a[112:115], a[16:19]
    v_mfma_f32_16x16x32_bf16 a[20:23], a[188:191], a[116:119], a[20:23]
    ds_read_b64_tr_b16 a[168:169], v6 offset:24576
    v_mfma_f32_16x16x32_bf16 a[24:27], a[188:191], a[120:123], a[24:27]
    s_add_u32 m0, s59, 0x22000
    v_mfma_f32_16x16x32_bf16 a[28:31], a[188:191], a[124:127], a[28:31]
    ds_read_b64_tr_b16 a[170:171], v6 offset:25088
    v_mfma_f32_16x16x32_bf16 a[60:63], a[192:195], a[124:127], a[60:63]
    buffer_load_dwordx4 v14, s[24:27], s43 offen nt lds
    v_mfma_f32_16x16x32_bf16 a[56:59], a[192:195], a[120:123], a[56:59]
    ds_read_b64_tr_b16 a[172:173], v8 offset:24576
    v_mfma_f32_16x16x32_bf16 a[52:55], a[192:195], a[116:119], a[52:55]
    ds_read_b64_tr_b16 a[174:175], v8 offset:25088
    v_mfma_f32_16x16x32_bf16 a[48:51], a[192:195], a[112:115], a[48:51]
    v_mfma_f32_16x16x32_bf16 a[44:47], a[192:195], a[108:111], a[44:47]
    ds_read_b64_tr_b16 a[176:177], v6 offset:28672
    v_mfma_f32_16x16x32_bf16 a[40:43], a[192:195], a[104:107], a[40:43]
    s_add_u32 s62, s62, 1
    v_mfma_f32_16x16x32_bf16 a[36:39], a[192:195], a[100:103], a[36:39]
    ds_read_b64_tr_b16 a[178:179], v6 offset:29184
    v_mfma_f32_16x16x32_bf16 a[32:35], a[192:195], a[96:99], a[32:35]
    s_and_b32 s62, s62, 31
    v_mfma_f32_16x16x32_bf16 a[64:67], a[196:199], a[96:99], a[64:67]
    v_mfma_f32_16x16x32_bf16 a[68:71], a[196:199], a[100:103], a[68:71]
    s_add_u32 m0, s59, 0x23000
    v_mfma_f32_16x16x32_bf16 a[72:75], a[196:199], a[104:107], a[72:75]
    buffer_load_dwordx4 v14, s[28:31], s43 offen nt lds
    v_mfma_f32_16x16x32_bf16 a[76:79], a[196:199], a[108:111], a[76:79]
    v_mfma_f32_16x16x32_bf16 a[80:83], a[196:199], a[112:115], a[80:83]
    s_cmp_eq_u32 s48, s67
    s_cbranch_scc1 L_cs1A4
    L_cs1A4b:
    v_mfma_f32_16x16x32_bf16 a[84:87], a[196:199], a[116:119], a[84:87]
    s_mul_i32 s43, s62, 229376
    v_mfma_f32_16x16x32_bf16 a[88:91], a[196:199], a[120:123], a[88:91]
    s_mul_i32 s42, s62, 196608
    v_mfma_f32_16x16x32_bf16 a[92:95], a[196:199], a[124:127], a[92:95]
    s_waitcnt lgkmcnt(0)
    v_mfma_f32_16x16x32_bf16 v[32:35], a[128:131], a[160:163], v[32:35]
    ds_read_b64_tr_b16 a[180:181], v8 offset:28672
    v_mfma_f32_16x16x32_bf16 v[36:39], a[132:135], a[160:163], v[36:39]
    s_add_u32 m0, s59, 0x10000
    v_mfma_f32_16x16x32_bf16 v[40:43], a[136:139], a[160:163], v[40:43]
    v_mfma_f32_16x16x32_bf16 v[44:47], a[140:143], a[160:163], v[44:47]
    ds_read_b64_tr_b16 a[182:183], v8 offset:29184
    v_mfma_f32_16x16x32_bf16 v[48:51], a[144:147], a[160:163], v[48:51]
    buffer_load_dwordx4 v13, s[12:15], s42 offen nt lds
    v_mfma_f32_16x16x32_bf16 v[52:55], a[148:151], a[160:163], v[52:55]
    v_mfma_f32_16x16x32_bf16 v[56:59], a[152:155], a[160:163], v[56:59]
    s_add_u32 m0, s59, 0x11000
    v_mfma_f32_16x16x32_bf16 v[60:63], a[156:159], a[160:163], v[60:63]
    ds_read_b64_tr_b16 a[184:185], v6 offset:32768
    v_mfma_f32_16x16x32_bf16 v[92:95], a[156:159], a[164:167], v[92:95]
    v_mfma_f32_16x16x32_bf16 v[88:91], a[152:155], a[164:167], v[88:91]
    buffer_load_dwordx4 v13, s[16:19], s42 offen nt lds
    v_mfma_f32_16x16x32_bf16 v[84:87], a[148:151], a[164:167], v[84:87]
    ds_read_b64_tr_b16 a[186:187], v6 offset:33280
    v_mfma_f32_16x16x32_bf16 v[80:83], a[144:147], a[164:167], v[80:83]
    v_mfma_f32_16x16x32_bf16 v[76:79], a[140:143], a[164:167], v[76:79]
    s_add_u32 m0, s59, 0x12000
    v_mfma_f32_16x16x32_bf16 v[72:75], a[136:139], a[164:167], v[72:75]
    ds_read_b64_tr_b16 a[188:189], v6 offset:36864
    v_mfma_f32_16x16x32_bf16 v[68:71], a[132:135], a[164:167], v[68:71]
    v_mfma_f32_16x16x32_bf16 v[64:67], a[128:131], a[164:167], v[64:67]
    buffer_load_dwordx4 v13, s[20:23], s42 offen nt lds
    v_mfma_f32_16x16x32_bf16 v[96:99], a[128:131], a[168:171], v[96:99]
    v_mfma_f32_16x16x32_bf16 v[100:103], a[132:135], a[168:171], v[100:103]
    ds_read_b64_tr_b16 a[190:191], v6 offset:37376
    v_mfma_f32_16x16x32_bf16 v[104:107], a[136:139], a[168:171], v[104:107]
    s_add_u32 m0, s59, 0x13000
    v_mfma_f32_16x16x32_bf16 v[108:111], a[140:143], a[168:171], v[108:111]
    v_mfma_f32_16x16x32_bf16 v[112:115], a[144:147], a[168:171], v[112:115]
    ds_read_b64_tr_b16 a[192:193], v8 offset:32768
    v_mfma_f32_16x16x32_bf16 v[116:119], a[148:151], a[168:171], v[116:119]
    buffer_load_dwordx4 v14, s[24:27], s43 offen nt lds
    v_mfma_f32_16x16x32_bf16 v[120:123], a[152:155], a[168:171], v[120:123]
    v_mfma_f32_16x16x32_bf16 v[124:127], a[156:159], a[168:171], v[124:127]
    ds_read_b64_tr_b16 a[194:195], v8 offset:33280
    v_mfma_f32_16x16x32_bf16 v[156:159], a[156:159], a[172:175], v[156:159]
    s_add_u32 s62, s62, 1
    v_mfma_f32_16x16x32_bf16 v[152:155], a[152:155], a[172:175], v[152:155]
    v_mfma_f32_16x16x32_bf16 v[148:151], a[148:151], a[172:175], v[148:151]
    s_and_b32 s62, s62, 31
    v_mfma_f32_16x16x32_bf16 v[144:147], a[144:147], a[172:175], v[144:147]
    ds_read_b64_tr_b16 a[196:197], v8 offset:36864
    v_mfma_f32_16x16x32_bf16 v[140:143], a[140:143], a[172:175], v[140:143]
    v_mfma_f32_16x16x32_bf16 v[136:139], a[136:139], a[172:175], v[136:139]
    s_add_u32 m0, s59, 0x14000
    v_mfma_f32_16x16x32_bf16 v[132:135], a[132:135], a[172:175], v[132:135]
    ds_read_b64_tr_b16 a[198:199], v8 offset:37376
    v_mfma_f32_16x16x32_bf16 v[128:131], a[128:131], a[172:175], v[128:131]
    v_mfma_f32_16x16x32_bf16 v[160:163], a[176:179], a[128:131], v[160:163]
    buffer_load_dwordx4 v14, s[28:31], s43 offen nt lds
    v_mfma_f32_16x16x32_bf16 v[164:167], a[176:179], a[132:135], v[164:167]
    v_mfma_f32_16x16x32_bf16 v[168:171], a[176:179], a[136:139], v[168:171]
    s_mul_i32 s43, s62, 229376
    v_mfma_f32_16x16x32_bf16 v[172:175], a[176:179], a[140:143], v[172:175]
    v_mfma_f32_16x16x32_bf16 v[176:179], a[176:179], a[144:147], v[176:179]
    s_cmp_eq_u32 s48, s66
    s_cbranch_scc1 L_cs0A5
    L_cs0A5b:
    v_mfma_f32_16x16x32_bf16 v[180:183], a[176:179], a[148:151], v[180:183]
    s_mul_i32 s42, s62, 196608
    v_mfma_f32_16x16x32_bf16 v[184:187], a[176:179], a[152:155], v[184:187]
    v_mfma_f32_16x16x32_bf16 v[188:191], a[176:179], a[156:159], v[188:191]
    s_waitcnt vmcnt(10) lgkmcnt(0)
    s_barrier
    v_mfma_f32_16x16x32_bf16 v[192:195], a[180:183], a[128:131], v[192:195]
    ds_read_b64_tr_b16 a[160:161], v7 offset:0
    v_mfma_f32_16x16x32_bf16 v[196:199], a[180:183], a[132:135], v[196:199]
    s_add_u32 m0, s58, 0x0
    v_mfma_f32_16x16x32_bf16 v[200:203], a[180:183], a[136:139], v[200:203]
    ds_read_b64_tr_b16 a[162:163], v7 offset:512
    v_mfma_f32_16x16x32_bf16 v[204:207], a[180:183], a[140:143], v[204:207]
    v_mfma_f32_16x16x32_bf16 v[208:211], a[180:183], a[144:147], v[208:211]
    ds_read_b128 a[96:99], v4 offset:32768
    v_mfma_f32_16x16x32_bf16 v[212:215], a[180:183], a[148:151], v[212:215]
    ds_read_b128 a[100:103], v4 offset:34816
    v_mfma_f32_16x16x32_bf16 v[216:219], a[180:183], a[152:155], v[216:219]
    v_mfma_f32_16x16x32_bf16 v[220:223], a[180:183], a[156:159], v[220:223]
    ds_read_b128 a[104:107], v4 offset:36864
    v_mfma_f32_16x16x32_bf16 v[252:255], a[184:187], a[156:159], v[252:255]
    v_mfma_f32_16x16x32_bf16 v[248:251], a[184:187], a[152:155], v[248:251]
    ds_read_b128 a[108:111], v4 offset:38912
    v_mfma_f32_16x16x32_bf16 v[244:247], a[184:187], a[148:151], v[244:247]
    buffer_load_dwordx4 v21, s[8:11], s40 offen offset:0 lds
    v_mfma_f32_16x16x32_bf16 v[240:243], a[184:187], a[144:147], v[240:243]
    ds_read_b128 a[112:115], v4 offset:40960
    v_mfma_f32_16x16x32_bf16 v[236:239], a[184:187], a[140:143], v[236:239]
    ds_read_b128 a[116:119], v4 offset:43008
    v_mfma_f32_16x16x32_bf16 v[232:235], a[184:187], a[136:139], v[232:235]
    v_mfma_f32_16x16x32_bf16 v[228:231], a[184:187], a[132:135], v[228:231]
    ds_read_b128 a[120:123], v4 offset:45056
    v_mfma_f32_16x16x32_bf16 v[224:227], a[184:187], a[128:131], v[224:227]
    v_mfma_f32_16x16x32_bf16 a[0:3], a[188:191], a[128:131], a[0:3]
    ds_read_b128 a[124:127], v4 offset:47104
    v_mfma_f32_16x16x32_bf16 a[4:7], a[188:191], a[132:135], a[4:7]
    v_mfma_f32_16x16x32_bf16 a[8:11], a[188:191], a[136:139], a[8:11]
    ds_read_b64_tr_b16 a[164:165], v9 offset:0
    v_mfma_f32_16x16x32_bf16 a[12:15], a[188:191], a[140:143], a[12:15]
    ds_read_b64_tr_b16 a[166:167], v9 offset:512
    v_mfma_f32_16x16x32_bf16 a[16:19], a[188:191], a[144:147], a[16:19]
    buffer_load_dwordx4 v22, s[8:11], s40 offen offset:1024 lds
    v_mfma_f32_16x16x32_bf16 a[20:23], a[188:191], a[148:151], a[20:23]
    ds_read_b64_tr_b16 a[168:169], v7 offset:4096
    v_mfma_f32_16x16x32_bf16 a[24:27], a[188:191], a[152:155], a[24:27]
    v_mfma_f32_16x16x32_bf16 a[28:31], a[188:191], a[156:159], a[28:31]
    ds_read_b64_tr_b16 a[170:171], v7 offset:4608
    v_mfma_f32_16x16x32_bf16 a[60:63], a[192:195], a[156:159], a[60:63]
    v_mfma_f32_16x16x32_bf16 a[56:59], a[192:195], a[152:155], a[56:59]
    ds_read_b64_tr_b16 a[172:173], v9 offset:4096
    v_mfma_f32_16x16x32_bf16 a[52:55], a[192:195], a[148:151], a[52:55]
    ds_read_b64_tr_b16 a[174:175], v9 offset:4608
    v_mfma_f32_16x16x32_bf16 a[48:51], a[192:195], a[144:147], a[48:51]
    v_mfma_f32_16x16x32_bf16 a[44:47], a[192:195], a[140:143], a[44:47]
    ds_read_b64_tr_b16 a[176:177], v7 offset:8192
    v_mfma_f32_16x16x32_bf16 a[40:43], a[192:195], a[136:139], a[40:43]
    buffer_load_dwordx4 v23, s[8:11], s40 offen offset:2048 lds
    v_mfma_f32_16x16x32_bf16 a[36:39], a[192:195], a[132:135], a[36:39]
    ds_read_b64_tr_b16 a[178:179], v7 offset:8704
    v_mfma_f32_16x16x32_bf16 a[32:35], a[192:195], a[128:131], a[32:35]
    v_mfma_f32_16x16x32_bf16 a[64:67], a[196:199], a[128:131], a[64:67]
    v_mfma_f32_16x16x32_bf16 a[68:71], a[196:199], a[132:135], a[68:71]
    v_mfma_f32_16x16x32_bf16 a[72:75], a[196:199], a[136:139], a[72:75]
    buffer_load_dwordx4 v24, s[8:11], s40 offen offset:3072 lds
    v_mfma_f32_16x16x32_bf16 a[76:79], a[196:199], a[140:143], a[76:79]
    v_mfma_f32_16x16x32_bf16 a[80:83], a[196:199], a[144:147], a[80:83]
    s_cmp_eq_u32 s48, s67
    s_cbranch_scc1 L_cs1A5
    L_cs1A5b:
    v_mfma_f32_16x16x32_bf16 a[84:87], a[196:199], a[148:151], a[84:87]
    v_mfma_f32_16x16x32_bf16 a[88:91], a[196:199], a[152:155], a[88:91]
    v_mfma_f32_16x16x32_bf16 a[92:95], a[196:199], a[156:159], a[92:95]
    s_waitcnt lgkmcnt(0)
L_loopA_2:
    v_mfma_f32_16x16x32_bf16 v[32:35], a[96:99], a[160:163], v[32:35]
    ds_read_b64_tr_b16 a[180:181], v9 offset:8192
    v_mfma_f32_16x16x32_bf16 v[36:39], a[100:103], a[160:163], v[36:39]
    s_add_u32 m0, s58, 0x1000
    v_mfma_f32_16x16x32_bf16 v[40:43], a[104:107], a[160:163], v[40:43]
    v_mfma_f32_16x16x32_bf16 v[44:47], a[108:111], a[160:163], v[44:47]
    ds_read_b64_tr_b16 a[182:183], v9 offset:8704
    v_mfma_f32_16x16x32_bf16 v[48:51], a[112:115], a[160:163], v[48:51]
    buffer_load_dwordx4 v21, s[8:11], s41 offen offset:0 lds
    v_mfma_f32_16x16x32_bf16 v[52:55], a[116:119], a[160:163], v[52:55]
    v_mfma_f32_16x16x32_bf16 v[56:59], a[120:123], a[160:163], v[56:59]
    v_mfma_f32_16x16x32_bf16 v[60:63], a[124:127], a[160:163], v[60:63]
    ds_read_b64_tr_b16 a[184:185], v7 offset:12288
    v_mfma_f32_16x16x32_bf16 v[92:95], a[124:127], a[164:167], v[92:95]
    buffer_load_dwordx4 v22, s[8:11], s41 offen offset:1024 lds
    v_mfma_f32_16x16x32_bf16 v[88:91], a[120:123], a[164:167], v[88:91]
    v_mfma_f32_16x16x32_bf16 v[84:87], a[116:119], a[164:167], v[84:87]
    ds_read_b64_tr_b16 a[186:187], v7 offset:12800
    v_mfma_f32_16x16x32_bf16 v[80:83], a[112:115], a[164:167], v[80:83]
    s_add_u32 s63, s63, 128
    v_mfma_f32_16x16x32_bf16 v[76:79], a[108:111], a[164:167], v[76:79]
    v_mfma_f32_16x16x32_bf16 v[72:75], a[104:107], a[164:167], v[72:75]
    ds_read_b64_tr_b16 a[188:189], v7 offset:16384
    v_mfma_f32_16x16x32_bf16 v[68:71], a[100:103], a[164:167], v[68:71]
    v_mfma_f32_16x16x32_bf16 v[64:67], a[96:99], a[164:167], v[64:67]
    s_and_b32 s63, s63, 2047
    v_mfma_f32_16x16x32_bf16 v[96:99], a[96:99], a[168:171], v[96:99]
    v_mfma_f32_16x16x32_bf16 v[100:103], a[100:103], a[168:171], v[100:103]
    ds_read_b64_tr_b16 a[190:191], v7 offset:16896
    v_mfma_f32_16x16x32_bf16 v[104:107], a[104:107], a[168:171], v[104:107]
    v_mfma_f32_16x16x32_bf16 v[108:111], a[108:111], a[168:171], v[108:111]
    buffer_load_dwordx4 v23, s[8:11], s41 offen offset:2048 lds
    v_mfma_f32_16x16x32_bf16 v[112:115], a[112:115], a[168:171], v[112:115]
    ds_read_b64_tr_b16 a[192:193], v9 offset:12288
    v_mfma_f32_16x16x32_bf16 v[116:119], a[116:119], a[168:171], v[116:119]
    v_mfma_f32_16x16x32_bf16 v[120:123], a[120:123], a[168:171], v[120:123]
    s_add_u32 s40, s64, s63
    v_mfma_f32_16x16x32_bf16 v[124:127], a[124:127], a[168:171], v[124:127]
    ds_read_b64_tr_b16 a[194:195], v9 offset:12800
    v_mfma_f32_16x16x32_bf16 v[156:159], a[124:127], a[172:175], v[156:159]
    v_mfma_f32_16x16x32_bf16 v[152:155], a[120:123], a[172:175], v[152:155]
    v_mfma_f32_16x16x32_bf16 v[148:151], a[116:119], a[172:175], v[148:151]
    buffer_load_dwordx4 v24, s[8:11], s41 offen offset:3072 lds
    v_mfma_f32_16x16x32_bf16 v[144:147], a[112:115], a[172:175], v[144:147]
    ds_read_b64_tr_b16 a[196:197], v9 offset:16384
    v_mfma_f32_16x16x32_bf16 v[140:143], a[108:111], a[172:175], v[140:143]
    v_mfma_f32_16x16x32_bf16 v[136:139], a[104:107], a[172:175], v[136:139]
    v_mfma_f32_16x16x32_bf16 v[132:135], a[100:103], a[172:175], v[132:135]
    ds_read_b64_tr_b16 a[198:199], v9 offset:16896
    v_mfma_f32_16x16x32_bf16 v[128:131], a[96:99], a[172:175], v[128:131]
    s_add_u32 s41, s40, 0x10000
    v_mfma_f32_16x16x32_bf16 v[160:163], a[176:179], a[96:99], v[160:163]
    v_mfma_f32_16x16x32_bf16 v[164:167], a[176:179], a[100:103], v[164:167]
    buffer_load_dword v19, v18, s[36:39], s60 offen
    v_mfma_f32_16x16x32_bf16 v[168:171], a[176:179], a[104:107], v[168:171]
    v_mfma_f32_16x16x32_bf16 v[172:175], a[176:179], a[108:111], v[172:175]
    v_mfma_f32_16x16x32_bf16 v[176:179], a[176:179], a[112:115], v[176:179]
    s_cmp_eq_u32 s48, s66
    s_cbranch_scc1 L_cs0A6
    L_cs0A6b:
    v_mfma_f32_16x16x32_bf16 v[180:183], a[176:179], a[116:119], v[180:183]
    s_add_u32 s60, s60, s61
    v_mfma_f32_16x16x32_bf16 v[184:187], a[176:179], a[120:123], v[184:187]
    v_mfma_f32_16x16x32_bf16 v[188:191], a[176:179], a[124:127], v[188:191]
    s_waitcnt vmcnt(13) lgkmcnt(0)
    s_barrier
    v_mfma_f32_16x16x32_bf16 v[192:195], a[180:183], a[96:99], v[192:195]
    ds_read_b64_tr_b16 a[160:161], v7 offset:20480
    v_mfma_f32_16x16x32_bf16 v[196:199], a[180:183], a[100:103], v[196:199]
    s_add_u32 m0, s59, 0x15000
    v_mfma_f32_16x16x32_bf16 v[200:203], a[180:183], a[104:107], v[200:203]
    ds_read_b64_tr_b16 a[162:163], v7 offset:20992
    v_mfma_f32_16x16x32_bf16 v[204:207], a[180:183], a[108:111], v[204:207]
    buffer_load_dwordx4 v13, s[12:15], s42 offen nt lds
    v_mfma_f32_16x16x32_bf16 v[208:211], a[180:183], a[112:115], v[208:211]
    ds_read_b128 a[128:131], v5 offset:32768
    v_mfma_f32_16x16x32_bf16 v[212:215], a[180:183], a[116:119], v[212:215]
    ds_read_b128 a[132:135], v5 offset:34816
    v_mfma_f32_16x16x32_bf16 v[216:219], a[180:183], a[120:123], v[216:219]
    v_mfma_f32_16x16x32_bf16 v[220:223], a[180:183], a[124:127], v[220:223]
    ds_read_b128 a[136:139], v5 offset:36864
    v_mfma_f32_16x16x32_bf16 v[252:255], a[184:187], a[124:127], v[252:255]
    s_add_u32 m0, s59, 0x16000
    v_mfma_f32_16x16x32_bf16 v[248:251], a[184:187], a[120:123], v[248:251]
    ds_read_b128 a[140:143], v5 offset:38912
    v_mfma_f32_16x16x32_bf16 v[244:247], a[184:187], a[116:119], v[244:247]
    buffer_load_dwordx4 v13, s[16:19], s42 offen nt lds
    v_mfma_f32_16x16x32_bf16 v[240:243], a[184:187], a[112:115], v[240:243]
    ds_read_b128 a[144:147], v5 offset:40960
    v_mfma_f32_16x16x32_bf16 v[236:239], a[184:187], a[108:111], v[236:239]
    ds_read_b128 a[148:151], v5 offset:43008
    v_mfma_f32_16x16x32_bf16 v[232:235], a[184:187], a[104:107], v[232:235]
    v_mfma_f32_16x16x32_bf16 v[228:231], a[184:187], a[100:103], v[228:231]
    ds_read_b128 a[152:155], v5 offset:45056
    v_mfma_f32_16x16x32_bf16 v[224:227], a[184:187], a[96:99], v[224:227]
    s_add_u32 m0, s59, 0x17000
    v_mfma_f32_16x16x32_bf16 a[0:3], a[188:191], a[96:99], a[0:3]
    ds_read_b128 a[156:159], v5 offset:47104
    v_mfma_f32_16x16x32_bf16 a[4:7], a[188:191], a[100:103], a[4:7]
    buffer_load_dwordx4 v13, s[20:23], s42 offen nt lds
    v_mfma_f32_16x16x32_bf16 a[8:11], a[188:191], a[104:107], a[8:11]
    ds_read_b64_tr_b16 a[164:165], v9 offset:20480
    v_mfma_f32_16x16x32_bf16 a[12:15], a[188:191], a[108:111], a[12:15]
    ds_read_b64_tr_b16 a[166:167], v9 offset:20992
    v_mfma_f32_16x16x32_bf16 a[16:19], a[188:191], a[112:115], a[16:19]
    v_mfma_f32_16x16x32_bf16 a[20:23], a[188:191], a[116:119], a[20:23]
    ds_read_b64_tr_b16 a[168:169], v7 offset:24576
    v_mfma_f32_16x16x32_bf16 a[24:27], a[188:191], a[120:123], a[24:27]
    s_add_u32 m0, s59, 0x18000
    v_mfma_f32_16x16x32_bf16 a[28:31], a[188:191], a[124:127], a[28:31]
    ds_read_b64_tr_b16 a[170:171], v7 offset:25088
    v_mfma_f32_16x16x32_bf16 a[60:63], a[192:195], a[124:127], a[60:63]
    buffer_load_dwordx4 v14, s[24:27], s43 offen nt lds
    v_mfma_f32_16x16x32_bf16 a[56:59], a[192:195], a[120:123], a[56:59]
    ds_read_b64_tr_b16 a[172:173], v9 offset:24576
    v_mfma_f32_16x16x32_bf16 a[52:55], a[192:195], a[116:119], a[52:55]
    ds_read_b64_tr_b16 a[174:175], v9 offset:25088
    v_mfma_f32_16x16x32_bf16 a[48:51], a[192:195], a[112:115], a[48:51]
    v_mfma_f32_16x16x32_bf16 a[44:47], a[192:195], a[108:111], a[44:47]
    ds_read_b64_tr_b16 a[176:177], v7 offset:28672
    v_mfma_f32_16x16x32_bf16 a[40:43], a[192:195], a[104:107], a[40:43]
    s_add_u32 s62, s62, 1
    v_mfma_f32_16x16x32_bf16 a[36:39], a[192:195], a[100:103], a[36:39]
    ds_read_b64_tr_b16 a[178:179], v7 offset:29184
    v_mfma_f32_16x16x32_bf16 a[32:35], a[192:195], a[96:99], a[32:35]
    s_and_b32 s62, s62, 31
    v_mfma_f32_16x16x32_bf16 a[64:67], a[196:199], a[96:99], a[64:67]
    v_mfma_f32_16x16x32_bf16 a[68:71], a[196:199], a[100:103], a[68:71]
    s_add_u32 m0, s59, 0x19000
    v_mfma_f32_16x16x32_bf16 a[72:75], a[196:199], a[104:107], a[72:75]
    buffer_load_dwordx4 v14, s[28:31], s43 offen nt lds
    v_mfma_f32_16x16x32_bf16 a[76:79], a[196:199], a[108:111], a[76:79]
    v_mfma_f32_16x16x32_bf16 a[80:83], a[196:199], a[112:115], a[80:83]
    s_cmp_eq_u32 s48, s67
    s_cbranch_scc1 L_cs1A6
    L_cs1A6b:
    v_mfma_f32_16x16x32_bf16 a[84:87], a[196:199], a[116:119], a[84:87]
    s_mul_i32 s43, s62, 229376
    v_mfma_f32_16x16x32_bf16 a[88:91], a[196:199], a[120:123], a[88:91]
    s_mul_i32 s42, s62, 196608
    v_mfma_f32_16x16x32_bf16 a[92:95], a[196:199], a[124:127], a[92:95]
    s_waitcnt lgkmcnt(0)
    v_mfma_f32_16x16x32_bf16 v[32:35], a[128:131], a[160:163], v[32:35]
    ds_read_b64_tr_b16 a[180:181], v9 offset:28672
    v_mfma_f32_16x16x32_bf16 v[36:39], a[132:135], a[160:163], v[36:39]
    s_add_u32 m0, s59, 0x1a000
    v_mfma_f32_16x16x32_bf16 v[40:43], a[136:139], a[160:163], v[40:43]
    v_mfma_f32_16x16x32_bf16 v[44:47], a[140:143], a[160:163], v[44:47]
    ds_read_b64_tr_b16 a[182:183], v9 offset:29184
    v_mfma_f32_16x16x32_bf16 v[48:51], a[144:147], a[160:163], v[48:51]
    buffer_load_dwordx4 v13, s[12:15], s42 offen nt lds
    v_mfma_f32_16x16x32_bf16 v[52:55], a[148:151], a[160:163], v[52:55]
    v_mfma_f32_16x16x32_bf16 v[56:59], a[152:155], a[160:163], v[56:59]
    s_add_u32 m0, s59, 0x1b000
    v_mfma_f32_16x16x32_bf16 v[60:63], a[156:159], a[160:163], v[60:63]
    ds_read_b64_tr_b16 a[184:185], v7 offset:32768
    v_mfma_f32_16x16x32_bf16 v[92:95], a[156:159], a[164:167], v[92:95]
    v_mfma_f32_16x16x32_bf16 v[88:91], a[152:155], a[164:167], v[88:91]
    buffer_load_dwordx4 v13, s[16:19], s42 offen nt lds
    v_mfma_f32_16x16x32_bf16 v[84:87], a[148:151], a[164:167], v[84:87]
    ds_read_b64_tr_b16 a[186:187], v7 offset:33280
    v_mfma_f32_16x16x32_bf16 v[80:83], a[144:147], a[164:167], v[80:83]
    v_mfma_f32_16x16x32_bf16 v[76:79], a[140:143], a[164:167], v[76:79]
    s_add_u32 m0, s59, 0x1c000
    v_mfma_f32_16x16x32_bf16 v[72:75], a[136:139], a[164:167], v[72:75]
    ds_read_b64_tr_b16 a[188:189], v7 offset:36864
    v_mfma_f32_16x16x32_bf16 v[68:71], a[132:135], a[164:167], v[68:71]
    v_mfma_f32_16x16x32_bf16 v[64:67], a[128:131], a[164:167], v[64:67]
    buffer_load_dwordx4 v13, s[20:23], s42 offen nt lds
    v_mfma_f32_16x16x32_bf16 v[96:99], a[128:131], a[168:171], v[96:99]
    v_mfma_f32_16x16x32_bf16 v[100:103], a[132:135], a[168:171], v[100:103]
    ds_read_b64_tr_b16 a[190:191], v7 offset:37376
    v_mfma_f32_16x16x32_bf16 v[104:107], a[136:139], a[168:171], v[104:107]
    s_add_u32 m0, s59, 0x1d000
    v_mfma_f32_16x16x32_bf16 v[108:111], a[140:143], a[168:171], v[108:111]
    v_mfma_f32_16x16x32_bf16 v[112:115], a[144:147], a[168:171], v[112:115]
    ds_read_b64_tr_b16 a[192:193], v9 offset:32768
    v_mfma_f32_16x16x32_bf16 v[116:119], a[148:151], a[168:171], v[116:119]
    buffer_load_dwordx4 v14, s[24:27], s43 offen nt lds
    v_mfma_f32_16x16x32_bf16 v[120:123], a[152:155], a[168:171], v[120:123]
    v_mfma_f32_16x16x32_bf16 v[124:127], a[156:159], a[168:171], v[124:127]
    ds_read_b64_tr_b16 a[194:195], v9 offset:33280
    v_mfma_f32_16x16x32_bf16 v[156:159], a[156:159], a[172:175], v[156:159]
    s_add_u32 s62, s62, 1
    v_mfma_f32_16x16x32_bf16 v[152:155], a[152:155], a[172:175], v[152:155]
    v_mfma_f32_16x16x32_bf16 v[148:151], a[148:151], a[172:175], v[148:151]
    s_and_b32 s62, s62, 31
    v_mfma_f32_16x16x32_bf16 v[144:147], a[144:147], a[172:175], v[144:147]
    ds_read_b64_tr_b16 a[196:197], v9 offset:36864
    v_mfma_f32_16x16x32_bf16 v[140:143], a[140:143], a[172:175], v[140:143]
    v_mfma_f32_16x16x32_bf16 v[136:139], a[136:139], a[172:175], v[136:139]
    s_add_u32 m0, s59, 0x1e000
    v_mfma_f32_16x16x32_bf16 v[132:135], a[132:135], a[172:175], v[132:135]
    ds_read_b64_tr_b16 a[198:199], v9 offset:37376
    v_mfma_f32_16x16x32_bf16 v[128:131], a[128:131], a[172:175], v[128:131]
    v_mfma_f32_16x16x32_bf16 v[160:163], a[176:179], a[128:131], v[160:163]
    buffer_load_dwordx4 v14, s[28:31], s43 offen nt lds
    v_mfma_f32_16x16x32_bf16 v[164:167], a[176:179], a[132:135], v[164:167]
    v_mfma_f32_16x16x32_bf16 v[168:171], a[176:179], a[136:139], v[168:171]
    s_mul_i32 s43, s62, 229376
    v_mfma_f32_16x16x32_bf16 v[172:175], a[176:179], a[140:143], v[172:175]
    v_mfma_f32_16x16x32_bf16 v[176:179], a[176:179], a[144:147], v[176:179]
    s_cmp_eq_u32 s48, s66
    s_cbranch_scc1 L_cs0A7
    L_cs0A7b:
    v_mfma_f32_16x16x32_bf16 v[180:183], a[176:179], a[148:151], v[180:183]
    s_mul_i32 s42, s62, 196608
    v_mfma_f32_16x16x32_bf16 v[184:187], a[176:179], a[152:155], v[184:187]
    v_mfma_f32_16x16x32_bf16 v[188:191], a[176:179], a[156:159], v[188:191]
    s_waitcnt vmcnt(10) lgkmcnt(0)
    s_barrier
    v_mfma_f32_16x16x32_bf16 v[192:195], a[180:183], a[128:131], v[192:195]
    ds_read_b64_tr_b16 a[160:161], v6 offset:0
    v_mfma_f32_16x16x32_bf16 v[196:199], a[180:183], a[132:135], v[196:199]
    s_add_u32 m0, s58, 0x8000
    v_mfma_f32_16x16x32_bf16 v[200:203], a[180:183], a[136:139], v[200:203]
    ds_read_b64_tr_b16 a[162:163], v6 offset:512
    v_mfma_f32_16x16x32_bf16 v[204:207], a[180:183], a[140:143], v[204:207]
    v_mfma_f32_16x16x32_bf16 v[208:211], a[180:183], a[144:147], v[208:211]
    ds_read_b128 a[96:99], v4 offset:0
    v_mfma_f32_16x16x32_bf16 v[212:215], a[180:183], a[148:151], v[212:215]
    ds_read_b128 a[100:103], v4 offset:2048
    v_mfma_f32_16x16x32_bf16 v[216:219], a[180:183], a[152:155], v[216:219]
    v_mfma_f32_16x16x32_bf16 v[220:223], a[180:183], a[156:159], v[220:223]
    ds_read_b128 a[104:107], v4 offset:4096
    v_mfma_f32_16x16x32_bf16 v[252:255], a[184:187], a[156:159], v[252:255]
    v_mfma_f32_16x16x32_bf16 v[248:251], a[184:187], a[152:155], v[248:251]
    ds_read_b128 a[108:111], v4 offset:6144
    v_mfma_f32_16x16x32_bf16 v[244:247], a[184:187], a[148:151], v[244:247]
    buffer_load_dwordx4 v21, s[8:11], s40 offen offset:0 lds
    v_mfma_f32_16x16x32_bf16 v[240:243], a[184:187], a[144:147], v[240:243]
    ds_read_b128 a[112:115], v4 offset:8192
    v_mfma_f32_16x16x32_bf16 v[236:239], a[184:187], a[140:143], v[236:239]
    ds_read_b128 a[116:119], v4 offset:10240
    v_mfma_f32_16x16x32_bf16 v[232:235], a[184:187], a[136:139], v[232:235]
    v_mfma_f32_16x16x32_bf16 v[228:231], a[184:187], a[132:135], v[228:231]
    ds_read_b128 a[120:123], v4 offset:12288
    v_mfma_f32_16x16x32_bf16 v[224:227], a[184:187], a[128:131], v[224:227]
    v_mfma_f32_16x16x32_bf16 a[0:3], a[188:191], a[128:131], a[0:3]
    ds_read_b128 a[124:127], v4 offset:14336
    v_mfma_f32_16x16x32_bf16 a[4:7], a[188:191], a[132:135], a[4:7]
    v_mfma_f32_16x16x32_bf16 a[8:11], a[188:191], a[136:139], a[8:11]
    ds_read_b64_tr_b16 a[164:165], v8 offset:0
    v_mfma_f32_16x16x32_bf16 a[12:15], a[188:191], a[140:143], a[12:15]
    ds_read_b64_tr_b16 a[166:167], v8 offset:512
    v_mfma_f32_16x16x32_bf16 a[16:19], a[188:191], a[144:147], a[16:19]
    buffer_load_dwordx4 v22, s[8:11], s40 offen offset:1024 lds
    v_mfma_f32_16x16x32_bf16 a[20:23], a[188:191], a[148:151], a[20:23]
    ds_read_b64_tr_b16 a[168:169], v6 offset:4096
    v_mfma_f32_16x16x32_bf16 a[24:27], a[188:191], a[152:155], a[24:27]
    v_mfma_f32_16x16x32_bf16 a[28:31], a[188:191], a[156:159], a[28:31]
    ds_read_b64_tr_b16 a[170:171], v6 offset:4608
    v_mfma_f32_16x16x32_bf16 a[60:63], a[192:195], a[156:159], a[60:63]
    v_mfma_f32_16x16x32_bf16 a[56:59], a[192:195], a[152:155], a[56:59]
    ds_read_b64_tr_b16 a[172:173], v8 offset:4096
    v_mfma_f32_16x16x32_bf16 a[52:55], a[192:195], a[148:151], a[52:55]
    ds_read_b64_tr_b16 a[174:175], v8 offset:4608
    v_mfma_f32_16x16x32_bf16 a[48:51], a[192:195], a[144:147], a[48:51]
    v_mfma_f32_16x16x32_bf16 a[44:47], a[192:195], a[140:143], a[44:47]
    ds_read_b64_tr_b16 a[176:177], v6 offset:8192
    v_mfma_f32_16x16x32_bf16 a[40:43], a[192:195], a[136:139], a[40:43]
    buffer_load_dwordx4 v23, s[8:11], s40 offen offset:2048 lds
    v_mfma_f32_16x16x32_bf16 a[36:39], a[192:195], a[132:135], a[36:39]
    ds_read_b64_tr_b16 a[178:179], v6 offset:8704
    v_mfma_f32_16x16x32_bf16 a[32:35], a[192:195], a[128:131], a[32:35]
    v_mfma_f32_16x16x32_bf16 a[64:67], a[196:199], a[128:131], a[64:67]
    v_mfma_f32_16x16x32_bf16 a[68:71], a[196:199], a[132:135], a[68:71]
    v_mfma_f32_16x16x32_bf16 a[72:75], a[196:199], a[136:139], a[72:75]
    buffer_load_dwordx4 v24, s[8:11], s40 offen offset:3072 lds
    v_mfma_f32_16x16x32_bf16 a[76:79], a[196:199], a[140:143], a[76:79]
    v_mfma_f32_16x16x32_bf16 a[80:83], a[196:199], a[144:147], a[80:83]
    s_cmp_eq_u32 s48, s67
    s_cbranch_scc1 L_cs1A7
    L_cs1A7b:
    v_mfma_f32_16x16x32_bf16 a[84:87], a[196:199], a[148:151], a[84:87]
    v_mfma_f32_16x16x32_bf16 a[88:91], a[196:199], a[152:155], a[88:91]
    v_mfma_f32_16x16x32_bf16 a[92:95], a[196:199], a[156:159], a[92:95]
    s_sub_u32 s48, s48, 1
    s_waitcnt lgkmcnt(0)
    s_cbranch_scc0 L_loopA
L_tailA:
    v_mfma_f32_16x16x32_bf16 v[32:35], a[96:99], a[160:163], v[32:35]
    ds_read_b64_tr_b16 a[180:181], v8 offset:8192
    v_mfma_f32_16x16x32_bf16 v[36:39], a[100:103], a[160:163], v[36:39]
    s_add_u32 m0, s58, 0x9000
    v_mfma_f32_16x16x32_bf16 v[40:43], a[104:107], a[160:163], v[40:43]
    s_lshl_b32 s52, s56, 1
    v_mfma_f32_16x16x32_bf16 v[44:47], a[108:111], a[160:163], v[44:47]
    ds_read_b64_tr_b16 a[182:183], v8 offset:8704
    v_mfma_f32_16x16x32_bf16 v[48:51], a[112:115], a[160:163], v[48:51]
    s_add_u32 s52, s52, s55
    v_mfma_f32_16x16x32_bf16 v[52:55], a[116:119], a[160:163], v[52:55]
    buffer_load_dwordx4 v21, s[8:11], s41 offen offset:0 lds
    v_mfma_f32_16x16x32_bf16 v[56:59], a[120:123], a[160:163], v[56:59]
    s_lshl_b32 s52, s52, 1
    v_mfma_f32_16x16x32_bf16 v[60:63], a[124:127], a[160:163], v[60:63]
    ds_read_b64_tr_b16 a[184:185], v6 offset:12288
    v_mfma_f32_16x16x32_bf16 v[92:95], a[124:127], a[164:167], v[92:95]
    s_add_u32 s52, s52, s54
    v_mfma_f32_16x16x32_bf16 v[88:91], a[120:123], a[164:167], v[88:91]
    buffer_load_dwordx4 v22, s[8:11], s41 offen offset:1024 lds
    v_mfma_f32_16x16x32_bf16 v[84:87], a[116:119], a[164:167], v[84:87]
    ds_read_b64_tr_b16 a[186:187], v6 offset:12800
    v_mfma_f32_16x16x32_bf16 v[80:83], a[112:115], a[164:167], v[80:83]
    s_mul_i32 s52, s52, 5120
    v_mfma_f32_16x16x32_bf16 v[76:79], a[108:111], a[164:167], v[76:79]
    s_mul_i32 s53, s50, 0x88
    v_mfma_f32_16x16x32_bf16 v[72:75], a[104:107], a[164:167], v[72:75]
    ds_read_b64_tr_b16 a[188:189], v6 offset:16384
    v_mfma_f32_16x16x32_bf16 v[68:71], a[100:103], a[164:167], v[68:71]
    s_and_b32 s53, s53, 0x308
    v_mfma_f32_16x16x32_bf16 v[64:67], a[96:99], a[164:167], v[64:67]
    s_add_u32 s63, s63, 128
    v_mfma_f32_16x16x32_bf16 v[96:99], a[96:99], a[168:171], v[96:99]
    s_add_u32 s52, s52, s53
    v_mfma_f32_16x16x32_bf16 v[100:103], a[100:103], a[168:171], v[100:103]
    ds_read_b64_tr_b16 a[190:191], v6 offset:16896
    v_mfma_f32_16x16x32_bf16 v[104:107], a[104:107], a[168:171], v[104:107]
    s_add_u32 s52, s52, 0x110000
    v_mfma_f32_16x16x32_bf16 v[108:111], a[108:111], a[168:171], v[108:111]
    s_and_b32 s63, s63, 2047
    v_mfma_f32_16x16x32_bf16 v[112:115], a[112:115], a[168:171], v[112:115]
    ds_read_b64_tr_b16 a[192:193], v8 offset:12288
    v_mfma_f32_16x16x32_bf16 v[116:119], a[116:119], a[168:171], v[116:119]
    v_lshrrev_b32 v28, 4, v2
    v_mfma_f32_16x16x32_bf16 v[120:123], a[120:123], a[168:171], v[120:123]
    v_lshl_or_b32 v25, v28, 22, v12
    v_mfma_f32_16x16x32_bf16 v[124:127], a[124:127], a[168:171], v[124:127]
    ds_read_b64_tr_b16 a[194:195], v8 offset:12800
    v_mfma_f32_16x16x32_bf16 v[156:159], a[124:127], a[172:175], v[156:159]
    buffer_load_dwordx4 v23, s[8:11], s41 offen offset:2048 lds
    v_mfma_f32_16x16x32_bf16 v[152:155], a[120:123], a[172:175], v[152:155]
    v_accvgpr_read_b32 v28, a200
    v_mfma_f32_16x16x32_bf16 v[148:151], a[116:119], a[172:175], v[148:151]
    v_cvt_pk_bf16_f32 v29, v28, v28
    v_mfma_f32_16x16x32_bf16 v[144:147], a[112:115], a[172:175], v[144:147]
    ds_read_b64_tr_b16 a[196:197], v8 offset:16384
    v_mfma_f32_16x16x32_bf16 v[140:143], a[108:111], a[172:175], v[140:143]
    v_lshlrev_b32 v29, 16, v29
    v_mfma_f32_16x16x32_bf16 v[136:139], a[104:107], a[172:175], v[136:139]
    s_add_u32 s40, s64, s63
    v_mfma_f32_16x16x32_bf16 v[132:135], a[100:103], a[172:175], v[132:135]
    ds_read_b64_tr_b16 a[198:199], v8 offset:16896
    v_mfma_f32_16x16x32_bf16 v[128:131], a[96:99], a[172:175], v[128:131]
    v_sub_f32 v30, v28, v29
    v_mfma_f32_16x16x32_bf16 v[160:163], a[176:179], a[96:99], v[160:163]
    v_cvt_pk_bf16_f32 v26, v28, v30
    v_mfma_f32_16x16x32_bf16 v[164:167], a[176:179], a[100:103], v[164:167]
    buffer_load_dwordx4 v24, s[8:11], s41 offen offset:3072 lds
    v_mfma_f32_16x16x32_bf16 v[168:171], a[176:179], a[104:107], v[168:171]
    v_and_b32 v29, 0xffff0000, v26
    v_mfma_f32_16x16x32_bf16 v[172:175], a[176:179], a[108:111], v[172:175]
    v_sub_f32 v30, v30, v29
    v_mfma_f32_16x16x32_bf16 v[176:179], a[176:179], a[112:115], v[176:179]
    s_add_u32 s41, s40, 0x10000
    v_mfma_f32_16x16x32_bf16 v[180:183], a[176:179], a[116:119], v[180:183]
    v_cvt_pk_bf16_f32 v27, v30, 0
    v_mfma_f32_16x16x32_bf16 v[184:187], a[176:179], a[120:123], v[184:187]
    buffer_store_dwordx2 v[26:27], v25, s[44:47], s52 offen offset:0 sc1
    v_mfma_f32_16x16x32_bf16 v[188:191], a[176:179], a[124:127], v[188:191]
    v_accvgpr_read_b32 v28, a204
    s_waitcnt vmcnt(14) lgkmcnt(0)
    s_barrier
    v_mfma_f32_16x16x32_bf16 v[192:195], a[180:183], a[96:99], v[192:195]
    ds_read_b64_tr_b16 a[160:161], v6 offset:20480
    v_mfma_f32_16x16x32_bf16 v[196:199], a[180:183], a[100:103], v[196:199]
    s_add_u32 m0, s59, 0x1f000
    v_mfma_f32_16x16x32_bf16 v[200:203], a[180:183], a[104:107], v[200:203]
    ds_read_b64_tr_b16 a[162:163], v6 offset:20992
    v_mfma_f32_16x16x32_bf16 v[204:207], a[180:183], a[108:111], v[204:207]
    buffer_load_dwordx4 v13, s[12:15], s42 offen nt lds
    v_mfma_f32_16x16x32_bf16 v[208:211], a[180:183], a[112:115], v[208:211]
    ds_read_b128 a[128:131], v5 offset:0
    v_mfma_f32_16x16x32_bf16 v[212:215], a[180:183], a[116:119], v[212:215]
    ds_read_b128 a[132:135], v5 offset:2048
    v_mfma_f32_16x16x32_bf16 v[216:219], a[180:183], a[120:123], v[216:219]
    v_cvt_pk_bf16_f32 v29, v28, v28
    v_mfma_f32_16x16x32_bf16 v[220:223], a[180:183], a[124:127], v[220:223]
    ds_read_b128 a[136:139], v5 offset:4096
    v_mfma_f32_16x16x32_bf16 v[252:255], a[184:187], a[124:127], v[252:255]
    s_add_u32 m0, s59, 0x20000
    v_mfma_f32_16x16x32_bf16 v[248:251], a[184:187], a[120:123], v[248:251]
    ds_read_b128 a[140:143], v5 offset:6144
    v_mfma_f32_16x16x32_bf16 v[244:247], a[184:187], a[116:119], v[244:247]
    buffer_load_dwordx4 v13, s[16:19], s42 offen nt lds
    v_mfma_f32_16x16x32_bf16 v[240:243], a[184:187], a[112:115], v[240:243]
    ds_read_b128 a[144:147], v5 offset:8192
    v_mfma_f32_16x16x32_bf16 v[236:239], a[184:187], a[108:111], v[236:239]
    ds_read_b128 a[148:151], v5 offset:10240
    v_mfma_f32_16x16x32_bf16 v[232:235], a[184:187], a[104:107], v[232:235]
    v_lshlrev_b32 v29, 16, v29
    v_mfma_f32_16x16x32_bf16 v[228:231], a[184:187], a[100:103], v[228:231]
    ds_read_b128 a[152:155], v5 offset:12288
    v_mfma_f32_16x16x32_bf16 v[224:227], a[184:187], a[96:99], v[224:227]
    s_add_u32 m0, s59, 0x21000
    v_mfma_f32_16x16x32_bf16 a[0:3], a[188:191], a[96:99], a[0:3]
    ds_read_b128 a[156:159], v5 offset:14336
    v_mfma_f32_16x16x32_bf16 a[4:7], a[188:191], a[100:103], a[4:7]
    buffer_load_dwordx4 v13, s[20:23], s42 offen nt lds
    v_mfma_f32_16x16x32_bf16 a[8:11], a[188:191], a[104:107], a[8:11]
    ds_read_b64_tr_b16 a[164:165], v8 offset:20480
    v_mfma_f32_16x16x32_bf16 a[12:15], a[188:191], a[108:111], a[12:15]
    ds_read_b64_tr_b16 a[166:167], v8 offset:20992
    v_mfma_f32_16x16x32_bf16 a[16:19], a[188:191], a[112:115], a[16:19]
    v_sub_f32 v30, v28, v29
    v_mfma_f32_16x16x32_bf16 a[20:23], a[188:191], a[116:119], a[20:23]
    ds_read_b64_tr_b16 a[168:169], v6 offset:24576
    v_mfma_f32_16x16x32_bf16 a[24:27], a[188:191], a[120:123], a[24:27]
    s_add_u32 m0, s59, 0x22000
    v_mfma_f32_16x16x32_bf16 a[28:31], a[188:191], a[124:127], a[28:31]
    ds_read_b64_tr_b16 a[170:171], v6 offset:25088
    v_mfma_f32_16x16x32_bf16 a[60:63], a[192:195], a[124:127], a[60:63]
    v_cvt_pk_bf16_f32 v0, v28, v30
    v_mfma_f32_16x16x32_bf16 a[56:59], a[192:195], a[120:123], a[56:59]
    ds_read_b64_tr_b16 a[172:173], v8 offset:24576
    v_mfma_f32_16x16x32_bf16 a[52:55], a[192:195], a[116:119], a[52:55]
    ds_read_b64_tr_b16 a[174:175], v8 offset:25088
    v_mfma_f32_16x16x32_bf16 a[48:51], a[192:195], a[112:115], a[48:51]
    buffer_load_dwordx4 v14, s[24:27], s43 offen nt lds
    v_mfma_f32_16x16x32_bf16 a[44:47], a[192:195], a[108:111], a[44:47]
    ds_read_b64_tr_b16 a[176:177], v6 offset:28672
    v_mfma_f32_16x16x32_bf16 a[40:43], a[192:195], a[104:107], a[40:43]
    s_add_u32 s62, s62, 1
    v_mfma_f32_16x16x32_bf16 a[36:39], a[192:195], a[100:103], a[36:39]
    ds_read_b64_tr_b16 a[178:179], v6 offset:29184
    v_mfma_f32_16x16x32_bf16 a[32:35], a[192:195], a[96:99], a[32:35]
    v_and_b32 v29, 0xffff0000, v0
    v_mfma_f32_16x16x32_bf16 a[64:67], a[196:199], a[96:99], a[64:67]
    s_and_b32 s62, s62, 31
    v_mfma_f32_16x16x32_bf16 a[68:71], a[196:199], a[100:103], a[68:71]
    s_add_u32 m0, s59, 0x23000
    v_mfma_f32_16x16x32_bf16 a[72:75], a[196:199], a[104:107], a[72:75]
    v_sub_f32 v30, v30, v29
    v_mfma_f32_16x16x32_bf16 a[76:79], a[196:199], a[108:111], a[76:79]
    buffer_load_dwordx4 v14, s[28:31], s43 offen nt lds
    v_mfma_f32_16x16x32_bf16 a[80:83], a[196:199], a[112:115], a[80:83]
    s_mul_i32 s43, s62, 229376
    v_mfma_f32_16x16x32_bf16 a[84:87], a[196:199], a[116:119], a[84:87]
    v_cvt_pk_bf16_f32 v1, v30, 0
    v_mfma_f32_16x16x32_bf16 a[88:91], a[196:199], a[120:123], a[88:91]
    s_mul_i32 s42, s62, 196608
    v_mfma_f32_16x16x32_bf16 a[92:95], a[196:199], a[124:127], a[92:95]
    buffer_store_dwordx2 v[0:1], v25, s[44:47], s52 offen offset:1024 sc1
    s_waitcnt lgkmcnt(0)
    v_mfma_f32_16x16x32_bf16 v[32:35], a[128:131], a[160:163], v[32:35]
    ds_read_b64_tr_b16 a[180:181], v8 offset:28672
    v_mfma_f32_16x16x32_bf16 v[36:39], a[132:135], a[160:163], v[36:39]
    s_add_u32 m0, s59, 0x10000
    v_mfma_f32_16x16x32_bf16 v[40:43], a[136:139], a[160:163], v[40:43]
    v_accvgpr_read_b32 v28, a208
    v_mfma_f32_16x16x32_bf16 v[44:47], a[140:143], a[160:163], v[44:47]
    ds_read_b64_tr_b16 a[182:183], v8 offset:29184
    v_mfma_f32_16x16x32_bf16 v[48:51], a[144:147], a[160:163], v[48:51]
    buffer_load_dwordx4 v13, s[12:15], s42 offen nt lds
    v_mfma_f32_16x16x32_bf16 v[52:55], a[148:151], a[160:163], v[52:55]
    v_cvt_pk_bf16_f32 v29, v28, v28
    v_mfma_f32_16x16x32_bf16 v[56:59], a[152:155], a[160:163], v[56:59]
    s_add_u32 m0, s59, 0x11000
    v_mfma_f32_16x16x32_bf16 v[60:63], a[156:159], a[160:163], v[60:63]
    ds_read_b64_tr_b16 a[184:185], v6 offset:32768
    v_mfma_f32_16x16x32_bf16 v[92:95], a[156:159], a[164:167], v[92:95]
    v_lshlrev_b32 v29, 16, v29
    v_mfma_f32_16x16x32_bf16 v[88:91], a[152:155], a[164:167], v[88:91]
    buffer_load_dwordx4 v13, s[16:19], s42 offen nt lds
    v_mfma_f32_16x16x32_bf16 v[84:87], a[148:151], a[164:167], v[84:87]
    ds_read_b64_tr_b16 a[186:187], v6 offset:33280
    v_mfma_f32_16x16x32_bf16 v[80:83], a[144:147], a[164:167], v[80:83]
    v_sub_f32 v30, v28, v29
    v_mfma_f32_16x16x32_bf16 v[76:79], a[140:143], a[164:167], v[76:79]
    s_add_u32 m0, s59, 0x12000
    v_mfma_f32_16x16x32_bf16 v[72:75], a[136:139], a[164:167], v[72:75]
    ds_read_b64_tr_b16 a[188:189], v6 offset:36864
    v_mfma_f32_16x16x32_bf16 v[68:71], a[132:135], a[164:167], v[68:71]
    v_cvt_pk_bf16_f32 v26, v28, v30
    v_mfma_f32_16x16x32_bf16 v[64:67], a[128:131], a[164:167], v[64:67]
    buffer_load_dwordx4 v13, s[20:23], s42 offen nt lds
    v_mfma_f32_16x16x32_bf16 v[96:99], a[128:131], a[168:171], v[96:99]
    v_and_b32 v29, 0xffff0000, v26
    v_mfma_f32_16x16x32_bf16 v[100:103], a[132:135], a[168:171], v[100:103]
    ds_read_b64_tr_b16 a[190:191], v6 offset:37376
    v_mfma_f32_16x16x32_bf16 v[104:107], a[136:139], a[168:171], v[104:107]
    s_add_u32 m0, s59, 0x13000
    v_mfma_f32_16x16x32_bf16 v[108:111], a[140:143], a[168:171], v[108:111]
    v_sub_f32 v30, v30, v29
    v_mfma_f32_16x16x32_bf16 v[112:115], a[144:147], a[168:171], v[112:115]
    ds_read_b64_tr_b16 a[192:193], v8 offset:32768
    v_mfma_f32_16x16x32_bf16 v[116:119], a[148:151], a[168:171], v[116:119]
    v_cvt_pk_bf16_f32 v27, v30, 0
    v_mfma_f32_16x16x32_bf16 v[120:123], a[152:155], a[168:171], v[120:123]
    buffer_load_dwordx4 v14, s[24:27], s43 offen nt lds
    v_mfma_f32_16x16x32_bf16 v[124:127], a[156:159], a[168:171], v[124:127]
    ds_read_b64_tr_b16 a[194:195], v8 offset:33280
    v_mfma_f32_16x16x32_bf16 v[156:159], a[156:159], a[172:175], v[156:159]
    v_mfma_f32_16x16x32_bf16 v[152:155], a[152:155], a[172:175], v[152:155]
    s_add_u32 s62, s62, 1
    v_mfma_f32_16x16x32_bf16 v[148:151], a[148:151], a[172:175], v[148:151]
    buffer_store_dwordx2 v[26:27], v25, s[44:47], s52 offen offset:2048 sc1
    v_mfma_f32_16x16x32_bf16 v[144:147], a[144:147], a[172:175], v[144:147]
    ds_read_b64_tr_b16 a[196:197], v8 offset:36864
    v_mfma_f32_16x16x32_bf16 v[140:143], a[140:143], a[172:175], v[140:143]
    s_and_b32 s62, s62, 31
    v_mfma_f32_16x16x32_bf16 v[136:139], a[136:139], a[172:175], v[136:139]
    v_accvgpr_read_b32 v28, a212
    v_mfma_f32_16x16x32_bf16 v[132:135], a[132:135], a[172:175], v[132:135]
    ds_read_b64_tr_b16 a[198:199], v8 offset:37376
    v_mfma_f32_16x16x32_bf16 v[128:131], a[128:131], a[172:175], v[128:131]
    s_add_u32 m0, s59, 0x14000
    v_mfma_f32_16x16x32_bf16 v[160:163], a[176:179], a[128:131], v[160:163]
    v_cvt_pk_bf16_f32 v29, v28, v28
    v_mfma_f32_16x16x32_bf16 v[164:167], a[176:179], a[132:135], v[164:167]
    buffer_load_dwordx4 v14, s[28:31], s43 offen nt lds
    v_mfma_f32_16x16x32_bf16 v[168:171], a[176:179], a[136:139], v[168:171]
    v_lshlrev_b32 v29, 16, v29
    v_mfma_f32_16x16x32_bf16 v[172:175], a[176:179], a[140:143], v[172:175]
    s_mul_i32 s43, s62, 229376
    v_mfma_f32_16x16x32_bf16 v[176:179], a[176:179], a[144:147], v[176:179]
    v_sub_f32 v30, v28, v29
    v_mfma_f32_16x16x32_bf16 v[180:183], a[176:179], a[148:151], v[180:183]
    s_mul_i32 s42, s62, 196608
    v_mfma_f32_16x16x32_bf16 v[184:187], a[176:179], a[152:155], v[184:187]
    v_cvt_pk_bf16_f32 v0, v28, v30
    v_mfma_f32_16x16x32_bf16 v[188:191], a[176:179], a[156:159], v[188:191]
    v_and_b32 v29, 0xffff0000, v0
    s_waitcnt vmcnt(13) lgkmcnt(0)
    s_barrier
    v_mfma_f32_16x16x32_bf16 v[192:195], a[180:183], a[128:131], v[192:195]
    ds_read_b64_tr_b16 a[160:161], v7 offset:0
    v_mfma_f32_16x16x32_bf16 v[196:199], a[180:183], a[132:135], v[196:199]
    s_add_u32 m0, s58, 0x0
    v_mfma_f32_16x16x32_bf16 v[200:203], a[180:183], a[136:139], v[200:203]
    ds_read_b64_tr_b16 a[162:163], v7 offset:512
    v_mfma_f32_16x16x32_bf16 v[204:207], a[180:183], a[140:143], v[204:207]
    v_sub_f32 v30, v30, v29
    v_mfma_f32_16x16x32_bf16 v[208:211], a[180:183], a[144:147], v[208:211]
    ds_read_b128 a[96:99], v4 offset:32768
    v_mfma_f32_16x16x32_bf16 v[212:215], a[180:183], a[148:151], v[212:215]
    ds_read_b128 a[100:103], v4 offset:34816
    v_mfma_f32_16x16x32_bf16 v[216:219], a[180:183], a[152:155], v[216:219]
    v_cvt_pk_bf16_f32 v1, v30, 0
    v_mfma_f32_16x16x32_bf16 v[220:223], a[180:183], a[156:159], v[220:223]
    ds_read_b128 a[104:107], v4 offset:36864
    v_mfma_f32_16x16x32_bf16 v[252:255], a[184:187], a[156:159], v[252:255]
    v_mfma_f32_16x16x32_bf16 v[248:251], a[184:187], a[152:155], v[248:251]
    ds_read_b128 a[108:111], v4 offset:38912
    v_mfma_f32_16x16x32_bf16 v[244:247], a[184:187], a[148:151], v[244:247]
    buffer_load_dwordx4 v21, s[8:11], s40 offen offset:0 lds
    v_mfma_f32_16x16x32_bf16 v[240:243], a[184:187], a[144:147], v[240:243]
    ds_read_b128 a[112:115], v4 offset:40960
    v_mfma_f32_16x16x32_bf16 v[236:239], a[184:187], a[140:143], v[236:239]
    ds_read_b128 a[116:119], v4 offset:43008
    v_mfma_f32_16x16x32_bf16 v[232:235], a[184:187], a[136:139], v[232:235]
    buffer_store_dwordx2 v[0:1], v25, s[44:47], s52 offen offset:3072 sc1
    v_mfma_f32_16x16x32_bf16 v[228:231], a[184:187], a[132:135], v[228:231]
    ds_read_b128 a[120:123], v4 offset:45056
    v_mfma_f32_16x16x32_bf16 v[224:227], a[184:187], a[128:131], v[224:227]
    s_add_u32 s52, s52, 4096
    v_mfma_f32_16x16x32_bf16 a[0:3], a[188:191], a[128:131], a[0:3]
    ds_read_b128 a[124:127], v4 offset:47104
    v_mfma_f32_16x16x32_bf16 a[4:7], a[188:191], a[132:135], a[4:7]
    v_accvgpr_read_b32 v28, a216
    v_mfma_f32_16x16x32_bf16 a[8:11], a[188:191], a[136:139], a[8:11]
    ds_read_b64_tr_b16 a[164:165], v9 offset:0
    v_mfma_f32_16x16x32_bf16 a[12:15], a[188:191], a[140:143], a[12:15]
    ds_read_b64_tr_b16 a[166:167], v9 offset:512
    v_mfma_f32_16x16x32_bf16 a[16:19], a[188:191], a[144:147], a[16:19]
    buffer_load_dwordx4 v22, s[8:11], s40 offen offset:1024 lds
    v_mfma_f32_16x16x32_bf16 a[20:23], a[188:191], a[148:151], a[20:23]
    ds_read_b64_tr_b16 a[168:169], v7 offset:4096
    v_mfma_f32_16x16x32_bf16 a[24:27], a[188:191], a[152:155], a[24:27]
    v_cvt_pk_bf16_f32 v29, v28, v28
    v_mfma_f32_16x16x32_bf16 a[28:31], a[188:191], a[156:159], a[28:31]
    ds_read_b64_tr_b16 a[170:171], v7 offset:4608
    v_mfma_f32_16x16x32_bf16 a[60:63], a[192:195], a[156:159], a[60:63]
    v_lshlrev_b32 v29, 16, v29
    v_mfma_f32_16x16x32_bf16 a[56:59], a[192:195], a[152:155], a[56:59]
    ds_read_b64_tr_b16 a[172:173], v9 offset:4096
    v_mfma_f32_16x16x32_bf16 a[52:55], a[192:195], a[148:151], a[52:55]
    ds_read_b64_tr_b16 a[174:175], v9 offset:4608
    v_mfma_f32_16x16x32_bf16 a[48:51], a[192:195], a[144:147], a[48:51]
    v_sub_f32 v30, v28, v29
    v_mfma_f32_16x16x32_bf16 a[44:47], a[192:195], a[140:143], a[44:47]
    ds_read_b64_tr_b16 a[176:177], v7 offset:8192
    v_mfma_f32_16x16x32_bf16 a[40:43], a[192:195], a[136:139], a[40:43]
    v_cvt_pk_bf16_f32 v26, v28, v30
    v_mfma_f32_16x16x32_bf16 a[36:39], a[192:195], a[132:135], a[36:39]
    ds_read_b64_tr_b16 a[178:179], v7 offset:8704
    v_mfma_f32_16x16x32_bf16 a[32:35], a[192:195], a[128:131], a[32:35]
    buffer_load_dwordx4 v23, s[8:11], s40 offen offset:2048 lds
    v_mfma_f32_16x16x32_bf16 a[64:67], a[196:199], a[128:131], a[64:67]
    v_and_b32 v29, 0xffff0000, v26
    v_mfma_f32_16x16x32_bf16 a[68:71], a[196:199], a[132:135], a[68:71]
    v_sub_f32 v30, v30, v29
    v_mfma_f32_16x16x32_bf16 a[72:75], a[196:199], a[136:139], a[72:75]
    v_cvt_pk_bf16_f32 v27, v30, 0
    v_mfma_f32_16x16x32_bf16 a[76:79], a[196:199], a[140:143], a[76:79]
    buffer_load_dwordx4 v24, s[8:11], s40 offen offset:3072 lds
    v_mfma_f32_16x16x32_bf16 a[80:83], a[196:199], a[144:147], a[80:83]
    v_mfma_f32_16x16x32_bf16 a[84:87], a[196:199], a[148:151], a[84:87]
    v_mfma_f32_16x16x32_bf16 a[88:91], a[196:199], a[152:155], a[88:91]
    buffer_store_dwordx2 v[26:27], v25, s[44:47], s52 offen offset:0 sc1
    v_mfma_f32_16x16x32_bf16 a[92:95], a[196:199], a[156:159], a[92:95]
    s_lshl_b32 s52, s50, 5
    s_waitcnt lgkmcnt(0)
    v_mfma_f32_16x16x32_bf16 v[32:35], a[96:99], a[160:163], v[32:35]
    ds_read_b64_tr_b16 a[180:181], v9 offset:8192
    v_mfma_f32_16x16x32_bf16 v[36:39], a[100:103], a[160:163], v[36:39]
    s_add_u32 m0, s58, 0x1000
    v_mfma_f32_16x16x32_bf16 v[40:43], a[104:107], a[160:163], v[40:43]
    s_add_u32 s52, s52, s56
    v_mfma_f32_16x16x32_bf16 v[44:47], a[108:111], a[160:163], v[44:47]
    ds_read_b64_tr_b16 a[182:183], v9 offset:8704
    v_mfma_f32_16x16x32_bf16 v[48:51], a[112:115], a[160:163], v[48:51]
    s_lshl_b32 s52, s52, 2
    v_mfma_f32_16x16x32_bf16 v[52:55], a[116:119], a[160:163], v[52:55]
    buffer_load_dwordx4 v21, s[8:11], s41 offen offset:0 lds
    v_mfma_f32_16x16x32_bf16 v[56:59], a[120:123], a[160:163], v[56:59]
    s_add_u32 s52, s52, s49
    v_mfma_f32_16x16x32_bf16 v[60:63], a[124:127], a[160:163], v[60:63]
    ds_read_b64_tr_b16 a[184:185], v7 offset:12288
    v_mfma_f32_16x16x32_bf16 v[92:95], a[124:127], a[164:167], v[92:95]
    s_lshl_b32 s52, s52, 2
    v_mfma_f32_16x16x32_bf16 v[88:91], a[120:123], a[164:167], v[88:91]
    buffer_load_dwordx4 v22, s[8:11], s41 offen offset:1024 lds
    v_mfma_f32_16x16x32_bf16 v[84:87], a[116:119], a[164:167], v[84:87]
    ds_read_b64_tr_b16 a[186:187], v7 offset:12800
    v_mfma_f32_16x16x32_bf16 v[80:83], a[112:115], a[164:167], v[80:83]
    s_add_u32 s52, s52, 0x1e0000
    v_mfma_f32_16x16x32_bf16 v[76:79], a[108:111], a[164:167], v[76:79]
    buffer_store_dword v3, v31, s[44:47], s52 offen sc1
    v_mfma_f32_16x16x32_bf16 v[72:75], a[104:107], a[164:167], v[72:75]
    ds_read_b64_tr_b16 a[188:189], v7 offset:16384
    v_mfma_f32_16x16x32_bf16 v[68:71], a[100:103], a[164:167], v[68:71]
    s_add_u32 s32, s6, 0x800000
    s_addc_u32 s33, s7, 0
    v_mfma_f32_16x16x32_bf16 v[64:67], a[96:99], a[164:167], v[64:67]
    s_add_u32 s63, s63, 128
    v_mfma_f32_16x16x32_bf16 v[96:99], a[96:99], a[168:171], v[96:99]
    s_and_b32 s33, s33, 0xffff
    v_mfma_f32_16x16x32_bf16 v[100:103], a[100:103], a[168:171], v[100:103]
    ds_read_b64_tr_b16 a[190:191], v7 offset:16896
    v_mfma_f32_16x16x32_bf16 v[104:107], a[104:107], a[168:171], v[104:107]
    s_mov_b32 s34, 0x1200000
    v_mfma_f32_16x16x32_bf16 v[108:111], a[108:111], a[168:171], v[108:111]
    s_and_b32 s63, s63, 2047
    v_mfma_f32_16x16x32_bf16 v[112:115], a[112:115], a[168:171], v[112:115]
    ds_read_b64_tr_b16 a[192:193], v9 offset:12288
    v_mfma_f32_16x16x32_bf16 v[116:119], a[116:119], a[168:171], v[116:119]
    s_mov_b32 s35, 0x20000
    v_mfma_f32_16x16x32_bf16 v[120:123], a[120:123], a[168:171], v[120:123]
    s_lshl_b32 s52, s56, 3
    v_mfma_f32_16x16x32_bf16 v[124:127], a[124:127], a[168:171], v[124:127]
    ds_read_b64_tr_b16 a[194:195], v9 offset:12800
    v_mfma_f32_16x16x32_bf16 v[156:159], a[124:127], a[172:175], v[156:159]
    buffer_load_dwordx4 v23, s[8:11], s41 offen offset:2048 lds
    v_mfma_f32_16x16x32_bf16 v[152:155], a[120:123], a[172:175], v[152:155]
    s_add_u32 s52, s52, s50
    v_mfma_f32_16x16x32_bf16 v[148:151], a[116:119], a[172:175], v[148:151]
    s_lshl_b32 s52, s52, 2
    v_mfma_f32_16x16x32_bf16 v[144:147], a[112:115], a[172:175], v[144:147]
    ds_read_b64_tr_b16 a[196:197], v9 offset:16384
    v_mfma_f32_16x16x32_bf16 v[140:143], a[108:111], a[172:175], v[140:143]
    s_add_u32 s52, s52, s49
    v_mfma_f32_16x16x32_bf16 v[136:139], a[104:107], a[172:175], v[136:139]
    s_add_u32 s40, s64, s63
    v_mfma_f32_16x16x32_bf16 v[132:135], a[100:103], a[172:175], v[132:135]
    ds_read_b64_tr_b16 a[198:199], v9 offset:16896
    v_mfma_f32_16x16x32_bf16 v[128:131], a[96:99], a[172:175], v[128:131]
    s_lshl_b32 s52, s52, 2
    v_mfma_f32_16x16x32_bf16 v[160:163], a[176:179], a[96:99], v[160:163]
    s_add_u32 s52, s52, 0x1e1000
    v_mfma_f32_16x16x32_bf16 v[164:167], a[176:179], a[100:103], v[164:167]
    buffer_load_dwordx4 v24, s[8:11], s41 offen offset:3072 lds
    v_mfma_f32_16x16x32_bf16 v[168:171], a[176:179], a[104:107], v[168:171]
    s_and_b32 s68, s2, 1
    v_mfma_f32_16x16x32_bf16 v[172:175], a[176:179], a[108:111], v[172:175]
    s_lshl_b32 s68, s68, 2
    v_mfma_f32_16x16x32_bf16 v[176:179], a[176:179], a[112:115], v[176:179]
    s_add_u32 s41, s40, 0x10000
    v_mfma_f32_16x16x32_bf16 v[180:183], a[176:179], a[116:119], v[180:183]
    s_lshr_b32 s53, s2, 6
    v_mfma_f32_16x16x32_bf16 v[184:187], a[176:179], a[120:123], v[184:187]
    s_add_u32 s69, s68, s53
    v_mfma_f32_16x16x32_bf16 v[188:191], a[176:179], a[124:127], v[188:191]
    s_lshl_b32 s68, s69, 8
    s_waitcnt vmcnt(18) lgkmcnt(0)
    s_barrier
    v_mfma_f32_16x16x32_bf16 v[192:195], a[180:183], a[96:99], v[192:195]
    ds_read_b64_tr_b16 a[160:161], v7 offset:20480
    v_mfma_f32_16x16x32_bf16 v[196:199], a[180:183], a[100:103], v[196:199]
    s_add_u32 m0, s59, 0x15000
    v_mfma_f32_16x16x32_bf16 v[200:203], a[180:183], a[104:107], v[200:203]
    ds_read_b64_tr_b16 a[162:163], v7 offset:20992
    v_mfma_f32_16x16x32_bf16 v[204:207], a[180:183], a[108:111], v[204:207]
    buffer_load_dwordx4 v13, s[12:15], s42 offen nt lds
    v_mfma_f32_16x16x32_bf16 v[208:211], a[180:183], a[112:115], v[208:211]
    ds_read_b128 a[128:131], v5 offset:32768
    v_mfma_f32_16x16x32_bf16 v[212:215], a[180:183], a[116:119], v[212:215]
    ds_read_b128 a[132:135], v5 offset:34816
    v_mfma_f32_16x16x32_bf16 v[216:219], a[180:183], a[120:123], v[216:219]
    s_lshl_b32 s70, s49, 13
    v_mfma_f32_16x16x32_bf16 v[220:223], a[180:183], a[124:127], v[220:223]
    ds_read_b128 a[136:139], v5 offset:36864
    v_mfma_f32_16x16x32_bf16 v[252:255], a[184:187], a[124:127], v[252:255]
    s_add_u32 m0, s59, 0x16000
    v_mfma_f32_16x16x32_bf16 v[248:251], a[184:187], a[120:123], v[248:251]
    ds_read_b128 a[140:143], v5 offset:38912
    v_mfma_f32_16x16x32_bf16 v[244:247], a[184:187], a[116:119], v[244:247]
    buffer_load_dwordx4 v13, s[16:19], s42 offen nt lds
    v_mfma_f32_16x16x32_bf16 v[240:243], a[184:187], a[112:115], v[240:243]
    ds_read_b128 a[144:147], v5 offset:40960
    v_mfma_f32_16x16x32_bf16 v[236:239], a[184:187], a[108:111], v[236:239]
    ds_read_b128 a[148:151], v5 offset:43008
    v_mfma_f32_16x16x32_bf16 v[232:235], a[184:187], a[104:107], v[232:235]
    s_lshl_b32 s72, s49, 3
    v_mfma_f32_16x16x32_bf16 v[228:231], a[184:187], a[100:103], v[228:231]
    ds_read_b128 a[152:155], v5 offset:45056
    v_mfma_f32_16x16x32_bf16 v[224:227], a[184:187], a[96:99], v[224:227]
    s_add_u32 m0, s59, 0x17000
    v_mfma_f32_16x16x32_bf16 a[0:3], a[188:191], a[96:99], a[0:3]
    ds_read_b128 a[156:159], v5 offset:47104
    v_mfma_f32_16x16x32_bf16 a[4:7], a[188:191], a[100:103], a[4:7]
    buffer_load_dwordx4 v13, s[20:23], s42 offen nt lds
    v_mfma_f32_16x16x32_bf16 a[8:11], a[188:191], a[104:107], a[8:11]
    ds_read_b64_tr_b16 a[164:165], v9 offset:20480
    v_mfma_f32_16x16x32_bf16 a[12:15], a[188:191], a[108:111], a[12:15]
    ds_read_b64_tr_b16 a[166:167], v9 offset:20992
    v_mfma_f32_16x16x32_bf16 a[16:19], a[188:191], a[112:115], a[16:19]
    s_bfe_u32 s67, s2, 0x10001
    v_mfma_f32_16x16x32_bf16 a[20:23], a[188:191], a[116:119], a[20:23]
    ds_read_b64_tr_b16 a[168:169], v7 offset:24576
    v_mfma_f32_16x16x32_bf16 a[24:27], a[188:191], a[120:123], a[24:27]
    s_add_u32 m0, s59, 0x18000
    v_mfma_f32_16x16x32_bf16 a[28:31], a[188:191], a[124:127], a[28:31]
    ds_read_b64_tr_b16 a[170:171], v7 offset:25088
    v_mfma_f32_16x16x32_bf16 a[60:63], a[192:195], a[124:127], a[60:63]
    s_lshl_b32 s67, s67, 3
    v_mfma_f32_16x16x32_bf16 a[56:59], a[192:195], a[120:123], a[56:59]
    ds_read_b64_tr_b16 a[172:173], v9 offset:24576
    v_mfma_f32_16x16x32_bf16 a[52:55], a[192:195], a[116:119], a[52:55]
    ds_read_b64_tr_b16 a[174:175], v9 offset:25088
    v_mfma_f32_16x16x32_bf16 a[48:51], a[192:195], a[112:115], a[48:51]
    buffer_load_dwordx4 v14, s[24:27], s43 offen nt lds
    v_mfma_f32_16x16x32_bf16 a[44:47], a[192:195], a[108:111], a[44:47]
    ds_read_b64_tr_b16 a[176:177], v7 offset:28672
    v_mfma_f32_16x16x32_bf16 a[40:43], a[192:195], a[104:107], a[40:43]
    s_add_u32 s62, s62, 1
    v_mfma_f32_16x16x32_bf16 a[36:39], a[192:195], a[100:103], a[36:39]
    ds_read_b64_tr_b16 a[178:179], v7 offset:29184
    v_mfma_f32_16x16x32_bf16 a[32:35], a[192:195], a[96:99], a[32:35]
    s_add_u32 s67, s67, s50
    v_mfma_f32_16x16x32_bf16 a[64:67], a[196:199], a[96:99], a[64:67]
    s_and_b32 s62, s62, 31
    v_mfma_f32_16x16x32_bf16 a[68:71], a[196:199], a[100:103], a[68:71]
    s_add_u32 m0, s59, 0x19000
    v_mfma_f32_16x16x32_bf16 a[72:75], a[196:199], a[104:107], a[72:75]
    v_mfma_f32_16x16x32_bf16 a[76:79], a[196:199], a[108:111], a[76:79]
    buffer_load_dwordx4 v14, s[28:31], s43 offen nt lds
    v_mfma_f32_16x16x32_bf16 a[80:83], a[196:199], a[112:115], a[80:83]
    s_mul_i32 s43, s62, 229376
    v_mfma_f32_16x16x32_bf16 a[84:87], a[196:199], a[116:119], a[84:87]
    v_mfma_f32_16x16x32_bf16 a[88:91], a[196:199], a[120:123], a[88:91]
    s_mul_i32 s42, s62, 196608
    v_mfma_f32_16x16x32_bf16 a[92:95], a[196:199], a[124:127], a[92:95]
    s_waitcnt vmcnt(10)
    buffer_store_dword v3, v31, s[44:47], s52 offen sc1
    s_waitcnt lgkmcnt(0)
    v_mfma_f32_16x16x32_bf16 v[32:35], a[128:131], a[160:163], v[32:35]
    ds_read_b64_tr_b16 a[180:181], v9 offset:28672
    v_mfma_f32_16x16x32_bf16 v[36:39], a[132:135], a[160:163], v[36:39]
    s_add_u32 m0, s59, 0x1a000
    v_mfma_f32_16x16x32_bf16 v[40:43], a[136:139], a[160:163], v[40:43]
    s_lshl_b32 s53, s67, 3
    v_mfma_f32_16x16x32_bf16 v[44:47], a[140:143], a[160:163], v[44:47]
    ds_read_b64_tr_b16 a[182:183], v9 offset:29184
    v_mfma_f32_16x16x32_bf16 v[48:51], a[144:147], a[160:163], v[48:51]
    buffer_load_dwordx4 v13, s[12:15], s42 offen nt lds
    v_mfma_f32_16x16x32_bf16 v[52:55], a[148:151], a[160:163], v[52:55]
    s_add_u32 s69, s69, s53
    v_mfma_f32_16x16x32_bf16 v[56:59], a[152:155], a[160:163], v[56:59]
    s_add_u32 m0, s59, 0x1b000
    v_mfma_f32_16x16x32_bf16 v[60:63], a[156:159], a[160:163], v[60:63]
    ds_read_b64_tr_b16 a[184:185], v7 offset:32768
    v_mfma_f32_16x16x32_bf16 v[92:95], a[156:159], a[164:167], v[92:95]
    s_and_b32 s73, s72, 8
    v_mfma_f32_16x16x32_bf16 v[88:91], a[152:155], a[164:167], v[88:91]
    buffer_load_dwordx4 v13, s[16:19], s42 offen nt lds
    v_mfma_f32_16x16x32_bf16 v[84:87], a[148:151], a[164:167], v[84:87]
    ds_read_b64_tr_b16 a[186:187], v7 offset:33280
    v_mfma_f32_16x16x32_bf16 v[80:83], a[144:147], a[164:167], v[80:83]
    s_add_u32 s71, s70, 0x18000
    v_mfma_f32_16x16x32_bf16 v[76:79], a[140:143], a[164:167], v[76:79]
    s_add_u32 m0, s59, 0x1c000
    v_mfma_f32_16x16x32_bf16 v[72:75], a[136:139], a[164:167], v[72:75]
    ds_read_b64_tr_b16 a[188:189], v7 offset:36864
    v_mfma_f32_16x16x32_bf16 v[68:71], a[132:135], a[164:167], v[68:71]
    s_lshl_b32 s76, s67, 8
    v_mfma_f32_16x16x32_bf16 v[64:67], a[128:131], a[164:167], v[64:67]
    buffer_load_dwordx4 v13, s[20:23], s42 offen nt lds
    v_mfma_f32_16x16x32_bf16 v[96:99], a[128:131], a[168:171], v[96:99]
    s_lshl_b32 s53, s69, 3
    v_mfma_f32_16x16x32_bf16 v[100:103], a[132:135], a[168:171], v[100:103]
    ds_read_b64_tr_b16 a[190:191], v7 offset:37376
    v_mfma_f32_16x16x32_bf16 v[104:107], a[136:139], a[168:171], v[104:107]
    s_add_u32 m0, s59, 0x1d000
    v_mfma_f32_16x16x32_bf16 v[108:111], a[140:143], a[168:171], v[108:111]
    s_add_u32 s53, s53, s49
    v_mfma_f32_16x16x32_bf16 v[112:115], a[144:147], a[168:171], v[112:115]
    ds_read_b64_tr_b16 a[192:193], v9 offset:32768
    v_mfma_f32_16x16x32_bf16 v[116:119], a[148:151], a[168:171], v[116:119]
    s_add_u32 s53, s53, 4
    v_mfma_f32_16x16x32_bf16 v[120:123], a[152:155], a[168:171], v[120:123]
    buffer_load_dwordx4 v14, s[24:27], s43 offen nt lds
    v_mfma_f32_16x16x32_bf16 v[124:127], a[156:159], a[168:171], v[124:127]
    ds_read_b64_tr_b16 a[194:195], v9 offset:33280
    v_mfma_f32_16x16x32_bf16 v[156:159], a[156:159], a[172:175], v[156:159]
    s_lshl_b32 s77, s53, 13
    v_mfma_f32_16x16x32_bf16 v[152:155], a[152:155], a[172:175], v[152:155]
    s_add_u32 s62, s62, 1
    v_mfma_f32_16x16x32_bf16 v[148:151], a[148:151], a[172:175], v[148:151]
    s_lshl_b32 s78, s69, 7
    v_mfma_f32_16x16x32_bf16 v[144:147], a[144:147], a[172:175], v[144:147]
    ds_read_b64_tr_b16 a[196:197], v9 offset:36864
    v_mfma_f32_16x16x32_bf16 v[140:143], a[140:143], a[172:175], v[140:143]
    s_and_b32 s62, s62, 31
    v_mfma_f32_16x16x32_bf16 v[136:139], a[136:139], a[172:175], v[136:139]
    s_lshl_b32 s53, s49, 2
    v_mfma_f32_16x16x32_bf16 v[132:135], a[132:135], a[172:175], v[132:135]
    ds_read_b64_tr_b16 a[198:199], v9 offset:37376
    v_mfma_f32_16x16x32_bf16 v[128:131], a[128:131], a[172:175], v[128:131]
    s_add_u32 m0, s59, 0x1e000
    v_mfma_f32_16x16x32_bf16 v[160:163], a[176:179], a[128:131], v[160:163]
    s_add_u32 s78, s78, s53
    v_mfma_f32_16x16x32_bf16 v[164:167], a[176:179], a[132:135], v[164:167]
    buffer_load_dwordx4 v14, s[28:31], s43 offen nt lds
    v_mfma_f32_16x16x32_bf16 v[168:171], a[176:179], a[136:139], v[168:171]
    s_add_u32 s78, s78, 0x1e6010
    v_mfma_f32_16x16x32_bf16 v[172:175], a[176:179], a[140:143], v[172:175]
    s_mul_i32 s43, s62, 229376
    v_mfma_f32_16x16x32_bf16 v[176:179], a[176:179], a[144:147], v[176:179]
    s_add_u32 s36, s6, 0x1c00000
    s_addc_u32 s37, s7, 0
    v_mfma_f32_16x16x32_bf16 v[180:183], a[176:179], a[148:151], v[180:183]
    s_mul_i32 s42, s62, 196608
    v_mfma_f32_16x16x32_bf16 v[184:187], a[176:179], a[152:155], v[184:187]
    s_and_b32 s37, s37, 0xffff
    v_mfma_f32_16x16x32_bf16 v[188:191], a[176:179], a[156:159], v[188:191]
    s_mov_b32 s38, 0x800000
    s_waitcnt vmcnt(11) lgkmcnt(0)
    s_barrier
    v_mfma_f32_16x16x32_bf16 v[192:195], a[180:183], a[128:131], v[192:195]
    ds_read_b64_tr_b16 a[160:161], v6 offset:0
    v_mfma_f32_16x16x32_bf16 v[196:199], a[180:183], a[132:135], v[196:199]
    s_add_u32 m0, s58, 0x8000
    v_mfma_f32_16x16x32_bf16 v[200:203], a[180:183], a[136:139], v[200:203]
    ds_read_b64_tr_b16 a[162:163], v6 offset:512
    v_mfma_f32_16x16x32_bf16 v[204:207], a[180:183], a[140:143], v[204:207]
    s_mov_b32 s39, 0x20000
    v_mfma_f32_16x16x32_bf16 v[208:211], a[180:183], a[144:147], v[208:211]
    ds_read_b128 a[96:99], v4 offset:0
    v_mfma_f32_16x16x32_bf16 v[212:215], a[180:183], a[148:151], v[212:215]
    ds_read_b128 a[100:103], v4 offset:2048
    v_mfma_f32_16x16x32_bf16 v[216:219], a[180:183], a[152:155], v[216:219]
    s_mov_b32 s53, 0x13121110
    v_mfma_f32_16x16x32_bf16 v[220:223], a[180:183], a[156:159], v[220:223]
    ds_read_b128 a[104:107], v4 offset:4096
    v_mfma_f32_16x16x32_bf16 v[252:255], a[184:187], a[156:159], v[252:255]
    v_writelane_b32 v18, s53, 4
    v_mfma_f32_16x16x32_bf16 v[248:251], a[184:187], a[152:155], v[248:251]
    ds_read_b128 a[108:111], v4 offset:6144
    v_mfma_f32_16x16x32_bf16 v[244:247], a[184:187], a[148:151], v[244:247]
    buffer_load_dwordx4 v21, s[8:11], s40 offen offset:0 lds
    v_mfma_f32_16x16x32_bf16 v[240:243], a[184:187], a[144:147], v[240:243]
    ds_read_b128 a[112:115], v4 offset:8192
    v_mfma_f32_16x16x32_bf16 v[236:239], a[184:187], a[140:143], v[236:239]
    ds_read_b128 a[116:119], v4 offset:10240
    v_mfma_f32_16x16x32_bf16 v[232:235], a[184:187], a[136:139], v[232:235]
    s_mov_b32 s53, 0x17161514
    v_mfma_f32_16x16x32_bf16 v[228:231], a[184:187], a[132:135], v[228:231]
    ds_read_b128 a[120:123], v4 offset:12288
    v_mfma_f32_16x16x32_bf16 v[224:227], a[184:187], a[128:131], v[224:227]
    v_writelane_b32 v18, s53, 5
    v_mfma_f32_16x16x32_bf16 a[0:3], a[188:191], a[128:131], a[0:3]
    ds_read_b128 a[124:127], v4 offset:14336
    v_mfma_f32_16x16x32_bf16 a[4:7], a[188:191], a[132:135], a[4:7]
    s_mov_b32 s53, 0x1b1a1918
    v_mfma_f32_16x16x32_bf16 a[8:11], a[188:191], a[136:139], a[8:11]
    ds_read_b64_tr_b16 a[164:165], v8 offset:0
    v_mfma_f32_16x16x32_bf16 a[12:15], a[188:191], a[140:143], a[12:15]
    ds_read_b64_tr_b16 a[166:167], v8 offset:512
    v_mfma_f32_16x16x32_bf16 a[16:19], a[188:191], a[144:147], a[16:19]
    buffer_load_dwordx4 v22, s[8:11], s40 offen offset:1024 lds
    v_mfma_f32_16x16x32_bf16 a[20:23], a[188:191], a[148:151], a[20:23]
    ds_read_b64_tr_b16 a[168:169], v6 offset:4096
    v_mfma_f32_16x16x32_bf16 a[24:27], a[188:191], a[152:155], a[24:27]
    v_writelane_b32 v18, s53, 6
    v_mfma_f32_16x16x32_bf16 a[28:31], a[188:191], a[156:159], a[28:31]
    ds_read_b64_tr_b16 a[170:171], v6 offset:4608
    v_mfma_f32_16x16x32_bf16 a[60:63], a[192:195], a[156:159], a[60:63]
    s_mov_b32 s53, 0x1f1e1d1c
    v_mfma_f32_16x16x32_bf16 a[56:59], a[192:195], a[152:155], a[56:59]
    ds_read_b64_tr_b16 a[172:173], v8 offset:4096
    v_mfma_f32_16x16x32_bf16 a[52:55], a[192:195], a[148:151], a[52:55]
    ds_read_b64_tr_b16 a[174:175], v8 offset:4608
    v_mfma_f32_16x16x32_bf16 a[48:51], a[192:195], a[144:147], a[48:51]
    v_writelane_b32 v18, s53, 7
    v_mfma_f32_16x16x32_bf16 a[44:47], a[192:195], a[140:143], a[44:47]
    ds_read_b64_tr_b16 a[176:177], v6 offset:8192
    v_mfma_f32_16x16x32_bf16 a[40:43], a[192:195], a[136:139], a[40:43]
    s_mov_b32 s53, 0x5453514f
    v_mfma_f32_16x16x32_bf16 a[36:39], a[192:195], a[132:135], a[36:39]
    ds_read_b64_tr_b16 a[178:179], v6 offset:8704
    v_mfma_f32_16x16x32_bf16 a[32:35], a[192:195], a[128:131], a[32:35]
    buffer_load_dwordx4 v23, s[8:11], s40 offen offset:2048 lds
    v_mfma_f32_16x16x32_bf16 a[64:67], a[196:199], a[128:131], a[64:67]
    v_writelane_b32 v18, s53, 8
    v_mfma_f32_16x16x32_bf16 a[68:71], a[196:199], a[132:135], a[68:71]
    s_mov_b32 s53, 0x5b595856
    v_mfma_f32_16x16x32_bf16 a[72:75], a[196:199], a[136:139], a[72:75]
    v_writelane_b32 v18, s53, 9
    v_mfma_f32_16x16x32_bf16 a[76:79], a[196:199], a[140:143], a[76:79]
    buffer_load_dwordx4 v24, s[8:11], s40 offen offset:3072 lds
    v_mfma_f32_16x16x32_bf16 a[80:83], a[196:199], a[144:147], a[80:83]
    s_mov_b32 s53, 0x62605e5d
    v_mfma_f32_16x16x32_bf16 a[84:87], a[196:199], a[148:151], a[84:87]
    v_writelane_b32 v18, s53, 10
    v_mfma_f32_16x16x32_bf16 a[88:91], a[196:199], a[152:155], a[88:91]
    s_mov_b32 s53, 0x68676563
    v_mfma_f32_16x16x32_bf16 a[92:95], a[196:199], a[156:159], a[92:95]
    v_writelane_b32 v18, s53, 11
    s_waitcnt lgkmcnt(0)
    v_mfma_f32_16x16x32_bf16 v[32:35], a[96:99], a[160:163], v[32:35]
    ds_read_b64_tr_b16 a[180:181], v8 offset:8192
    v_mfma_f32_16x16x32_bf16 v[36:39], a[100:103], a[160:163], v[36:39]
    s_add_u32 m0, s58, 0x9000
    v_mfma_f32_16x16x32_bf16 v[40:43], a[104:107], a[160:163], v[40:43]
    s_mov_b32 s53, 0x6f6d6c6a
    v_mfma_f32_16x16x32_bf16 v[44:47], a[108:111], a[160:163], v[44:47]
    ds_read_b64_tr_b16 a[182:183], v8 offset:8704
    v_mfma_f32_16x16x32_bf16 v[48:51], a[112:115], a[160:163], v[48:51]
    v_writelane_b32 v18, s53, 12
    v_mfma_f32_16x16x32_bf16 v[52:55], a[116:119], a[160:163], v[52:55]
    buffer_load_dwordx4 v21, s[8:11], s41 offen offset:0 lds
    v_mfma_f32_16x16x32_bf16 v[56:59], a[120:123], a[160:163], v[56:59]
    s_mov_b32 s79, 4
    v_mfma_f32_16x16x32_bf16 v[60:63], a[124:127], a[160:163], v[60:63]
    ds_read_b64_tr_b16 a[184:185], v6 offset:12288
    v_mfma_f32_16x16x32_bf16 v[92:95], a[124:127], a[164:167], v[92:95]
    s_lshl_b32 s66, s50, 1
    v_mfma_f32_16x16x32_bf16 v[88:91], a[120:123], a[164:167], v[88:91]
    buffer_load_dwordx4 v22, s[8:11], s41 offen offset:1024 lds
    v_mfma_f32_16x16x32_bf16 v[84:87], a[116:119], a[164:167], v[84:87]
    ds_read_b64_tr_b16 a[186:187], v6 offset:12800
    v_mfma_f32_16x16x32_bf16 v[80:83], a[112:115], a[164:167], v[80:83]
    s_add_u32 s66, s66, s54
    v_mfma_f32_16x16x32_bf16 v[76:79], a[108:111], a[164:167], v[76:79]
    s_mul_i32 s65, s66, 1179648
    v_mfma_f32_16x16x32_bf16 v[72:75], a[104:107], a[164:167], v[72:75]
    ds_read_b64_tr_b16 a[188:189], v6 offset:16384
    v_mfma_f32_16x16x32_bf16 v[68:71], a[100:103], a[164:167], v[68:71]
    s_lshl_b32 s61, s66, 12
    v_mfma_f32_16x16x32_bf16 v[64:67], a[96:99], a[164:167], v[64:67]
    s_add_u32 s63, s63, 128
    v_mfma_f32_16x16x32_bf16 v[96:99], a[96:99], a[168:171], v[96:99]
    s_add_u32 s61, s61, 0x1c0000
    v_mfma_f32_16x16x32_bf16 v[100:103], a[100:103], a[168:171], v[100:103]
    ds_read_b64_tr_b16 a[190:191], v6 offset:16896
    v_mfma_f32_16x16x32_bf16 v[104:107], a[104:107], a[168:171], v[104:107]
    s_lshl_b32 s60, s66, 9
    v_mfma_f32_16x16x32_bf16 v[108:111], a[108:111], a[168:171], v[108:111]
    s_and_b32 s63, s63, 2047
    v_mfma_f32_16x16x32_bf16 v[112:115], a[112:115], a[168:171], v[112:115]
    ds_read_b64_tr_b16 a[192:193], v8 offset:12288
    v_mfma_f32_16x16x32_bf16 v[116:119], a[116:119], a[168:171], v[116:119]
    s_add_u32 s60, s60, 0x1d0000
    v_mfma_f32_16x16x32_bf16 v[120:123], a[120:123], a[168:171], v[120:123]
    s_lshl_b32 s66, s66, 8
    v_mfma_f32_16x16x32_bf16 v[124:127], a[124:127], a[168:171], v[124:127]
    ds_read_b64_tr_b16 a[194:195], v8 offset:12800
    v_mfma_f32_16x16x32_bf16 v[156:159], a[124:127], a[172:175], v[156:159]
    buffer_load_dwordx4 v23, s[8:11], s41 offen offset:2048 lds
    v_mfma_f32_16x16x32_bf16 v[152:155], a[120:123], a[172:175], v[152:155]
    s_lshl_b32 s52, s56, 3
    v_mfma_f32_16x16x32_bf16 v[148:151], a[116:119], a[172:175], v[148:151]
    s_add_u32 s66, s66, s52
    v_mfma_f32_16x16x32_bf16 v[144:147], a[112:115], a[172:175], v[144:147]
    ds_read_b64_tr_b16 a[196:197], v8 offset:16384
    v_mfma_f32_16x16x32_bf16 v[140:143], a[108:111], a[172:175], v[140:143]
    s_lshl_b32 s52, s55, 2
    v_mfma_f32_16x16x32_bf16 v[136:139], a[104:107], a[172:175], v[136:139]
    s_add_u32 s40, s64, s63
    v_mfma_f32_16x16x32_bf16 v[132:135], a[100:103], a[172:175], v[132:135]
    ds_read_b64_tr_b16 a[198:199], v8 offset:16896
    v_mfma_f32_16x16x32_bf16 v[128:131], a[96:99], a[172:175], v[128:131]
    s_add_u32 s66, s66, s52
    v_mfma_f32_16x16x32_bf16 v[160:163], a[176:179], a[96:99], v[160:163]
    v_mfma_f32_16x16x32_bf16 v[164:167], a[176:179], a[100:103], v[164:167]
    buffer_load_dwordx4 v24, s[8:11], s41 offen offset:3072 lds
    v_mfma_f32_16x16x32_bf16 v[168:171], a[176:179], a[104:107], v[168:171]
    v_mfma_f32_16x16x32_bf16 v[172:175], a[176:179], a[108:111], v[172:175]
    v_mfma_f32_16x16x32_bf16 v[176:179], a[176:179], a[112:115], v[176:179]
    s_add_u32 s41, s40, 0x10000
    v_mfma_f32_16x16x32_bf16 v[180:183], a[176:179], a[116:119], v[180:183]
    v_mfma_f32_16x16x32_bf16 v[184:187], a[176:179], a[120:123], v[184:187]
    v_mfma_f32_16x16x32_bf16 v[188:191], a[176:179], a[124:127], v[188:191]
    s_waitcnt vmcnt(14) lgkmcnt(0)
    s_barrier
    v_mfma_f32_16x16x32_bf16 v[192:195], a[180:183], a[96:99], v[192:195]
    ds_read_b64_tr_b16 a[160:161], v6 offset:20480
    v_mfma_f32_16x16x32_bf16 v[196:199], a[180:183], a[100:103], v[196:199]
    s_add_u32 m0, s59, 0x1f000
    v_mfma_f32_16x16x32_bf16 v[200:203], a[180:183], a[104:107], v[200:203]
    ds_read_b64_tr_b16 a[162:163], v6 offset:20992
    v_mfma_f32_16x16x32_bf16 v[204:207], a[180:183], a[108:111], v[204:207]
    buffer_load_dwordx4 v13, s[12:15], s42 offen nt lds
    v_mfma_f32_16x16x32_bf16 v[208:211], a[180:183], a[112:115], v[208:211]
    ds_read_b128 a[128:131], v5 offset:0
    v_mfma_f32_16x16x32_bf16 v[212:215], a[180:183], a[116:119], v[212:215]
    ds_read_b128 a[132:135], v5 offset:2048
    v_mfma_f32_16x16x32_bf16 v[216:219], a[180:183], a[120:123], v[216:219]
    s_lshl_b32 s52, s50, 1
    v_mfma_f32_16x16x32_bf16 v[220:223], a[180:183], a[124:127], v[220:223]
    ds_read_b128 a[136:139], v5 offset:4096
    v_mfma_f32_16x16x32_bf16 v[252:255], a[184:187], a[124:127], v[252:255]
    s_add_u32 m0, s59, 0x20000
    v_mfma_f32_16x16x32_bf16 v[248:251], a[184:187], a[120:123], v[248:251]
    ds_read_b128 a[140:143], v5 offset:6144
    v_mfma_f32_16x16x32_bf16 v[244:247], a[184:187], a[116:119], v[244:247]
    buffer_load_dwordx4 v13, s[16:19], s42 offen nt lds
    v_mfma_f32_16x16x32_bf16 v[240:243], a[184:187], a[112:115], v[240:243]
    ds_read_b128 a[144:147], v5 offset:8192
    v_mfma_f32_16x16x32_bf16 v[236:239], a[184:187], a[108:111], v[236:239]
    ds_read_b128 a[148:151], v5 offset:10240
    v_mfma_f32_16x16x32_bf16 v[232:235], a[184:187], a[104:107], v[232:235]
    s_add_u32 s52, s52, s54
    v_mfma_f32_16x16x32_bf16 v[228:231], a[184:187], a[100:103], v[228:231]
    ds_read_b128 a[152:155], v5 offset:12288
    v_mfma_f32_16x16x32_bf16 v[224:227], a[184:187], a[96:99], v[224:227]
    s_add_u32 m0, s59, 0x21000
    v_mfma_f32_16x16x32_bf16 a[0:3], a[188:191], a[96:99], a[0:3]
    ds_read_b128 a[156:159], v5 offset:14336
    v_mfma_f32_16x16x32_bf16 a[4:7], a[188:191], a[100:103], a[4:7]
    buffer_load_dwordx4 v13, s[20:23], s42 offen nt lds
    v_mfma_f32_16x16x32_bf16 a[8:11], a[188:191], a[104:107], a[8:11]
    ds_read_b64_tr_b16 a[164:165], v8 offset:20480
    v_mfma_f32_16x16x32_bf16 a[12:15], a[188:191], a[108:111], a[12:15]
    ds_read_b64_tr_b16 a[166:167], v8 offset:20992
    v_mfma_f32_16x16x32_bf16 a[16:19], a[188:191], a[112:115], a[16:19]
    s_lshl_b32 s52, s52, 8
    v_mfma_f32_16x16x32_bf16 a[20:23], a[188:191], a[116:119], a[20:23]
    ds_read_b64_tr_b16 a[168:169], v6 offset:24576
    v_mfma_f32_16x16x32_bf16 a[24:27], a[188:191], a[120:123], a[24:27]
    s_add_u32 m0, s59, 0x22000
    v_mfma_f32_16x16x32_bf16 a[28:31], a[188:191], a[124:127], a[28:31]
    ds_read_b64_tr_b16 a[170:171], v6 offset:25088
    v_mfma_f32_16x16x32_bf16 a[60:63], a[192:195], a[124:127], a[60:63]
    s_add_u32 s52, s52, 0x1e0000
    v_mfma_f32_16x16x32_bf16 a[56:59], a[192:195], a[120:123], a[56:59]
    ds_read_b64_tr_b16 a[172:173], v8 offset:24576
    v_mfma_f32_16x16x32_bf16 a[52:55], a[192:195], a[116:119], a[52:55]
    ds_read_b64_tr_b16 a[174:175], v8 offset:25088
    v_mfma_f32_16x16x32_bf16 a[48:51], a[192:195], a[112:115], a[48:51]
    buffer_load_dwordx4 v14, s[24:27], s43 offen nt lds
    v_mfma_f32_16x16x32_bf16 a[44:47], a[192:195], a[108:111], a[44:47]
    ds_read_b64_tr_b16 a[176:177], v6 offset:28672
    v_mfma_f32_16x16x32_bf16 a[40:43], a[192:195], a[104:107], a[40:43]
    s_add_u32 s62, s62, 1
    v_mfma_f32_16x16x32_bf16 a[36:39], a[192:195], a[100:103], a[36:39]
    ds_read_b64_tr_b16 a[178:179], v6 offset:29184
    v_mfma_f32_16x16x32_bf16 a[32:35], a[192:195], a[96:99], a[32:35]
    v_lshlrev_b32 v25, 2, v2
    v_mfma_f32_16x16x32_bf16 a[64:67], a[196:199], a[96:99], a[64:67]
    s_and_b32 s62, s62, 31
    v_mfma_f32_16x16x32_bf16 a[68:71], a[196:199], a[100:103], a[68:71]
    s_add_u32 m0, s59, 0x23000
    v_mfma_f32_16x16x32_bf16 a[72:75], a[196:199], a[104:107], a[72:75]
    v_mfma_f32_16x16x32_bf16 a[76:79], a[196:199], a[108:111], a[76:79]
    buffer_load_dwordx4 v14, s[28:31], s43 offen nt lds
    v_mfma_f32_16x16x32_bf16 a[80:83], a[196:199], a[112:115], a[80:83]
    s_mul_i32 s43, s62, 229376
    v_mfma_f32_16x16x32_bf16 a[84:87], a[196:199], a[116:119], a[84:87]
    v_mfma_f32_16x16x32_bf16 a[88:91], a[196:199], a[120:123], a[88:91]
    s_mul_i32 s42, s62, 196608
    v_mfma_f32_16x16x32_bf16 a[92:95], a[196:199], a[124:127], a[92:95]
    buffer_load_dword v26, v25, s[44:47], s52 offen sc1
    s_waitcnt lgkmcnt(0)
    v_mfma_f32_16x16x32_bf16 v[32:35], a[128:131], a[160:163], v[32:35]
    ds_read_b64_tr_b16 a[180:181], v8 offset:28672
    v_mfma_f32_16x16x32_bf16 v[36:39], a[132:135], a[160:163], v[36:39]
    s_lshl_b32 s53, s56, 4
    v_mfma_f32_16x16x32_bf16 v[40:43], a[136:139], a[160:163], v[40:43]
    s_add_u32 s53, s53, s55
    v_mfma_f32_16x16x32_bf16 v[44:47], a[140:143], a[160:163], v[44:47]
    ds_read_b64_tr_b16 a[182:183], v8 offset:29184
    v_mfma_f32_16x16x32_bf16 v[48:51], a[144:147], a[160:163], v[48:51]
    s_lshl_b32 s53, s53, 3
    v_mfma_f32_16x16x32_bf16 v[52:55], a[148:151], a[160:163], v[52:55]
    s_add_u32 s53, s53, 0x1e1000
    v_mfma_f32_16x16x32_bf16 v[56:59], a[152:155], a[160:163], v[56:59]
    v_bfe_u32 v27, v2, 1, 3
    v_mfma_f32_16x16x32_bf16 v[60:63], a[156:159], a[160:163], v[60:63]
    ds_read_b64_tr_b16 a[184:185], v6 offset:32768
    v_mfma_f32_16x16x32_bf16 v[92:95], a[156:159], a[164:167], v[92:95]
    v_and_b32 v28, 1, v2
    v_mfma_f32_16x16x32_bf16 v[88:91], a[152:155], a[164:167], v[88:91]
    v_lshlrev_b32 v27, 4, v27
    v_mfma_f32_16x16x32_bf16 v[84:87], a[148:151], a[164:167], v[84:87]
    ds_read_b64_tr_b16 a[186:187], v6 offset:33280
    v_mfma_f32_16x16x32_bf16 v[80:83], a[144:147], a[164:167], v[80:83]
    v_lshl_add_u32 v27, v28, 2, v27
    v_mfma_f32_16x16x32_bf16 v[76:79], a[140:143], a[164:167], v[76:79]
    buffer_load_dword v28, v27, s[44:47], s53 offen sc1
    v_mfma_f32_16x16x32_bf16 v[72:75], a[136:139], a[164:167], v[72:75]
    ds_read_b64_tr_b16 a[188:189], v6 offset:36864
    v_mfma_f32_16x16x32_bf16 v[68:71], a[132:135], a[164:167], v[68:71]
    s_mov_b32 s16, s80
    v_mfma_f32_16x16x32_bf16 v[64:67], a[128:131], a[164:167], v[64:67]
    s_and_b32 s17, s81, 0xffff
    v_mfma_f32_16x16x32_bf16 v[96:99], a[128:131], a[168:171], v[96:99]
    s_mov_b32 s18, 0x700000
    v_mfma_f32_16x16x32_bf16 v[100:103], a[132:135], a[168:171], v[100:103]
    ds_read_b64_tr_b16 a[190:191], v6 offset:37376
    v_mfma_f32_16x16x32_bf16 v[104:107], a[136:139], a[168:171], v[104:107]
    s_mov_b32 s19, 0x20000
    v_mfma_f32_16x16x32_bf16 v[108:111], a[140:143], a[168:171], v[108:111]
    v_lshrrev_b32 v29, 4, v2
    v_mfma_f32_16x16x32_bf16 v[112:115], a[144:147], a[168:171], v[112:115]
    ds_read_b64_tr_b16 a[192:193], v8 offset:32768
    v_mfma_f32_16x16x32_bf16 v[116:119], a[148:151], a[168:171], v[116:119]
    v_and_b32 v30, 15, v2
    v_mfma_f32_16x16x32_bf16 v[120:123], a[152:155], a[168:171], v[120:123]
    v_lshlrev_b32 v21, 1, v29
    v_mfma_f32_16x16x32_bf16 v[124:127], a[156:159], a[168:171], v[124:127]
    ds_read_b64_tr_b16 a[194:195], v8 offset:33280
    v_mfma_f32_16x16x32_bf16 v[156:159], a[156:159], a[172:175], v[156:159]
    v_xor_b32 v30, v30, v21
    v_mfma_f32_16x16x32_bf16 v[152:155], a[152:155], a[172:175], v[152:155]
    v_lshlrev_b32 v29, 11, v29
    v_mfma_f32_16x16x32_bf16 v[148:151], a[148:151], a[172:175], v[148:151]
    v_lshl_add_u32 v29, v30, 4, v29
    v_mfma_f32_16x16x32_bf16 v[144:147], a[144:147], a[172:175], v[144:147]
    ds_read_b64_tr_b16 a[196:197], v8 offset:36864
    v_mfma_f32_16x16x32_bf16 v[140:143], a[140:143], a[172:175], v[140:143]
    v_add_u32 v13, s68, v29
    v_mfma_f32_16x16x32_bf16 v[136:139], a[136:139], a[172:175], v[136:139]
    v_xor_b32 v14, 128, v13
    v_mfma_f32_16x16x32_bf16 v[132:135], a[132:135], a[172:175], v[132:135]
    ds_read_b64_tr_b16 a[198:199], v8 offset:37376
    v_mfma_f32_16x16x32_bf16 v[128:131], a[128:131], a[172:175], v[128:131]
    v_add_u32 v15, 14336, v13
    v_mfma_f32_16x16x32_bf16 v[160:163], a[176:179], a[128:131], v[160:163]
    v_add_u32 v16, 21504, v14
    v_mfma_f32_16x16x32_bf16 v[164:167], a[176:179], a[132:135], v[164:167]
    v_add_u32 v14, 7168, v14
    v_mfma_f32_16x16x32_bf16 v[168:171], a[176:179], a[136:139], v[168:171]
    s_waitcnt vmcnt(0)
    v_mfma_f32_16x16x32_bf16 v[172:175], a[176:179], a[140:143], v[172:175]
    v_cmp_ne_u32 vcc, v3, v26
    v_mfma_f32_16x16x32_bf16 v[176:179], a[176:179], a[144:147], v[176:179]
    v_mfma_f32_16x16x32_bf16 v[180:183], a[176:179], a[148:151], v[180:183]
    v_mfma_f32_16x16x32_bf16 v[184:187], a[176:179], a[152:155], v[184:187]
    v_mfma_f32_16x16x32_bf16 v[188:191], a[176:179], a[156:159], v[188:191]
    s_waitcnt vmcnt(0) lgkmcnt(0)
    s_barrier
    v_mfma_f32_16x16x32_bf16 v[192:195], a[180:183], a[128:131], v[192:195]
    ds_read_b64_tr_b16 a[160:161], v7 offset:0
    v_mfma_f32_16x16x32_bf16 v[196:199], a[180:183], a[132:135], v[196:199]
    s_cbranch_vccnz L_pollSTA
    L_pollSTAb:
    v_mfma_f32_16x16x32_bf16 v[200:203], a[180:183], a[136:139], v[200:203]
    ds_read_b64_tr_b16 a[162:163], v7 offset:512
    v_mfma_f32_16x16x32_bf16 v[204:207], a[180:183], a[140:143], v[204:207]
    v_cmp_ne_u32 vcc, v3, v28
    v_mfma_f32_16x16x32_bf16 v[208:211], a[180:183], a[144:147], v[208:211]
    ds_read_b128 a[96:99], v4 offset:32768
    v_mfma_f32_16x16x32_bf16 v[212:215], a[180:183], a[148:151], v[212:215]
    ds_read_b128 a[100:103], v4 offset:34816
    v_mfma_f32_16x16x32_bf16 v[216:219], a[180:183], a[152:155], v[216:219]
    v_mfma_f32_16x16x32_bf16 v[220:223], a[180:183], a[156:159], v[220:223]
    ds_read_b128 a[104:107], v4 offset:36864
    v_mfma_f32_16x16x32_bf16 v[252:255], a[184:187], a[156:159], v[252:255]
    v_mfma_f32_16x16x32_bf16 v[248:251], a[184:187], a[152:155], v[248:251]
    ds_read_b128 a[108:111], v4 offset:38912
    v_mfma_f32_16x16x32_bf16 v[244:247], a[184:187], a[148:151], v[244:247]
    v_mfma_f32_16x16x32_bf16 v[240:243], a[184:187], a[144:147], v[240:243]
    ds_read_b128 a[112:115], v4 offset:40960
    v_mfma_f32_16x16x32_bf16 v[236:239], a[184:187], a[140:143], v[236:239]
    ds_read_b128 a[116:119], v4 offset:43008
    v_mfma_f32_16x16x32_bf16 v[232:235], a[184:187], a[136:139], v[232:235]
    v_mfma_f32_16x16x32_bf16 v[228:231], a[184:187], a[132:135], v[228:231]
    ds_read_b128 a[120:123], v4 offset:45056
    v_mfma_f32_16x16x32_bf16 v[224:227], a[184:187], a[128:131], v[224:227]
    s_cbranch_vccnz L_pollCSA
    L_pollCSAb:
    v_mfma_f32_16x16x32_bf16 a[0:3], a[188:191], a[128:131], a[0:3]
    ds_read_b128 a[124:127], v4 offset:47104
    v_mfma_f32_16x16x32_bf16 a[4:7], a[188:191], a[132:135], a[4:7]
    s_lshl_b32 s52, s56, 1
    v_mfma_f32_16x16x32_bf16 a[8:11], a[188:191], a[136:139], a[8:11]
    ds_read_b64_tr_b16 a[164:165], v9 offset:0
    v_mfma_f32_16x16x32_bf16 a[12:15], a[188:191], a[140:143], a[12:15]
    ds_read_b64_tr_b16 a[166:167], v9 offset:512
    v_mfma_f32_16x16x32_bf16 a[16:19], a[188:191], a[144:147], a[16:19]
    s_add_u32 s52, s52, s55
    v_mfma_f32_16x16x32_bf16 a[20:23], a[188:191], a[148:151], a[20:23]
    ds_read_b64_tr_b16 a[168:169], v7 offset:4096
    v_mfma_f32_16x16x32_bf16 a[24:27], a[188:191], a[152:155], a[24:27]
    s_mul_i32 s52, s52, 10240
    v_mfma_f32_16x16x32_bf16 a[28:31], a[188:191], a[156:159], a[28:31]
    ds_read_b64_tr_b16 a[170:171], v7 offset:4608
    v_mfma_f32_16x16x32_bf16 a[60:63], a[192:195], a[156:159], a[60:63]
    s_add_u32 s52, s52, 0x110000
    v_mfma_f32_16x16x32_bf16 a[56:59], a[192:195], a[152:155], a[56:59]
    ds_read_b64_tr_b16 a[172:173], v9 offset:4096
    v_mfma_f32_16x16x32_bf16 a[52:55], a[192:195], a[148:151], a[52:55]
    ds_read_b64_tr_b16 a[174:175], v9 offset:4608
    v_mfma_f32_16x16x32_bf16 a[48:51], a[192:195], a[144:147], a[48:51]
    v_and_b32 v25, 15, v2
    v_mfma_f32_16x16x32_bf16 a[44:47], a[192:195], a[140:143], a[44:47]
    ds_read_b64_tr_b16 a[176:177], v7 offset:8192
    v_mfma_f32_16x16x32_bf16 a[40:43], a[192:195], a[136:139], a[40:43]
    v_and_b32 v1, 48, v2
    v_mfma_f32_16x16x32_bf16 a[36:39], a[192:195], a[132:135], a[36:39]
    ds_read_b64_tr_b16 a[178:179], v7 offset:8704
    v_mfma_f32_16x16x32_bf16 a[32:35], a[192:195], a[128:131], a[32:35]
    v_lshlrev_b32 v0, 5, v25
    v_mfma_f32_16x16x32_bf16 a[64:67], a[196:199], a[128:131], a[64:67]
    buffer_load_dwordx4 a[200:203], v12, s[44:47], s52 offen offset:0 sc1
    v_mfma_f32_16x16x32_bf16 a[68:71], a[196:199], a[132:135], a[68:71]
    s_mul_i32 s53, s67, 1179648
    v_mfma_f32_16x16x32_bf16 a[72:75], a[196:199], a[136:139], a[72:75]
    s_add_u32 s53, s53, 0x800000
    v_mfma_f32_16x16x32_bf16 a[76:79], a[196:199], a[140:143], a[76:79]
    buffer_load_dwordx4 a[204:207], v12, s[44:47], s52 offen offset:1024 sc1
    v_mfma_f32_16x16x32_bf16 a[80:83], a[196:199], a[144:147], a[80:83]
    s_add_u32 s12, s6, s53
    s_addc_u32 s13, s7, 0
    v_mfma_f32_16x16x32_bf16 a[84:87], a[196:199], a[148:151], a[84:87]
    s_and_b32 s13, s13, 0xffff
    v_mfma_f32_16x16x32_bf16 a[88:91], a[196:199], a[152:155], a[88:91]
    buffer_load_dwordx4 a[208:211], v12, s[44:47], s52 offen offset:2048 sc1
    v_mfma_f32_16x16x32_bf16 a[92:95], a[196:199], a[156:159], a[92:95]
    s_mov_b32 s14, 0x120000
    s_waitcnt lgkmcnt(0)
    v_mfma_f32_16x16x32_bf16 v[32:35], a[96:99], a[160:163], v[32:35]
    ds_read_b64_tr_b16 a[180:181], v9 offset:8192
    v_mfma_f32_16x16x32_bf16 v[36:39], a[100:103], a[160:163], v[36:39]
    buffer_load_dwordx4 a[212:215], v12, s[44:47], s52 offen offset:3072 sc1
    v_mfma_f32_16x16x32_bf16 v[40:43], a[104:107], a[160:163], v[40:43]
    s_add_u32 s52, s52, 4096
    v_mfma_f32_16x16x32_bf16 v[44:47], a[108:111], a[160:163], v[44:47]
    ds_read_b64_tr_b16 a[182:183], v9 offset:8704
    v_mfma_f32_16x16x32_bf16 v[48:51], a[112:115], a[160:163], v[48:51]
    buffer_load_dwordx4 a[216:219], v12, s[44:47], s52 offen offset:0 sc1
    v_mfma_f32_16x16x32_bf16 v[52:55], a[116:119], a[160:163], v[52:55]
    s_mov_b32 s15, 0x20000
    v_mfma_f32_16x16x32_bf16 v[56:59], a[120:123], a[160:163], v[56:59]
    s_mov_b32 s20, s74
    v_mfma_f32_16x16x32_bf16 v[60:63], a[124:127], a[160:163], v[60:63]
    ds_read_b64_tr_b16 a[184:185], v7 offset:12288
    v_mfma_f32_16x16x32_bf16 v[92:95], a[124:127], a[164:167], v[92:95]
    buffer_load_dwordx4 a[220:223], v12, s[44:47], s52 offen offset:1024 sc1
    v_mfma_f32_16x16x32_bf16 v[88:91], a[120:123], a[164:167], v[88:91]
    s_and_b32 s21, s75, 0xffff
    v_mfma_f32_16x16x32_bf16 v[84:87], a[116:119], a[164:167], v[84:87]
    ds_read_b64_tr_b16 a[186:187], v7 offset:12800
    v_mfma_f32_16x16x32_bf16 v[80:83], a[112:115], a[164:167], v[80:83]
    buffer_load_dwordx4 a[224:227], v12, s[44:47], s52 offen offset:2048 sc1
    v_mfma_f32_16x16x32_bf16 v[76:79], a[108:111], a[164:167], v[76:79]
    s_mov_b32 s22, 0x200000
    v_mfma_f32_16x16x32_bf16 v[72:75], a[104:107], a[164:167], v[72:75]
    ds_read_b64_tr_b16 a[188:189], v7 offset:16384
    v_mfma_f32_16x16x32_bf16 v[68:71], a[100:103], a[164:167], v[68:71]
    buffer_load_dwordx4 a[228:231], v12, s[44:47], s52 offen offset:3072 sc1
    v_mfma_f32_16x16x32_bf16 v[64:67], a[96:99], a[164:167], v[64:67]
    s_add_u32 s52, s52, 4096
    v_mfma_f32_16x16x32_bf16 v[96:99], a[96:99], a[168:171], v[96:99]
    s_mov_b32 s23, 0x20000
    v_mfma_f32_16x16x32_bf16 v[100:103], a[100:103], a[168:171], v[100:103]
    ds_read_b64_tr_b16 a[190:191], v7 offset:16896
    v_mfma_f32_16x16x32_bf16 v[104:107], a[104:107], a[168:171], v[104:107]
    buffer_load_dwordx4 a[232:235], v12, s[44:47], s52 offen offset:0 sc1
    v_mfma_f32_16x16x32_bf16 v[108:111], a[108:111], a[168:171], v[108:111]
    s_mov_b32 s24, s82
    v_mfma_f32_16x16x32_bf16 v[112:115], a[112:115], a[168:171], v[112:115]
    ds_read_b64_tr_b16 a[192:193], v9 offset:12288
    v_mfma_f32_16x16x32_bf16 v[116:119], a[116:119], a[168:171], v[116:119]
    buffer_load_dwordx4 a[236:239], v12, s[44:47], s52 offen offset:1024 sc1
    v_mfma_f32_16x16x32_bf16 v[120:123], a[120:123], a[168:171], v[120:123]
    s_and_b32 s25, s83, 0xffff
    v_mfma_f32_16x16x32_bf16 v[124:127], a[124:127], a[168:171], v[124:127]
    ds_read_b64_tr_b16 a[194:195], v9 offset:12800
    v_mfma_f32_16x16x32_bf16 v[156:159], a[124:127], a[172:175], v[156:159]
    buffer_load_dwordx2 a[240:241], v0, s[44:47], s61 offen offset:16 sc1
    v_mfma_f32_16x16x32_bf16 v[152:155], a[120:123], a[172:175], v[152:155]
    s_mov_b32 s26, 0x400000
    v_mfma_f32_16x16x32_bf16 v[148:151], a[116:119], a[172:175], v[148:151]
    s_mov_b32 s27, 0x20000
    v_mfma_f32_16x16x32_bf16 v[144:147], a[112:115], a[172:175], v[144:147]
    ds_read_b64_tr_b16 a[196:197], v9 offset:16384
    v_mfma_f32_16x16x32_bf16 v[140:143], a[108:111], a[172:175], v[140:143]
    buffer_load_dwordx2 a[242:243], v0, s[44:47], s61 offen offset:528 sc1
    v_mfma_f32_16x16x32_bf16 v[136:139], a[104:107], a[172:175], v[136:139]
    s_add_u32 s68, s68, 128
    v_mfma_f32_16x16x32_bf16 v[132:135], a[100:103], a[172:175], v[132:135]
    ds_read_b64_tr_b16 a[198:199], v9 offset:16896
    v_mfma_f32_16x16x32_bf16 v[128:131], a[96:99], a[172:175], v[128:131]
    buffer_load_dwordx2 a[244:245], v0, s[44:47], s61 offen offset:1040 sc1
    v_mfma_f32_16x16x32_bf16 v[160:163], a[176:179], a[96:99], v[160:163]
    v_and_b32 v30, 7, v2
    v_mfma_f32_16x16x32_bf16 v[164:167], a[176:179], a[100:103], v[164:167]
    v_xor_b32 v30, v30, v21
    v_mfma_f32_16x16x32_bf16 v[168:171], a[176:179], a[104:107], v[168:171]
    buffer_load_dwordx2 a[246:247], v0, s[44:47], s61 offen offset:1552 sc1
    v_mfma_f32_16x16x32_bf16 v[172:175], a[176:179], a[108:111], v[172:175]
    v_lshrrev_b32 v29, 3, v2
    v_mfma_f32_16x16x32_bf16 v[176:179], a[176:179], a[112:115], v[176:179]
    v_lshlrev_b32 v29, 11, v29
    v_mfma_f32_16x16x32_bf16 v[180:183], a[176:179], a[116:119], v[180:183]
    buffer_load_dwordx2 a[248:249], v0, s[44:47], s61 offen offset:2064 sc1
    v_mfma_f32_16x16x32_bf16 v[184:187], a[176:179], a[120:123], v[184:187]
    v_lshl_add_u32 v29, v30, 4, v29
    v_mfma_f32_16x16x32_bf16 v[188:191], a[176:179], a[124:127], v[188:191]
    s_lshl_b32 s53, s49, 16
    s_waitcnt vmcnt(15) lgkmcnt(0)
    s_barrier
    v_mfma_f32_16x16x32_bf16 v[192:195], a[180:183], a[96:99], v[192:195]
    ds_read_b64_tr_b16 a[160:161], v7 offset:20480
    v_mfma_f32_16x16x32_bf16 v[196:199], a[180:183], a[100:103], v[196:199]
    s_add_u32 m0, s70, 0
    v_mfma_f32_16x16x32_bf16 v[200:203], a[180:183], a[104:107], v[200:203]
    ds_read_b64_tr_b16 a[162:163], v7 offset:20992
    v_mfma_f32_16x16x32_bf16 v[204:207], a[180:183], a[108:111], v[204:207]
    s_lshr_b32 s59, 0x504d4b48, s72
    v_mfma_f32_16x16x32_bf16 v[208:211], a[180:183], a[112:115], v[208:211]
    ds_read_b128 a[128:131], v5 offset:32768
    v_mfma_f32_16x16x32_bf16 v[212:215], a[180:183], a[116:119], v[212:215]
    ds_read_b128 a[132:135], v5 offset:34816
    v_mfma_f32_16x16x32_bf16 v[216:219], a[180:183], a[120:123], v[216:219]
    buffer_load_dwordx2 a[250:251], v0, s[44:47], s61 offen offset:2576 sc1
    v_mfma_f32_16x16x32_bf16 v[220:223], a[180:183], a[124:127], v[220:223]
    ds_read_b128 a[136:139], v5 offset:36864
    v_mfma_f32_16x16x32_bf16 v[252:255], a[184:187], a[124:127], v[252:255]
    s_and_b32 s59, s59, 255
    v_mfma_f32_16x16x32_bf16 v[248:251], a[184:187], a[120:123], v[248:251]
    ds_read_b128 a[140:143], v5 offset:38912
    v_mfma_f32_16x16x32_bf16 v[244:247], a[184:187], a[116:119], v[244:247]
    s_lshl_b32 s59, s59, 16
    v_mfma_f32_16x16x32_bf16 v[240:243], a[184:187], a[112:115], v[240:243]
    ds_read_b128 a[144:147], v5 offset:40960
    v_mfma_f32_16x16x32_bf16 v[236:239], a[184:187], a[108:111], v[236:239]
    ds_read_b128 a[148:151], v5 offset:43008
    v_mfma_f32_16x16x32_bf16 v[232:235], a[184:187], a[104:107], v[232:235]
    s_add_u32 s53, s53, s68
    v_mfma_f32_16x16x32_bf16 v[228:231], a[184:187], a[100:103], v[228:231]
    ds_read_b128 a[152:155], v5 offset:45056
    v_mfma_f32_16x16x32_bf16 v[224:227], a[184:187], a[96:99], v[224:227]
    buffer_load_dwordx4 v13, s[16:19], s59 offen offset:0 lds
    v_mfma_f32_16x16x32_bf16 a[0:3], a[188:191], a[96:99], a[0:3]
    ds_read_b128 a[156:159], v5 offset:47104
    v_mfma_f32_16x16x32_bf16 a[4:7], a[188:191], a[100:103], a[4:7]
    buffer_load_dwordx4 v14, s[16:19], s59 offen offset:1024 lds
    v_mfma_f32_16x16x32_bf16 a[8:11], a[188:191], a[104:107], a[8:11]
    ds_read_b64_tr_b16 a[164:165], v9 offset:20480
    v_mfma_f32_16x16x32_bf16 a[12:15], a[188:191], a[108:111], a[12:15]
    ds_read_b64_tr_b16 a[166:167], v9 offset:20992
    v_mfma_f32_16x16x32_bf16 a[16:19], a[188:191], a[112:115], a[16:19]
    v_add_u32 v17, s53, v29
    v_mfma_f32_16x16x32_bf16 a[20:23], a[188:191], a[116:119], a[20:23]
    ds_read_b64_tr_b16 a[168:169], v7 offset:24576
    v_mfma_f32_16x16x32_bf16 a[24:27], a[188:191], a[120:123], a[24:27]
    buffer_load_dwordx4 v15, s[16:19], s59 offen offset:2048 lds
    v_mfma_f32_16x16x32_bf16 a[28:31], a[188:191], a[124:127], a[28:31]
    ds_read_b64_tr_b16 a[170:171], v7 offset:25088
    v_mfma_f32_16x16x32_bf16 a[60:63], a[192:195], a[124:127], a[60:63]
    s_lshl_b32 s53, s49, 11
    v_mfma_f32_16x16x32_bf16 a[56:59], a[192:195], a[120:123], a[56:59]
    ds_read_b64_tr_b16 a[172:173], v9 offset:24576
    v_mfma_f32_16x16x32_bf16 a[52:55], a[192:195], a[116:119], a[52:55]
    ds_read_b64_tr_b16 a[174:175], v9 offset:25088
    v_mfma_f32_16x16x32_bf16 a[48:51], a[192:195], a[112:115], a[48:51]
    buffer_load_dwordx4 v16, s[16:19], s59 offen offset:3072 lds
    v_mfma_f32_16x16x32_bf16 a[44:47], a[192:195], a[108:111], a[44:47]
    ds_read_b64_tr_b16 a[176:177], v7 offset:28672
    v_mfma_f32_16x16x32_bf16 a[40:43], a[192:195], a[104:107], a[40:43]
    s_add_u32 m0, s70, 4096
    v_mfma_f32_16x16x32_bf16 a[36:39], a[192:195], a[100:103], a[36:39]
    ds_read_b64_tr_b16 a[178:179], v7 offset:29184
    v_mfma_f32_16x16x32_bf16 a[32:35], a[192:195], a[96:99], a[32:35]
    v_add_u32 v21, s53, v12
    v_mfma_f32_16x16x32_bf16 a[64:67], a[196:199], a[96:99], a[64:67]
    s_add_u32 s59, s59, 32768
    v_mfma_f32_16x16x32_bf16 a[68:71], a[196:199], a[100:103], a[68:71]
    buffer_load_dwordx4 v13, s[16:19], s59 offen offset:0 lds
    v_mfma_f32_16x16x32_bf16 a[72:75], a[196:199], a[104:107], a[72:75]
    v_xor_b32 v22, 0x800, v21
    v_mfma_f32_16x16x32_bf16 a[76:79], a[196:199], a[108:111], a[76:79]
    buffer_load_dwordx4 v14, s[16:19], s59 offen offset:1024 lds
    v_mfma_f32_16x16x32_bf16 a[80:83], a[196:199], a[112:115], a[80:83]
    buffer_load_dwordx4 v15, s[16:19], s59 offen offset:2048 lds
    v_mfma_f32_16x16x32_bf16 a[84:87], a[196:199], a[116:119], a[84:87]
    s_mov_b32 s64, 0xfffe0000
    v_mfma_f32_16x16x32_bf16 a[88:91], a[196:199], a[120:123], a[88:91]
    buffer_load_dwordx4 v16, s[16:19], s59 offen offset:3072 lds
    v_mfma_f32_16x16x32_bf16 a[92:95], a[196:199], a[124:127], a[92:95]
    s_mov_b32 s63, 0
    s_waitcnt lgkmcnt(0)
    v_mfma_f32_16x16x32_bf16 v[32:35], a[128:131], a[160:163], v[32:35]
    ds_read_b64_tr_b16 a[180:181], v9 offset:28672
    v_mfma_f32_16x16x32_bf16 v[36:39], a[132:135], a[160:163], v[36:39]
    buffer_load_dwordx4 a[96:99], v0, s[44:47], s61 offen offset:0 sc1
    v_mfma_f32_16x16x32_bf16 v[40:43], a[136:139], a[160:163], v[40:43]
    s_mov_b32 s41, 3
    v_mfma_f32_16x16x32_bf16 v[44:47], a[140:143], a[160:163], v[44:47]
    ds_read_b64_tr_b16 a[182:183], v9 offset:29184
    v_mfma_f32_16x16x32_bf16 v[48:51], a[144:147], a[160:163], v[48:51]
    v_mfma_f32_16x16x32_bf16 v[52:55], a[148:151], a[160:163], v[52:55]
    buffer_load_dwordx4 a[100:103], v0, s[44:47], s61 offen offset:512 sc1
    v_mfma_f32_16x16x32_bf16 v[56:59], a[152:155], a[160:163], v[56:59]
    v_mfma_f32_16x16x32_bf16 v[60:63], a[156:159], a[160:163], v[60:63]
    ds_read_b64_tr_b16 a[184:185], v7 offset:32768
    v_mfma_f32_16x16x32_bf16 v[92:95], a[156:159], a[164:167], v[92:95]
    buffer_load_dwordx2 a[252:253], v0, s[44:47], s61 offen offset:3088 sc1
    v_mfma_f32_16x16x32_bf16 v[88:91], a[152:155], a[164:167], v[88:91]
    v_mfma_f32_16x16x32_bf16 v[84:87], a[148:151], a[164:167], v[84:87]
    ds_read_b64_tr_b16 a[186:187], v7 offset:33280
    v_mfma_f32_16x16x32_bf16 v[80:83], a[144:147], a[164:167], v[80:83]
    buffer_load_dwordx4 a[104:107], v0, s[44:47], s61 offen offset:1024 sc1
    v_mfma_f32_16x16x32_bf16 v[76:79], a[140:143], a[164:167], v[76:79]
    v_mfma_f32_16x16x32_bf16 v[72:75], a[136:139], a[164:167], v[72:75]
    ds_read_b64_tr_b16 a[188:189], v7 offset:36864
    v_mfma_f32_16x16x32_bf16 v[68:71], a[132:135], a[164:167], v[68:71]
    v_mfma_f32_16x16x32_bf16 v[64:67], a[128:131], a[164:167], v[64:67]
    v_mfma_f32_16x16x32_bf16 v[96:99], a[128:131], a[168:171], v[96:99]
    buffer_load_dwordx4 a[108:111], v0, s[44:47], s61 offen offset:1536 sc1
    v_mfma_f32_16x16x32_bf16 v[100:103], a[132:135], a[168:171], v[100:103]
    ds_read_b64_tr_b16 a[190:191], v7 offset:37376
    v_mfma_f32_16x16x32_bf16 v[104:107], a[136:139], a[168:171], v[104:107]
    v_mfma_f32_16x16x32_bf16 v[108:111], a[140:143], a[168:171], v[108:111]
    buffer_load_dwordx2 a[254:255], v0, s[44:47], s61 offen offset:3600 sc1
    v_mfma_f32_16x16x32_bf16 v[112:115], a[144:147], a[168:171], v[112:115]
    ds_read_b64_tr_b16 a[192:193], v9 offset:32768
    v_mfma_f32_16x16x32_bf16 v[116:119], a[148:151], a[168:171], v[116:119]
    v_mfma_f32_16x16x32_bf16 v[120:123], a[152:155], a[168:171], v[120:123]
    buffer_load_dwordx4 a[112:115], v0, s[44:47], s61 offen offset:2048 sc1
    v_mfma_f32_16x16x32_bf16 v[124:127], a[156:159], a[168:171], v[124:127]
    ds_read_b64_tr_b16 a[194:195], v9 offset:33280
    v_mfma_f32_16x16x32_bf16 v[156:159], a[156:159], a[172:175], v[156:159]
    v_mfma_f32_16x16x32_bf16 v[152:155], a[152:155], a[172:175], v[152:155]
    v_mfma_f32_16x16x32_bf16 v[148:151], a[148:151], a[172:175], v[148:151]
    buffer_load_dwordx4 a[116:119], v0, s[44:47], s61 offen offset:2560 sc1
    v_mfma_f32_16x16x32_bf16 v[144:147], a[144:147], a[172:175], v[144:147]
    ds_read_b64_tr_b16 a[196:197], v9 offset:36864
    v_mfma_f32_16x16x32_bf16 v[140:143], a[140:143], a[172:175], v[140:143]
    v_mfma_f32_16x16x32_bf16 v[136:139], a[136:139], a[172:175], v[136:139]
    v_mfma_f32_16x16x32_bf16 v[132:135], a[132:135], a[172:175], v[132:135]
    ds_read_b64_tr_b16 a[198:199], v9 offset:37376
    v_mfma_f32_16x16x32_bf16 v[128:131], a[128:131], a[172:175], v[128:131]
    v_mfma_f32_16x16x32_bf16 v[160:163], a[176:179], a[128:131], v[160:163]
    buffer_load_dwordx4 a[120:123], v0, s[44:47], s61 offen offset:3072 sc1
    v_mfma_f32_16x16x32_bf16 v[164:167], a[176:179], a[132:135], v[164:167]
    v_mfma_f32_16x16x32_bf16 v[168:171], a[176:179], a[136:139], v[168:171]
    v_mfma_f32_16x16x32_bf16 v[172:175], a[176:179], a[140:143], v[172:175]
    v_mfma_f32_16x16x32_bf16 v[176:179], a[176:179], a[144:147], v[176:179]
    buffer_load_dwordx4 a[124:127], v0, s[44:47], s61 offen offset:3584 sc1
    v_mfma_f32_16x16x32_bf16 v[180:183], a[176:179], a[148:151], v[180:183]
    v_mfma_f32_16x16x32_bf16 v[184:187], a[176:179], a[152:155], v[184:187]
    v_mfma_f32_16x16x32_bf16 v[188:191], a[176:179], a[156:159], v[188:191]
    s_waitcnt vmcnt(34) lgkmcnt(0)
    s_barrier
    v_mfma_f32_16x16x32_bf16 v[192:195], a[180:183], a[128:131], v[192:195]
    s_add_u32 m0, s70, 32768
    v_mfma_f32_16x16x32_bf16 v[196:199], a[180:183], a[132:135], v[196:199]
    v_mfma_f32_16x16x32_bf16 v[200:203], a[180:183], a[136:139], v[200:203]
    s_lshr_b32 s59, 0x5a575552, s72
    v_mfma_f32_16x16x32_bf16 v[204:207], a[180:183], a[140:143], v[204:207]
    v_mfma_f32_16x16x32_bf16 v[208:211], a[180:183], a[144:147], v[208:211]
    v_mfma_f32_16x16x32_bf16 v[212:215], a[180:183], a[148:151], v[212:215]
    s_and_b32 s59, s59, 255
    v_mfma_f32_16x16x32_bf16 v[216:219], a[180:183], a[152:155], v[216:219]
    v_mfma_f32_16x16x32_bf16 v[220:223], a[180:183], a[156:159], v[220:223]
    v_mfma_f32_16x16x32_bf16 v[252:255], a[184:187], a[156:159], v[252:255]
    s_lshl_b32 s59, s59, 16
    v_mfma_f32_16x16x32_bf16 v[248:251], a[184:187], a[152:155], v[248:251]
    v_mfma_f32_16x16x32_bf16 v[244:247], a[184:187], a[148:151], v[244:247]
    v_mfma_f32_16x16x32_bf16 v[240:243], a[184:187], a[144:147], v[240:243]
    buffer_load_dwordx4 v13, s[16:19], s59 offen offset:0 lds
    v_mfma_f32_16x16x32_bf16 v[236:239], a[184:187], a[140:143], v[236:239]
    v_mfma_f32_16x16x32_bf16 v[232:235], a[184:187], a[136:139], v[232:235]
    v_mfma_f32_16x16x32_bf16 v[228:231], a[184:187], a[132:135], v[228:231]
    buffer_load_dwordx4 v14, s[16:19], s59 offen offset:1024 lds
    v_mfma_f32_16x16x32_bf16 v[224:227], a[184:187], a[128:131], v[224:227]
    v_mfma_f32_16x16x32_bf16 a[0:3], a[188:191], a[128:131], a[0:3]
    v_mfma_f32_16x16x32_bf16 a[4:7], a[188:191], a[132:135], a[4:7]
    buffer_load_dwordx4 v15, s[16:19], s59 offen offset:2048 lds
    v_mfma_f32_16x16x32_bf16 a[8:11], a[188:191], a[136:139], a[8:11]
    v_mfma_f32_16x16x32_bf16 a[12:15], a[188:191], a[140:143], a[12:15]
    v_mfma_f32_16x16x32_bf16 a[16:19], a[188:191], a[144:147], a[16:19]
    buffer_load_dwordx4 v16, s[16:19], s59 offen offset:3072 lds
    v_mfma_f32_16x16x32_bf16 a[20:23], a[188:191], a[148:151], a[20:23]
    v_mfma_f32_16x16x32_bf16 a[24:27], a[188:191], a[152:155], a[24:27]
    s_add_u32 m0, s70, 36864
    v_mfma_f32_16x16x32_bf16 a[28:31], a[188:191], a[156:159], a[28:31]
    v_mfma_f32_16x16x32_bf16 a[60:63], a[192:195], a[156:159], a[60:63]
    v_mfma_f32_16x16x32_bf16 a[56:59], a[192:195], a[152:155], a[56:59]
    s_add_u32 s59, s59, 32768
    v_mfma_f32_16x16x32_bf16 a[52:55], a[192:195], a[148:151], a[52:55]
    v_mfma_f32_16x16x32_bf16 a[48:51], a[192:195], a[144:147], a[48:51]
    v_mfma_f32_16x16x32_bf16 a[44:47], a[192:195], a[140:143], a[44:47]
    buffer_load_dwordx4 v13, s[16:19], s59 offen offset:0 lds
    v_mfma_f32_16x16x32_bf16 a[40:43], a[192:195], a[136:139], a[40:43]
    v_mfma_f32_16x16x32_bf16 a[36:39], a[192:195], a[132:135], a[36:39]
    v_mfma_f32_16x16x32_bf16 a[32:35], a[192:195], a[128:131], a[32:35]
    buffer_load_dwordx4 v14, s[16:19], s59 offen offset:1024 lds
    v_mfma_f32_16x16x32_bf16 a[64:67], a[196:199], a[128:131], a[64:67]
    v_mfma_f32_16x16x32_bf16 a[68:71], a[196:199], a[132:135], a[68:71]
    v_mfma_f32_16x16x32_bf16 a[72:75], a[196:199], a[136:139], a[72:75]
    buffer_load_dwordx4 v15, s[16:19], s59 offen offset:2048 lds
    v_mfma_f32_16x16x32_bf16 a[76:79], a[196:199], a[140:143], a[76:79]
    v_mfma_f32_16x16x32_bf16 a[80:83], a[196:199], a[144:147], a[80:83]
    v_mfma_f32_16x16x32_bf16 a[84:87], a[196:199], a[148:151], a[84:87]
    buffer_load_dwordx4 v16, s[16:19], s59 offen offset:3072 lds
    v_mfma_f32_16x16x32_bf16 a[88:91], a[196:199], a[152:155], a[88:91]
    v_mfma_f32_16x16x32_bf16 a[92:95], a[196:199], a[156:159], a[92:95]
    s_waitcnt lgkmcnt(0)
    s_waitcnt vmcnt(8)
    v_add_u32 v23, 4096, v12
    buffer_load_dwordx4 a[128:131], v1, s[44:47], s60 offen offset:0 sc1
    buffer_load_dwordx4 a[144:147], v1, s[44:47], s60 offen offset:256 sc1
    buffer_load_dwordx4 a[132:135], v1, s[44:47], s60 offen offset:64 sc1
    buffer_load_dwordx4 a[148:151], v1, s[44:47], s60 offen offset:320 sc1
    buffer_load_dwordx4 a[136:139], v1, s[44:47], s60 offen offset:128 sc1
    buffer_load_dwordx4 a[152:155], v1, s[44:47], s60 offen offset:384 sc1
    buffer_load_dwordx4 a[140:143], v1, s[44:47], s60 offen offset:192 sc1
    buffer_load_dwordx4 a[156:159], v1, s[44:47], s60 offen offset:448 sc1
    v_mfma_f32_16x16x32_bf16 v[32:35], a[96:99], a[200:203], v[32:35]
    v_mfma_f32_16x16x32_bf16 v[64:67], a[96:99], a[204:207], v[64:67]
    v_mfma_f32_16x16x32_bf16 v[96:99], a[96:99], a[208:211], v[96:99]
    v_mfma_f32_16x16x32_bf16 v[128:131], a[96:99], a[212:215], v[128:131]
    v_mfma_f32_16x16x32_bf16 v[48:51], a[112:115], a[200:203], v[48:51]
    v_mfma_f32_16x16x32_bf16 v[80:83], a[112:115], a[204:207], v[80:83]
    v_mfma_f32_16x16x32_bf16 v[112:115], a[112:115], a[208:211], v[112:115]
    v_mfma_f32_16x16x32_bf16 v[144:147], a[112:115], a[212:215], v[144:147]
    v_mfma_f32_16x16x32_bf16 v[36:39], a[100:103], a[200:203], v[36:39]
    v_mfma_f32_16x16x32_bf16 v[68:71], a[100:103], a[204:207], v[68:71]
    v_mfma_f32_16x16x32_bf16 v[100:103], a[100:103], a[208:211], v[100:103]
    v_mfma_f32_16x16x32_bf16 v[132:135], a[100:103], a[212:215], v[132:135]
    v_mfma_f32_16x16x32_bf16 v[52:55], a[116:119], a[200:203], v[52:55]
    v_mfma_f32_16x16x32_bf16 v[84:87], a[116:119], a[204:207], v[84:87]
    v_mfma_f32_16x16x32_bf16 v[116:119], a[116:119], a[208:211], v[116:119]
    v_mfma_f32_16x16x32_bf16 v[148:151], a[116:119], a[212:215], v[148:151]
    v_mfma_f32_16x16x32_bf16 v[40:43], a[104:107], a[200:203], v[40:43]
    v_mfma_f32_16x16x32_bf16 v[72:75], a[104:107], a[204:207], v[72:75]
    v_mfma_f32_16x16x32_bf16 v[104:107], a[104:107], a[208:211], v[104:107]
    v_mfma_f32_16x16x32_bf16 v[136:139], a[104:107], a[212:215], v[136:139]
    v_mfma_f32_16x16x32_bf16 v[56:59], a[120:123], a[200:203], v[56:59]
    v_mfma_f32_16x16x32_bf16 v[88:91], a[120:123], a[204:207], v[88:91]
    v_mfma_f32_16x16x32_bf16 v[120:123], a[120:123], a[208:211], v[120:123]
    v_mfma_f32_16x16x32_bf16 v[152:155], a[120:123], a[212:215], v[152:155]
    v_mfma_f32_16x16x32_bf16 v[44:47], a[108:111], a[200:203], v[44:47]
    v_mfma_f32_16x16x32_bf16 v[76:79], a[108:111], a[204:207], v[76:79]
    v_mfma_f32_16x16x32_bf16 v[108:111], a[108:111], a[208:211], v[108:111]
    v_mfma_f32_16x16x32_bf16 v[140:143], a[108:111], a[212:215], v[140:143]
    v_mfma_f32_16x16x32_bf16 v[60:63], a[124:127], a[200:203], v[60:63]
    v_mfma_f32_16x16x32_bf16 v[92:95], a[124:127], a[204:207], v[92:95]
    v_mfma_f32_16x16x32_bf16 v[124:127], a[124:127], a[208:211], v[124:127]
    v_mfma_f32_16x16x32_bf16 v[156:159], a[124:127], a[212:215], v[156:159]
    s_lshl_b32 s58, s51, 1
    s_add_u32 s58, s58, s55
    v_mov_b32 v0, 0x3f803f80
    s_mov_b32 s60, 0x3fb8aa3b
    v_accvgpr_write_b32 a184, v0
    v_accvgpr_write_b32 a185, v0
    v_mfma_f32_16x16x32_bf16 v[224:227], a[224:227], a[96:99], v[224:227]
    v_accvgpr_write_b32 a186, v0
    v_accvgpr_write_b32 a187, v0
    s_waitcnt vmcnt(0)
    v_accvgpr_read_b32 v4, a128
    v_mfma_f32_16x16x32_bf16 a[0:3], a[228:231], a[96:99], a[0:3]
    v_accvgpr_read_b32 v5, a129
    v_accvgpr_read_b32 v6, a130
    v_accvgpr_read_b32 v7, a131
    v_mfma_f32_16x16x32_bf16 a[32:35], a[232:235], a[96:99], a[32:35]
    s_add_u32 m0, s70, 65536
    s_lshr_b32 s59, 0x64615f5c, s72
    s_and_b32 s59, s59, 255
    s_lshl_b32 s59, s59, 16
    buffer_load_dwordx4 v13, s[16:19], s59 offen offset:0 lds
    v_accvgpr_read_b32 v8, a144
    v_accvgpr_read_b32 v9, a145
    v_accvgpr_read_b32 v10, a146
    v_mfma_f32_16x16x32_bf16 a[64:67], a[236:239], a[96:99], a[64:67]
    v_accvgpr_read_b32 v11, a147
    v_pk_mul_f32 v[32:33], v[32:33], v[4:5]
    v_pk_mul_f32 v[34:35], v[34:35], v[6:7]
    v_pk_mul_f32 v[64:65], v[64:65], v[4:5]
    v_pk_mul_f32 v[66:67], v[66:67], v[6:7]
    v_pk_mul_f32 v[96:97], v[96:97], v[4:5]
    v_pk_mul_f32 v[98:99], v[98:99], v[6:7]
    v_pk_mul_f32 v[128:129], v[128:129], v[4:5]
    v_pk_mul_f32 v[130:131], v[130:131], v[6:7]
    v_pk_mul_f32 v[48:49], v[48:49], v[8:9]
    v_pk_mul_f32 v[50:51], v[50:51], v[10:11]
    v_pk_mul_f32 v[80:81], v[80:81], v[8:9]
    v_pk_mul_f32 v[82:83], v[82:83], v[10:11]
    v_pk_mul_f32 v[112:113], v[112:113], v[8:9]
    v_pk_mul_f32 v[114:115], v[114:115], v[10:11]
    v_pk_mul_f32 v[144:145], v[144:145], v[8:9]
    v_pk_mul_f32 v[146:147], v[146:147], v[10:11]
    v_cvt_pk_bf16_f32 v96, v96, v97
    v_cvt_pk_bf16_f32 v97, v98, v99
    v_mfma_f32_16x16x32_bf16 v[228:231], a[224:227], a[100:103], v[228:231]
    v_cvt_pk_bf16_f32 v98, v112, v113
    v_cvt_pk_bf16_f32 v99, v114, v115
    v_cvt_pk_bf16_f32 v128, v128, v129
    v_mfma_f32_16x16x32_bf16 a[4:7], a[228:231], a[100:103], a[4:7]
    buffer_load_dwordx4 v14, s[16:19], s59 offen offset:1024 lds
    v_cvt_pk_bf16_f32 v129, v130, v131
    v_cvt_pk_bf16_f32 v130, v144, v145
    v_cvt_pk_bf16_f32 v131, v146, v147
    v_mfma_f32_16x16x32_bf16 a[36:39], a[232:235], a[100:103], a[36:39]
    v_pk_mul_f32 v[4:5], v[32:33], s[60:61] op_sel_hi:[1,0]
    v_pk_mul_f32 v[6:7], v[34:35], s[60:61] op_sel_hi:[1,0]
    v_pk_mul_f32 v[8:9], v[48:49], s[60:61] op_sel_hi:[1,0]
    v_pk_mul_f32 v[10:11], v[50:51], s[60:61] op_sel_hi:[1,0]
    v_exp_f32 v4, v4 clamp
    v_exp_f32 v5, v5 clamp
    v_mfma_f32_16x16x32_bf16 a[68:71], a[236:239], a[100:103], a[68:71]
    v_exp_f32 v6, v6 clamp
    v_exp_f32 v7, v7 clamp
    v_exp_f32 v8, v8 clamp
    v_mfma_f32_16x16x32_bf16 v[232:235], a[224:227], a[104:107], v[232:235]
    buffer_load_dwordx4 v15, s[16:19], s59 offen offset:2048 lds
    v_exp_f32 v9, v9 clamp
    v_exp_f32 v10, v10 clamp
    v_exp_f32 v11, v11 clamp
    v_mfma_f32_16x16x32_bf16 a[8:11], a[228:231], a[104:107], a[8:11]
    v_max_f32 v32, 0x358637bd, v32
    v_max_f32 v33, 0x358637bd, v33
    v_max_f32 v34, 0x358637bd, v34
    v_mfma_f32_16x16x32_bf16 a[40:43], a[232:235], a[104:107], a[40:43]
    v_max_f32 v35, 0x358637bd, v35
    v_max_f32 v48, 0x358637bd, v48
    v_max_f32 v49, 0x358637bd, v49
    v_mfma_f32_16x16x32_bf16 a[72:75], a[236:239], a[104:107], a[72:75]
    buffer_load_dwordx4 v16, s[16:19], s59 offen offset:3072 lds
    v_max_f32 v50, 0x358637bd, v50
    v_max_f32 v51, 0x358637bd, v51
    v_pk_add_f32 v[32:33], v[32:33], v[4:5]
    v_pk_add_f32 v[34:35], v[34:35], v[6:7]
    v_pk_add_f32 v[48:49], v[48:49], v[8:9]
    v_pk_add_f32 v[50:51], v[50:51], v[10:11]
    v_cvt_pk_bf16_f32 v32, v32, v33
    v_cvt_pk_bf16_f32 v33, v34, v35
    v_mfma_f32_16x16x32_bf16 v[236:239], a[224:227], a[108:111], v[236:239]
    v_cvt_pk_bf16_f32 v34, v48, v49
    v_cvt_pk_bf16_f32 v35, v50, v51
    v_pk_mul_f32 v[4:5], v[64:65], s[60:61] op_sel_hi:[1,0]
    v_pk_mul_f32 v[6:7], v[66:67], s[60:61] op_sel_hi:[1,0]
    v_pk_mul_f32 v[8:9], v[80:81], s[60:61] op_sel_hi:[1,0]
    v_pk_mul_f32 v[10:11], v[82:83], s[60:61] op_sel_hi:[1,0]
    v_exp_f32 v4, v4 clamp
    v_exp_f32 v5, v5 clamp
    v_mfma_f32_16x16x32_bf16 a[12:15], a[228:231], a[108:111], a[12:15]
    v_exp_f32 v6, v6 clamp
    v_exp_f32 v7, v7 clamp
    v_exp_f32 v8, v8 clamp
    v_mfma_f32_16x16x32_bf16 a[44:47], a[232:235], a[108:111], a[44:47]
    s_add_u32 m0, s70, 69632
    s_add_u32 s59, s59, 32768
    buffer_load_dwordx4 v13, s[16:19], s59 offen offset:0 lds
    v_exp_f32 v9, v9 clamp
    v_exp_f32 v10, v10 clamp
    v_exp_f32 v11, v11 clamp
    v_mfma_f32_16x16x32_bf16 a[76:79], a[236:239], a[108:111], a[76:79]
    v_max_f32 v64, 0x358637bd, v64
    v_max_f32 v65, 0x358637bd, v65
    v_max_f32 v66, 0x358637bd, v66
    v_mfma_f32_16x16x32_bf16 v[240:243], a[224:227], a[112:115], v[240:243]
    v_max_f32 v67, 0x358637bd, v67
    v_max_f32 v80, 0x358637bd, v80
    v_max_f32 v81, 0x358637bd, v81
    v_mfma_f32_16x16x32_bf16 a[16:19], a[228:231], a[112:115], a[16:19]
    buffer_load_dwordx4 v14, s[16:19], s59 offen offset:1024 lds
    v_max_f32 v82, 0x358637bd, v82
    v_max_f32 v83, 0x358637bd, v83
    v_pk_add_f32 v[64:65], v[64:65], v[4:5]
    v_pk_add_f32 v[66:67], v[66:67], v[6:7]
    v_pk_add_f32 v[80:81], v[80:81], v[8:9]
    v_pk_add_f32 v[82:83], v[82:83], v[10:11]
    v_cvt_pk_bf16_f32 v64, v64, v65
    v_cvt_pk_bf16_f32 v65, v66, v67
    v_mfma_f32_16x16x32_bf16 a[48:51], a[232:235], a[112:115], a[48:51]
    v_cvt_pk_bf16_f32 v66, v80, v81
    v_cvt_pk_bf16_f32 v67, v82, v83
    s_nop 1
    v_mfma_f32_16x16x32_bf16 a[160:163], v[32:35], v[96:99], 0
    v_mfma_f32_16x16x32_bf16 a[80:83], a[236:239], a[112:115], a[80:83]
    v_mfma_f32_16x16x32_bf16 a[168:171], v[32:35], v[128:131], 0
    v_mfma_f32_16x16x32_bf16 a[176:179], v[32:35], a[184:187], 0
    v_mfma_f32_16x16x32_bf16 a[164:167], v[64:67], v[96:99], 0
    v_mfma_f32_16x16x32_bf16 v[244:247], a[224:227], a[116:119], v[244:247]
    buffer_load_dwordx4 v15, s[16:19], s59 offen offset:2048 lds
    v_mfma_f32_16x16x32_bf16 a[172:175], v[64:67], v[128:131], 0
    v_mfma_f32_16x16x32_bf16 a[180:183], v[64:67], a[184:187], 0
    v_accvgpr_read_b32 v4, a132
    v_mfma_f32_16x16x32_bf16 a[20:23], a[228:231], a[116:119], a[20:23]
    v_accvgpr_read_b32 v5, a133
    v_accvgpr_read_b32 v6, a134
    v_accvgpr_read_b32 v7, a135
    v_mfma_f32_16x16x32_bf16 a[52:55], a[232:235], a[116:119], a[52:55]
    v_accvgpr_read_b32 v8, a148
    v_accvgpr_read_b32 v9, a149
    v_accvgpr_read_b32 v10, a150
    v_mfma_f32_16x16x32_bf16 a[84:87], a[236:239], a[116:119], a[84:87]
    buffer_load_dwordx4 v16, s[16:19], s59 offen offset:3072 lds
    v_accvgpr_read_b32 v11, a151
    v_pk_mul_f32 v[36:37], v[36:37], v[4:5]
    v_pk_mul_f32 v[38:39], v[38:39], v[6:7]
    v_pk_mul_f32 v[68:69], v[68:69], v[4:5]
    v_pk_mul_f32 v[70:71], v[70:71], v[6:7]
    v_pk_mul_f32 v[100:101], v[100:101], v[4:5]
    v_pk_mul_f32 v[102:103], v[102:103], v[6:7]
    v_pk_mul_f32 v[132:133], v[132:133], v[4:5]
    v_pk_mul_f32 v[134:135], v[134:135], v[6:7]
    v_pk_mul_f32 v[52:53], v[52:53], v[8:9]
    v_pk_mul_f32 v[54:55], v[54:55], v[10:11]
    v_pk_mul_f32 v[84:85], v[84:85], v[8:9]
    v_pk_mul_f32 v[86:87], v[86:87], v[10:11]
    v_pk_mul_f32 v[116:117], v[116:117], v[8:9]
    v_pk_mul_f32 v[118:119], v[118:119], v[10:11]
    v_pk_mul_f32 v[148:149], v[148:149], v[8:9]
    v_pk_mul_f32 v[150:151], v[150:151], v[10:11]
    v_cvt_pk_bf16_f32 v100, v100, v101
    v_cvt_pk_bf16_f32 v101, v102, v103
    v_mfma_f32_16x16x32_bf16 v[248:251], a[224:227], a[120:123], v[248:251]
    v_cvt_pk_bf16_f32 v102, v116, v117
    v_cvt_pk_bf16_f32 v103, v118, v119
    v_cvt_pk_bf16_f32 v132, v132, v133
    v_mfma_f32_16x16x32_bf16 a[24:27], a[228:231], a[120:123], a[24:27]
    v_cvt_pk_bf16_f32 v133, v134, v135
    v_cvt_pk_bf16_f32 v134, v148, v149
    v_cvt_pk_bf16_f32 v135, v150, v151
    v_mfma_f32_16x16x32_bf16 a[56:59], a[232:235], a[120:123], a[56:59]
    s_add_u32 m0, s70, 98304
    s_lshr_b32 s59, 0x6e6b6966, s72
    s_and_b32 s59, s59, 255
    s_lshl_b32 s59, s59, 16
    buffer_load_dwordx4 v13, s[16:19], s59 offen offset:0 lds
    v_pk_mul_f32 v[4:5], v[36:37], s[60:61] op_sel_hi:[1,0]
    v_pk_mul_f32 v[6:7], v[38:39], s[60:61] op_sel_hi:[1,0]
    v_pk_mul_f32 v[8:9], v[52:53], s[60:61] op_sel_hi:[1,0]
    v_pk_mul_f32 v[10:11], v[54:55], s[60:61] op_sel_hi:[1,0]
    v_exp_f32 v4, v4 clamp
    v_exp_f32 v5, v5 clamp
    v_mfma_f32_16x16x32_bf16 a[88:91], a[236:239], a[120:123], a[88:91]
    v_exp_f32 v6, v6 clamp
    v_exp_f32 v7, v7 clamp
    v_exp_f32 v8, v8 clamp
    v_mfma_f32_16x16x32_bf16 v[252:255], a[224:227], a[124:127], v[252:255]
    v_exp_f32 v9, v9 clamp
    v_exp_f32 v10, v10 clamp
    v_exp_f32 v11, v11 clamp
    v_mfma_f32_16x16x32_bf16 a[28:31], a[228:231], a[124:127], a[28:31]
    buffer_load_dwordx4 v14, s[16:19], s59 offen offset:1024 lds
    v_max_f32 v36, 0x358637bd, v36
    v_max_f32 v37, 0x358637bd, v37
    v_max_f32 v38, 0x358637bd, v38
    v_mfma_f32_16x16x32_bf16 a[60:63], a[232:235], a[124:127], a[60:63]
    v_max_f32 v39, 0x358637bd, v39
    v_max_f32 v52, 0x358637bd, v52
    v_max_f32 v53, 0x358637bd, v53
    v_mfma_f32_16x16x32_bf16 a[92:95], a[236:239], a[124:127], a[92:95]
    v_max_f32 v54, 0x358637bd, v54
    v_max_f32 v55, 0x358637bd, v55
    v_pk_add_f32 v[36:37], v[36:37], v[4:5]
    v_pk_add_f32 v[38:39], v[38:39], v[6:7]
    v_pk_add_f32 v[52:53], v[52:53], v[8:9]
    v_pk_add_f32 v[54:55], v[54:55], v[10:11]
    v_cvt_pk_bf16_f32 v36, v36, v37
    v_cvt_pk_bf16_f32 v37, v38, v39
    v_mfma_f32_16x16x32_bf16 v[160:163], a[216:219], a[96:99], v[160:163]
    buffer_load_dwordx4 v15, s[16:19], s59 offen offset:2048 lds
    v_cvt_pk_bf16_f32 v38, v52, v53
    v_cvt_pk_bf16_f32 v39, v54, v55
    v_pk_mul_f32 v[4:5], v[68:69], s[60:61] op_sel_hi:[1,0]
    v_pk_mul_f32 v[6:7], v[70:71], s[60:61] op_sel_hi:[1,0]
    v_pk_mul_f32 v[8:9], v[84:85], s[60:61] op_sel_hi:[1,0]
    v_pk_mul_f32 v[10:11], v[86:87], s[60:61] op_sel_hi:[1,0]
    v_exp_f32 v4, v4 clamp
    v_exp_f32 v5, v5 clamp
    v_mfma_f32_16x16x32_bf16 v[192:195], a[220:223], a[96:99], v[192:195]
    v_exp_f32 v6, v6 clamp
    v_exp_f32 v7, v7 clamp
    v_exp_f32 v8, v8 clamp
    v_mfma_f32_16x16x32_bf16 v[164:167], a[216:219], a[100:103], v[164:167]
    v_exp_f32 v9, v9 clamp
    v_exp_f32 v10, v10 clamp
    v_exp_f32 v11, v11 clamp
    v_mfma_f32_16x16x32_bf16 v[196:199], a[220:223], a[100:103], v[196:199]
    buffer_load_dwordx4 v16, s[16:19], s59 offen offset:3072 lds
    v_max_f32 v68, 0x358637bd, v68
    v_max_f32 v69, 0x358637bd, v69
    v_max_f32 v70, 0x358637bd, v70
    v_mfma_f32_16x16x32_bf16 v[168:171], a[216:219], a[104:107], v[168:171]
    v_max_f32 v71, 0x358637bd, v71
    v_max_f32 v84, 0x358637bd, v84
    v_max_f32 v85, 0x358637bd, v85
    v_mfma_f32_16x16x32_bf16 v[200:203], a[220:223], a[104:107], v[200:203]
    v_max_f32 v86, 0x358637bd, v86
    v_max_f32 v87, 0x358637bd, v87
    v_pk_add_f32 v[68:69], v[68:69], v[4:5]
    v_pk_add_f32 v[70:71], v[70:71], v[6:7]
    v_pk_add_f32 v[84:85], v[84:85], v[8:9]
    v_pk_add_f32 v[86:87], v[86:87], v[10:11]
    v_cvt_pk_bf16_f32 v68, v68, v69
    v_cvt_pk_bf16_f32 v69, v70, v71
    v_mfma_f32_16x16x32_bf16 v[172:175], a[216:219], a[108:111], v[172:175]
    s_add_u32 m0, s70, 102400
    s_add_u32 s59, s59, 32768
    buffer_load_dwordx4 v13, s[16:19], s59 offen offset:0 lds
    v_cvt_pk_bf16_f32 v70, v84, v85
    v_cvt_pk_bf16_f32 v71, v86, v87
    s_nop 1
    v_mfma_f32_16x16x32_bf16 a[160:163], v[36:39], v[100:103], a[160:163]
    v_mfma_f32_16x16x32_bf16 v[204:207], a[220:223], a[108:111], v[204:207]
    v_mfma_f32_16x16x32_bf16 a[168:171], v[36:39], v[132:135], a[168:171]
    v_mfma_f32_16x16x32_bf16 a[176:179], v[36:39], a[184:187], a[176:179]
    v_mfma_f32_16x16x32_bf16 a[164:167], v[68:71], v[100:103], a[164:167]
    v_mfma_f32_16x16x32_bf16 v[176:179], a[216:219], a[112:115], v[176:179]
    v_mfma_f32_16x16x32_bf16 a[172:175], v[68:71], v[132:135], a[172:175]
    v_mfma_f32_16x16x32_bf16 a[180:183], v[68:71], a[184:187], a[180:183]
    v_accvgpr_read_b32 v4, a136
    v_mfma_f32_16x16x32_bf16 v[208:211], a[220:223], a[112:115], v[208:211]
    buffer_load_dwordx4 v14, s[16:19], s59 offen offset:1024 lds
    v_accvgpr_read_b32 v5, a137
    v_accvgpr_read_b32 v6, a138
    v_accvgpr_read_b32 v7, a139
    v_mfma_f32_16x16x32_bf16 v[180:183], a[216:219], a[116:119], v[180:183]
    v_accvgpr_read_b32 v8, a152
    v_accvgpr_read_b32 v9, a153
    v_accvgpr_read_b32 v10, a154
    v_mfma_f32_16x16x32_bf16 v[212:215], a[220:223], a[116:119], v[212:215]
    v_accvgpr_read_b32 v11, a155
    v_pk_mul_f32 v[40:41], v[40:41], v[4:5]
    v_pk_mul_f32 v[42:43], v[42:43], v[6:7]
    v_pk_mul_f32 v[72:73], v[72:73], v[4:5]
    v_pk_mul_f32 v[74:75], v[74:75], v[6:7]
    v_pk_mul_f32 v[104:105], v[104:105], v[4:5]
    v_pk_mul_f32 v[106:107], v[106:107], v[6:7]
    v_pk_mul_f32 v[136:137], v[136:137], v[4:5]
    v_pk_mul_f32 v[138:139], v[138:139], v[6:7]
    v_pk_mul_f32 v[56:57], v[56:57], v[8:9]
    v_pk_mul_f32 v[58:59], v[58:59], v[10:11]
    v_pk_mul_f32 v[88:89], v[88:89], v[8:9]
    v_pk_mul_f32 v[90:91], v[90:91], v[10:11]
    v_pk_mul_f32 v[120:121], v[120:121], v[8:9]
    v_pk_mul_f32 v[122:123], v[122:123], v[10:11]
    v_pk_mul_f32 v[152:153], v[152:153], v[8:9]
    v_pk_mul_f32 v[154:155], v[154:155], v[10:11]
    v_cvt_pk_bf16_f32 v104, v104, v105
    v_cvt_pk_bf16_f32 v105, v106, v107
    v_mfma_f32_16x16x32_bf16 v[184:187], a[216:219], a[120:123], v[184:187]
    buffer_load_dwordx4 v15, s[16:19], s59 offen offset:2048 lds
    v_cvt_pk_bf16_f32 v106, v120, v121
    v_cvt_pk_bf16_f32 v107, v122, v123
    v_cvt_pk_bf16_f32 v136, v136, v137
    v_mfma_f32_16x16x32_bf16 v[216:219], a[220:223], a[120:123], v[216:219]
    v_cvt_pk_bf16_f32 v137, v138, v139
    v_cvt_pk_bf16_f32 v138, v152, v153
    v_cvt_pk_bf16_f32 v139, v154, v155
    v_mfma_f32_16x16x32_bf16 v[188:191], a[216:219], a[124:127], v[188:191]
    v_pk_mul_f32 v[4:5], v[40:41], s[60:61] op_sel_hi:[1,0]
    v_pk_mul_f32 v[6:7], v[42:43], s[60:61] op_sel_hi:[1,0]
    v_pk_mul_f32 v[8:9], v[56:57], s[60:61] op_sel_hi:[1,0]
    v_pk_mul_f32 v[10:11], v[58:59], s[60:61] op_sel_hi:[1,0]
    v_exp_f32 v4, v4 clamp
    v_exp_f32 v5, v5 clamp
    v_mfma_f32_16x16x32_bf16 v[220:223], a[220:223], a[124:127], v[220:223]
    buffer_load_dwordx4 v16, s[16:19], s59 offen offset:3072 lds
    v_exp_f32 v6, v6 clamp
    v_exp_f32 v7, v7 clamp
    v_exp_f32 v8, v8 clamp
    v_exp_f32 v9, v9 clamp
    v_exp_f32 v10, v10 clamp
    v_exp_f32 v11, v11 clamp
    v_max_f32 v40, 0x358637bd, v40
    v_max_f32 v41, 0x358637bd, v41
    v_max_f32 v42, 0x358637bd, v42
    v_max_f32 v43, 0x358637bd, v43
    v_max_f32 v56, 0x358637bd, v56
    v_max_f32 v57, 0x358637bd, v57
    v_max_f32 v58, 0x358637bd, v58
    v_max_f32 v59, 0x358637bd, v59
    v_pk_add_f32 v[40:41], v[40:41], v[4:5]
    v_pk_add_f32 v[42:43], v[42:43], v[6:7]
    v_pk_add_f32 v[56:57], v[56:57], v[8:9]
    v_pk_add_f32 v[58:59], v[58:59], v[10:11]
    v_cvt_pk_bf16_f32 v40, v40, v41
    v_cvt_pk_bf16_f32 v41, v42, v43
    v_cvt_pk_bf16_f32 v42, v56, v57
    v_cvt_pk_bf16_f32 v43, v58, v59
    v_pk_mul_f32 v[4:5], v[72:73], s[60:61] op_sel_hi:[1,0]
    v_pk_mul_f32 v[6:7], v[74:75], s[60:61] op_sel_hi:[1,0]
    v_pk_mul_f32 v[8:9], v[88:89], s[60:61] op_sel_hi:[1,0]
    v_pk_mul_f32 v[10:11], v[90:91], s[60:61] op_sel_hi:[1,0]
    v_exp_f32 v4, v4 clamp
    v_exp_f32 v5, v5 clamp
    v_exp_f32 v6, v6 clamp
    v_exp_f32 v7, v7 clamp
    v_exp_f32 v8, v8 clamp
    v_exp_f32 v9, v9 clamp
    v_exp_f32 v10, v10 clamp
    v_exp_f32 v11, v11 clamp
    v_max_f32 v72, 0x358637bd, v72
    v_max_f32 v73, 0x358637bd, v73
    v_max_f32 v74, 0x358637bd, v74
    v_max_f32 v75, 0x358637bd, v75
    v_max_f32 v88, 0x358637bd, v88
    v_max_f32 v89, 0x358637bd, v89
    v_max_f32 v90, 0x358637bd, v90
    v_max_f32 v91, 0x358637bd, v91
    v_pk_add_f32 v[72:73], v[72:73], v[4:5]
    v_pk_add_f32 v[74:75], v[74:75], v[6:7]
    v_pk_add_f32 v[88:89], v[88:89], v[8:9]
    v_pk_add_f32 v[90:91], v[90:91], v[10:11]
    v_cvt_pk_bf16_f32 v72, v72, v73
    v_cvt_pk_bf16_f32 v73, v74, v75
    v_cvt_pk_bf16_f32 v74, v88, v89
    v_cvt_pk_bf16_f32 v75, v90, v91
    s_nop 1
    v_mfma_f32_16x16x32_bf16 a[160:163], v[40:43], v[104:107], a[160:163]
    v_mfma_f32_16x16x32_bf16 a[168:171], v[40:43], v[136:139], a[168:171]
    v_mfma_f32_16x16x32_bf16 a[176:179], v[40:43], a[184:187], a[176:179]
    v_mfma_f32_16x16x32_bf16 a[164:167], v[72:75], v[104:107], a[164:167]
    v_mfma_f32_16x16x32_bf16 a[172:175], v[72:75], v[136:139], a[172:175]
    v_mfma_f32_16x16x32_bf16 a[180:183], v[72:75], a[184:187], a[180:183]
    v_accvgpr_read_b32 v4, a140
    v_accvgpr_read_b32 v5, a141
    v_accvgpr_read_b32 v6, a142
    v_accvgpr_read_b32 v7, a143
    v_accvgpr_read_b32 v8, a156
    v_accvgpr_read_b32 v9, a157
    v_accvgpr_read_b32 v10, a158
    v_accvgpr_read_b32 v11, a159
    v_pk_mul_f32 v[44:45], v[44:45], v[4:5]
    v_pk_mul_f32 v[46:47], v[46:47], v[6:7]
    v_pk_mul_f32 v[76:77], v[76:77], v[4:5]
    v_pk_mul_f32 v[78:79], v[78:79], v[6:7]
    v_pk_mul_f32 v[108:109], v[108:109], v[4:5]
    v_pk_mul_f32 v[110:111], v[110:111], v[6:7]
    v_pk_mul_f32 v[140:141], v[140:141], v[4:5]
    v_pk_mul_f32 v[142:143], v[142:143], v[6:7]
    v_pk_mul_f32 v[60:61], v[60:61], v[8:9]
    v_pk_mul_f32 v[62:63], v[62:63], v[10:11]
    v_pk_mul_f32 v[92:93], v[92:93], v[8:9]
    v_pk_mul_f32 v[94:95], v[94:95], v[10:11]
    v_pk_mul_f32 v[124:125], v[124:125], v[8:9]
    v_pk_mul_f32 v[126:127], v[126:127], v[10:11]
    v_pk_mul_f32 v[156:157], v[156:157], v[8:9]
    v_pk_mul_f32 v[158:159], v[158:159], v[10:11]
    v_cvt_pk_bf16_f32 v108, v108, v109
    v_cvt_pk_bf16_f32 v109, v110, v111
    v_cvt_pk_bf16_f32 v110, v124, v125
    v_cvt_pk_bf16_f32 v111, v126, v127
    v_cvt_pk_bf16_f32 v140, v140, v141
    v_cvt_pk_bf16_f32 v141, v142, v143
    v_cvt_pk_bf16_f32 v142, v156, v157
    v_cvt_pk_bf16_f32 v143, v158, v159
    v_pk_mul_f32 v[4:5], v[44:45], s[60:61] op_sel_hi:[1,0]
    v_pk_mul_f32 v[6:7], v[46:47], s[60:61] op_sel_hi:[1,0]
    v_pk_mul_f32 v[8:9], v[60:61], s[60:61] op_sel_hi:[1,0]
    v_pk_mul_f32 v[10:11], v[62:63], s[60:61] op_sel_hi:[1,0]
    v_exp_f32 v4, v4 clamp
    v_exp_f32 v5, v5 clamp
    v_exp_f32 v6, v6 clamp
    v_exp_f32 v7, v7 clamp
    v_exp_f32 v8, v8 clamp
    v_exp_f32 v9, v9 clamp
    v_exp_f32 v10, v10 clamp
    v_exp_f32 v11, v11 clamp
    v_max_f32 v44, 0x358637bd, v44
    v_max_f32 v45, 0x358637bd, v45
    v_max_f32 v46, 0x358637bd, v46
    v_max_f32 v47, 0x358637bd, v47
    v_max_f32 v60, 0x358637bd, v60
    v_max_f32 v61, 0x358637bd, v61
    v_max_f32 v62, 0x358637bd, v62
    v_max_f32 v63, 0x358637bd, v63
    v_pk_add_f32 v[44:45], v[44:45], v[4:5]
    v_pk_add_f32 v[46:47], v[46:47], v[6:7]
    v_pk_add_f32 v[60:61], v[60:61], v[8:9]
    v_pk_add_f32 v[62:63], v[62:63], v[10:11]
    v_cvt_pk_bf16_f32 v44, v44, v45
    v_cvt_pk_bf16_f32 v45, v46, v47
    v_cvt_pk_bf16_f32 v46, v60, v61
    v_cvt_pk_bf16_f32 v47, v62, v63
    v_pk_mul_f32 v[4:5], v[76:77], s[60:61] op_sel_hi:[1,0]
    v_pk_mul_f32 v[6:7], v[78:79], s[60:61] op_sel_hi:[1,0]
    v_pk_mul_f32 v[8:9], v[92:93], s[60:61] op_sel_hi:[1,0]
    v_pk_mul_f32 v[10:11], v[94:95], s[60:61] op_sel_hi:[1,0]
    v_exp_f32 v4, v4 clamp
    v_exp_f32 v5, v5 clamp
    v_exp_f32 v6, v6 clamp
    v_exp_f32 v7, v7 clamp
    v_exp_f32 v8, v8 clamp
    v_exp_f32 v9, v9 clamp
    v_exp_f32 v10, v10 clamp
    v_exp_f32 v11, v11 clamp
    v_max_f32 v76, 0x358637bd, v76
    v_max_f32 v77, 0x358637bd, v77
    v_max_f32 v78, 0x358637bd, v78
    v_max_f32 v79, 0x358637bd, v79
    v_max_f32 v92, 0x358637bd, v92
    v_max_f32 v93, 0x358637bd, v93
    v_max_f32 v94, 0x358637bd, v94
    v_max_f32 v95, 0x358637bd, v95
    v_pk_add_f32 v[76:77], v[76:77], v[4:5]
    v_pk_add_f32 v[78:79], v[78:79], v[6:7]
    v_pk_add_f32 v[92:93], v[92:93], v[8:9]
    v_pk_add_f32 v[94:95], v[94:95], v[10:11]
    v_cvt_pk_bf16_f32 v76, v76, v77
    v_cvt_pk_bf16_f32 v77, v78, v79
    v_cvt_pk_bf16_f32 v78, v92, v93
    v_cvt_pk_bf16_f32 v79, v94, v95
    s_nop 1
    v_mfma_f32_16x16x32_bf16 a[160:163], v[44:47], v[108:111], a[160:163]
    v_mfma_f32_16x16x32_bf16 a[168:171], v[44:47], v[140:143], a[168:171]
    v_mfma_f32_16x16x32_bf16 a[176:179], v[44:47], a[184:187], a[176:179]
    v_mfma_f32_16x16x32_bf16 a[164:167], v[76:79], v[108:111], a[164:167]
    v_mfma_f32_16x16x32_bf16 a[172:175], v[76:79], v[140:143], a[172:175]
    v_mfma_f32_16x16x32_bf16 a[180:183], v[76:79], a[184:187], a[180:183]
    s_lshl_b32 s52, s55, 14
    s_add_u32 s52, s52, 0x20000
    v_add_u32 v0, s52, v12
    v_lshrrev_b32 v1, 4, v2
    v_lshlrev_b32 v1, 5, v1
    s_nop 7
    s_cmp_eq_u32 s54, 0
    s_cbranch_scc1 L_cons
    ds_write_b128 v0, a[160:163] offset:0
    ds_write_b128 v0, a[164:167] offset:1024
    ds_write_b128 v0, a[168:171] offset:2048
    ds_write_b128 v0, a[172:175] offset:3072
    ds_write_b128 v0, a[176:179] offset:4096
    ds_write_b128 v0, a[180:183] offset:5120
    s_waitcnt lgkmcnt(0)
    s_barrier
    s_branch L_q
L_cons:
    v_accvgpr_read_b32 v64, a160
    v_accvgpr_read_b32 v65, a161
    v_accvgpr_read_b32 v66, a162
    v_accvgpr_read_b32 v67, a163
    v_accvgpr_read_b32 v68, a164
    v_accvgpr_read_b32 v69, a165
    v_accvgpr_read_b32 v70, a166
    v_accvgpr_read_b32 v71, a167
    v_accvgpr_read_b32 v72, a168
    v_accvgpr_read_b32 v73, a169
    v_accvgpr_read_b32 v74, a170
    v_accvgpr_read_b32 v75, a171
    v_accvgpr_read_b32 v76, a172
    v_accvgpr_read_b32 v77, a173
    v_accvgpr_read_b32 v78, a174
    v_accvgpr_read_b32 v79, a175
    v_accvgpr_read_b32 v80, a176
    v_accvgpr_read_b32 v81, a177
    v_accvgpr_read_b32 v82, a178
    v_accvgpr_read_b32 v83, a179
    v_accvgpr_read_b32 v84, a180
    v_accvgpr_read_b32 v85, a181
    v_accvgpr_read_b32 v86, a182
    v_accvgpr_read_b32 v87, a183
    v_and_b32 v88, 1, v2
    v_cmp_ne_u32 vcc, 0, v88
    v_lshl_add_u32 v88, v88, 4, v1
    v_and_b32 v89, 14, v2
    v_lshl_add_u32 v88, v89, 21, v88
    s_barrier
    ds_read_b128 v[32:35], v0 offset:0
    ds_read_b128 v[36:39], v0 offset:1024
    ds_read_b128 v[40:43], v0 offset:2048
    ds_read_b128 v[44:47], v0 offset:3072
    ds_read_b128 v[48:51], v0 offset:4096
    ds_read_b128 v[52:55], v0 offset:5120
    s_lshl_b32 s52, s58, 3
    s_add_u32 s52, s52, s50
    s_lshl_b32 s53, s52, 7
    s_add_u32 s53, s53, 0x100000
    s_lshl_b32 s52, s52, 12
    s_waitcnt lgkmcnt(0)
    v_pk_add_f32 v[32:33], v[32:33], v[64:65]
    v_pk_add_f32 v[34:35], v[34:35], v[66:67]
    v_pk_add_f32 v[36:37], v[36:37], v[68:69]
    v_pk_add_f32 v[38:39], v[38:39], v[70:71]
    v_pk_add_f32 v[40:41], v[40:41], v[72:73]
    v_pk_add_f32 v[42:43], v[42:43], v[74:75]
    v_pk_add_f32 v[44:45], v[44:45], v[76:77]
    v_pk_add_f32 v[46:47], v[46:47], v[78:79]
    v_pk_add_f32 v[48:49], v[48:49], v[80:81]
    v_pk_add_f32 v[50:51], v[50:51], v[82:83]
    v_pk_add_f32 v[52:53], v[52:53], v[84:85]
    v_pk_add_f32 v[54:55], v[54:55], v[86:87]
    buffer_store_dwordx4 v[32:35], v12, s[44:47], s52 offen offset:0 sc1
    buffer_store_dwordx4 v[36:39], v12, s[44:47], s52 offen offset:1024 sc1
    buffer_store_dwordx4 v[40:43], v12, s[44:47], s52 offen offset:2048 sc1
    buffer_store_dwordx4 v[44:47], v12, s[44:47], s52 offen offset:3072 sc1
    v_cndmask_b32 v48, v48, v52, vcc
    v_cndmask_b32 v49, v49, v53, vcc
    v_cndmask_b32 v50, v50, v54, vcc
    v_cndmask_b32 v51, v51, v55, vcc
    buffer_store_dwordx4 v[48:51], v88, s[44:47], s53 offen sc1
L_q:
    s_xor_b32 s61, s58, 2
    s_lshl_b32 s61, s61, 13
    s_add_u32 s61, s61, s65
    s_xor_b32 s66, s66, 8
    s_lshl_b32 s42, s58, 7
    s_add_u32 s42, s42, 0x1e2000
    v_accvgpr_read_b32 v108, a240
    s_add_u32 m0, s70, 131072
    s_lshr_b32 s59, 0x13121110, s72
    s_and_b32 s59, s59, 255
    s_lshl_b32 s59, s59, 16
    buffer_load_dwordx4 v13, s[16:19], s59 offen offset:0 lds
    v_accvgpr_read_b32 v109, a241
    v_accvgpr_read_b32 v96, a0
    v_accvgpr_read_b32 v97, a1
    v_accvgpr_read_b32 v98, a2
    v_accvgpr_read_b32 v99, a3
    v_accvgpr_read_b32 v100, a32
    v_accvgpr_read_b32 v101, a33
    v_accvgpr_read_b32 v102, a34
    v_accvgpr_read_b32 v103, a35
    v_accvgpr_read_b32 v104, a64
    v_accvgpr_read_b32 v105, a65
    v_accvgpr_read_b32 v106, a66
    v_accvgpr_read_b32 v107, a67
    v_pk_mul_f32 v[96:97], v[224:225], v[96:97]
    v_pk_mul_f32 v[98:99], v[226:227], v[98:99]
    v_pk_mul_f32 v[224:225], v[224:225], v[108:109] op_sel:[0,0] op_sel_hi:[1,0]
    v_pk_mul_f32 v[226:227], v[226:227], v[108:109] op_sel:[0,0] op_sel_hi:[1,0]
    v_pk_mul_f32 v[104:105], v[100:101], v[104:105]
    v_pk_mul_f32 v[106:107], v[102:103], v[106:107]
    v_pk_mul_f32 v[100:101], v[100:101], v[108:109] op_sel:[0,0] op_sel_hi:[1,0]
    v_pk_mul_f32 v[102:103], v[102:103], v[108:109] op_sel:[0,0] op_sel_hi:[1,0]
    v_exp_f32 v224, v224
    v_exp_f32 v225, v225
    buffer_load_dwordx4 v14, s[16:19], s59 offen offset:1024 lds
    v_exp_f32 v226, v226
    v_exp_f32 v227, v227
    v_exp_f32 v100, v100
    v_exp_f32 v101, v101
    v_exp_f32 v102, v102
    v_exp_f32 v103, v103
    v_pk_fma_f32 v[224:225], v[224:225], v[108:109], v[108:109] op_sel:[0,1,1] op_sel_hi:[1,1,1]
    v_pk_fma_f32 v[226:227], v[226:227], v[108:109], v[108:109] op_sel:[0,1,1] op_sel_hi:[1,1,1]
    v_pk_fma_f32 v[100:101], v[100:101], v[108:109], v[108:109] op_sel:[0,1,1] op_sel_hi:[1,1,1]
    v_pk_fma_f32 v[102:103], v[102:103], v[108:109], v[108:109] op_sel:[0,1,1] op_sel_hi:[1,1,1]
    v_rcp_f32 v224, v224
    v_rcp_f32 v225, v225
    v_rcp_f32 v226, v226
    v_rcp_f32 v227, v227
    v_rcp_f32 v100, v100
    v_rcp_f32 v101, v101
    v_rcp_f32 v102, v102
    v_rcp_f32 v103, v103
    v_pk_mul_f32 v[96:97], v[96:97], v[224:225]
    v_pk_mul_f32 v[98:99], v[98:99], v[226:227]
    v_pk_mul_f32 v[104:105], v[104:105], v[100:101]
    v_pk_mul_f32 v[106:107], v[106:107], v[102:103]
    v_cvt_pk_bf16_f32 v224, v96, v97
    v_cvt_pk_bf16_f32 v225, v98, v99
    buffer_load_dwordx4 v15, s[16:19], s59 offen offset:2048 lds
    v_cvt_pk_bf16_f32 v226, v104, v105
    v_cvt_pk_bf16_f32 v227, v106, v107
    buffer_store_dwordx4 v[224:227], v12, s[32:35], s61 offen offset:0 sc1
    v_accvgpr_read_b32 v124, a242
    v_accvgpr_read_b32 v125, a243
    v_accvgpr_read_b32 v112, a4
    v_accvgpr_read_b32 v113, a5
    v_accvgpr_read_b32 v114, a6
    v_accvgpr_read_b32 v115, a7
    v_accvgpr_read_b32 v116, a36
    v_accvgpr_read_b32 v117, a37
    v_accvgpr_read_b32 v118, a38
    v_accvgpr_read_b32 v119, a39
    v_accvgpr_read_b32 v120, a68
    v_accvgpr_read_b32 v121, a69
    v_accvgpr_read_b32 v122, a70
    v_accvgpr_read_b32 v123, a71
    v_pk_mul_f32 v[112:113], v[228:229], v[112:113]
    v_pk_mul_f32 v[114:115], v[230:231], v[114:115]
    v_pk_mul_f32 v[228:229], v[228:229], v[124:125] op_sel:[0,0] op_sel_hi:[1,0]
    v_pk_mul_f32 v[230:231], v[230:231], v[124:125] op_sel:[0,0] op_sel_hi:[1,0]
    v_pk_mul_f32 v[120:121], v[116:117], v[120:121]
    v_pk_mul_f32 v[122:123], v[118:119], v[122:123]
    v_pk_mul_f32 v[116:117], v[116:117], v[124:125] op_sel:[0,0] op_sel_hi:[1,0]
    v_pk_mul_f32 v[118:119], v[118:119], v[124:125] op_sel:[0,0] op_sel_hi:[1,0]
    v_exp_f32 v228, v228
    v_exp_f32 v229, v229
    buffer_load_dwordx4 v16, s[16:19], s59 offen offset:3072 lds
    v_exp_f32 v230, v230
    v_exp_f32 v231, v231
    v_exp_f32 v116, v116
    v_exp_f32 v117, v117
    v_exp_f32 v118, v118
    v_exp_f32 v119, v119
    v_pk_fma_f32 v[228:229], v[228:229], v[124:125], v[124:125] op_sel:[0,1,1] op_sel_hi:[1,1,1]
    v_pk_fma_f32 v[230:231], v[230:231], v[124:125], v[124:125] op_sel:[0,1,1] op_sel_hi:[1,1,1]
    v_pk_fma_f32 v[116:117], v[116:117], v[124:125], v[124:125] op_sel:[0,1,1] op_sel_hi:[1,1,1]
    v_pk_fma_f32 v[118:119], v[118:119], v[124:125], v[124:125] op_sel:[0,1,1] op_sel_hi:[1,1,1]
    v_rcp_f32 v228, v228
    v_rcp_f32 v229, v229
    v_rcp_f32 v230, v230
    v_rcp_f32 v231, v231
    v_rcp_f32 v116, v116
    v_rcp_f32 v117, v117
    v_rcp_f32 v118, v118
    v_rcp_f32 v119, v119
    v_pk_mul_f32 v[112:113], v[112:113], v[228:229]
    v_pk_mul_f32 v[114:115], v[114:115], v[230:231]
    v_pk_mul_f32 v[120:121], v[120:121], v[116:117]
    v_pk_mul_f32 v[122:123], v[122:123], v[118:119]
    v_cvt_pk_bf16_f32 v228, v112, v113
    v_cvt_pk_bf16_f32 v229, v114, v115
    s_add_u32 m0, s70, 135168
    s_add_u32 s59, s59, 32768
    buffer_load_dwordx4 v13, s[16:19], s59 offen offset:0 lds
    v_cvt_pk_bf16_f32 v230, v120, v121
    v_cvt_pk_bf16_f32 v231, v122, v123
    buffer_store_dwordx4 v[228:231], v12, s[32:35], s61 offen offset:1024 sc1
    v_accvgpr_read_b32 v108, a244
    v_accvgpr_read_b32 v109, a245
    v_accvgpr_read_b32 v96, a8
    v_accvgpr_read_b32 v97, a9
    v_accvgpr_read_b32 v98, a10
    v_accvgpr_read_b32 v99, a11
    v_accvgpr_read_b32 v100, a40
    v_accvgpr_read_b32 v101, a41
    v_accvgpr_read_b32 v102, a42
    v_accvgpr_read_b32 v103, a43
    v_accvgpr_read_b32 v104, a72
    v_accvgpr_read_b32 v105, a73
    v_accvgpr_read_b32 v106, a74
    v_accvgpr_read_b32 v107, a75
    v_pk_mul_f32 v[96:97], v[232:233], v[96:97]
    v_pk_mul_f32 v[98:99], v[234:235], v[98:99]
    v_pk_mul_f32 v[232:233], v[232:233], v[108:109] op_sel:[0,0] op_sel_hi:[1,0]
    v_pk_mul_f32 v[234:235], v[234:235], v[108:109] op_sel:[0,0] op_sel_hi:[1,0]
    v_pk_mul_f32 v[104:105], v[100:101], v[104:105]
    v_pk_mul_f32 v[106:107], v[102:103], v[106:107]
    v_pk_mul_f32 v[100:101], v[100:101], v[108:109] op_sel:[0,0] op_sel_hi:[1,0]
    v_pk_mul_f32 v[102:103], v[102:103], v[108:109] op_sel:[0,0] op_sel_hi:[1,0]
    v_exp_f32 v232, v232
    v_exp_f32 v233, v233
    buffer_load_dwordx4 v14, s[16:19], s59 offen offset:1024 lds
    v_exp_f32 v234, v234
    v_exp_f32 v235, v235
    v_exp_f32 v100, v100
    v_exp_f32 v101, v101
    v_exp_f32 v102, v102
    v_exp_f32 v103, v103
    v_pk_fma_f32 v[232:233], v[232:233], v[108:109], v[108:109] op_sel:[0,1,1] op_sel_hi:[1,1,1]
    v_pk_fma_f32 v[234:235], v[234:235], v[108:109], v[108:109] op_sel:[0,1,1] op_sel_hi:[1,1,1]
    v_pk_fma_f32 v[100:101], v[100:101], v[108:109], v[108:109] op_sel:[0,1,1] op_sel_hi:[1,1,1]
    v_pk_fma_f32 v[102:103], v[102:103], v[108:109], v[108:109] op_sel:[0,1,1] op_sel_hi:[1,1,1]
    v_rcp_f32 v232, v232
    v_rcp_f32 v233, v233
    v_rcp_f32 v234, v234
    v_rcp_f32 v235, v235
    v_rcp_f32 v100, v100
    v_rcp_f32 v101, v101
    v_rcp_f32 v102, v102
    v_rcp_f32 v103, v103
    v_pk_mul_f32 v[96:97], v[96:97], v[232:233]
    v_pk_mul_f32 v[98:99], v[98:99], v[234:235]
    v_pk_mul_f32 v[104:105], v[104:105], v[100:101]
    v_pk_mul_f32 v[106:107], v[106:107], v[102:103]
    v_cvt_pk_bf16_f32 v232, v96, v97
    v_cvt_pk_bf16_f32 v233, v98, v99
    buffer_load_dwordx4 v15, s[16:19], s59 offen offset:2048 lds
    v_cvt_pk_bf16_f32 v234, v104, v105
    v_cvt_pk_bf16_f32 v235, v106, v107
    buffer_store_dwordx4 v[232:235], v12, s[32:35], s61 offen offset:2048 sc1
    v_accvgpr_read_b32 v124, a246
    v_accvgpr_read_b32 v125, a247
    v_accvgpr_read_b32 v112, a12
    v_accvgpr_read_b32 v113, a13
    v_accvgpr_read_b32 v114, a14
    v_accvgpr_read_b32 v115, a15
    v_accvgpr_read_b32 v116, a44
    v_accvgpr_read_b32 v117, a45
    v_accvgpr_read_b32 v118, a46
    v_accvgpr_read_b32 v119, a47
    v_accvgpr_read_b32 v120, a76
    v_accvgpr_read_b32 v121, a77
    v_accvgpr_read_b32 v122, a78
    v_accvgpr_read_b32 v123, a79
    v_pk_mul_f32 v[112:113], v[236:237], v[112:113]
    v_pk_mul_f32 v[114:115], v[238:239], v[114:115]
    v_pk_mul_f32 v[236:237], v[236:237], v[124:125] op_sel:[0,0] op_sel_hi:[1,0]
    v_pk_mul_f32 v[238:239], v[238:239], v[124:125] op_sel:[0,0] op_sel_hi:[1,0]
    v_pk_mul_f32 v[120:121], v[116:117], v[120:121]
    v_pk_mul_f32 v[122:123], v[118:119], v[122:123]
    v_pk_mul_f32 v[116:117], v[116:117], v[124:125] op_sel:[0,0] op_sel_hi:[1,0]
    v_pk_mul_f32 v[118:119], v[118:119], v[124:125] op_sel:[0,0] op_sel_hi:[1,0]
    v_exp_f32 v236, v236
    v_exp_f32 v237, v237
    buffer_load_dwordx4 v16, s[16:19], s59 offen offset:3072 lds
    v_exp_f32 v238, v238
    v_exp_f32 v239, v239
    v_exp_f32 v116, v116
    v_exp_f32 v117, v117
    v_exp_f32 v118, v118
    v_exp_f32 v119, v119
    v_pk_fma_f32 v[236:237], v[236:237], v[124:125], v[124:125] op_sel:[0,1,1] op_sel_hi:[1,1,1]
    v_pk_fma_f32 v[238:239], v[238:239], v[124:125], v[124:125] op_sel:[0,1,1] op_sel_hi:[1,1,1]
    v_pk_fma_f32 v[116:117], v[116:117], v[124:125], v[124:125] op_sel:[0,1,1] op_sel_hi:[1,1,1]
    v_pk_fma_f32 v[118:119], v[118:119], v[124:125], v[124:125] op_sel:[0,1,1] op_sel_hi:[1,1,1]
    v_rcp_f32 v236, v236
    v_rcp_f32 v237, v237
    v_rcp_f32 v238, v238
    v_rcp_f32 v239, v239
    v_rcp_f32 v116, v116
    v_rcp_f32 v117, v117
    v_rcp_f32 v118, v118
    v_rcp_f32 v119, v119
    v_pk_mul_f32 v[112:113], v[112:113], v[236:237]
    v_pk_mul_f32 v[114:115], v[114:115], v[238:239]
    v_pk_mul_f32 v[120:121], v[120:121], v[116:117]
    v_pk_mul_f32 v[122:123], v[122:123], v[118:119]
    v_cvt_pk_bf16_f32 v236, v112, v113
    v_cvt_pk_bf16_f32 v237, v114, v115
    v_cvt_pk_bf16_f32 v238, v120, v121
    v_cvt_pk_bf16_f32 v239, v122, v123
    buffer_store_dwordx4 v[236:239], v12, s[32:35], s61 offen offset:3072 sc1
    s_waitcnt vmcnt(12)
    s_lshl_b32 s53, s50, 2
    s_add_u32 s52, s42, s53
    s_cmp_lg_u32 s54, 0
    s_cselect_b32 s52, 0x400000, s52
    buffer_store_dword v3, v31, s[44:47], s52 offen sc1
    v_accvgpr_read_b32 v108, a248
    v_accvgpr_read_b32 v109, a249
    v_accvgpr_read_b32 v96, a16
    v_accvgpr_read_b32 v97, a17
    v_accvgpr_read_b32 v98, a18
    v_accvgpr_read_b32 v99, a19
    v_accvgpr_read_b32 v100, a48
    v_accvgpr_read_b32 v101, a49
    v_accvgpr_read_b32 v102, a50
    v_accvgpr_read_b32 v103, a51
    v_accvgpr_read_b32 v104, a80
    v_accvgpr_read_b32 v105, a81
    v_accvgpr_read_b32 v106, a82
    v_accvgpr_read_b32 v107, a83
    v_pk_mul_f32 v[96:97], v[240:241], v[96:97]
    v_pk_mul_f32 v[98:99], v[242:243], v[98:99]
    v_pk_mul_f32 v[240:241], v[240:241], v[108:109] op_sel:[0,0] op_sel_hi:[1,0]
    v_pk_mul_f32 v[242:243], v[242:243], v[108:109] op_sel:[0,0] op_sel_hi:[1,0]
    v_pk_mul_f32 v[104:105], v[100:101], v[104:105]
    v_pk_mul_f32 v[106:107], v[102:103], v[106:107]
    v_pk_mul_f32 v[100:101], v[100:101], v[108:109] op_sel:[0,0] op_sel_hi:[1,0]
    v_pk_mul_f32 v[102:103], v[102:103], v[108:109] op_sel:[0,0] op_sel_hi:[1,0]
    v_exp_f32 v240, v240
    v_exp_f32 v241, v241
    v_exp_f32 v242, v242
    v_exp_f32 v243, v243
    v_exp_f32 v100, v100
    v_exp_f32 v101, v101
    v_exp_f32 v102, v102
    v_exp_f32 v103, v103
    v_pk_fma_f32 v[240:241], v[240:241], v[108:109], v[108:109] op_sel:[0,1,1] op_sel_hi:[1,1,1]
    v_pk_fma_f32 v[242:243], v[242:243], v[108:109], v[108:109] op_sel:[0,1,1] op_sel_hi:[1,1,1]
    v_pk_fma_f32 v[100:101], v[100:101], v[108:109], v[108:109] op_sel:[0,1,1] op_sel_hi:[1,1,1]
    v_pk_fma_f32 v[102:103], v[102:103], v[108:109], v[108:109] op_sel:[0,1,1] op_sel_hi:[1,1,1]
    v_rcp_f32 v240, v240
    v_rcp_f32 v241, v241
    v_rcp_f32 v242, v242
    v_rcp_f32 v243, v243
    v_rcp_f32 v100, v100
    v_rcp_f32 v101, v101
    v_rcp_f32 v102, v102
    v_rcp_f32 v103, v103
    v_pk_mul_f32 v[96:97], v[96:97], v[240:241]
    v_pk_mul_f32 v[98:99], v[98:99], v[242:243]
    v_pk_mul_f32 v[104:105], v[104:105], v[100:101]
    v_pk_mul_f32 v[106:107], v[106:107], v[102:103]
    v_cvt_pk_bf16_f32 v240, v96, v97
    v_cvt_pk_bf16_f32 v241, v98, v99
    v_cvt_pk_bf16_f32 v242, v104, v105
    v_cvt_pk_bf16_f32 v243, v106, v107
    buffer_store_dwordx4 v[240:243], v23, s[32:35], s61 offen offset:0 sc1
    v_accvgpr_read_b32 v124, a250
    v_accvgpr_read_b32 v125, a251
    v_accvgpr_read_b32 v112, a20
    v_accvgpr_read_b32 v113, a21
    v_accvgpr_read_b32 v114, a22
    v_accvgpr_read_b32 v115, a23
    v_accvgpr_read_b32 v116, a52
    v_accvgpr_read_b32 v117, a53
    v_accvgpr_read_b32 v118, a54
    v_accvgpr_read_b32 v119, a55
    v_accvgpr_read_b32 v120, a84
    v_accvgpr_read_b32 v121, a85
    v_accvgpr_read_b32 v122, a86
    v_accvgpr_read_b32 v123, a87
    v_pk_mul_f32 v[112:113], v[244:245], v[112:113]
    v_pk_mul_f32 v[114:115], v[246:247], v[114:115]
    v_pk_mul_f32 v[244:245], v[244:245], v[124:125] op_sel:[0,0] op_sel_hi:[1,0]
    v_pk_mul_f32 v[246:247], v[246:247], v[124:125] op_sel:[0,0] op_sel_hi:[1,0]
    v_pk_mul_f32 v[120:121], v[116:117], v[120:121]
    v_pk_mul_f32 v[122:123], v[118:119], v[122:123]
    v_pk_mul_f32 v[116:117], v[116:117], v[124:125] op_sel:[0,0] op_sel_hi:[1,0]
    v_pk_mul_f32 v[118:119], v[118:119], v[124:125] op_sel:[0,0] op_sel_hi:[1,0]
    v_exp_f32 v244, v244
    v_exp_f32 v245, v245
    v_exp_f32 v246, v246
    v_exp_f32 v247, v247
    v_exp_f32 v116, v116
    v_exp_f32 v117, v117
    v_exp_f32 v118, v118
    v_exp_f32 v119, v119
    v_pk_fma_f32 v[244:245], v[244:245], v[124:125], v[124:125] op_sel:[0,1,1] op_sel_hi:[1,1,1]
    v_pk_fma_f32 v[246:247], v[246:247], v[124:125], v[124:125] op_sel:[0,1,1] op_sel_hi:[1,1,1]
    v_pk_fma_f32 v[116:117], v[116:117], v[124:125], v[124:125] op_sel:[0,1,1] op_sel_hi:[1,1,1]
    v_pk_fma_f32 v[118:119], v[118:119], v[124:125], v[124:125] op_sel:[0,1,1] op_sel_hi:[1,1,1]
    v_rcp_f32 v244, v244
    v_rcp_f32 v245, v245
    v_rcp_f32 v246, v246
    v_rcp_f32 v247, v247
    v_rcp_f32 v116, v116
    v_rcp_f32 v117, v117
    v_rcp_f32 v118, v118
    v_rcp_f32 v119, v119
    v_pk_mul_f32 v[112:113], v[112:113], v[244:245]
    v_pk_mul_f32 v[114:115], v[114:115], v[246:247]
    v_pk_mul_f32 v[120:121], v[120:121], v[116:117]
    v_pk_mul_f32 v[122:123], v[122:123], v[118:119]
    v_cvt_pk_bf16_f32 v244, v112, v113
    v_cvt_pk_bf16_f32 v245, v114, v115
    v_cvt_pk_bf16_f32 v246, v120, v121
    v_cvt_pk_bf16_f32 v247, v122, v123
    buffer_store_dwordx4 v[244:247], v23, s[32:35], s61 offen offset:1024 sc1
    v_accvgpr_read_b32 v108, a252
    v_accvgpr_read_b32 v109, a253
    v_accvgpr_read_b32 v96, a24
    v_accvgpr_read_b32 v97, a25
    v_accvgpr_read_b32 v98, a26
    v_accvgpr_read_b32 v99, a27
    v_accvgpr_read_b32 v100, a56
    v_accvgpr_read_b32 v101, a57
    v_accvgpr_read_b32 v102, a58
    v_accvgpr_read_b32 v103, a59
    v_accvgpr_read_b32 v104, a88
    v_accvgpr_read_b32 v105, a89
    v_accvgpr_read_b32 v106, a90
    v_accvgpr_read_b32 v107, a91
    v_pk_mul_f32 v[96:97], v[248:249], v[96:97]
    v_pk_mul_f32 v[98:99], v[250:251], v[98:99]
    v_pk_mul_f32 v[248:249], v[248:249], v[108:109] op_sel:[0,0] op_sel_hi:[1,0]
    v_pk_mul_f32 v[250:251], v[250:251], v[108:109] op_sel:[0,0] op_sel_hi:[1,0]
    v_pk_mul_f32 v[104:105], v[100:101], v[104:105]
    v_pk_mul_f32 v[106:107], v[102:103], v[106:107]
    v_pk_mul_f32 v[100:101], v[100:101], v[108:109] op_sel:[0,0] op_sel_hi:[1,0]
    v_pk_mul_f32 v[102:103], v[102:103], v[108:109] op_sel:[0,0] op_sel_hi:[1,0]
    v_exp_f32 v248, v248
    v_exp_f32 v249, v249
    v_exp_f32 v250, v250
    v_exp_f32 v251, v251
    v_exp_f32 v100, v100
    v_exp_f32 v101, v101
    v_exp_f32 v102, v102
    v_exp_f32 v103, v103
    v_pk_fma_f32 v[248:249], v[248:249], v[108:109], v[108:109] op_sel:[0,1,1] op_sel_hi:[1,1,1]
    v_pk_fma_f32 v[250:251], v[250:251], v[108:109], v[108:109] op_sel:[0,1,1] op_sel_hi:[1,1,1]
    v_pk_fma_f32 v[100:101], v[100:101], v[108:109], v[108:109] op_sel:[0,1,1] op_sel_hi:[1,1,1]
    v_pk_fma_f32 v[102:103], v[102:103], v[108:109], v[108:109] op_sel:[0,1,1] op_sel_hi:[1,1,1]
    v_rcp_f32 v248, v248
    v_rcp_f32 v249, v249
    v_rcp_f32 v250, v250
    v_rcp_f32 v251, v251
    v_rcp_f32 v100, v100
    v_rcp_f32 v101, v101
    v_rcp_f32 v102, v102
    v_rcp_f32 v103, v103
    v_pk_mul_f32 v[96:97], v[96:97], v[248:249]
    v_pk_mul_f32 v[98:99], v[98:99], v[250:251]
    v_pk_mul_f32 v[104:105], v[104:105], v[100:101]
    v_pk_mul_f32 v[106:107], v[106:107], v[102:103]
    v_cvt_pk_bf16_f32 v248, v96, v97
    v_cvt_pk_bf16_f32 v249, v98, v99
    v_cvt_pk_bf16_f32 v250, v104, v105
    v_cvt_pk_bf16_f32 v251, v106, v107
    buffer_store_dwordx4 v[248:251], v23, s[32:35], s61 offen offset:2048 sc1
    v_and_b32 v0, 7, v2
    v_lshl_add_u32 v1, v0, 7, v1
    v_lshlrev_b32 v0, 2, v0
    buffer_load_dword v19, v0, s[44:47], s42 offen sc1
    v_max_u32 v28, 48, v2
    v_min_u32 v28, 63, v28
    v_lshlrev_b32 v28, 2, v28
    s_add_u32 s53, s76, 0x1e3000
    buffer_load_dword v29, v28, s[44:47], s53 offen sc1
    v_accvgpr_read_b32 v124, a254
    v_accvgpr_read_b32 v125, a255
    v_accvgpr_read_b32 v112, a28
    v_accvgpr_read_b32 v113, a29
    v_accvgpr_read_b32 v114, a30
    v_accvgpr_read_b32 v115, a31
    v_accvgpr_read_b32 v116, a60
    v_accvgpr_read_b32 v117, a61
    v_accvgpr_read_b32 v118, a62
    v_accvgpr_read_b32 v119, a63
    v_accvgpr_read_b32 v120, a92
    v_accvgpr_read_b32 v121, a93
    v_accvgpr_read_b32 v122, a94
    v_accvgpr_read_b32 v123, a95
    v_pk_mul_f32 v[112:113], v[252:253], v[112:113]
    v_pk_mul_f32 v[114:115], v[254:255], v[114:115]
    v_pk_mul_f32 v[252:253], v[252:253], v[124:125] op_sel:[0,0] op_sel_hi:[1,0]
    v_pk_mul_f32 v[254:255], v[254:255], v[124:125] op_sel:[0,0] op_sel_hi:[1,0]
    v_pk_mul_f32 v[120:121], v[116:117], v[120:121]
    v_pk_mul_f32 v[122:123], v[118:119], v[122:123]
    v_pk_mul_f32 v[116:117], v[116:117], v[124:125] op_sel:[0,0] op_sel_hi:[1,0]
    v_pk_mul_f32 v[118:119], v[118:119], v[124:125] op_sel:[0,0] op_sel_hi:[1,0]
    v_exp_f32 v252, v252
    v_exp_f32 v253, v253
    v_exp_f32 v254, v254
    v_exp_f32 v255, v255
    v_exp_f32 v116, v116
    v_exp_f32 v117, v117
    v_exp_f32 v118, v118
    v_exp_f32 v119, v119
    v_pk_fma_f32 v[252:253], v[252:253], v[124:125], v[124:125] op_sel:[0,1,1] op_sel_hi:[1,1,1]
    v_pk_fma_f32 v[254:255], v[254:255], v[124:125], v[124:125] op_sel:[0,1,1] op_sel_hi:[1,1,1]
    v_pk_fma_f32 v[116:117], v[116:117], v[124:125], v[124:125] op_sel:[0,1,1] op_sel_hi:[1,1,1]
    v_pk_fma_f32 v[118:119], v[118:119], v[124:125], v[124:125] op_sel:[0,1,1] op_sel_hi:[1,1,1]
    v_rcp_f32 v252, v252
    v_rcp_f32 v253, v253
    v_rcp_f32 v254, v254
    v_rcp_f32 v255, v255
    v_rcp_f32 v116, v116
    v_rcp_f32 v117, v117
    v_rcp_f32 v118, v118
    v_rcp_f32 v119, v119
    v_pk_mul_f32 v[112:113], v[112:113], v[252:253]
    v_pk_mul_f32 v[114:115], v[114:115], v[254:255]
    v_pk_mul_f32 v[120:121], v[120:121], v[116:117]
    v_pk_mul_f32 v[122:123], v[122:123], v[118:119]
    v_cvt_pk_bf16_f32 v252, v112, v113
    v_cvt_pk_bf16_f32 v253, v114, v115
    v_cvt_pk_bf16_f32 v254, v120, v121
    v_cvt_pk_bf16_f32 v255, v122, v123
    buffer_store_dwordx4 v[252:255], v23, s[32:35], s61 offen offset:3072 sc1
    s_waitcnt vmcnt(1)
    s_mov_b32 s48, 0x20000
L_pollKV:
    v_cmp_ne_u32 vcc, v3, v19
    s_sub_u32 s48, s48, 1
    s_nop 3
    s_cbranch_vccz L_pollKV_d
    s_cmp_eq_u32 s48, 0
    s_cbranch_scc1 L_pollKV_d
    s_sleep 1
    buffer_load_dword v19, v0, s[44:47], s42 offen sc1
    s_waitcnt vmcnt(0)
    s_branch L_pollKV
L_pollKV_d:
    s_lshl_b32 s60, s58, 15
    s_lshl_b32 s42, s58, 10
    s_add_u32 s42, s42, 0x100000
    v_accvgpr_read_b32 v224, a240
    buffer_load_dwordx4 v[32:35], v12, s[44:47], s60 offen offset:0 sc1
    v_accvgpr_read_b32 v225, a241
    v_mul_f32 v226, 0xbf317218, v224
    v_mul_f32 v227, v226, v225
    v_mul_f32 v227, 0x358637bd, v227
    buffer_load_dwordx4 v[36:39], v12, s[44:47], s60 offen offset:1024 sc1
    v_pk_mul_f32 v[4:5], v[160:161], v[224:225] op_sel:[0,0] op_sel_hi:[1,0] neg_lo:[0,1] neg_hi:[0,1]
    v_pk_mul_f32 v[6:7], v[162:163], v[224:225] op_sel:[0,0] op_sel_hi:[1,0] neg_lo:[0,1] neg_hi:[0,1]
    v_pk_mul_f32 v[8:9], v[192:193], v[224:225] op_sel:[0,0] op_sel_hi:[1,0] neg_lo:[0,1] neg_hi:[0,1]
    v_pk_mul_f32 v[10:11], v[194:195], v[224:225] op_sel:[0,0] op_sel_hi:[1,0] neg_lo:[0,1] neg_hi:[0,1]
    v_exp_f32 v4, v4 clamp
    v_exp_f32 v5, v5 clamp
    buffer_load_dwordx4 v[40:43], v12, s[44:47], s60 offen offset:2048 sc1
    v_exp_f32 v6, v6 clamp
    v_exp_f32 v7, v7 clamp
    v_exp_f32 v8, v8 clamp
    v_exp_f32 v9, v9 clamp
    buffer_load_dwordx4 v[44:47], v12, s[44:47], s60 offen offset:3072 sc1
    s_add_u32 s60, s60, 4096
    v_exp_f32 v10, v10 clamp
    v_exp_f32 v11, v11 clamp
    v_max_f32 v160, v227, v160
    v_max_f32 v161, v227, v161
    buffer_load_dwordx4 v[48:51], v12, s[44:47], s60 offen offset:0 sc1
    v_max_f32 v162, v227, v162
    v_max_f32 v163, v227, v163
    v_max_f32 v192, v227, v192
    v_max_f32 v193, v227, v193
    buffer_load_dwordx4 v[52:55], v12, s[44:47], s60 offen offset:1024 sc1
    v_max_f32 v194, v227, v194
    v_max_f32 v195, v227, v195
    v_pk_fma_f32 v[160:161], v[160:161], v[226:227], v[4:5] op_sel_hi:[1,0,1]
    v_pk_fma_f32 v[162:163], v[162:163], v[226:227], v[6:7] op_sel_hi:[1,0,1]
    v_pk_fma_f32 v[192:193], v[192:193], v[226:227], v[8:9] op_sel_hi:[1,0,1]
    v_pk_fma_f32 v[194:195], v[194:195], v[226:227], v[10:11] op_sel_hi:[1,0,1]
    v_cvt_pk_bf16_f32 v160, v160, v161
    v_cvt_pk_bf16_f32 v161, v162, v163
    buffer_load_dwordx4 v[56:59], v12, s[44:47], s60 offen offset:2048 sc1
    v_cvt_pk_bf16_f32 v162, v192, v193
    v_cvt_pk_bf16_f32 v163, v194, v195
    v_accvgpr_read_b32 v228, a242
    v_accvgpr_read_b32 v229, a243
    buffer_load_dwordx4 v[60:63], v12, s[44:47], s60 offen offset:3072 sc1
    s_add_u32 s60, s60, 4096
    v_mul_f32 v230, 0xbf317218, v228
    v_mul_f32 v231, v230, v229
    v_mul_f32 v231, 0x358637bd, v231
    v_pk_mul_f32 v[4:5], v[164:165], v[228:229] op_sel:[0,0] op_sel_hi:[1,0] neg_lo:[0,1] neg_hi:[0,1]
    v_pk_mul_f32 v[6:7], v[166:167], v[228:229] op_sel:[0,0] op_sel_hi:[1,0] neg_lo:[0,1] neg_hi:[0,1]
    v_pk_mul_f32 v[8:9], v[196:197], v[228:229] op_sel:[0,0] op_sel_hi:[1,0] neg_lo:[0,1] neg_hi:[0,1]
    v_pk_mul_f32 v[10:11], v[198:199], v[228:229] op_sel:[0,0] op_sel_hi:[1,0] neg_lo:[0,1] neg_hi:[0,1]
    v_exp_f32 v4, v4 clamp
    v_exp_f32 v5, v5 clamp
    buffer_load_dwordx4 v[64:67], v12, s[44:47], s60 offen offset:0 sc1
    v_exp_f32 v6, v6 clamp
    v_exp_f32 v7, v7 clamp
    v_exp_f32 v8, v8 clamp
    v_exp_f32 v9, v9 clamp
    buffer_load_dwordx4 v[68:71], v12, s[44:47], s60 offen offset:1024 sc1
    v_exp_f32 v10, v10 clamp
    v_exp_f32 v11, v11 clamp
    v_max_f32 v164, v231, v164
    v_max_f32 v165, v231, v165
    buffer_load_dwordx4 v[72:75], v12, s[44:47], s60 offen offset:2048 sc1
    v_max_f32 v166, v231, v166
    v_max_f32 v167, v231, v167
    v_max_f32 v196, v231, v196
    v_max_f32 v197, v231, v197
    buffer_load_dwordx4 v[76:79], v12, s[44:47], s60 offen offset:3072 sc1
    s_add_u32 s60, s60, 4096
    v_max_f32 v198, v231, v198
    v_max_f32 v199, v231, v199
    v_pk_fma_f32 v[164:165], v[164:165], v[230:231], v[4:5] op_sel_hi:[1,0,1]
    v_pk_fma_f32 v[166:167], v[166:167], v[230:231], v[6:7] op_sel_hi:[1,0,1]
    v_pk_fma_f32 v[196:197], v[196:197], v[230:231], v[8:9] op_sel_hi:[1,0,1]
    v_pk_fma_f32 v[198:199], v[198:199], v[230:231], v[10:11] op_sel_hi:[1,0,1]
    v_cvt_pk_bf16_f32 v164, v164, v165
    v_cvt_pk_bf16_f32 v165, v166, v167
    buffer_load_dwordx4 v[80:83], v12, s[44:47], s60 offen offset:0 sc1
    v_cvt_pk_bf16_f32 v166, v196, v197
    v_cvt_pk_bf16_f32 v167, v198, v199
    v_accvgpr_read_b32 v232, a244
    v_accvgpr_read_b32 v233, a245
    buffer_load_dwordx4 v[84:87], v12, s[44:47], s60 offen offset:1024 sc1
    v_mul_f32 v234, 0xbf317218, v232
    v_mul_f32 v235, v234, v233
    v_mul_f32 v235, 0x358637bd, v235
    v_pk_mul_f32 v[4:5], v[168:169], v[232:233] op_sel:[0,0] op_sel_hi:[1,0] neg_lo:[0,1] neg_hi:[0,1]
    v_pk_mul_f32 v[6:7], v[170:171], v[232:233] op_sel:[0,0] op_sel_hi:[1,0] neg_lo:[0,1] neg_hi:[0,1]
    v_pk_mul_f32 v[8:9], v[200:201], v[232:233] op_sel:[0,0] op_sel_hi:[1,0] neg_lo:[0,1] neg_hi:[0,1]
    v_pk_mul_f32 v[10:11], v[202:203], v[232:233] op_sel:[0,0] op_sel_hi:[1,0] neg_lo:[0,1] neg_hi:[0,1]
    v_exp_f32 v4, v4 clamp
    v_exp_f32 v5, v5 clamp
    buffer_load_dwordx4 v[88:91], v12, s[44:47], s60 offen offset:2048 sc1
    v_exp_f32 v6, v6 clamp
    v_exp_f32 v7, v7 clamp
    v_exp_f32 v8, v8 clamp
    v_exp_f32 v9, v9 clamp
    buffer_load_dwordx4 v[92:95], v12, s[44:47], s60 offen offset:3072 sc1
    s_add_u32 s60, s60, 4096
    v_exp_f32 v10, v10 clamp
    v_exp_f32 v11, v11 clamp
    v_max_f32 v168, v235, v168
    v_max_f32 v169, v235, v169
    buffer_load_dwordx4 v[96:99], v12, s[44:47], s60 offen offset:0 sc1
    v_max_f32 v170, v235, v170
    v_max_f32 v171, v235, v171
    v_max_f32 v200, v235, v200
    v_max_f32 v201, v235, v201
    buffer_load_dwordx4 v[100:103], v12, s[44:47], s60 offen offset:1024 sc1
    v_max_f32 v202, v235, v202
    v_max_f32 v203, v235, v203
    v_pk_fma_f32 v[168:169], v[168:169], v[234:235], v[4:5] op_sel_hi:[1,0,1]
    v_pk_fma_f32 v[170:171], v[170:171], v[234:235], v[6:7] op_sel_hi:[1,0,1]
    v_pk_fma_f32 v[200:201], v[200:201], v[234:235], v[8:9] op_sel_hi:[1,0,1]
    v_pk_fma_f32 v[202:203], v[202:203], v[234:235], v[10:11] op_sel_hi:[1,0,1]
    v_cvt_pk_bf16_f32 v168, v168, v169
    v_cvt_pk_bf16_f32 v169, v170, v171
    buffer_load_dwordx4 v[104:107], v12, s[44:47], s60 offen offset:2048 sc1
    v_cvt_pk_bf16_f32 v170, v200, v201
    v_cvt_pk_bf16_f32 v171, v202, v203
    v_accvgpr_read_b32 v236, a246
    v_accvgpr_read_b32 v237, a247
    buffer_load_dwordx4 v[108:111], v12, s[44:47], s60 offen offset:3072 sc1
    s_add_u32 s60, s60, 4096
    v_mul_f32 v238, 0xbf317218, v236
    v_mul_f32 v239, v238, v237
    v_mul_f32 v239, 0x358637bd, v239
    v_pk_mul_f32 v[4:5], v[172:173], v[236:237] op_sel:[0,0] op_sel_hi:[1,0] neg_lo:[0,1] neg_hi:[0,1]
    v_pk_mul_f32 v[6:7], v[174:175], v[236:237] op_sel:[0,0] op_sel_hi:[1,0] neg_lo:[0,1] neg_hi:[0,1]
    v_pk_mul_f32 v[8:9], v[204:205], v[236:237] op_sel:[0,0] op_sel_hi:[1,0] neg_lo:[0,1] neg_hi:[0,1]
    v_pk_mul_f32 v[10:11], v[206:207], v[236:237] op_sel:[0,0] op_sel_hi:[1,0] neg_lo:[0,1] neg_hi:[0,1]
    v_exp_f32 v4, v4 clamp
    v_exp_f32 v5, v5 clamp
    buffer_load_dwordx4 v[112:115], v12, s[44:47], s60 offen offset:0 sc1
    v_exp_f32 v6, v6 clamp
    v_exp_f32 v7, v7 clamp
    v_exp_f32 v8, v8 clamp
    v_exp_f32 v9, v9 clamp
    buffer_load_dwordx4 v[116:119], v12, s[44:47], s60 offen offset:1024 sc1
    v_exp_f32 v10, v10 clamp
    v_exp_f32 v11, v11 clamp
    v_max_f32 v172, v239, v172
    v_max_f32 v173, v239, v173
    buffer_load_dwordx4 v[120:123], v12, s[44:47], s60 offen offset:2048 sc1
    v_max_f32 v174, v239, v174
    v_max_f32 v175, v239, v175
    v_max_f32 v204, v239, v204
    v_max_f32 v205, v239, v205
    buffer_load_dwordx4 v[124:127], v12, s[44:47], s60 offen offset:3072 sc1
    s_add_u32 s60, s60, 4096
    v_max_f32 v206, v239, v206
    v_max_f32 v207, v239, v207
    v_pk_fma_f32 v[172:173], v[172:173], v[238:239], v[4:5] op_sel_hi:[1,0,1]
    v_pk_fma_f32 v[174:175], v[174:175], v[238:239], v[6:7] op_sel_hi:[1,0,1]
    v_pk_fma_f32 v[204:205], v[204:205], v[238:239], v[8:9] op_sel_hi:[1,0,1]
    v_pk_fma_f32 v[206:207], v[206:207], v[238:239], v[10:11] op_sel_hi:[1,0,1]
    v_cvt_pk_bf16_f32 v172, v172, v173
    v_cvt_pk_bf16_f32 v173, v174, v175
    buffer_load_dwordx4 v[128:131], v12, s[44:47], s60 offen offset:0 sc1
    v_cvt_pk_bf16_f32 v174, v204, v205
    v_cvt_pk_bf16_f32 v175, v206, v207
    s_waitcnt vmcnt(25)
    s_add_u32 s48, s66, 0x1e4000
    buffer_store_dword v3, v31, s[44:47], s48 offen sc1
    v_accvgpr_read_b32 v240, a248
    v_accvgpr_read_b32 v241, a249
    buffer_load_dwordx4 v[132:135], v12, s[44:47], s60 offen offset:1024 sc1
    v_mul_f32 v242, 0xbf317218, v240
    v_mul_f32 v243, v242, v241
    v_mul_f32 v243, 0x358637bd, v243
    v_pk_mul_f32 v[4:5], v[176:177], v[240:241] op_sel:[0,0] op_sel_hi:[1,0] neg_lo:[0,1] neg_hi:[0,1]
    v_pk_mul_f32 v[6:7], v[178:179], v[240:241] op_sel:[0,0] op_sel_hi:[1,0] neg_lo:[0,1] neg_hi:[0,1]
    v_pk_mul_f32 v[8:9], v[208:209], v[240:241] op_sel:[0,0] op_sel_hi:[1,0] neg_lo:[0,1] neg_hi:[0,1]
    v_pk_mul_f32 v[10:11], v[210:211], v[240:241] op_sel:[0,0] op_sel_hi:[1,0] neg_lo:[0,1] neg_hi:[0,1]
    v_exp_f32 v4, v4 clamp
    v_exp_f32 v5, v5 clamp
    buffer_load_dwordx4 v[136:139], v12, s[44:47], s60 offen offset:2048 sc1
    v_exp_f32 v6, v6 clamp
    v_exp_f32 v7, v7 clamp
    v_exp_f32 v8, v8 clamp
    v_exp_f32 v9, v9 clamp
    buffer_load_dwordx4 v[140:143], v12, s[44:47], s60 offen offset:3072 sc1
    s_add_u32 s60, s60, 4096
    v_exp_f32 v10, v10 clamp
    v_exp_f32 v11, v11 clamp
    v_max_f32 v176, v243, v176
    v_max_f32 v177, v243, v177
    buffer_load_dwordx4 v[144:147], v12, s[44:47], s60 offen offset:0 sc1
    v_max_f32 v178, v243, v178
    v_max_f32 v179, v243, v179
    v_max_f32 v208, v243, v208
    v_max_f32 v209, v243, v209
    buffer_load_dwordx4 v[148:151], v12, s[44:47], s60 offen offset:1024 sc1
    v_max_f32 v210, v243, v210
    v_max_f32 v211, v243, v211
    v_pk_fma_f32 v[176:177], v[176:177], v[242:243], v[4:5] op_sel_hi:[1,0,1]
    v_pk_fma_f32 v[178:179], v[178:179], v[242:243], v[6:7] op_sel_hi:[1,0,1]
    v_pk_fma_f32 v[208:209], v[208:209], v[242:243], v[8:9] op_sel_hi:[1,0,1]
    v_pk_fma_f32 v[210:211], v[210:211], v[242:243], v[10:11] op_sel_hi:[1,0,1]
    v_cvt_pk_bf16_f32 v176, v176, v177
    v_cvt_pk_bf16_f32 v177, v178, v179
    buffer_load_dwordx4 v[152:155], v12, s[44:47], s60 offen offset:2048 sc1
    v_cvt_pk_bf16_f32 v178, v208, v209
    v_cvt_pk_bf16_f32 v179, v210, v211
    v_accvgpr_read_b32 v244, a250
    v_accvgpr_read_b32 v245, a251
    buffer_load_dwordx4 v[156:159], v12, s[44:47], s60 offen offset:3072 sc1
    s_add_u32 s60, s60, 4096
    v_mul_f32 v246, 0xbf317218, v244
    v_mul_f32 v247, v246, v245
    v_mul_f32 v247, 0x358637bd, v247
    v_pk_mul_f32 v[4:5], v[180:181], v[244:245] op_sel:[0,0] op_sel_hi:[1,0] neg_lo:[0,1] neg_hi:[0,1]
    v_pk_mul_f32 v[6:7], v[182:183], v[244:245] op_sel:[0,0] op_sel_hi:[1,0] neg_lo:[0,1] neg_hi:[0,1]
    v_pk_mul_f32 v[8:9], v[212:213], v[244:245] op_sel:[0,0] op_sel_hi:[1,0] neg_lo:[0,1] neg_hi:[0,1]
    v_pk_mul_f32 v[10:11], v[214:215], v[244:245] op_sel:[0,0] op_sel_hi:[1,0] neg_lo:[0,1] neg_hi:[0,1]
    v_exp_f32 v4, v4 clamp
    v_exp_f32 v5, v5 clamp
    v_exp_f32 v6, v6 clamp
    v_exp_f32 v7, v7 clamp
    v_exp_f32 v8, v8 clamp
    v_exp_f32 v9, v9 clamp
    v_exp_f32 v10, v10 clamp
    v_exp_f32 v11, v11 clamp
    v_max_f32 v180, v247, v180
    v_max_f32 v181, v247, v181
    v_max_f32 v182, v247, v182
    v_max_f32 v183, v247, v183
    v_max_f32 v212, v247, v212
    v_max_f32 v213, v247, v213
    v_max_f32 v214, v247, v214
    v_max_f32 v215, v247, v215
    v_pk_fma_f32 v[180:181], v[180:181], v[246:247], v[4:5] op_sel_hi:[1,0,1]
    v_pk_fma_f32 v[182:183], v[182:183], v[246:247], v[6:7] op_sel_hi:[1,0,1]
    v_pk_fma_f32 v[212:213], v[212:213], v[246:247], v[8:9] op_sel_hi:[1,0,1]
    v_pk_fma_f32 v[214:215], v[214:215], v[246:247], v[10:11] op_sel_hi:[1,0,1]
    v_cvt_pk_bf16_f32 v180, v180, v181
    v_cvt_pk_bf16_f32 v181, v182, v183
    v_cvt_pk_bf16_f32 v182, v212, v213
    v_cvt_pk_bf16_f32 v183, v214, v215
    v_accvgpr_read_b32 v248, a252
    v_accvgpr_read_b32 v249, a253
    v_mul_f32 v250, 0xbf317218, v248
    v_mul_f32 v251, v250, v249
    v_mul_f32 v251, 0x358637bd, v251
    v_pk_mul_f32 v[4:5], v[184:185], v[248:249] op_sel:[0,0] op_sel_hi:[1,0] neg_lo:[0,1] neg_hi:[0,1]
    v_pk_mul_f32 v[6:7], v[186:187], v[248:249] op_sel:[0,0] op_sel_hi:[1,0] neg_lo:[0,1] neg_hi:[0,1]
    v_pk_mul_f32 v[8:9], v[216:217], v[248:249] op_sel:[0,0] op_sel_hi:[1,0] neg_lo:[0,1] neg_hi:[0,1]
    v_pk_mul_f32 v[10:11], v[218:219], v[248:249] op_sel:[0,0] op_sel_hi:[1,0] neg_lo:[0,1] neg_hi:[0,1]
    v_exp_f32 v4, v4 clamp
    v_exp_f32 v5, v5 clamp
    v_exp_f32 v6, v6 clamp
    v_exp_f32 v7, v7 clamp
    v_exp_f32 v8, v8 clamp
    v_exp_f32 v9, v9 clamp
    v_exp_f32 v10, v10 clamp
    v_exp_f32 v11, v11 clamp
    v_max_f32 v184, v251, v184
    v_max_f32 v185, v251, v185
    v_max_f32 v186, v251, v186
    v_max_f32 v187, v251, v187
    v_max_f32 v216, v251, v216
    v_max_f32 v217, v251, v217
    v_max_f32 v218, v251, v218
    v_max_f32 v219, v251, v219
    v_pk_fma_f32 v[184:185], v[184:185], v[250:251], v[4:5] op_sel_hi:[1,0,1]
    v_pk_fma_f32 v[186:187], v[186:187], v[250:251], v[6:7] op_sel_hi:[1,0,1]
    v_pk_fma_f32 v[216:217], v[216:217], v[250:251], v[8:9] op_sel_hi:[1,0,1]
    v_pk_fma_f32 v[218:219], v[218:219], v[250:251], v[10:11] op_sel_hi:[1,0,1]
    v_cvt_pk_bf16_f32 v184, v184, v185
    v_cvt_pk_bf16_f32 v185, v186, v187
    v_cvt_pk_bf16_f32 v186, v216, v217
    v_cvt_pk_bf16_f32 v187, v218, v219
    v_accvgpr_read_b32 v252, a254
    v_accvgpr_read_b32 v253, a255
    v_mul_f32 v254, 0xbf317218, v252
    v_mul_f32 v255, v254, v253
    v_mul_f32 v255, 0x358637bd, v255
    v_pk_mul_f32 v[4:5], v[188:189], v[252:253] op_sel:[0,0] op_sel_hi:[1,0] neg_lo:[0,1] neg_hi:[0,1]
    v_pk_mul_f32 v[6:7], v[190:191], v[252:253] op_sel:[0,0] op_sel_hi:[1,0] neg_lo:[0,1] neg_hi:[0,1]
    v_pk_mul_f32 v[8:9], v[220:221], v[252:253] op_sel:[0,0] op_sel_hi:[1,0] neg_lo:[0,1] neg_hi:[0,1]
    v_pk_mul_f32 v[10:11], v[222:223], v[252:253] op_sel:[0,0] op_sel_hi:[1,0] neg_lo:[0,1] neg_hi:[0,1]
    v_exp_f32 v4, v4 clamp
    v_exp_f32 v5, v5 clamp
    v_exp_f32 v6, v6 clamp
    v_exp_f32 v7, v7 clamp
    v_exp_f32 v8, v8 clamp
    v_exp_f32 v9, v9 clamp
    v_exp_f32 v10, v10 clamp
    v_exp_f32 v11, v11 clamp
    v_max_f32 v188, v255, v188
    v_max_f32 v189, v255, v189
    v_max_f32 v190, v255, v190
    v_max_f32 v191, v255, v191
    v_max_f32 v220, v255, v220
    v_max_f32 v221, v255, v221
    v_max_f32 v222, v255, v222
    v_max_f32 v223, v255, v223
    v_pk_fma_f32 v[188:189], v[188:189], v[254:255], v[4:5] op_sel_hi:[1,0,1]
    v_pk_fma_f32 v[190:191], v[190:191], v[254:255], v[6:7] op_sel_hi:[1,0,1]
    v_pk_fma_f32 v[220:221], v[220:221], v[254:255], v[8:9] op_sel_hi:[1,0,1]
    v_pk_fma_f32 v[222:223], v[222:223], v[254:255], v[10:11] op_sel_hi:[1,0,1]
    v_cvt_pk_bf16_f32 v188, v188, v189
    v_cvt_pk_bf16_f32 v189, v190, v191
    v_cvt_pk_bf16_f32 v190, v220, v221
    v_cvt_pk_bf16_f32 v191, v222, v223
    buffer_load_dwordx4 v[192:195], v1, s[44:47], s42 offen offset:0 sc1
    buffer_load_dwordx4 v[196:199], v1, s[44:47], s42 offen offset:16 sc1
    s_waitcnt vmcnt(35)
    s_mov_b32 s48, 0x20000
L_pollH1A:
    v_cmp_ne_u32 vcc, v3, v29
    s_sub_u32 s48, s48, 1
    s_nop 3
    s_cbranch_vccz L_pollH1A_d
    s_cmp_eq_u32 s48, 0
    s_cbranch_scc1 L_pollH1A_d
    s_sleep 1
    buffer_load_dword v29, v28, s[44:47], s53 offen sc1
    s_waitcnt vmcnt(0)
    s_branch L_pollH1A
L_pollH1A_d:
    v_lshrrev_b32 v26, 2, v2
    v_and_b32 v27, 7, v26
    v_lshlrev_b32 v26, 8, v26
    v_lshl_add_u32 v26, v27, 5, v26
    v_and_b32 v27, 3, v2
    v_lshl_add_u32 v26, v27, 3, v26
    s_lshl_b32 s52, s73, 10
    v_add_u32 v26, s52, v26
    v_xor_b32 v4, 128, v26
    v_xor_b32 v5, 160, v26
    v_xor_b32 v6, 192, v26
    v_xor_b32 v7, 224, v26
    v_xor_b32 v8, 0, v26
    v_xor_b32 v9, 32, v26
    v_xor_b32 v10, 64, v26
    v_xor_b32 v11, 96, v26
    s_lshr_b32 s30, 0x5a575552, s73
    s_mov_b32 s51, 0x64615f5c
    s_mov_b32 s31, 0x6e6b6966
    ds_read_b64_tr_b16 a[160:161], v4 offset:0
    ds_read_b64_tr_b16 a[162:163], v4 offset:4096
    ds_read_b64_tr_b16 a[164:165], v5 offset:0
    ds_read_b64_tr_b16 a[166:167], v5 offset:4096
    ds_read_b64_tr_b16 a[168:169], v6 offset:0
    ds_read_b64_tr_b16 a[170:171], v6 offset:4096
    ds_read_b64_tr_b16 a[172:173], v7 offset:0
    ds_read_b64_tr_b16 a[174:175], v7 offset:4096
    ds_read_b64_tr_b16 a[176:177], v8 offset:0
    ds_read_b64_tr_b16 a[178:179], v8 offset:4096
    ds_read_b64_tr_b16 a[180:181], v9 offset:0
    ds_read_b64_tr_b16 a[182:183], v9 offset:4096
    ds_read_b64_tr_b16 a[184:185], v10 offset:0
    ds_read_b64_tr_b16 a[186:187], v10 offset:4096
    ds_read_b64_tr_b16 a[188:189], v11 offset:0
    ds_read_b64_tr_b16 a[190:191], v11 offset:4096
    s_waitcnt vmcnt(27)
    v_pk_add_f32 v[32:33], v[32:33], v[48:49]
    v_pk_add_f32 v[34:35], v[34:35], v[50:51]
    v_pk_add_f32 v[36:37], v[36:37], v[52:53]
    v_pk_add_f32 v[38:39], v[38:39], v[54:55]
    v_pk_add_f32 v[40:41], v[40:41], v[56:57]
    v_pk_add_f32 v[42:43], v[42:43], v[58:59]
    v_pk_add_f32 v[44:45], v[44:45], v[60:61]
    v_pk_add_f32 v[46:47], v[46:47], v[62:63]
    s_lshr_b32 s40, 0x504d4b48, s73
    s_and_b32 s40, s40, 255
    s_lshl_b32 s40, s40, 13
    buffer_load_dwordx4 a[96:99], v21, s[12:15], s40 offen offset:0 sc1
    buffer_load_dwordx4 a[100:103], v21, s[12:15], s40 offen offset:1024 sc1
    s_waitcnt vmcnt(25)
    v_pk_add_f32 v[32:33], v[32:33], v[64:65]
    v_pk_add_f32 v[34:35], v[34:35], v[66:67]
    v_pk_add_f32 v[36:37], v[36:37], v[68:69]
    v_pk_add_f32 v[38:39], v[38:39], v[70:71]
    v_pk_add_f32 v[40:41], v[40:41], v[72:73]
    v_pk_add_f32 v[42:43], v[42:43], v[74:75]
    v_pk_add_f32 v[44:45], v[44:45], v[76:77]
    v_pk_add_f32 v[46:47], v[46:47], v[78:79]
    buffer_load_dwordx4 a[104:107], v22, s[12:15], s40 offen offset:0 sc1
    buffer_load_dwordx4 a[108:111], v22, s[12:15], s40 offen offset:1024 sc1
    s_waitcnt vmcnt(23)
    v_pk_add_f32 v[32:33], v[32:33], v[80:81]
    v_pk_add_f32 v[34:35], v[34:35], v[82:83]
    v_pk_add_f32 v[36:37], v[36:37], v[84:85]
    v_pk_add_f32 v[38:39], v[38:39], v[86:87]
    v_pk_add_f32 v[40:41], v[40:41], v[88:89]
    v_pk_add_f32 v[42:43], v[42:43], v[90:91]
    v_pk_add_f32 v[44:45], v[44:45], v[92:93]
    v_pk_add_f32 v[46:47], v[46:47], v[94:95]
    s_lshr_b32 s40, 0x504d, s73
    s_and_b32 s40, s40, 255
    s_lshl_b32 s40, s40, 13
    buffer_load_dwordx4 a[112:115], v21, s[12:15], s40 offen offset:0 sc1
    buffer_load_dwordx4 a[116:119], v21, s[12:15], s40 offen offset:1024 sc1
    s_waitcnt vmcnt(21)
    v_pk_add_f32 v[32:33], v[32:33], v[96:97]
    v_pk_add_f32 v[34:35], v[34:35], v[98:99]
    v_pk_add_f32 v[36:37], v[36:37], v[100:101]
    v_pk_add_f32 v[38:39], v[38:39], v[102:103]
    v_pk_add_f32 v[40:41], v[40:41], v[104:105]
    v_pk_add_f32 v[42:43], v[42:43], v[106:107]
    v_pk_add_f32 v[44:45], v[44:45], v[108:109]
    v_pk_add_f32 v[46:47], v[46:47], v[110:111]
    buffer_load_dwordx4 a[120:123], v22, s[12:15], s40 offen offset:0 sc1
    buffer_load_dwordx4 a[124:127], v22, s[12:15], s40 offen offset:1024 sc1
    s_waitcnt vmcnt(19)
    v_pk_add_f32 v[32:33], v[32:33], v[112:113]
    v_pk_add_f32 v[34:35], v[34:35], v[114:115]
    v_pk_add_f32 v[36:37], v[36:37], v[116:117]
    v_pk_add_f32 v[38:39], v[38:39], v[118:119]
    v_pk_add_f32 v[40:41], v[40:41], v[120:121]
    v_pk_add_f32 v[42:43], v[42:43], v[122:123]
    v_pk_add_f32 v[44:45], v[44:45], v[124:125]
    v_pk_add_f32 v[46:47], v[46:47], v[126:127]
    s_lshr_b32 s40, 0x5a575552, s73
    s_and_b32 s40, s40, 255
    s_lshl_b32 s40, s40, 13
    buffer_load_dwordx4 a[128:131], v21, s[12:15], s40 offen offset:0 sc1
    buffer_load_dwordx4 a[132:135], v21, s[12:15], s40 offen offset:1024 sc1
    s_waitcnt vmcnt(16)
    v_pk_add_f32 v[32:33], v[32:33], v[128:129]
    v_pk_add_f32 v[34:35], v[34:35], v[130:131]
    v_pk_add_f32 v[36:37], v[36:37], v[132:133]
    v_pk_add_f32 v[38:39], v[38:39], v[134:135]
    v_pk_add_f32 v[40:41], v[40:41], v[136:137]
    v_pk_add_f32 v[42:43], v[42:43], v[138:139]
    v_pk_add_f32 v[44:45], v[44:45], v[140:141]
    v_pk_add_f32 v[46:47], v[46:47], v[142:143]
    buffer_load_dwordx4 a[136:139], v22, s[12:15], s40 offen offset:0 sc1
    buffer_load_dwordx4 a[140:143], v22, s[12:15], s40 offen offset:1024 sc1
    s_waitcnt vmcnt(14)
    v_pk_add_f32 v[32:33], v[32:33], v[144:145]
    v_pk_add_f32 v[34:35], v[34:35], v[146:147]
    v_pk_add_f32 v[36:37], v[36:37], v[148:149]
    v_pk_add_f32 v[38:39], v[38:39], v[150:151]
    v_pk_add_f32 v[40:41], v[40:41], v[152:153]
    v_pk_add_f32 v[42:43], v[42:43], v[154:155]
    v_pk_add_f32 v[44:45], v[44:45], v[156:157]
    v_pk_add_f32 v[46:47], v[46:47], v[158:159]
    s_waitcnt vmcnt(12)
    v_add_f32_dpp v192, v192, v192 quad_perm:[1,0,3,2] row_mask:0xf bank_mask:0xf
    v_add_f32_dpp v193, v193, v193 quad_perm:[1,0,3,2] row_mask:0xf bank_mask:0xf
    v_add_f32_dpp v194, v194, v194 quad_perm:[1,0,3,2] row_mask:0xf bank_mask:0xf
    v_add_f32_dpp v195, v195, v195 quad_perm:[1,0,3,2] row_mask:0xf bank_mask:0xf
    v_add_f32_dpp v196, v196, v196 quad_perm:[1,0,3,2] row_mask:0xf bank_mask:0xf
    v_add_f32_dpp v197, v197, v197 quad_perm:[1,0,3,2] row_mask:0xf bank_mask:0xf
    v_add_f32_dpp v198, v198, v198 quad_perm:[1,0,3,2] row_mask:0xf bank_mask:0xf
    v_add_f32_dpp v199, v199, v199 quad_perm:[1,0,3,2] row_mask:0xf bank_mask:0xf
    v_add_f32_dpp v192, v192, v192 quad_perm:[2,3,0,1] row_mask:0xf bank_mask:0xf
    v_add_f32_dpp v193, v193, v193 quad_perm:[2,3,0,1] row_mask:0xf bank_mask:0xf
    v_add_f32_dpp v194, v194, v194 quad_perm:[2,3,0,1] row_mask:0xf bank_mask:0xf
    v_add_f32_dpp v195, v195, v195 quad_perm:[2,3,0,1] row_mask:0xf bank_mask:0xf
    v_add_f32_dpp v196, v196, v196 quad_perm:[2,3,0,1] row_mask:0xf bank_mask:0xf
    v_add_f32_dpp v197, v197, v197 quad_perm:[2,3,0,1] row_mask:0xf bank_mask:0xf
    v_add_f32_dpp v198, v198, v198 quad_perm:[2,3,0,1] row_mask:0xf bank_mask:0xf
    v_add_f32_dpp v199, v199, v199 quad_perm:[2,3,0,1] row_mask:0xf bank_mask:0xf
    v_add_f32_dpp v192, v192, v192 row_half_mirror row_mask:0xf bank_mask:0xf
    v_add_f32_dpp v193, v193, v193 row_half_mirror row_mask:0xf bank_mask:0xf
    v_add_f32_dpp v194, v194, v194 row_half_mirror row_mask:0xf bank_mask:0xf
    v_add_f32_dpp v195, v195, v195 row_half_mirror row_mask:0xf bank_mask:0xf
    v_add_f32_dpp v196, v196, v196 row_half_mirror row_mask:0xf bank_mask:0xf
    v_add_f32_dpp v197, v197, v197 row_half_mirror row_mask:0xf bank_mask:0xf
    v_add_f32_dpp v198, v198, v198 row_half_mirror row_mask:0xf bank_mask:0xf
    v_add_f32_dpp v199, v199, v199 row_half_mirror row_mask:0xf bank_mask:0xf
    v_cvt_pk_bf16_f32 v48, v32, v33
    v_cvt_pk_bf16_f32 v49, v34, v35
    v_cvt_pk_bf16_f32 v50, v36, v37
    v_cvt_pk_bf16_f32 v51, v38, v39
    v_cvt_pk_bf16_f32 v52, v40, v41
    v_cvt_pk_bf16_f32 v53, v42, v43
    v_cvt_pk_bf16_f32 v54, v44, v45
    v_cvt_pk_bf16_f32 v55, v46, v47
    v_cvt_pk_bf16_f32 v56, v192, v193
    v_cvt_pk_bf16_f32 v57, v194, v195
    v_cvt_pk_bf16_f32 v58, v196, v197
    v_cvt_pk_bf16_f32 v59, v198, v199
    s_add_u32 s61, s58, 112
    s_lshl_b32 s61, s61, 13
    s_add_u32 s61, s61, s65
    s_nop 0
    v_mfma_f32_16x16x32_bf16 v[64:67], v[48:51], v[160:163], 0
    v_mfma_f32_16x16x32_bf16 v[68:71], v[52:55], v[160:163], 0
    v_mfma_f32_16x16x32_bf16 v[72:75], v[56:59], v[160:163], 0
    v_mfma_f32_16x16x32_bf16 v[76:79], v[48:51], v[164:167], 0
    v_mfma_f32_16x16x32_bf16 v[80:83], v[52:55], v[164:167], 0
    v_mfma_f32_16x16x32_bf16 v[84:87], v[56:59], v[164:167], 0
    v_mfma_f32_16x16x32_bf16 v[88:91], v[48:51], v[168:171], 0
    v_mfma_f32_16x16x32_bf16 v[92:95], v[52:55], v[168:171], 0
    v_mfma_f32_16x16x32_bf16 v[96:99], v[56:59], v[168:171], 0
    v_mfma_f32_16x16x32_bf16 v[100:103], v[48:51], v[172:175], 0
    v_mfma_f32_16x16x32_bf16 v[104:107], v[52:55], v[172:175], 0
    v_mfma_f32_16x16x32_bf16 v[108:111], v[56:59], v[172:175], 0
    v_mfma_f32_16x16x32_bf16 v[112:115], v[48:51], v[176:179], 0
    v_mfma_f32_16x16x32_bf16 v[116:119], v[52:55], v[176:179], 0
    v_mfma_f32_16x16x32_bf16 v[120:123], v[56:59], v[176:179], 0
    v_mfma_f32_16x16x32_bf16 v[124:127], v[48:51], v[180:183], 0
    v_mfma_f32_16x16x32_bf16 v[128:131], v[52:55], v[180:183], 0
    v_mfma_f32_16x16x32_bf16 v[132:135], v[56:59], v[180:183], 0
    v_mfma_f32_16x16x32_bf16 v[136:139], v[48:51], v[184:187], 0
    v_mfma_f32_16x16x32_bf16 v[140:143], v[52:55], v[184:187], 0
    v_mfma_f32_16x16x32_bf16 v[144:147], v[56:59], v[184:187], 0
    v_mfma_f32_16x16x32_bf16 v[148:151], v[48:51], v[188:191], 0
    v_mfma_f32_16x16x32_bf16 v[152:155], v[52:55], v[188:191], 0
    v_mfma_f32_16x16x32_bf16 v[156:159], v[56:59], v[188:191], 0
    s_nop 7
    v_add_f32 v72, 0x358637bd, v72
    v_add_f32 v84, 0x358637bd, v84
    v_add_f32 v96, 0x358637bd, v96
    v_add_f32 v108, 0x358637bd, v108
    v_add_f32 v120, 0x358637bd, v120
    v_add_f32 v132, 0x358637bd, v132
    v_add_f32 v144, 0x358637bd, v144
    v_add_f32 v156, 0x358637bd, v156
    v_rcp_f32 v72, v72
    v_rcp_f32 v84, v84
    v_rcp_f32 v96, v96
    v_rcp_f32 v108, v108
    v_rcp_f32 v120, v120
    v_rcp_f32 v132, v132
    v_rcp_f32 v144, v144
    v_rcp_f32 v156, v156
    v_pk_mul_f32 v[64:65], v[64:65], v[72:73] op_sel:[0,0] op_sel_hi:[1,0]
    v_pk_mul_f32 v[66:67], v[66:67], v[72:73] op_sel:[0,0] op_sel_hi:[1,0]
    v_pk_mul_f32 v[68:69], v[68:69], v[72:73] op_sel:[0,0] op_sel_hi:[1,0]
    v_pk_mul_f32 v[70:71], v[70:71], v[72:73] op_sel:[0,0] op_sel_hi:[1,0]
    v_cvt_pk_bf16_f32 v72, v64, v65
    v_cvt_pk_bf16_f32 v73, v66, v67
    v_cvt_pk_bf16_f32 v74, v68, v69
    v_cvt_pk_bf16_f32 v75, v70, v71
    buffer_store_dwordx4 v[72:75], v12, s[32:35], s61 offen offset:0 sc1
    v_pk_mul_f32 v[76:77], v[76:77], v[84:85] op_sel:[0,0] op_sel_hi:[1,0]
    v_pk_mul_f32 v[78:79], v[78:79], v[84:85] op_sel:[0,0] op_sel_hi:[1,0]
    v_pk_mul_f32 v[80:81], v[80:81], v[84:85] op_sel:[0,0] op_sel_hi:[1,0]
    v_pk_mul_f32 v[82:83], v[82:83], v[84:85] op_sel:[0,0] op_sel_hi:[1,0]
    v_cvt_pk_bf16_f32 v84, v76, v77
    v_cvt_pk_bf16_f32 v85, v78, v79
    v_cvt_pk_bf16_f32 v86, v80, v81
    v_cvt_pk_bf16_f32 v87, v82, v83
    buffer_store_dwordx4 v[84:87], v12, s[32:35], s61 offen offset:1024 sc1
    v_pk_mul_f32 v[88:89], v[88:89], v[96:97] op_sel:[0,0] op_sel_hi:[1,0]
    v_pk_mul_f32 v[90:91], v[90:91], v[96:97] op_sel:[0,0] op_sel_hi:[1,0]
    v_pk_mul_f32 v[92:93], v[92:93], v[96:97] op_sel:[0,0] op_sel_hi:[1,0]
    v_pk_mul_f32 v[94:95], v[94:95], v[96:97] op_sel:[0,0] op_sel_hi:[1,0]
    v_cvt_pk_bf16_f32 v96, v88, v89
    v_cvt_pk_bf16_f32 v97, v90, v91
    v_cvt_pk_bf16_f32 v98, v92, v93
    v_cvt_pk_bf16_f32 v99, v94, v95
    buffer_store_dwordx4 v[96:99], v12, s[32:35], s61 offen offset:2048 sc1
    v_pk_mul_f32 v[100:101], v[100:101], v[108:109] op_sel:[0,0] op_sel_hi:[1,0]
    v_pk_mul_f32 v[102:103], v[102:103], v[108:109] op_sel:[0,0] op_sel_hi:[1,0]
    v_pk_mul_f32 v[104:105], v[104:105], v[108:109] op_sel:[0,0] op_sel_hi:[1,0]
    v_pk_mul_f32 v[106:107], v[106:107], v[108:109] op_sel:[0,0] op_sel_hi:[1,0]
    v_cvt_pk_bf16_f32 v108, v100, v101
    v_cvt_pk_bf16_f32 v109, v102, v103
    v_cvt_pk_bf16_f32 v110, v104, v105
    v_cvt_pk_bf16_f32 v111, v106, v107
    buffer_store_dwordx4 v[108:111], v12, s[32:35], s61 offen offset:3072 sc1
    v_pk_mul_f32 v[112:113], v[112:113], v[120:121] op_sel:[0,0] op_sel_hi:[1,0]
    v_pk_mul_f32 v[114:115], v[114:115], v[120:121] op_sel:[0,0] op_sel_hi:[1,0]
    v_pk_mul_f32 v[116:117], v[116:117], v[120:121] op_sel:[0,0] op_sel_hi:[1,0]
    v_pk_mul_f32 v[118:119], v[118:119], v[120:121] op_sel:[0,0] op_sel_hi:[1,0]
    v_cvt_pk_bf16_f32 v120, v112, v113
    v_cvt_pk_bf16_f32 v121, v114, v115
    v_cvt_pk_bf16_f32 v122, v116, v117
    v_cvt_pk_bf16_f32 v123, v118, v119
    buffer_store_dwordx4 v[120:123], v23, s[32:35], s61 offen offset:0 sc1
    v_pk_mul_f32 v[124:125], v[124:125], v[132:133] op_sel:[0,0] op_sel_hi:[1,0]
    v_pk_mul_f32 v[126:127], v[126:127], v[132:133] op_sel:[0,0] op_sel_hi:[1,0]
    v_pk_mul_f32 v[128:129], v[128:129], v[132:133] op_sel:[0,0] op_sel_hi:[1,0]
    v_pk_mul_f32 v[130:131], v[130:131], v[132:133] op_sel:[0,0] op_sel_hi:[1,0]
    v_cvt_pk_bf16_f32 v132, v124, v125
    v_cvt_pk_bf16_f32 v133, v126, v127
    v_cvt_pk_bf16_f32 v134, v128, v129
    v_cvt_pk_bf16_f32 v135, v130, v131
    buffer_store_dwordx4 v[132:135], v23, s[32:35], s61 offen offset:1024 sc1
    v_pk_mul_f32 v[136:137], v[136:137], v[144:145] op_sel:[0,0] op_sel_hi:[1,0]
    v_pk_mul_f32 v[138:139], v[138:139], v[144:145] op_sel:[0,0] op_sel_hi:[1,0]
    v_pk_mul_f32 v[140:141], v[140:141], v[144:145] op_sel:[0,0] op_sel_hi:[1,0]
    v_pk_mul_f32 v[142:143], v[142:143], v[144:145] op_sel:[0,0] op_sel_hi:[1,0]
    v_cvt_pk_bf16_f32 v144, v136, v137
    v_cvt_pk_bf16_f32 v145, v138, v139
    v_cvt_pk_bf16_f32 v146, v140, v141
    v_cvt_pk_bf16_f32 v147, v142, v143
    buffer_store_dwordx4 v[144:147], v23, s[32:35], s61 offen offset:2048 sc1
    v_pk_mul_f32 v[148:149], v[148:149], v[156:157] op_sel:[0,0] op_sel_hi:[1,0]
    v_pk_mul_f32 v[150:151], v[150:151], v[156:157] op_sel:[0,0] op_sel_hi:[1,0]
    v_pk_mul_f32 v[152:153], v[152:153], v[156:157] op_sel:[0,0] op_sel_hi:[1,0]
    v_pk_mul_f32 v[154:155], v[154:155], v[156:157] op_sel:[0,0] op_sel_hi:[1,0]
    v_cvt_pk_bf16_f32 v156, v148, v149
    v_cvt_pk_bf16_f32 v157, v150, v151
    v_cvt_pk_bf16_f32 v158, v152, v153
    v_cvt_pk_bf16_f32 v159, v154, v155
    buffer_store_dwordx4 v[156:159], v23, s[32:35], s61 offen offset:3072 sc1
    v_max_u32 v28, 16, v2
    v_min_u32 v28, 31, v28
    v_lshlrev_b32 v28, 2, v28
    s_add_u32 s53, s76, 0x1e4000
    s_waitcnt vmcnt(16)
    s_waitcnt lgkmcnt(12)
    v_mfma_f32_16x16x32_bf16 v[128:131], a[160:163], a[96:99], 0
    v_mfma_f32_16x16x32_bf16 v[160:163], a[160:163], a[100:103], 0
    v_mfma_f32_16x16x32_bf16 v[192:195], a[160:163], a[104:107], 0
    v_mfma_f32_16x16x32_bf16 v[224:227], a[160:163], a[108:111], 0
    ds_read_b64_tr_b16 a[160:161], v4 offset:16384
    ds_read_b64_tr_b16 a[162:163], v4 offset:20480
    v_mfma_f32_16x16x32_bf16 v[132:135], a[164:167], a[96:99], 0
    s_bfe_u32 s40, s30, 0x80010
    v_mfma_f32_16x16x32_bf16 v[164:167], a[164:167], a[100:103], 0
    s_lshl_b32 s40, s40, 13
    v_mfma_f32_16x16x32_bf16 v[196:199], a[164:167], a[104:107], 0
    buffer_load_dwordx4 a[144:147], v21, s[12:15], s40 offen offset:0 sc1
    v_mfma_f32_16x16x32_bf16 v[228:231], a[164:167], a[108:111], 0
    ds_read_b64_tr_b16 a[164:165], v5 offset:16384
    ds_read_b64_tr_b16 a[166:167], v5 offset:20480
    s_waitcnt lgkmcnt(12)
    v_mfma_f32_16x16x32_bf16 v[136:139], a[168:171], a[96:99], 0
    v_mfma_f32_16x16x32_bf16 v[168:171], a[168:171], a[100:103], 0
    s_lshr_b32 s30, s51, s73
    v_mfma_f32_16x16x32_bf16 v[200:203], a[168:171], a[104:107], 0
    v_mfma_f32_16x16x32_bf16 v[232:235], a[168:171], a[108:111], 0
    ds_read_b64_tr_b16 a[168:169], v6 offset:16384
    ds_read_b64_tr_b16 a[170:171], v6 offset:20480
    v_mfma_f32_16x16x32_bf16 v[140:143], a[172:175], a[96:99], 0
    s_mov_b32 s51, s31
    v_mfma_f32_16x16x32_bf16 v[172:175], a[172:175], a[100:103], 0
    s_add_u32 s41, s41, 1
    v_mfma_f32_16x16x32_bf16 v[204:207], a[172:175], a[104:107], 0
    buffer_load_dwordx4 a[148:151], v21, s[12:15], s40 offen offset:1024 sc1
    v_mfma_f32_16x16x32_bf16 v[236:239], a[172:175], a[108:111], 0
    ds_read_b64_tr_b16 a[172:173], v7 offset:16384
    ds_read_b64_tr_b16 a[174:175], v7 offset:20480
    s_waitcnt lgkmcnt(12)
    v_mfma_f32_16x16x32_bf16 v[144:147], a[176:179], a[96:99], 0
    v_mfma_f32_16x16x32_bf16 v[176:179], a[176:179], a[100:103], 0
    v_readlane_b32 s31, v18, s41
    v_mfma_f32_16x16x32_bf16 v[208:211], a[176:179], a[104:107], 0
    v_mfma_f32_16x16x32_bf16 v[240:243], a[176:179], a[108:111], 0
    ds_read_b64_tr_b16 a[176:177], v8 offset:16384
    ds_read_b64_tr_b16 a[178:179], v8 offset:20480
    v_mfma_f32_16x16x32_bf16 v[148:151], a[180:183], a[96:99], 0
    s_cmp_eq_u32 s63, 0x20000
    s_cselect_b32 s62, s64, 0x8000
    v_mfma_f32_16x16x32_bf16 v[180:183], a[180:183], a[100:103], 0
    v_mfma_f32_16x16x32_bf16 v[212:215], a[180:183], a[104:107], 0
    buffer_load_dwordx4 a[152:155], v22, s[12:15], s40 offen offset:0 sc1
    v_mfma_f32_16x16x32_bf16 v[244:247], a[180:183], a[108:111], 0
    ds_read_b64_tr_b16 a[180:181], v9 offset:16384
    ds_read_b64_tr_b16 a[182:183], v9 offset:20480
    s_waitcnt lgkmcnt(12)
    v_mfma_f32_16x16x32_bf16 v[152:155], a[184:187], a[96:99], 0
    s_add_u32 s63, s63, s62
    v_mfma_f32_16x16x32_bf16 v[184:187], a[184:187], a[100:103], 0
    v_mfma_f32_16x16x32_bf16 v[216:219], a[184:187], a[104:107], 0
    v_mfma_f32_16x16x32_bf16 v[248:251], a[184:187], a[108:111], 0
    ds_read_b64_tr_b16 a[184:185], v10 offset:16384
    ds_read_b64_tr_b16 a[186:187], v10 offset:20480
    v_mfma_f32_16x16x32_bf16 v[156:159], a[188:191], a[96:99], 0
    v_mfma_f32_16x16x32_bf16 v[188:191], a[188:191], a[100:103], 0
    v_mfma_f32_16x16x32_bf16 v[220:223], a[188:191], a[104:107], 0
    buffer_load_dwordx4 a[156:159], v22, s[12:15], s40 offen offset:1024 sc1
    v_mfma_f32_16x16x32_bf16 v[252:255], a[188:191], a[108:111], 0
    ds_read_b64_tr_b16 a[188:189], v11 offset:16384
    ds_read_b64_tr_b16 a[190:191], v11 offset:20480
    s_waitcnt vmcnt(16)
    s_barrier
    s_waitcnt lgkmcnt(12)
    v_mfma_f32_16x16x32_bf16 v[128:131], a[160:163], a[112:115], v[128:131]
    v_add_u32 v4, s62, v4
    v_mfma_f32_16x16x32_bf16 v[160:163], a[160:163], a[116:119], v[160:163]
    v_mfma_f32_16x16x32_bf16 v[192:195], a[160:163], a[120:123], v[192:195]
    v_mfma_f32_16x16x32_bf16 v[224:227], a[160:163], a[124:127], v[224:227]
    ds_read_b64_tr_b16 a[160:161], v4 offset:0
    ds_read_b64_tr_b16 a[162:163], v4 offset:4096
    v_mfma_f32_16x16x32_bf16 v[132:135], a[164:167], a[112:115], v[132:135]
    s_bfe_u32 s40, s30, 0x80000
    v_add_u32 v5, s62, v5
    v_mfma_f32_16x16x32_bf16 v[164:167], a[164:167], a[116:119], v[164:167]
    s_lshl_b32 s40, s40, 13
    v_mfma_f32_16x16x32_bf16 v[196:199], a[164:167], a[120:123], v[196:199]
    buffer_load_dwordx4 a[96:99], v21, s[12:15], s40 offen offset:0 sc1
    v_mfma_f32_16x16x32_bf16 v[228:231], a[164:167], a[124:127], v[228:231]
    ds_read_b64_tr_b16 a[164:165], v5 offset:0
    ds_read_b64_tr_b16 a[166:167], v5 offset:4096
    s_waitcnt lgkmcnt(12)
    v_mfma_f32_16x16x32_bf16 v[136:139], a[168:171], a[112:115], v[136:139]
    v_add_u32 v6, s62, v6
    v_mfma_f32_16x16x32_bf16 v[168:171], a[168:171], a[116:119], v[168:171]
    v_mfma_f32_16x16x32_bf16 v[200:203], a[168:171], a[120:123], v[200:203]
    v_mfma_f32_16x16x32_bf16 v[232:235], a[168:171], a[124:127], v[232:235]
    ds_read_b64_tr_b16 a[168:169], v6 offset:0
    ds_read_b64_tr_b16 a[170:171], v6 offset:4096
    v_mfma_f32_16x16x32_bf16 v[140:143], a[172:175], a[112:115], v[140:143]
    v_add_u32 v7, s62, v7
    v_mfma_f32_16x16x32_bf16 v[172:175], a[172:175], a[116:119], v[172:175]
    v_mfma_f32_16x16x32_bf16 v[204:207], a[172:175], a[120:123], v[204:207]
    buffer_load_dwordx4 a[100:103], v21, s[12:15], s40 offen offset:1024 sc1
    v_mfma_f32_16x16x32_bf16 v[236:239], a[172:175], a[124:127], v[236:239]
    ds_read_b64_tr_b16 a[172:173], v7 offset:0
    ds_read_b64_tr_b16 a[174:175], v7 offset:4096
    s_waitcnt lgkmcnt(12)
    v_mfma_f32_16x16x32_bf16 v[144:147], a[176:179], a[112:115], v[144:147]
    v_add_u32 v8, s62, v8
    v_mfma_f32_16x16x32_bf16 v[176:179], a[176:179], a[116:119], v[176:179]
    v_mfma_f32_16x16x32_bf16 v[208:211], a[176:179], a[120:123], v[208:211]
    v_mfma_f32_16x16x32_bf16 v[240:243], a[176:179], a[124:127], v[240:243]
    ds_read_b64_tr_b16 a[176:177], v8 offset:0
    ds_read_b64_tr_b16 a[178:179], v8 offset:4096
    v_mfma_f32_16x16x32_bf16 v[148:151], a[180:183], a[112:115], v[148:151]
    v_add_u32 v9, s62, v9
    v_mfma_f32_16x16x32_bf16 v[180:183], a[180:183], a[116:119], v[180:183]
    v_mfma_f32_16x16x32_bf16 v[212:215], a[180:183], a[120:123], v[212:215]
    buffer_load_dwordx4 a[104:107], v22, s[12:15], s40 offen offset:0 sc1
    v_mfma_f32_16x16x32_bf16 v[244:247], a[180:183], a[124:127], v[244:247]
    ds_read_b64_tr_b16 a[180:181], v9 offset:0
    ds_read_b64_tr_b16 a[182:183], v9 offset:4096
    s_waitcnt lgkmcnt(12)
    v_mfma_f32_16x16x32_bf16 v[152:155], a[184:187], a[112:115], v[152:155]
    v_add_u32 v10, s62, v10
    v_mfma_f32_16x16x32_bf16 v[184:187], a[184:187], a[116:119], v[184:187]
    s_cmp_ge_u32 s71, 0x20000
    s_cselect_b32 s52, s64, 0x8000
    v_mfma_f32_16x16x32_bf16 v[216:219], a[184:187], a[120:123], v[216:219]
    v_mfma_f32_16x16x32_bf16 v[248:251], a[184:187], a[124:127], v[248:251]
    ds_read_b64_tr_b16 a[184:185], v10 offset:0
    ds_read_b64_tr_b16 a[186:187], v10 offset:4096
    v_mfma_f32_16x16x32_bf16 v[156:159], a[188:191], a[112:115], v[156:159]
    v_add_u32 v11, s62, v11
    v_mfma_f32_16x16x32_bf16 v[188:191], a[188:191], a[116:119], v[188:191]
    s_add_u32 s71, s71, s52
    v_mfma_f32_16x16x32_bf16 v[220:223], a[188:191], a[120:123], v[220:223]
    buffer_load_dwordx4 a[108:111], v22, s[12:15], s40 offen offset:1024 sc1
    v_mfma_f32_16x16x32_bf16 v[252:255], a[188:191], a[124:127], v[252:255]
    ds_read_b64_tr_b16 a[188:189], v11 offset:0
    ds_read_b64_tr_b16 a[190:191], v11 offset:4096
    s_waitcnt vmcnt(16)
    s_waitcnt lgkmcnt(12)
    v_mfma_f32_16x16x32_bf16 v[128:131], a[160:163], a[128:131], v[128:131]
    v_mfma_f32_16x16x32_bf16 v[160:163], a[160:163], a[132:135], v[160:163]
    v_mfma_f32_16x16x32_bf16 v[192:195], a[160:163], a[136:139], v[192:195]
    v_mfma_f32_16x16x32_bf16 v[224:227], a[160:163], a[140:143], v[224:227]
    ds_read_b64_tr_b16 a[160:161], v4 offset:16384
    ds_read_b64_tr_b16 a[162:163], v4 offset:20480
    v_mfma_f32_16x16x32_bf16 v[132:135], a[164:167], a[128:131], v[132:135]
    s_bfe_u32 s40, s30, 0x80010
    v_mfma_f32_16x16x32_bf16 v[164:167], a[164:167], a[132:135], v[164:167]
    s_lshl_b32 s40, s40, 13
    v_mfma_f32_16x16x32_bf16 v[196:199], a[164:167], a[136:139], v[196:199]
    buffer_load_dwordx4 a[112:115], v21, s[12:15], s40 offen offset:0 sc1
    v_mfma_f32_16x16x32_bf16 v[228:231], a[164:167], a[140:143], v[228:231]
    ds_read_b64_tr_b16 a[164:165], v5 offset:16384
    ds_read_b64_tr_b16 a[166:167], v5 offset:20480
    s_waitcnt lgkmcnt(12)
    v_mfma_f32_16x16x32_bf16 v[136:139], a[168:171], a[128:131], v[136:139]
    buffer_load_dword v29, v28, s[44:47], s53 offen sc1
    v_mfma_f32_16x16x32_bf16 v[168:171], a[168:171], a[132:135], v[168:171]
    s_lshr_b32 s30, s51, s73
    v_mfma_f32_16x16x32_bf16 v[200:203], a[168:171], a[136:139], v[200:203]
    v_mfma_f32_16x16x32_bf16 v[232:235], a[168:171], a[140:143], v[232:235]
    ds_read_b64_tr_b16 a[168:169], v6 offset:16384
    ds_read_b64_tr_b16 a[170:171], v6 offset:20480
    v_mfma_f32_16x16x32_bf16 v[140:143], a[172:175], a[128:131], v[140:143]
    s_mov_b32 s51, s31
    v_mfma_f32_16x16x32_bf16 v[172:175], a[172:175], a[132:135], v[172:175]
    s_add_u32 s41, s41, 1
    v_mfma_f32_16x16x32_bf16 v[204:207], a[172:175], a[136:139], v[204:207]
    buffer_load_dwordx4 a[116:119], v21, s[12:15], s40 offen offset:1024 sc1
    v_mfma_f32_16x16x32_bf16 v[236:239], a[172:175], a[140:143], v[236:239]
    ds_read_b64_tr_b16 a[172:173], v7 offset:16384
    ds_read_b64_tr_b16 a[174:175], v7 offset:20480
    s_waitcnt lgkmcnt(12)
    v_mfma_f32_16x16x32_bf16 v[144:147], a[176:179], a[128:131], v[144:147]
    v_mfma_f32_16x16x32_bf16 v[176:179], a[176:179], a[132:135], v[176:179]
    v_readlane_b32 s31, v18, s41
    v_mfma_f32_16x16x32_bf16 v[208:211], a[176:179], a[136:139], v[208:211]
    v_mfma_f32_16x16x32_bf16 v[240:243], a[176:179], a[140:143], v[240:243]
    ds_read_b64_tr_b16 a[176:177], v8 offset:16384
    ds_read_b64_tr_b16 a[178:179], v8 offset:20480
    v_mfma_f32_16x16x32_bf16 v[148:151], a[180:183], a[128:131], v[148:151]
    s_cmp_eq_u32 s63, 0x20000
    s_cselect_b32 s62, s64, 0x8000
    v_mfma_f32_16x16x32_bf16 v[180:183], a[180:183], a[132:135], v[180:183]
    v_mfma_f32_16x16x32_bf16 v[212:215], a[180:183], a[136:139], v[212:215]
    buffer_load_dwordx4 a[120:123], v22, s[12:15], s40 offen offset:0 sc1
    v_mfma_f32_16x16x32_bf16 v[244:247], a[180:183], a[140:143], v[244:247]
    ds_read_b64_tr_b16 a[180:181], v9 offset:16384
    ds_read_b64_tr_b16 a[182:183], v9 offset:20480
    s_waitcnt lgkmcnt(12)
    v_mfma_f32_16x16x32_bf16 v[152:155], a[184:187], a[128:131], v[152:155]
    s_add_u32 s63, s63, s62
    v_mfma_f32_16x16x32_bf16 v[184:187], a[184:187], a[132:135], v[184:187]
    v_mfma_f32_16x16x32_bf16 v[216:219], a[184:187], a[136:139], v[216:219]
    v_mfma_f32_16x16x32_bf16 v[248:251], a[184:187], a[140:143], v[248:251]
    ds_read_b64_tr_b16 a[184:185], v10 offset:16384
    ds_read_b64_tr_b16 a[186:187], v10 offset:20480
    v_mfma_f32_16x16x32_bf16 v[156:159], a[188:191], a[128:131], v[156:159]
    v_mfma_f32_16x16x32_bf16 v[188:191], a[188:191], a[132:135], v[188:191]
    v_mfma_f32_16x16x32_bf16 v[220:223], a[188:191], a[136:139], v[220:223]
    buffer_load_dwordx4 a[124:127], v22, s[12:15], s40 offen offset:1024 sc1
    v_mfma_f32_16x16x32_bf16 v[252:255], a[188:191], a[140:143], v[252:255]
    ds_read_b64_tr_b16 a[188:189], v11 offset:16384
    ds_read_b64_tr_b16 a[190:191], v11 offset:20480
    s_waitcnt vmcnt(9)
    s_barrier
    s_waitcnt lgkmcnt(12)
    v_mfma_f32_16x16x32_bf16 v[128:131], a[160:163], a[144:147], v[128:131]
    v_add_u32 v4, s62, v4
    v_mfma_f32_16x16x32_bf16 v[160:163], a[160:163], a[148:151], v[160:163]
    v_mfma_f32_16x16x32_bf16 v[192:195], a[160:163], a[152:155], v[192:195]
    v_mfma_f32_16x16x32_bf16 v[224:227], a[160:163], a[156:159], v[224:227]
    ds_read_b64_tr_b16 a[160:161], v4 offset:0
    ds_read_b64_tr_b16 a[162:163], v4 offset:4096
    v_mfma_f32_16x16x32_bf16 v[132:135], a[164:167], a[144:147], v[132:135]
    s_bfe_u32 s40, s30, 0x80000
    v_add_u32 v5, s62, v5
    v_mfma_f32_16x16x32_bf16 v[164:167], a[164:167], a[148:151], v[164:167]
    s_lshl_b32 s40, s40, 13
    v_mfma_f32_16x16x32_bf16 v[196:199], a[164:167], a[152:155], v[196:199]
    buffer_load_dwordx4 a[128:131], v21, s[12:15], s40 offen offset:0 sc1
    v_mfma_f32_16x16x32_bf16 v[228:231], a[164:167], a[156:159], v[228:231]
    ds_read_b64_tr_b16 a[164:165], v5 offset:0
    ds_read_b64_tr_b16 a[166:167], v5 offset:4096
    s_waitcnt lgkmcnt(12)
    v_mfma_f32_16x16x32_bf16 v[136:139], a[168:171], a[144:147], v[136:139]
    v_add_u32 v6, s62, v6
    v_mfma_f32_16x16x32_bf16 v[168:171], a[168:171], a[148:151], v[168:171]
    v_mfma_f32_16x16x32_bf16 v[200:203], a[168:171], a[152:155], v[200:203]
    v_mfma_f32_16x16x32_bf16 v[232:235], a[168:171], a[156:159], v[232:235]
    ds_read_b64_tr_b16 a[168:169], v6 offset:0
    ds_read_b64_tr_b16 a[170:171], v6 offset:4096
    v_mfma_f32_16x16x32_bf16 v[140:143], a[172:175], a[144:147], v[140:143]
    v_add_u32 v7, s62, v7
    v_mfma_f32_16x16x32_bf16 v[172:175], a[172:175], a[148:151], v[172:175]
    v_mfma_f32_16x16x32_bf16 v[204:207], a[172:175], a[152:155], v[204:207]
    buffer_load_dwordx4 a[132:135], v21, s[12:15], s40 offen offset:1024 sc1
    v_mfma_f32_16x16x32_bf16 v[236:239], a[172:175], a[156:159], v[236:239]
    ds_read_b64_tr_b16 a[172:173], v7 offset:0
    ds_read_b64_tr_b16 a[174:175], v7 offset:4096
    s_waitcnt lgkmcnt(12)
    v_mfma_f32_16x16x32_bf16 v[144:147], a[176:179], a[144:147], v[144:147]
    v_add_u32 v8, s62, v8
    v_mfma_f32_16x16x32_bf16 v[176:179], a[176:179], a[148:151], v[176:179]
    v_mfma_f32_16x16x32_bf16 v[208:211], a[176:179], a[152:155], v[208:211]
    v_mfma_f32_16x16x32_bf16 v[240:243], a[176:179], a[156:159], v[240:243]
    ds_read_b64_tr_b16 a[176:177], v8 offset:0
    ds_read_b64_tr_b16 a[178:179], v8 offset:4096
    v_mfma_f32_16x16x32_bf16 v[148:151], a[180:183], a[144:147], v[148:151]
    v_add_u32 v9, s62, v9
    v_mfma_f32_16x16x32_bf16 v[180:183], a[180:183], a[148:151], v[180:183]
    v_mfma_f32_16x16x32_bf16 v[212:215], a[180:183], a[152:155], v[212:215]
    buffer_load_dwordx4 a[136:139], v22, s[12:15], s40 offen offset:0 sc1
    v_mfma_f32_16x16x32_bf16 v[244:247], a[180:183], a[156:159], v[244:247]
    ds_read_b64_tr_b16 a[180:181], v9 offset:0
    ds_read_b64_tr_b16 a[182:183], v9 offset:4096
    s_waitcnt lgkmcnt(12)
    v_mfma_f32_16x16x32_bf16 v[152:155], a[184:187], a[144:147], v[152:155]
    v_add_u32 v10, s62, v10
    v_mfma_f32_16x16x32_bf16 v[184:187], a[184:187], a[148:151], v[184:187]
    s_cmp_ge_u32 s71, 0x20000
    s_cselect_b32 s52, s64, 0x8000
    v_mfma_f32_16x16x32_bf16 v[216:219], a[184:187], a[152:155], v[216:219]
    v_mfma_f32_16x16x32_bf16 v[248:251], a[184:187], a[156:159], v[248:251]
    ds_read_b64_tr_b16 a[184:185], v10 offset:0
    ds_read_b64_tr_b16 a[186:187], v10 offset:4096
    v_mfma_f32_16x16x32_bf16 v[156:159], a[188:191], a[144:147], v[156:159]
    v_add_u32 v11, s62, v11
    v_mfma_f32_16x16x32_bf16 v[188:191], a[188:191], a[148:151], v[188:191]
    s_add_u32 s71, s71, s52
    v_mfma_f32_16x16x32_bf16 v[220:223], a[188:191], a[152:155], v[220:223]
    buffer_load_dwordx4 a[140:143], v22, s[12:15], s40 offen offset:1024 sc1
    v_mfma_f32_16x16x32_bf16 v[252:255], a[188:191], a[156:159], v[252:255]
    ds_read_b64_tr_b16 a[188:189], v11 offset:0
    ds_read_b64_tr_b16 a[190:191], v11 offset:4096
    s_waitcnt vmcnt(7)
    s_mov_b32 s48, 0x20000
L_pollCAA:
    v_cmp_ne_u32 vcc, v3, v29
    s_sub_u32 s48, s48, 1
    s_nop 3
    s_cbranch_vccz L_pollCAA_d
    s_cmp_eq_u32 s48, 0
    s_cbranch_scc1 L_pollCAA_d
    s_sleep 1
    buffer_load_dword v29, v28, s[44:47], s53 offen sc1
    s_waitcnt vmcnt(0)
    s_branch L_pollCAA
L_pollCAA_d:
    s_waitcnt vmcnt(7)
    s_add_u32 s48, s66, 0x1e5000
    buffer_store_dword v3, v31, s[44:47], s48 offen sc1
    s_waitcnt vmcnt(8)
    s_waitcnt lgkmcnt(12)
    v_mfma_f32_16x16x32_bf16 v[128:131], a[160:163], a[96:99], v[128:131]
    s_lshr_b32 s59, s31, s72
    s_mov_b32 m0, s71
    v_mfma_f32_16x16x32_bf16 v[160:163], a[160:163], a[100:103], v[160:163]
    s_and_b32 s59, s59, 255
    s_lshl_b32 s59, s59, 16
    v_mfma_f32_16x16x32_bf16 v[192:195], a[160:163], a[104:107], v[192:195]
    buffer_load_dwordx4 v13, s[16:19], s59 offen offset:0 lds
    v_mfma_f32_16x16x32_bf16 v[224:227], a[160:163], a[108:111], v[224:227]
    ds_read_b64_tr_b16 a[160:161], v4 offset:16384
    ds_read_b64_tr_b16 a[162:163], v4 offset:20480
    v_mfma_f32_16x16x32_bf16 v[132:135], a[164:167], a[96:99], v[132:135]
    s_bfe_u32 s40, s30, 0x80010
    v_mfma_f32_16x16x32_bf16 v[164:167], a[164:167], a[100:103], v[164:167]
    s_lshl_b32 s40, s40, 13
    v_mfma_f32_16x16x32_bf16 v[196:199], a[164:167], a[104:107], v[196:199]
    buffer_load_dwordx4 a[144:147], v21, s[12:15], s40 offen offset:0 sc1
    v_mfma_f32_16x16x32_bf16 v[228:231], a[164:167], a[108:111], v[228:231]
    ds_read_b64_tr_b16 a[164:165], v5 offset:16384
    ds_read_b64_tr_b16 a[166:167], v5 offset:20480
    s_waitcnt lgkmcnt(12)
    v_mfma_f32_16x16x32_bf16 v[136:139], a[168:171], a[96:99], v[136:139]
    v_mfma_f32_16x16x32_bf16 v[168:171], a[168:171], a[100:103], v[168:171]
    s_lshr_b32 s30, s51, s73
    v_mfma_f32_16x16x32_bf16 v[200:203], a[168:171], a[104:107], v[200:203]
    buffer_load_dwordx4 v14, s[16:19], s59 offen offset:1024 lds
    v_mfma_f32_16x16x32_bf16 v[232:235], a[168:171], a[108:111], v[232:235]
    ds_read_b64_tr_b16 a[168:169], v6 offset:16384
    ds_read_b64_tr_b16 a[170:171], v6 offset:20480
    v_mfma_f32_16x16x32_bf16 v[140:143], a[172:175], a[96:99], v[140:143]
    s_mov_b32 s51, s31
    v_mfma_f32_16x16x32_bf16 v[172:175], a[172:175], a[100:103], v[172:175]
    s_add_u32 s41, s41, 1
    v_mfma_f32_16x16x32_bf16 v[204:207], a[172:175], a[104:107], v[204:207]
    buffer_load_dwordx4 a[148:151], v21, s[12:15], s40 offen offset:1024 sc1
    v_mfma_f32_16x16x32_bf16 v[236:239], a[172:175], a[108:111], v[236:239]
    ds_read_b64_tr_b16 a[172:173], v7 offset:16384
    ds_read_b64_tr_b16 a[174:175], v7 offset:20480
    s_waitcnt lgkmcnt(12)
    v_mfma_f32_16x16x32_bf16 v[144:147], a[176:179], a[96:99], v[144:147]
    v_mfma_f32_16x16x32_bf16 v[176:179], a[176:179], a[100:103], v[176:179]
    v_readlane_b32 s31, v18, s41
    v_mfma_f32_16x16x32_bf16 v[208:211], a[176:179], a[104:107], v[208:211]
    buffer_load_dwordx4 v15, s[16:19], s59 offen offset:2048 lds
    v_mfma_f32_16x16x32_bf16 v[240:243], a[176:179], a[108:111], v[240:243]
    ds_read_b64_tr_b16 a[176:177], v8 offset:16384
    ds_read_b64_tr_b16 a[178:179], v8 offset:20480
    v_mfma_f32_16x16x32_bf16 v[148:151], a[180:183], a[96:99], v[148:151]
    s_cmp_eq_u32 s63, 0x20000
    s_cselect_b32 s62, s64, 0x8000
    v_mfma_f32_16x16x32_bf16 v[180:183], a[180:183], a[100:103], v[180:183]
    v_mfma_f32_16x16x32_bf16 v[212:215], a[180:183], a[104:107], v[212:215]
    buffer_load_dwordx4 a[152:155], v22, s[12:15], s40 offen offset:0 sc1
    v_mfma_f32_16x16x32_bf16 v[244:247], a[180:183], a[108:111], v[244:247]
    ds_read_b64_tr_b16 a[180:181], v9 offset:16384
    ds_read_b64_tr_b16 a[182:183], v9 offset:20480
    s_waitcnt lgkmcnt(12)
    v_mfma_f32_16x16x32_bf16 v[152:155], a[184:187], a[96:99], v[152:155]
    s_add_u32 s63, s63, s62
    v_mfma_f32_16x16x32_bf16 v[184:187], a[184:187], a[100:103], v[184:187]
    v_mfma_f32_16x16x32_bf16 v[216:219], a[184:187], a[104:107], v[216:219]
    buffer_load_dwordx4 v16, s[16:19], s59 offen offset:3072 lds
    v_mfma_f32_16x16x32_bf16 v[248:251], a[184:187], a[108:111], v[248:251]
    ds_read_b64_tr_b16 a[184:185], v10 offset:16384
    ds_read_b64_tr_b16 a[186:187], v10 offset:20480
    v_mfma_f32_16x16x32_bf16 v[156:159], a[188:191], a[96:99], v[156:159]
    v_mfma_f32_16x16x32_bf16 v[188:191], a[188:191], a[100:103], v[188:191]
    v_mfma_f32_16x16x32_bf16 v[220:223], a[188:191], a[104:107], v[220:223]
    buffer_load_dwordx4 a[156:159], v22, s[12:15], s40 offen offset:1024 sc1
    v_mfma_f32_16x16x32_bf16 v[252:255], a[188:191], a[108:111], v[252:255]
    ds_read_b64_tr_b16 a[188:189], v11 offset:16384
    ds_read_b64_tr_b16 a[190:191], v11 offset:20480
    s_waitcnt vmcnt(13)
    s_barrier
    s_waitcnt lgkmcnt(12)
    v_mfma_f32_16x16x32_bf16 v[128:131], a[160:163], a[112:115], v[128:131]
    s_add_u32 m0, s71, 4096
    v_add_u32 v4, s62, v4
    v_mfma_f32_16x16x32_bf16 v[160:163], a[160:163], a[116:119], v[160:163]
    s_add_u32 s59, s59, 32768
    v_mfma_f32_16x16x32_bf16 v[192:195], a[160:163], a[120:123], v[192:195]
    buffer_load_dwordx4 v13, s[16:19], s59 offen offset:0 lds
    v_mfma_f32_16x16x32_bf16 v[224:227], a[160:163], a[124:127], v[224:227]
    ds_read_b64_tr_b16 a[160:161], v4 offset:0
    ds_read_b64_tr_b16 a[162:163], v4 offset:4096
    v_mfma_f32_16x16x32_bf16 v[132:135], a[164:167], a[112:115], v[132:135]
    s_bfe_u32 s40, s30, 0x80000
    v_add_u32 v5, s62, v5
    v_mfma_f32_16x16x32_bf16 v[164:167], a[164:167], a[116:119], v[164:167]
    s_lshl_b32 s40, s40, 13
    v_mfma_f32_16x16x32_bf16 v[196:199], a[164:167], a[120:123], v[196:199]
    buffer_load_dwordx4 a[96:99], v21, s[12:15], s40 offen offset:0 sc1
    v_mfma_f32_16x16x32_bf16 v[228:231], a[164:167], a[124:127], v[228:231]
    ds_read_b64_tr_b16 a[164:165], v5 offset:0
    ds_read_b64_tr_b16 a[166:167], v5 offset:4096
    s_waitcnt lgkmcnt(12)
    v_mfma_f32_16x16x32_bf16 v[136:139], a[168:171], a[112:115], v[136:139]
    v_add_u32 v6, s62, v6
    v_mfma_f32_16x16x32_bf16 v[168:171], a[168:171], a[116:119], v[168:171]
    v_mfma_f32_16x16x32_bf16 v[200:203], a[168:171], a[120:123], v[200:203]
    buffer_load_dwordx4 v14, s[16:19], s59 offen offset:1024 lds
    v_mfma_f32_16x16x32_bf16 v[232:235], a[168:171], a[124:127], v[232:235]
    ds_read_b64_tr_b16 a[168:169], v6 offset:0
    ds_read_b64_tr_b16 a[170:171], v6 offset:4096
    v_mfma_f32_16x16x32_bf16 v[140:143], a[172:175], a[112:115], v[140:143]
    v_add_u32 v7, s62, v7
    v_mfma_f32_16x16x32_bf16 v[172:175], a[172:175], a[116:119], v[172:175]
    v_mfma_f32_16x16x32_bf16 v[204:207], a[172:175], a[120:123], v[204:207]
    buffer_load_dwordx4 a[100:103], v21, s[12:15], s40 offen offset:1024 sc1
    v_mfma_f32_16x16x32_bf16 v[236:239], a[172:175], a[124:127], v[236:239]
    ds_read_b64_tr_b16 a[172:173], v7 offset:0
    ds_read_b64_tr_b16 a[174:175], v7 offset:4096
    s_waitcnt lgkmcnt(12)
    v_mfma_f32_16x16x32_bf16 v[144:147], a[176:179], a[112:115], v[144:147]
    v_add_u32 v8, s62, v8
    v_mfma_f32_16x16x32_bf16 v[176:179], a[176:179], a[116:119], v[176:179]
    v_mfma_f32_16x16x32_bf16 v[208:211], a[176:179], a[120:123], v[208:211]
    buffer_load_dwordx4 v15, s[16:19], s59 offen offset:2048 lds
    v_mfma_f32_16x16x32_bf16 v[240:243], a[176:179], a[124:127], v[240:243]
    ds_read_b64_tr_b16 a[176:177], v8 offset:0
    ds_read_b64_tr_b16 a[178:179], v8 offset:4096
    v_mfma_f32_16x16x32_bf16 v[148:151], a[180:183], a[112:115], v[148:151]
    v_add_u32 v9, s62, v9
    v_mfma_f32_16x16x32_bf16 v[180:183], a[180:183], a[116:119], v[180:183]
    v_mfma_f32_16x16x32_bf16 v[212:215], a[180:183], a[120:123], v[212:215]
    buffer_load_dwordx4 a[104:107], v22, s[12:15], s40 offen offset:0 sc1
    v_mfma_f32_16x16x32_bf16 v[244:247], a[180:183], a[124:127], v[244:247]
    ds_read_b64_tr_b16 a[180:181], v9 offset:0
    ds_read_b64_tr_b16 a[182:183], v9 offset:4096
    s_waitcnt lgkmcnt(12)
    v_mfma_f32_16x16x32_bf16 v[152:155], a[184:187], a[112:115], v[152:155]
    v_add_u32 v10, s62, v10
    v_mfma_f32_16x16x32_bf16 v[184:187], a[184:187], a[116:119], v[184:187]
    s_cmp_ge_u32 s71, 0x20000
    s_cselect_b32 s52, s64, 0x8000
    v_mfma_f32_16x16x32_bf16 v[216:219], a[184:187], a[120:123], v[216:219]
    buffer_load_dwordx4 v16, s[16:19], s59 offen offset:3072 lds
    v_mfma_f32_16x16x32_bf16 v[248:251], a[184:187], a[124:127], v[248:251]
    ds_read_b64_tr_b16 a[184:185], v10 offset:0
    ds_read_b64_tr_b16 a[186:187], v10 offset:4096
    v_mfma_f32_16x16x32_bf16 v[156:159], a[188:191], a[112:115], v[156:159]
    v_add_u32 v11, s62, v11
    v_mfma_f32_16x16x32_bf16 v[188:191], a[188:191], a[116:119], v[188:191]
    s_add_u32 s71, s71, s52
    v_mfma_f32_16x16x32_bf16 v[220:223], a[188:191], a[120:123], v[220:223]
    buffer_load_dwordx4 a[108:111], v22, s[12:15], s40 offen offset:1024 sc1
    v_mfma_f32_16x16x32_bf16 v[252:255], a[188:191], a[124:127], v[252:255]
    ds_read_b64_tr_b16 a[188:189], v11 offset:0
    ds_read_b64_tr_b16 a[190:191], v11 offset:4096
    s_branch L_common
L_endA:
L_clsB:
    s_mul_i32 s52, s54, 320
    v_add_u32 v104, s52, v2
    v_mul_u32_u24 v105, 3277, v104
    v_lshrrev_b32 v105, 16, v105
    v_mul_u32_u24 v106, 20, v105
    v_sub_u32 v104, v104, v106
    v_bfe_u32 v106, v105, 3, 1
    v_lshlrev_b32 v106, 1, v106
    v_xor_b32 v104, v104, v106
    v_mul_u32_u24 v105, 7168, v105
    v_lshl_add_u32 v13, v104, 4, v105
    v_add_u32 v104, s52, v2
    v_add_u32 v104, 64, v104
    v_mul_u32_u24 v105, 3277, v104
    v_lshrrev_b32 v105, 16, v105
    v_mul_u32_u24 v106, 20, v105
    v_sub_u32 v104, v104, v106
    v_bfe_u32 v106, v105, 3, 1
    v_lshlrev_b32 v106, 1, v106
    v_xor_b32 v104, v104, v106
    v_mul_u32_u24 v105, 7168, v105
    v_lshl_add_u32 v14, v104, 4, v105
    v_subrev_u32 v14, 1024, v14
    v_add_u32 v104, s52, v2
    v_add_u32 v104, 128, v104
    v_mul_u32_u24 v105, 3277, v104
    v_lshrrev_b32 v105, 16, v105
    v_mul_u32_u24 v106, 20, v105
    v_sub_u32 v104, v104, v106
    v_bfe_u32 v106, v105, 3, 1
    v_lshlrev_b32 v106, 1, v106
    v_xor_b32 v104, v104, v106
    v_mul_u32_u24 v105, 7168, v105
    v_lshl_add_u32 v15, v104, 4, v105
    v_subrev_u32 v15, 2048, v15
    v_add_u32 v104, s52, v2
    v_add_u32 v104, 192, v104
    v_mul_u32_u24 v105, 3277, v104
    v_lshrrev_b32 v105, 16, v105
    v_mul_u32_u24 v106, 20, v105
    v_sub_u32 v104, v104, v106
    v_bfe_u32 v106, v105, 3, 1
    v_lshlrev_b32 v106, 1, v106
    v_xor_b32 v104, v104, v106
    v_mul_u32_u24 v105, 7168, v105
    v_lshl_add_u32 v16, v104, 4, v105
    v_subrev_u32 v16, 3072, v16
    v_add_u32 v104, s52, v2
    v_add_u32 v104, 256, v104
    v_mul_u32_u24 v105, 3277, v104
    v_lshrrev_b32 v105, 16, v105
    v_mul_u32_u24 v106, 20, v105
    v_sub_u32 v104, v104, v106
    v_bfe_u32 v106, v105, 3, 1
    v_lshlrev_b32 v106, 1, v106
    v_xor_b32 v104, v104, v106
    v_mul_u32_u24 v105, 7168, v105
    v_lshl_add_u32 v17, v104, 4, v105
    s_mul_i32 s59, s49, 5120
    s_and_b32 s52, s50, 3
    s_lshl_b32 s52, s52, 1
    s_add_u32 s52, s52, s54
    s_lshl_b32 s52, s52, 4
    v_and_b32 v104, 15, v2
    v_add_u32 v104, s52, v104
    v_mul_u32_u24 v104, 7168, v104
    v_min_u32 v105, 2, v96
    v_lshl_add_u32 v30, v105, 7, v104
    s_cmp_lg_u32 s55, 0
    s_cselect_b32 s70, s78, s76
    s_cselect_b32 s71, s79, s77
    s_mul_i32 s52, s51, 320
    s_add_u32 s52, s52, 2048
    s_add_u32 s12, s70, s52
    s_addc_u32 s13, s71, 0
    s_and_b32 s13, s13, 0xffff
    s_sub_u32 s14, 0x700000, s52
    s_mov_b32 s15, 0x20000
    s_add_u32 m0, s59, 0x10000
    s_nop 0
    buffer_load_dwordx4 v13, s[12:15], s43 offen offset:0 nt lds
    buffer_load_dwordx4 v14, s[12:15], s43 offen offset:1024 nt lds
    buffer_load_dwordx4 v15, s[12:15], s43 offen offset:2048 nt lds
    buffer_load_dwordx4 v16, s[12:15], s43 offen offset:3072 nt lds
    s_add_u32 s62, s62, 1
    s_and_b32 s62, s62, 31
    s_add_u32 m0, s59, 0x11000
    s_nop 0
    buffer_load_dwordx4 v17, s[12:15], s43 offen offset:0 nt lds
    s_mul_i32 s43, s62, 229376
    s_add_u32 m0, s58, 0x1000
    s_nop 0
    buffer_load_dwordx4 v21, s[8:11], s41 offen offset:0 lds
    buffer_load_dwordx4 v22, s[8:11], s41 offen offset:1024 lds
    s_add_u32 s63, s63, 128
    s_and_b32 s63, s63, 2047
    buffer_load_dwordx4 v23, s[8:11], s41 offen offset:2048 lds
    s_add_u32 s40, s64, s63
    buffer_load_dwordx4 v24, s[8:11], s41 offen offset:3072 lds
    s_add_u32 s41, s40, 0x10000
    v_and_b32 v104, 15, v2
    v_lshrrev_b32 v105, 1, v104
    v_xor_b32 v105, v105, v96
    v_lshlrev_b32 v104, 7, v104
    v_lshl_add_u32 v104, v105, 4, v104
    s_lshl_b32 s52, s54, 14
    v_add_u32 v4, s52, v104
    v_xor_b32 v5, 64, v4
    v_bfe_u32 v100, v2, 2, 2
    v_and_b32 v101, 3, v2
    v_lshl_add_u32 v102, v96, 3, v100
    v_mul_u32_u24 v104, 320, v102
    v_lshl_add_u32 v104, v101, 3, v104
    v_and_b32 v105, 1, v96
    v_lshlrev_b32 v105, 5, v105
    s_mul_i32 s52, s55, 192
    s_add_u32 s52, s52, 0x10000
    v_add3_u32 v6, v104, v105, s52
    v_sub_u32 v106, v104, v105
    v_add_u32 v8, s52, v106
    s_lshl_b32 s52, s55, 5
    v_xor_b32 v105, s52, v105
    v_add_u32 v105, v104, v105
    v_add_u32 v10, 0x10080, v105
    v_add_u32 v7, 0xa000, v6
    v_add_u32 v9, 0xa000, v8
    v_add_u32 v11, 0xa000, v10
    s_cmp_eq_u32 s49, 3
    s_cselect_b32 s36, s74, s80
    s_cselect_b32 s37, s75, s81
    s_mov_b32 s38, 0x700000
    s_cselect_b32 s38, 0x200000, s38
    s_mov_b32 s61, 0x138000
    s_cselect_b32 s61, 0x68000, s61
    s_cselect_b32 s60, 0, s49
    s_and_b32 s37, s37, 0xffff
    s_mov_b32 s39, 0x20000
    s_lshl_b32 s60, s60, 8
    s_add_u32 s60, s60, s2
    s_mul_i32 s60, s60, 1664
    v_min_u32 v18, 12, v2
    v_lshlrev_b32 v18, 7, v18
    s_cmp_eq_u32 s54, 0
    s_cselect_b32 s66, s65, 99
    s_cselect_b32 s67, 99, s65
    s_getpc_b64 s[32:33]
L_pcB:
    s_add_u32 s32, s32, L_tailB-L_pcB
    s_addc_u32 s33, s33, 0
    s_and_b32 s33, s33, 0xffff
    s_mov_b32 s34, L_endC-L_tailB
    s_mov_b32 s35, 0x20000
    s_lshr_b32 s65, s2, 3
    s_lshl_b32 s65, s65, 2
    s_add_u32 s65, s65, s49
    s_mul_i32 s65, s65, 1664
    v_mov_b32 v0, 0x3f803f80
    v_accvgpr_write_b32 a200, 0
    v_accvgpr_write_b32 a201, 0
    v_accvgpr_write_b32 a202, 0
    v_accvgpr_write_b32 a203, 0
    v_accvgpr_write_b32 a204, 0
    v_accvgpr_write_b32 a205, 0
    v_accvgpr_write_b32 a206, 0
    v_accvgpr_write_b32 a207, 0
    v_accvgpr_write_b32 a208, 0
    v_accvgpr_write_b32 a209, 0
    v_accvgpr_write_b32 a210, 0
    v_accvgpr_write_b32 a211, 0
    v_accvgpr_write_b32 a212, 0
    v_accvgpr_write_b32 a213, 0
    v_accvgpr_write_b32 a214, 0
    v_accvgpr_write_b32 a215, 0
    v_accvgpr_write_b32 a216, 0
    v_accvgpr_write_b32 a217, 0
    v_accvgpr_write_b32 a218, 0
    v_accvgpr_write_b32 a219, 0
    v_accvgpr_write_b32 a220, v0
    v_accvgpr_write_b32 a221, v0
    v_accvgpr_write_b32 a222, v0
    v_accvgpr_write_b32 a223, v0
    s_waitcnt vmcnt(15)
    v_lshlrev_b32 v56, 16, v40
    v_and_b32 v57, 0xffff0000, v40
    v_lshlrev_b32 v58, 16, v41
    v_and_b32 v59, 0xffff0000, v41
    v_lshlrev_b32 v60, 16, v42
    v_and_b32 v61, 0xffff0000, v42
    v_lshlrev_b32 v62, 16, v43
    v_and_b32 v63, 0xffff0000, v43
    v_lshlrev_b32 v64, 16, v44
    v_and_b32 v65, 0xffff0000, v44
    v_lshlrev_b32 v66, 16, v45
    v_and_b32 v67, 0xffff0000, v45
    v_lshlrev_b32 v68, 16, v46
    v_and_b32 v69, 0xffff0000, v46
    v_lshlrev_b32 v70, 16, v47
    v_and_b32 v71, 0xffff0000, v47
    v_lshlrev_b32 v72, 16, v48
    v_and_b32 v73, 0xffff0000, v48
    v_lshlrev_b32 v74, 16, v49
    v_and_b32 v75, 0xffff0000, v49
    v_lshlrev_b32 v76, 16, v50
    v_and_b32 v77, 0xffff0000, v50
    v_lshlrev_b32 v78, 16, v51
    v_and_b32 v79, 0xffff0000, v51
    v_lshlrev_b32 v80, 16, v52
    v_and_b32 v81, 0xffff0000, v52
    v_lshlrev_b32 v82, 16, v53
    v_and_b32 v83, 0xffff0000, v53
    v_lshlrev_b32 v84, 16, v54
    v_and_b32 v85, 0xffff0000, v54
    v_lshlrev_b32 v86, 16, v55
    v_and_b32 v87, 0xffff0000, v55
    v_add_f32 v88, v56, v57
    v_add_f32 v89, v58, v59
    v_add_f32 v88, v88, v60
    v_add_f32 v89, v89, v61
    v_add_f32 v88, v88, v62
    v_add_f32 v89, v89, v63
    v_add_f32 v88, v88, v64
    v_add_f32 v89, v89, v65
    v_add_f32 v88, v88, v66
    v_add_f32 v89, v89, v67
    v_add_f32 v88, v88, v68
    v_add_f32 v89, v89, v69
    v_add_f32 v88, v88, v70
    v_add_f32 v89, v89, v71
    v_add_f32 v88, v88, v72
    v_add_f32 v89, v89, v73
    v_add_f32 v88, v88, v74
    v_add_f32 v89, v89, v75
    v_add_f32 v88, v88, v76
    v_add_f32 v89, v89, v77
    v_add_f32 v88, v88, v78
    v_add_f32 v89, v89, v79
    v_add_f32 v88, v88, v80
    v_add_f32 v89, v89, v81
    v_add_f32 v88, v88, v82
    v_add_f32 v89, v89, v83
    v_add_f32 v88, v88, v84
    v_add_f32 v89, v89, v85
    v_add_f32 v88, v88, v86
    v_add_f32 v89, v89, v87
    v_add_f32 v88, v88, v89
    s_nop 1
    v_add_f32_dpp v88, v88, v88 quad_perm:[1,0,3,2] row_mask:0xf bank_mask:0xf
    s_nop 1
    v_add_f32_dpp v88, v88, v88 quad_perm:[2,3,0,1] row_mask:0xf bank_mask:0xf
    s_nop 1
    v_add_f32_dpp v88, v88, v88 row_half_mirror row_mask:0xf bank_mask:0xf
    s_nop 1
    v_add_f32_dpp v88, v88, v88 row_mirror row_mask:0xf bank_mask:0xf
    v_mov_b32 v90, v88
    s_nop 1
    v_permlane16_swap_b32 v90, v88
    s_nop 1
    v_add_f32 v88, v88, v90
    v_mul_f32 v88, 0x3a800000, v88
    v_sub_f32 v90, v56, v88
    v_sub_f32 v91, v57, v88
    v_mul_f32 v92, v90, v90
    v_mul_f32 v93, v91, v91
    v_sub_f32 v90, v58, v88
    v_sub_f32 v91, v59, v88
    v_fmac_f32 v92, v90, v90
    v_fmac_f32 v93, v91, v91
    v_sub_f32 v90, v60, v88
    v_sub_f32 v91, v61, v88
    v_fmac_f32 v92, v90, v90
    v_fmac_f32 v93, v91, v91
    v_sub_f32 v90, v62, v88
    v_sub_f32 v91, v63, v88
    v_fmac_f32 v92, v90, v90
    v_fmac_f32 v93, v91, v91
    v_sub_f32 v90, v64, v88
    v_sub_f32 v91, v65, v88
    v_fmac_f32 v92, v90, v90
    v_fmac_f32 v93, v91, v91
    v_sub_f32 v90, v66, v88
    v_sub_f32 v91, v67, v88
    v_fmac_f32 v92, v90, v90
    v_fmac_f32 v93, v91, v91
    v_sub_f32 v90, v68, v88
    v_sub_f32 v91, v69, v88
    v_fmac_f32 v92, v90, v90
    v_fmac_f32 v93, v91, v91
    v_sub_f32 v90, v70, v88
    v_sub_f32 v91, v71, v88
    v_fmac_f32 v92, v90, v90
    v_fmac_f32 v93, v91, v91
    v_sub_f32 v90, v72, v88
    v_sub_f32 v91, v73, v88
    v_fmac_f32 v92, v90, v90
    v_fmac_f32 v93, v91, v91
    v_sub_f32 v90, v74, v88
    v_sub_f32 v91, v75, v88
    v_fmac_f32 v92, v90, v90
    v_fmac_f32 v93, v91, v91
    v_sub_f32 v90, v76, v88
    v_sub_f32 v91, v77, v88
    v_fmac_f32 v92, v90, v90
    v_fmac_f32 v93, v91, v91
    v_sub_f32 v90, v78, v88
    v_sub_f32 v91, v79, v88
    v_fmac_f32 v92, v90, v90
    v_fmac_f32 v93, v91, v91
    v_sub_f32 v90, v80, v88
    v_sub_f32 v91, v81, v88
    v_fmac_f32 v92, v90, v90
    v_fmac_f32 v93, v91, v91
    v_sub_f32 v90, v82, v88
    v_sub_f32 v91, v83, v88
    v_fmac_f32 v92, v90, v90
    v_fmac_f32 v93, v91, v91
    v_sub_f32 v90, v84, v88
    v_sub_f32 v91, v85, v88
    v_fmac_f32 v92, v90, v90
    v_fmac_f32 v93, v91, v91
    v_sub_f32 v90, v86, v88
    v_sub_f32 v91, v87, v88
    v_fmac_f32 v92, v90, v90
    v_fmac_f32 v93, v91, v91
    v_add_f32 v92, v92, v93
    s_nop 1
    v_add_f32_dpp v92, v92, v92 quad_perm:[1,0,3,2] row_mask:0xf bank_mask:0xf
    s_nop 1
    v_add_f32_dpp v92, v92, v92 quad_perm:[2,3,0,1] row_mask:0xf bank_mask:0xf
    s_nop 1
    v_add_f32_dpp v92, v92, v92 row_half_mirror row_mask:0xf bank_mask:0xf
    s_nop 1
    v_add_f32_dpp v92, v92, v92 row_mirror row_mask:0xf bank_mask:0xf
    v_mov_b32 v90, v92
    s_nop 1
    v_permlane16_swap_b32 v90, v92
    s_nop 1
    v_add_f32 v92, v92, v90
    v_mul_f32 v92, 0x3a800000, v92
    v_cvt_pk_bf16_f32 v92, v92, v92
    v_lshlrev_b32 v92, 16, v92
    v_add_f32 v92, 0x3727c5ac, v92
    v_cvt_pk_bf16_f32 v92, v92, v92
    v_lshlrev_b32 v92, 16, v92
    v_sqrt_f32 v92, v92
    v_sub_f32 v88, 0, v88
    v_cvt_pk_bf16_f32 v40, v88, v88
    v_cvt_pk_bf16_f32 v92, v92, v92
    v_lshlrev_b32 v92, 16, v92
    v_rcp_f32 v46, v92
    v_mov_b32 v41, v40
    v_mov_b32 v42, v40
    v_mov_b32 v43, v40
    v_mul_f32 v45, v92, v92
    v_mul_f32 v44, s57, v46
    s_lshl_b32 s52, s50, 8
    v_add_u32 v32, s52, v32
    v_lshlrev_b32 v90, 5, v32
    v_lshlrev_b32 v91, 2, v32
    s_mov_b32 s52, 0x1c0000
    s_mov_b32 s53, 0x1d0000
    s_mov_b32 exec_lo, 1
    s_mov_b32 exec_hi, 1
    buffer_store_dwordx4 v[40:43], v90, s[44:47], s52 offen sc1
    buffer_store_dwordx2 v[44:45], v90, s[44:47], s52 offen offset:16 sc1
    buffer_store_dword v46, v91, s[44:47], s53 offen sc1
    s_mov_b64 exec, -1
    s_add_u32 m0, s59, 0x15000
    s_nop 0
    buffer_load_dwordx4 v13, s[12:15], s43 offen offset:0 nt lds
    buffer_load_dwordx4 v14, s[12:15], s43 offen offset:1024 nt lds
    buffer_load_dwordx4 v15, s[12:15], s43 offen offset:2048 nt lds
    buffer_load_dwordx4 v16, s[12:15], s43 offen offset:3072 nt lds
    s_add_u32 s62, s62, 1
    s_and_b32 s62, s62, 31
    s_add_u32 m0, s59, 0x16000
    s_nop 0
    buffer_load_dwordx4 v17, s[12:15], s43 offen offset:0 nt lds
    s_mul_i32 s43, s62, 229376
    s_waitcnt vmcnt(8)
    s_barrier
    ds_read_b64_tr_b16 a[160:161], v6 offset:0
    ds_read_b64_tr_b16 a[162:163], v6 offset:1280
    ds_read_b128 a[96:99], v4 offset:0
    ds_read_b128 a[100:103], v4 offset:2048
    ds_read_b128 a[104:107], v4 offset:4096
    ds_read_b128 a[108:111], v4 offset:6144
    ds_read_b128 a[112:115], v4 offset:8192
    ds_read_b128 a[116:119], v4 offset:10240
    ds_read_b128 a[120:123], v4 offset:12288
    ds_read_b128 a[124:127], v4 offset:14336
    ds_read_b64_tr_b16 a[164:165], v6 offset:10240
    ds_read_b64_tr_b16 a[166:167], v6 offset:11520
    ds_read_b64_tr_b16 a[168:169], v8 offset:32
    ds_read_b64_tr_b16 a[170:171], v8 offset:1312
    ds_read_b64_tr_b16 a[172:173], v8 offset:10272
    ds_read_b64_tr_b16 a[174:175], v8 offset:11552
    ds_read_b64_tr_b16 a[176:177], v6 offset:64
    ds_read_b64_tr_b16 a[178:179], v6 offset:1344
    s_mov_b32 s52, 1664525
    v_mul_lo_u32 v3, v3, s52
    v_add_u32 v3, 0x3c6ef35f, v3
    s_mov_b32 s48, 5
    s_waitcnt lgkmcnt(0)
    v_mfma_f32_16x16x32_bf16 v[32:35], a[160:163], a[96:99], 0
    ds_read_b64_tr_b16 a[180:181], v6 offset:10304
    v_mfma_f32_16x16x32_bf16 v[36:39], a[160:163], a[100:103], 0
    s_add_u32 m0, s58, 0x8000
    v_mfma_f32_16x16x32_bf16 v[40:43], a[160:163], a[104:107], 0
    v_mfma_f32_16x16x32_bf16 v[44:47], a[160:163], a[108:111], 0
    ds_read_b64_tr_b16 a[182:183], v6 offset:11584
    v_mfma_f32_16x16x32_bf16 v[48:51], a[160:163], a[112:115], 0
    buffer_load_dwordx4 v21, s[8:11], s40 offen offset:0 lds
    v_mfma_f32_16x16x32_bf16 v[52:55], a[160:163], a[116:119], 0
    v_mfma_f32_16x16x32_bf16 v[56:59], a[160:163], a[120:123], 0
    buffer_load_dwordx4 v22, s[8:11], s40 offen offset:1024 lds
    v_mfma_f32_16x16x32_bf16 v[60:63], a[160:163], a[124:127], 0
    ds_read_b64_tr_b16 a[184:185], v8 offset:96
    v_mfma_f32_16x16x32_bf16 v[92:95], a[164:167], a[124:127], 0
    v_mfma_f32_16x16x32_bf16 v[88:91], a[164:167], a[120:123], 0
    buffer_load_dwordx4 v23, s[8:11], s40 offen offset:2048 lds
    v_mfma_f32_16x16x32_bf16 v[84:87], a[164:167], a[116:119], 0
    ds_read_b64_tr_b16 a[186:187], v8 offset:1376
    v_mfma_f32_16x16x32_bf16 v[80:83], a[164:167], a[112:115], 0
    v_mfma_f32_16x16x32_bf16 v[76:79], a[164:167], a[108:111], 0
    buffer_load_dwordx4 v24, s[8:11], s40 offen offset:3072 lds
    v_mfma_f32_16x16x32_bf16 v[72:75], a[164:167], a[104:107], 0
    ds_read_b64_tr_b16 a[188:189], v8 offset:10336
    v_mfma_f32_16x16x32_bf16 v[68:71], a[164:167], a[100:103], 0
    v_mfma_f32_16x16x32_bf16 v[64:67], a[164:167], a[96:99], 0
    s_add_u32 m0, s58, 0x9000
    v_mfma_f32_16x16x32_bf16 v[96:99], a[168:171], a[96:99], 0
    v_mfma_f32_16x16x32_bf16 v[100:103], a[168:171], a[100:103], 0
    ds_read_b64_tr_b16 a[190:191], v8 offset:11616
    v_mfma_f32_16x16x32_bf16 v[104:107], a[168:171], a[104:107], 0
    buffer_load_dwordx4 v21, s[8:11], s41 offen offset:0 lds
    v_mfma_f32_16x16x32_bf16 v[108:111], a[168:171], a[108:111], 0
    v_mfma_f32_16x16x32_bf16 v[112:115], a[168:171], a[112:115], 0
    ds_read_b64_tr_b16 a[192:193], v10 offset:0
    v_mfma_f32_16x16x32_bf16 v[116:119], a[168:171], a[116:119], 0
    buffer_load_dwordx4 v22, s[8:11], s41 offen offset:1024 lds
    v_mfma_f32_16x16x32_bf16 v[120:123], a[168:171], a[120:123], 0
    v_mfma_f32_16x16x32_bf16 v[124:127], a[168:171], a[124:127], 0
    ds_read_b64_tr_b16 a[194:195], v10 offset:1280
    v_mfma_f32_16x16x32_bf16 v[156:159], a[172:175], a[124:127], 0
    s_add_u32 s63, s63, 128
    v_mfma_f32_16x16x32_bf16 v[152:155], a[172:175], a[120:123], 0
    v_mfma_f32_16x16x32_bf16 v[148:151], a[172:175], a[116:119], 0
    s_and_b32 s63, s63, 2047
    v_mfma_f32_16x16x32_bf16 v[144:147], a[172:175], a[112:115], 0
    ds_read_b64_tr_b16 a[196:197], v10 offset:10240
    v_mfma_f32_16x16x32_bf16 v[140:143], a[172:175], a[108:111], 0
    v_mfma_f32_16x16x32_bf16 v[136:139], a[172:175], a[104:107], 0
    buffer_load_dwordx4 v23, s[8:11], s41 offen offset:2048 lds
    v_mfma_f32_16x16x32_bf16 v[132:135], a[172:175], a[100:103], 0
    ds_read_b64_tr_b16 a[198:199], v10 offset:11520
    v_mfma_f32_16x16x32_bf16 v[128:131], a[172:175], a[96:99], 0
    v_mfma_f32_16x16x32_bf16 v[160:163], a[176:179], a[96:99], 0
    s_add_u32 s40, s64, s63
    v_mfma_f32_16x16x32_bf16 v[164:167], a[176:179], a[100:103], 0
    v_mfma_f32_16x16x32_bf16 v[168:171], a[176:179], a[104:107], 0
    buffer_load_dwordx4 v24, s[8:11], s41 offen offset:3072 lds
    v_mfma_f32_16x16x32_bf16 v[172:175], a[176:179], a[108:111], 0
    v_mfma_f32_16x16x32_bf16 v[176:179], a[176:179], a[112:115], 0
    s_cmp_eq_u32 s48, s66
    s_cbranch_scc1 L_cs0Bp0
    L_cs0Bp0b:
    v_mfma_f32_16x16x32_bf16 v[180:183], a[176:179], a[116:119], 0
    s_add_u32 s41, s40, 0x10000
    v_mfma_f32_16x16x32_bf16 v[184:187], a[176:179], a[120:123], 0
    v_mfma_f32_16x16x32_bf16 v[188:191], a[176:179], a[124:127], 0
    s_waitcnt vmcnt(8) lgkmcnt(0)
    s_barrier
    v_mfma_f32_16x16x32_bf16 v[192:195], a[180:183], a[96:99], 0
    ds_read_b64_tr_b16 a[160:161], v6 offset:20480
    v_mfma_f32_16x16x32_bf16 v[196:199], a[180:183], a[100:103], 0
    s_add_u32 m0, s59, 0x1a000
    v_mfma_f32_16x16x32_bf16 v[200:203], a[180:183], a[104:107], 0
    ds_read_b64_tr_b16 a[162:163], v6 offset:21760
    v_mfma_f32_16x16x32_bf16 v[204:207], a[180:183], a[108:111], 0
    buffer_load_dwordx4 v13, s[12:15], s43 offen offset:0 nt lds
    v_mfma_f32_16x16x32_bf16 v[208:211], a[180:183], a[112:115], 0
    ds_read_b128 a[128:131], v5 offset:0
    v_mfma_f32_16x16x32_bf16 v[212:215], a[180:183], a[116:119], 0
    ds_read_b128 a[132:135], v5 offset:2048
    v_mfma_f32_16x16x32_bf16 v[216:219], a[180:183], a[120:123], 0
    buffer_load_dwordx4 v14, s[12:15], s43 offen offset:1024 nt lds
    v_mfma_f32_16x16x32_bf16 v[220:223], a[180:183], a[124:127], 0
    ds_read_b128 a[136:139], v5 offset:4096
    v_mfma_f32_16x16x32_bf16 v[252:255], a[184:187], a[124:127], 0
    buffer_load_dwordx4 v15, s[12:15], s43 offen offset:2048 nt lds
    v_mfma_f32_16x16x32_bf16 v[248:251], a[184:187], a[120:123], 0
    ds_read_b128 a[140:143], v5 offset:6144
    v_mfma_f32_16x16x32_bf16 v[244:247], a[184:187], a[116:119], 0
    buffer_load_dwordx4 v16, s[12:15], s43 offen offset:3072 nt lds
    v_mfma_f32_16x16x32_bf16 v[240:243], a[184:187], a[112:115], 0
    ds_read_b128 a[144:147], v5 offset:8192
    v_mfma_f32_16x16x32_bf16 v[236:239], a[184:187], a[108:111], 0
    ds_read_b128 a[148:151], v5 offset:10240
    v_mfma_f32_16x16x32_bf16 v[232:235], a[184:187], a[104:107], 0
    s_add_u32 s62, s62, 1
    v_mfma_f32_16x16x32_bf16 v[228:231], a[184:187], a[100:103], 0
    ds_read_b128 a[152:155], v5 offset:12288
    v_mfma_f32_16x16x32_bf16 v[224:227], a[184:187], a[96:99], 0
    s_and_b32 s62, s62, 31
    v_mfma_f32_16x16x32_bf16 a[0:3], a[188:191], a[96:99], 0
    ds_read_b128 a[156:159], v5 offset:14336
    v_mfma_f32_16x16x32_bf16 a[4:7], a[188:191], a[100:103], 0
    s_add_u32 m0, s59, 0x1b000
    v_mfma_f32_16x16x32_bf16 a[8:11], a[188:191], a[104:107], 0
    ds_read_b64_tr_b16 a[164:165], v6 offset:30720
    v_mfma_f32_16x16x32_bf16 a[12:15], a[188:191], a[108:111], 0
    ds_read_b64_tr_b16 a[166:167], v6 offset:32000
    v_mfma_f32_16x16x32_bf16 a[16:19], a[188:191], a[112:115], 0
    buffer_load_dwordx4 v17, s[12:15], s43 offen offset:0 nt lds
    v_mfma_f32_16x16x32_bf16 a[20:23], a[188:191], a[116:119], 0
    ds_read_b64_tr_b16 a[168:169], v8 offset:20512
    v_mfma_f32_16x16x32_bf16 a[24:27], a[188:191], a[120:123], 0
    s_mul_i32 s43, s62, 229376
    v_mfma_f32_16x16x32_bf16 a[28:31], a[188:191], a[124:127], 0
    ds_read_b64_tr_b16 a[170:171], v8 offset:21792
    v_mfma_f32_16x16x32_bf16 a[60:63], a[192:195], a[124:127], 0
    s_add_u32 m0, s59, 0x1f000
    v_mfma_f32_16x16x32_bf16 a[56:59], a[192:195], a[120:123], 0
    ds_read_b64_tr_b16 a[172:173], v8 offset:30752
    v_mfma_f32_16x16x32_bf16 a[52:55], a[192:195], a[116:119], 0
    ds_read_b64_tr_b16 a[174:175], v8 offset:32032
    v_mfma_f32_16x16x32_bf16 a[48:51], a[192:195], a[112:115], 0
    buffer_load_dwordx4 v13, s[12:15], s43 offen offset:0 nt lds
    v_mfma_f32_16x16x32_bf16 a[44:47], a[192:195], a[108:111], 0
    ds_read_b64_tr_b16 a[176:177], v6 offset:20544
    v_mfma_f32_16x16x32_bf16 a[40:43], a[192:195], a[104:107], 0
    buffer_load_dwordx4 v14, s[12:15], s43 offen offset:1024 nt lds
    v_mfma_f32_16x16x32_bf16 a[36:39], a[192:195], a[100:103], 0
    ds_read_b64_tr_b16 a[178:179], v6 offset:21824
    v_mfma_f32_16x16x32_bf16 a[32:35], a[192:195], a[96:99], 0
    buffer_load_dwordx4 v15, s[12:15], s43 offen offset:2048 nt lds
    v_mfma_f32_16x16x32_bf16 a[64:67], a[196:199], a[96:99], 0
    buffer_load_dwordx4 v16, s[12:15], s43 offen offset:3072 nt lds
    v_mfma_f32_16x16x32_bf16 a[68:71], a[196:199], a[100:103], 0
    s_add_u32 s62, s62, 1
    v_mfma_f32_16x16x32_bf16 a[72:75], a[196:199], a[104:107], 0
    s_and_b32 s62, s62, 31
    v_mfma_f32_16x16x32_bf16 a[76:79], a[196:199], a[108:111], 0
    s_add_u32 m0, s59, 0x20000
    v_mfma_f32_16x16x32_bf16 a[80:83], a[196:199], a[112:115], 0
    s_cmp_eq_u32 s48, s67
    s_cbranch_scc1 L_cs1Bp0
    L_cs1Bp0b:
    v_mfma_f32_16x16x32_bf16 a[84:87], a[196:199], a[116:119], 0
    buffer_load_dwordx4 v17, s[12:15], s43 offen offset:0 nt lds
    v_mfma_f32_16x16x32_bf16 a[88:91], a[196:199], a[120:123], 0
    s_mul_i32 s43, s62, 229376
    v_mfma_f32_16x16x32_bf16 a[92:95], a[196:199], a[124:127], 0
    s_waitcnt lgkmcnt(0)
    v_mfma_f32_16x16x32_bf16 v[32:35], a[160:163], a[128:131], v[32:35]
    ds_read_b64_tr_b16 a[180:181], v6 offset:30784
    v_mfma_f32_16x16x32_bf16 v[36:39], a[160:163], a[132:135], v[36:39]
    s_add_u32 m0, s59, 0x10000
    v_mfma_f32_16x16x32_bf16 v[40:43], a[160:163], a[136:139], v[40:43]
    buffer_load_dwordx4 v13, s[12:15], s43 offen offset:0 nt lds
    v_mfma_f32_16x16x32_bf16 v[44:47], a[160:163], a[140:143], v[44:47]
    ds_read_b64_tr_b16 a[182:183], v6 offset:32064
    v_mfma_f32_16x16x32_bf16 v[48:51], a[160:163], a[144:147], v[48:51]
    v_mfma_f32_16x16x32_bf16 v[52:55], a[160:163], a[148:151], v[52:55]
    buffer_load_dwordx4 v14, s[12:15], s43 offen offset:1024 nt lds
    v_mfma_f32_16x16x32_bf16 v[56:59], a[160:163], a[152:155], v[56:59]
    v_mfma_f32_16x16x32_bf16 v[60:63], a[160:163], a[156:159], v[60:63]
    ds_read_b64_tr_b16 a[184:185], v8 offset:20576
    v_mfma_f32_16x16x32_bf16 v[92:95], a[164:167], a[156:159], v[92:95]
    buffer_load_dwordx4 v15, s[12:15], s43 offen offset:2048 nt lds
    v_mfma_f32_16x16x32_bf16 v[88:91], a[164:167], a[152:155], v[88:91]
    v_mfma_f32_16x16x32_bf16 v[84:87], a[164:167], a[148:151], v[84:87]
    ds_read_b64_tr_b16 a[186:187], v8 offset:21856
    v_mfma_f32_16x16x32_bf16 v[80:83], a[164:167], a[144:147], v[80:83]
    buffer_load_dwordx4 v16, s[12:15], s43 offen offset:3072 nt lds
    v_mfma_f32_16x16x32_bf16 v[76:79], a[164:167], a[140:143], v[76:79]
    v_mfma_f32_16x16x32_bf16 v[72:75], a[164:167], a[136:139], v[72:75]
    ds_read_b64_tr_b16 a[188:189], v8 offset:30816
    v_mfma_f32_16x16x32_bf16 v[68:71], a[164:167], a[132:135], v[68:71]
    s_add_u32 s62, s62, 1
    v_mfma_f32_16x16x32_bf16 v[64:67], a[164:167], a[128:131], v[64:67]
    v_mfma_f32_16x16x32_bf16 v[96:99], a[168:171], a[128:131], v[96:99]
    s_and_b32 s62, s62, 31
    v_mfma_f32_16x16x32_bf16 v[100:103], a[168:171], a[132:135], v[100:103]
    ds_read_b64_tr_b16 a[190:191], v8 offset:32096
    v_mfma_f32_16x16x32_bf16 v[104:107], a[168:171], a[136:139], v[104:107]
    v_mfma_f32_16x16x32_bf16 v[108:111], a[168:171], a[140:143], v[108:111]
    s_add_u32 m0, s59, 0x11000
    v_mfma_f32_16x16x32_bf16 v[112:115], a[168:171], a[144:147], v[112:115]
    ds_read_b64_tr_b16 a[192:193], v10 offset:20480
    v_mfma_f32_16x16x32_bf16 v[116:119], a[168:171], a[148:151], v[116:119]
    v_mfma_f32_16x16x32_bf16 v[120:123], a[168:171], a[152:155], v[120:123]
    buffer_load_dwordx4 v17, s[12:15], s43 offen offset:0 nt lds
    v_mfma_f32_16x16x32_bf16 v[124:127], a[168:171], a[156:159], v[124:127]
    ds_read_b64_tr_b16 a[194:195], v10 offset:21760
    v_mfma_f32_16x16x32_bf16 v[156:159], a[172:175], a[156:159], v[156:159]
    v_mfma_f32_16x16x32_bf16 v[152:155], a[172:175], a[152:155], v[152:155]
    s_mul_i32 s43, s62, 229376
    v_mfma_f32_16x16x32_bf16 v[148:151], a[172:175], a[148:151], v[148:151]
    v_mfma_f32_16x16x32_bf16 v[144:147], a[172:175], a[144:147], v[144:147]
    ds_read_b64_tr_b16 a[196:197], v10 offset:30720
    v_mfma_f32_16x16x32_bf16 v[140:143], a[172:175], a[140:143], v[140:143]
    s_lshl_b32 s52, s2, 2
    v_mfma_f32_16x16x32_bf16 v[136:139], a[172:175], a[136:139], v[136:139]
    v_mfma_f32_16x16x32_bf16 v[132:135], a[172:175], a[132:135], v[132:135]
    ds_read_b64_tr_b16 a[198:199], v10 offset:32000
    v_mfma_f32_16x16x32_bf16 v[128:131], a[172:175], a[128:131], v[128:131]
    s_add_u32 s52, s52, s49
    v_mfma_f32_16x16x32_bf16 v[160:163], a[176:179], a[128:131], v[160:163]
    v_mfma_f32_16x16x32_bf16 v[164:167], a[176:179], a[132:135], v[164:167]
    s_lshl_b32 s52, s52, 10
    v_mfma_f32_16x16x32_bf16 v[168:171], a[176:179], a[136:139], v[168:171]
    v_mfma_f32_16x16x32_bf16 v[172:175], a[176:179], a[140:143], v[172:175]
    s_add_u32 s52, s52, 0x100000
    v_mfma_f32_16x16x32_bf16 v[176:179], a[176:179], a[144:147], v[176:179]
    s_cmp_eq_u32 s48, s66
    s_cbranch_scc1 L_cs0Bp1
    L_cs0Bp1b:
    v_mfma_f32_16x16x32_bf16 v[180:183], a[176:179], a[148:151], v[180:183]
    v_mfma_f32_16x16x32_bf16 v[184:187], a[176:179], a[152:155], v[184:187]
    buffer_load_dword v19, v18, s[44:47], s52 offen
    v_mfma_f32_16x16x32_bf16 v[188:191], a[176:179], a[156:159], v[188:191]
    s_waitcnt vmcnt(11) lgkmcnt(0)
    s_barrier
    v_mfma_f32_16x16x32_bf16 v[192:195], a[180:183], a[128:131], v[192:195]
    ds_read_b64_tr_b16 a[160:161], v7 offset:0
    v_mfma_f32_16x16x32_bf16 v[196:199], a[180:183], a[132:135], v[196:199]
    s_add_u32 m0, s58, 0x0
    v_mfma_f32_16x16x32_bf16 v[200:203], a[180:183], a[136:139], v[200:203]
    ds_read_b64_tr_b16 a[162:163], v7 offset:1280
    v_mfma_f32_16x16x32_bf16 v[204:207], a[180:183], a[140:143], v[204:207]
    v_mfma_f32_16x16x32_bf16 v[208:211], a[180:183], a[144:147], v[208:211]
    ds_read_b128 a[96:99], v4 offset:32768
    v_mfma_f32_16x16x32_bf16 v[212:215], a[180:183], a[148:151], v[212:215]
    ds_read_b128 a[100:103], v4 offset:34816
    v_mfma_f32_16x16x32_bf16 v[216:219], a[180:183], a[152:155], v[216:219]
    v_mfma_f32_16x16x32_bf16 v[220:223], a[180:183], a[156:159], v[220:223]
    ds_read_b128 a[104:107], v4 offset:36864
    v_mfma_f32_16x16x32_bf16 v[252:255], a[184:187], a[156:159], v[252:255]
    v_mfma_f32_16x16x32_bf16 v[248:251], a[184:187], a[152:155], v[248:251]
    ds_read_b128 a[108:111], v4 offset:38912
    v_mfma_f32_16x16x32_bf16 v[244:247], a[184:187], a[148:151], v[244:247]
    buffer_load_dwordx4 v21, s[8:11], s40 offen offset:0 lds
    v_mfma_f32_16x16x32_bf16 v[240:243], a[184:187], a[144:147], v[240:243]
    ds_read_b128 a[112:115], v4 offset:40960
    v_mfma_f32_16x16x32_bf16 v[236:239], a[184:187], a[140:143], v[236:239]
    ds_read_b128 a[116:119], v4 offset:43008
    v_mfma_f32_16x16x32_bf16 v[232:235], a[184:187], a[136:139], v[232:235]
    v_mfma_f32_16x16x32_bf16 v[228:231], a[184:187], a[132:135], v[228:231]
    ds_read_b128 a[120:123], v4 offset:45056
    v_mfma_f32_16x16x32_bf16 v[224:227], a[184:187], a[128:131], v[224:227]
    v_mfma_f32_16x16x32_bf16 a[0:3], a[188:191], a[128:131], a[0:3]
    ds_read_b128 a[124:127], v4 offset:47104
    v_mfma_f32_16x16x32_bf16 a[4:7], a[188:191], a[132:135], a[4:7]
    v_mfma_f32_16x16x32_bf16 a[8:11], a[188:191], a[136:139], a[8:11]
    ds_read_b64_tr_b16 a[164:165], v7 offset:10240
    v_mfma_f32_16x16x32_bf16 a[12:15], a[188:191], a[140:143], a[12:15]
    ds_read_b64_tr_b16 a[166:167], v7 offset:11520
    v_mfma_f32_16x16x32_bf16 a[16:19], a[188:191], a[144:147], a[16:19]
    buffer_load_dwordx4 v22, s[8:11], s40 offen offset:1024 lds
    v_mfma_f32_16x16x32_bf16 a[20:23], a[188:191], a[148:151], a[20:23]
    ds_read_b64_tr_b16 a[168:169], v9 offset:32
    v_mfma_f32_16x16x32_bf16 a[24:27], a[188:191], a[152:155], a[24:27]
    v_mfma_f32_16x16x32_bf16 a[28:31], a[188:191], a[156:159], a[28:31]
    ds_read_b64_tr_b16 a[170:171], v9 offset:1312
    v_mfma_f32_16x16x32_bf16 a[60:63], a[192:195], a[156:159], a[60:63]
    v_mfma_f32_16x16x32_bf16 a[56:59], a[192:195], a[152:155], a[56:59]
    ds_read_b64_tr_b16 a[172:173], v9 offset:10272
    v_mfma_f32_16x16x32_bf16 a[52:55], a[192:195], a[148:151], a[52:55]
    ds_read_b64_tr_b16 a[174:175], v9 offset:11552
    v_mfma_f32_16x16x32_bf16 a[48:51], a[192:195], a[144:147], a[48:51]
    v_mfma_f32_16x16x32_bf16 a[44:47], a[192:195], a[140:143], a[44:47]
    ds_read_b64_tr_b16 a[176:177], v7 offset:64
    v_mfma_f32_16x16x32_bf16 a[40:43], a[192:195], a[136:139], a[40:43]
    buffer_load_dwordx4 v23, s[8:11], s40 offen offset:2048 lds
    v_mfma_f32_16x16x32_bf16 a[36:39], a[192:195], a[132:135], a[36:39]
    ds_read_b64_tr_b16 a[178:179], v7 offset:1344
    v_mfma_f32_16x16x32_bf16 a[32:35], a[192:195], a[128:131], a[32:35]
    v_mfma_f32_16x16x32_bf16 a[64:67], a[196:199], a[128:131], a[64:67]
    v_mfma_f32_16x16x32_bf16 a[68:71], a[196:199], a[132:135], a[68:71]
    v_mfma_f32_16x16x32_bf16 a[72:75], a[196:199], a[136:139], a[72:75]
    buffer_load_dwordx4 v24, s[8:11], s40 offen offset:3072 lds
    v_mfma_f32_16x16x32_bf16 a[76:79], a[196:199], a[140:143], a[76:79]
    v_mfma_f32_16x16x32_bf16 a[80:83], a[196:199], a[144:147], a[80:83]
    s_cmp_eq_u32 s48, s67
    s_cbranch_scc1 L_cs1Bp1
    L_cs1Bp1b:
    v_mfma_f32_16x16x32_bf16 a[84:87], a[196:199], a[148:151], a[84:87]
    v_mfma_f32_16x16x32_bf16 a[88:91], a[196:199], a[152:155], a[88:91]
    v_mfma_f32_16x16x32_bf16 a[92:95], a[196:199], a[156:159], a[92:95]
    s_waitcnt lgkmcnt(0)
    s_branch L_loopB_2
L_cs0Bp0:
    v_mfma_f32_16x16x32_bf16 a[200:203], a[220:223], a[160:163], a[200:203]
    v_mfma_f32_16x16x32_bf16 a[204:207], a[220:223], a[164:167], a[204:207]
    v_mfma_f32_16x16x32_bf16 a[208:211], a[220:223], a[168:171], a[208:211]
    v_mfma_f32_16x16x32_bf16 a[212:215], a[220:223], a[172:175], a[212:215]
    v_mfma_f32_16x16x32_bf16 a[216:219], a[220:223], a[176:179], a[216:219]
    s_branch L_cs0Bp0b
L_cs1Bp0:
    v_mfma_f32_16x16x32_bf16 a[200:203], a[220:223], a[180:183], a[200:203]
    v_mfma_f32_16x16x32_bf16 a[204:207], a[220:223], a[184:187], a[204:207]
    v_mfma_f32_16x16x32_bf16 a[208:211], a[220:223], a[188:191], a[208:211]
    v_mfma_f32_16x16x32_bf16 a[212:215], a[220:223], a[192:195], a[212:215]
    v_mfma_f32_16x16x32_bf16 a[216:219], a[220:223], a[196:199], a[216:219]
    s_branch L_cs1Bp0b
L_cs0Bp1:
    v_mfma_f32_16x16x32_bf16 a[200:203], a[220:223], a[160:163], a[200:203]
    v_mfma_f32_16x16x32_bf16 a[204:207], a[220:223], a[164:167], a[204:207]
    v_mfma_f32_16x16x32_bf16 a[208:211], a[220:223], a[168:171], a[208:211]
    v_mfma_f32_16x16x32_bf16 a[212:215], a[220:223], a[172:175], a[212:215]
    v_mfma_f32_16x16x32_bf16 a[216:219], a[220:223], a[176:179], a[216:219]
    s_branch L_cs0Bp1b
L_cs1Bp1:
    v_mfma_f32_16x16x32_bf16 a[200:203], a[220:223], a[180:183], a[200:203]
    v_mfma_f32_16x16x32_bf16 a[204:207], a[220:223], a[184:187], a[204:207]
    v_mfma_f32_16x16x32_bf16 a[208:211], a[220:223], a[188:191], a[208:211]
    v_mfma_f32_16x16x32_bf16 a[212:215], a[220:223], a[192:195], a[212:215]
    v_mfma_f32_16x16x32_bf16 a[216:219], a[220:223], a[196:199], a[216:219]
    s_branch L_cs1Bp1b
L_cs0B4:
    v_mfma_f32_16x16x32_bf16 a[200:203], a[220:223], a[160:163], a[200:203]
    v_mfma_f32_16x16x32_bf16 a[204:207], a[220:223], a[164:167], a[204:207]
    v_mfma_f32_16x16x32_bf16 a[208:211], a[220:223], a[168:171], a[208:211]
    v_mfma_f32_16x16x32_bf16 a[212:215], a[220:223], a[172:175], a[212:215]
    v_mfma_f32_16x16x32_bf16 a[216:219], a[220:223], a[176:179], a[216:219]
    s_branch L_cs0B4b
L_cs1B4:
    v_mfma_f32_16x16x32_bf16 a[200:203], a[220:223], a[180:183], a[200:203]
    v_mfma_f32_16x16x32_bf16 a[204:207], a[220:223], a[184:187], a[204:207]
    v_mfma_f32_16x16x32_bf16 a[208:211], a[220:223], a[188:191], a[208:211]
    v_mfma_f32_16x16x32_bf16 a[212:215], a[220:223], a[192:195], a[212:215]
    v_mfma_f32_16x16x32_bf16 a[216:219], a[220:223], a[196:199], a[216:219]
    s_branch L_cs1B4b
L_cs0B5:
    v_mfma_f32_16x16x32_bf16 a[200:203], a[220:223], a[160:163], a[200:203]
    v_mfma_f32_16x16x32_bf16 a[204:207], a[220:223], a[164:167], a[204:207]
    v_mfma_f32_16x16x32_bf16 a[208:211], a[220:223], a[168:171], a[208:211]
    v_mfma_f32_16x16x32_bf16 a[212:215], a[220:223], a[172:175], a[212:215]
    v_mfma_f32_16x16x32_bf16 a[216:219], a[220:223], a[176:179], a[216:219]
    s_branch L_cs0B5b
L_cs1B5:
    v_mfma_f32_16x16x32_bf16 a[200:203], a[220:223], a[180:183], a[200:203]
    v_mfma_f32_16x16x32_bf16 a[204:207], a[220:223], a[184:187], a[204:207]
    v_mfma_f32_16x16x32_bf16 a[208:211], a[220:223], a[188:191], a[208:211]
    v_mfma_f32_16x16x32_bf16 a[212:215], a[220:223], a[192:195], a[212:215]
    v_mfma_f32_16x16x32_bf16 a[216:219], a[220:223], a[196:199], a[216:219]
    s_branch L_cs1B5b
L_cs0B6:
    v_mfma_f32_16x16x32_bf16 a[200:203], a[220:223], a[160:163], a[200:203]
    v_mfma_f32_16x16x32_bf16 a[204:207], a[220:223], a[164:167], a[204:207]
    v_mfma_f32_16x16x32_bf16 a[208:211], a[220:223], a[168:171], a[208:211]
    v_mfma_f32_16x16x32_bf16 a[212:215], a[220:223], a[172:175], a[212:215]
    v_mfma_f32_16x16x32_bf16 a[216:219], a[220:223], a[176:179], a[216:219]
    s_branch L_cs0B6b
L_cs1B6:
    v_mfma_f32_16x16x32_bf16 a[200:203], a[220:223], a[180:183], a[200:203]
    v_mfma_f32_16x16x32_bf16 a[204:207], a[220:223], a[184:187], a[204:207]
    v_mfma_f32_16x16x32_bf16 a[208:211], a[220:223], a[188:191], a[208:211]
    v_mfma_f32_16x16x32_bf16 a[212:215], a[220:223], a[192:195], a[212:215]
    v_mfma_f32_16x16x32_bf16 a[216:219], a[220:223], a[196:199], a[216:219]
    s_branch L_cs1B6b
L_cs0B7:
    v_mfma_f32_16x16x32_bf16 a[200:203], a[220:223], a[160:163], a[200:203]
    v_mfma_f32_16x16x32_bf16 a[204:207], a[220:223], a[164:167], a[204:207]
    v_mfma_f32_16x16x32_bf16 a[208:211], a[220:223], a[168:171], a[208:211]
    v_mfma_f32_16x16x32_bf16 a[212:215], a[220:223], a[172:175], a[212:215]
    v_mfma_f32_16x16x32_bf16 a[216:219], a[220:223], a[176:179], a[216:219]
    s_branch L_cs0B7b
L_cs1B7:
    v_mfma_f32_16x16x32_bf16 a[200:203], a[220:223], a[180:183], a[200:203]
    v_mfma_f32_16x16x32_bf16 a[204:207], a[220:223], a[184:187], a[204:207]
    v_mfma_f32_16x16x32_bf16 a[208:211], a[220:223], a[188:191], a[208:211]
    v_mfma_f32_16x16x32_bf16 a[212:215], a[220:223], a[192:195], a[212:215]
    v_mfma_f32_16x16x32_bf16 a[216:219], a[220:223], a[196:199], a[216:219]
    s_branch L_cs1B7b
.p2align 6
L_loopB:
    v_mfma_f32_16x16x32_bf16 v[32:35], a[160:163], a[96:99], v[32:35]
    ds_read_b64_tr_b16 a[180:181], v6 offset:10304
    v_mfma_f32_16x16x32_bf16 v[36:39], a[160:163], a[100:103], v[36:39]
    s_add_u32 m0, s58, 0x9000
    v_mfma_f32_16x16x32_bf16 v[40:43], a[160:163], a[104:107], v[40:43]
    v_mfma_f32_16x16x32_bf16 v[44:47], a[160:163], a[108:111], v[44:47]
    ds_read_b64_tr_b16 a[182:183], v6 offset:11584
    v_mfma_f32_16x16x32_bf16 v[48:51], a[160:163], a[112:115], v[48:51]
    buffer_load_dwordx4 v21, s[8:11], s41 offen offset:0 lds
    v_mfma_f32_16x16x32_bf16 v[52:55], a[160:163], a[116:119], v[52:55]
    v_mfma_f32_16x16x32_bf16 v[56:59], a[160:163], a[120:123], v[56:59]
    v_mfma_f32_16x16x32_bf16 v[60:63], a[160:163], a[124:127], v[60:63]
    ds_read_b64_tr_b16 a[184:185], v8 offset:96
    v_mfma_f32_16x16x32_bf16 v[92:95], a[164:167], a[124:127], v[92:95]
    buffer_load_dwordx4 v22, s[8:11], s41 offen offset:1024 lds
    v_mfma_f32_16x16x32_bf16 v[88:91], a[164:167], a[120:123], v[88:91]
    v_mfma_f32_16x16x32_bf16 v[84:87], a[164:167], a[116:119], v[84:87]
    ds_read_b64_tr_b16 a[186:187], v8 offset:1376
    v_mfma_f32_16x16x32_bf16 v[80:83], a[164:167], a[112:115], v[80:83]
    v_mfma_f32_16x16x32_bf16 v[76:79], a[164:167], a[108:111], v[76:79]
    s_add_u32 s63, s63, 128
    v_mfma_f32_16x16x32_bf16 v[72:75], a[164:167], a[104:107], v[72:75]
    ds_read_b64_tr_b16 a[188:189], v8 offset:10336
    v_mfma_f32_16x16x32_bf16 v[68:71], a[164:167], a[100:103], v[68:71]
    v_mfma_f32_16x16x32_bf16 v[64:67], a[164:167], a[96:99], v[64:67]
    v_mfma_f32_16x16x32_bf16 v[96:99], a[168:171], a[96:99], v[96:99]
    s_and_b32 s63, s63, 2047
    v_mfma_f32_16x16x32_bf16 v[100:103], a[168:171], a[100:103], v[100:103]
    ds_read_b64_tr_b16 a[190:191], v8 offset:11616
    v_mfma_f32_16x16x32_bf16 v[104:107], a[168:171], a[104:107], v[104:107]
    v_mfma_f32_16x16x32_bf16 v[108:111], a[168:171], a[108:111], v[108:111]
    v_mfma_f32_16x16x32_bf16 v[112:115], a[168:171], a[112:115], v[112:115]
    ds_read_b64_tr_b16 a[192:193], v10 offset:0
    v_mfma_f32_16x16x32_bf16 v[116:119], a[168:171], a[116:119], v[116:119]
    buffer_load_dwordx4 v23, s[8:11], s41 offen offset:2048 lds
    v_mfma_f32_16x16x32_bf16 v[120:123], a[168:171], a[120:123], v[120:123]
    v_mfma_f32_16x16x32_bf16 v[124:127], a[168:171], a[124:127], v[124:127]
    ds_read_b64_tr_b16 a[194:195], v10 offset:1280
    v_mfma_f32_16x16x32_bf16 v[156:159], a[172:175], a[124:127], v[156:159]
    v_mfma_f32_16x16x32_bf16 v[152:155], a[172:175], a[120:123], v[152:155]
    s_add_u32 s40, s64, s63
    v_mfma_f32_16x16x32_bf16 v[148:151], a[172:175], a[116:119], v[148:151]
    v_mfma_f32_16x16x32_bf16 v[144:147], a[172:175], a[112:115], v[144:147]
    ds_read_b64_tr_b16 a[196:197], v10 offset:10240
    v_mfma_f32_16x16x32_bf16 v[140:143], a[172:175], a[108:111], v[140:143]
    v_mfma_f32_16x16x32_bf16 v[136:139], a[172:175], a[104:107], v[136:139]
    buffer_load_dwordx4 v24, s[8:11], s41 offen offset:3072 lds
    v_mfma_f32_16x16x32_bf16 v[132:135], a[172:175], a[100:103], v[132:135]
    ds_read_b64_tr_b16 a[198:199], v10 offset:11520
    v_mfma_f32_16x16x32_bf16 v[128:131], a[172:175], a[96:99], v[128:131]
    v_mfma_f32_16x16x32_bf16 v[160:163], a[176:179], a[96:99], v[160:163]
    v_mfma_f32_16x16x32_bf16 v[164:167], a[176:179], a[100:103], v[164:167]
    s_add_u32 s41, s40, 0x10000
    v_mfma_f32_16x16x32_bf16 v[168:171], a[176:179], a[104:107], v[168:171]
    v_mfma_f32_16x16x32_bf16 v[172:175], a[176:179], a[108:111], v[172:175]
    v_mfma_f32_16x16x32_bf16 v[176:179], a[176:179], a[112:115], v[176:179]
    s_cmp_eq_u32 s48, s66
    s_cbranch_scc1 L_cs0B4
    L_cs0B4b:
    v_mfma_f32_16x16x32_bf16 v[180:183], a[176:179], a[116:119], v[180:183]
    buffer_load_dword v19, v18, s[32:35], s65 offen
    v_mfma_f32_16x16x32_bf16 v[184:187], a[176:179], a[120:123], v[184:187]
    v_mfma_f32_16x16x32_bf16 v[188:191], a[176:179], a[124:127], v[188:191]
    s_waitcnt vmcnt(13) lgkmcnt(0)
    s_barrier
    v_mfma_f32_16x16x32_bf16 v[192:195], a[180:183], a[96:99], v[192:195]
    ds_read_b64_tr_b16 a[160:161], v6 offset:20480
    v_mfma_f32_16x16x32_bf16 v[196:199], a[180:183], a[100:103], v[196:199]
    s_add_u32 m0, s59, 0x1f000
    v_mfma_f32_16x16x32_bf16 v[200:203], a[180:183], a[104:107], v[200:203]
    ds_read_b64_tr_b16 a[162:163], v6 offset:21760
    v_mfma_f32_16x16x32_bf16 v[204:207], a[180:183], a[108:111], v[204:207]
    v_mfma_f32_16x16x32_bf16 v[208:211], a[180:183], a[112:115], v[208:211]
    ds_read_b128 a[128:131], v5 offset:0
    v_mfma_f32_16x16x32_bf16 v[212:215], a[180:183], a[116:119], v[212:215]
    ds_read_b128 a[132:135], v5 offset:2048
    v_mfma_f32_16x16x32_bf16 v[216:219], a[180:183], a[120:123], v[216:219]
    buffer_load_dwordx4 v13, s[12:15], s43 offen offset:0 nt lds
    v_mfma_f32_16x16x32_bf16 v[220:223], a[180:183], a[124:127], v[220:223]
    ds_read_b128 a[136:139], v5 offset:4096
    v_mfma_f32_16x16x32_bf16 v[252:255], a[184:187], a[124:127], v[252:255]
    v_mfma_f32_16x16x32_bf16 v[248:251], a[184:187], a[120:123], v[248:251]
    ds_read_b128 a[140:143], v5 offset:6144
    v_mfma_f32_16x16x32_bf16 v[244:247], a[184:187], a[116:119], v[244:247]
    buffer_load_dwordx4 v14, s[12:15], s43 offen offset:1024 nt lds
    v_mfma_f32_16x16x32_bf16 v[240:243], a[184:187], a[112:115], v[240:243]
    ds_read_b128 a[144:147], v5 offset:8192
    v_mfma_f32_16x16x32_bf16 v[236:239], a[184:187], a[108:111], v[236:239]
    ds_read_b128 a[148:151], v5 offset:10240
    v_mfma_f32_16x16x32_bf16 v[232:235], a[184:187], a[104:107], v[232:235]
    v_mfma_f32_16x16x32_bf16 v[228:231], a[184:187], a[100:103], v[228:231]
    ds_read_b128 a[152:155], v5 offset:12288
    v_mfma_f32_16x16x32_bf16 v[224:227], a[184:187], a[96:99], v[224:227]
    buffer_load_dwordx4 v15, s[12:15], s43 offen offset:2048 nt lds
    v_mfma_f32_16x16x32_bf16 a[0:3], a[188:191], a[96:99], a[0:3]
    ds_read_b128 a[156:159], v5 offset:14336
    v_mfma_f32_16x16x32_bf16 a[4:7], a[188:191], a[100:103], a[4:7]
    v_mfma_f32_16x16x32_bf16 a[8:11], a[188:191], a[104:107], a[8:11]
    ds_read_b64_tr_b16 a[164:165], v6 offset:30720
    v_mfma_f32_16x16x32_bf16 a[12:15], a[188:191], a[108:111], a[12:15]
    ds_read_b64_tr_b16 a[166:167], v6 offset:32000
    v_mfma_f32_16x16x32_bf16 a[16:19], a[188:191], a[112:115], a[16:19]
    buffer_load_dwordx4 v16, s[12:15], s43 offen offset:3072 nt lds
    v_mfma_f32_16x16x32_bf16 a[20:23], a[188:191], a[116:119], a[20:23]
    ds_read_b64_tr_b16 a[168:169], v8 offset:20512
    v_mfma_f32_16x16x32_bf16 a[24:27], a[188:191], a[120:123], a[24:27]
    v_mfma_f32_16x16x32_bf16 a[28:31], a[188:191], a[124:127], a[28:31]
    ds_read_b64_tr_b16 a[170:171], v8 offset:21792
    v_mfma_f32_16x16x32_bf16 a[60:63], a[192:195], a[124:127], a[60:63]
    s_add_u32 s62, s62, 1
    v_mfma_f32_16x16x32_bf16 a[56:59], a[192:195], a[120:123], a[56:59]
    ds_read_b64_tr_b16 a[172:173], v8 offset:30752
    v_mfma_f32_16x16x32_bf16 a[52:55], a[192:195], a[116:119], a[52:55]
    ds_read_b64_tr_b16 a[174:175], v8 offset:32032
    v_mfma_f32_16x16x32_bf16 a[48:51], a[192:195], a[112:115], a[48:51]
    v_mfma_f32_16x16x32_bf16 a[44:47], a[192:195], a[108:111], a[44:47]
    ds_read_b64_tr_b16 a[176:177], v6 offset:20544
    v_mfma_f32_16x16x32_bf16 a[40:43], a[192:195], a[104:107], a[40:43]
    s_and_b32 s62, s62, 31
    v_mfma_f32_16x16x32_bf16 a[36:39], a[192:195], a[100:103], a[36:39]
    ds_read_b64_tr_b16 a[178:179], v6 offset:21824
    v_mfma_f32_16x16x32_bf16 a[32:35], a[192:195], a[96:99], a[32:35]
    v_mfma_f32_16x16x32_bf16 a[64:67], a[196:199], a[96:99], a[64:67]
    s_add_u32 m0, s59, 0x20000
    v_mfma_f32_16x16x32_bf16 a[68:71], a[196:199], a[100:103], a[68:71]
    v_mfma_f32_16x16x32_bf16 a[72:75], a[196:199], a[104:107], a[72:75]
    buffer_load_dwordx4 v17, s[12:15], s43 offen offset:0 nt lds
    v_mfma_f32_16x16x32_bf16 a[76:79], a[196:199], a[108:111], a[76:79]
    v_mfma_f32_16x16x32_bf16 a[80:83], a[196:199], a[112:115], a[80:83]
    s_cmp_eq_u32 s48, s67
    s_cbranch_scc1 L_cs1B4
    L_cs1B4b:
    v_mfma_f32_16x16x32_bf16 a[84:87], a[196:199], a[116:119], a[84:87]
    s_mul_i32 s43, s62, 229376
    v_mfma_f32_16x16x32_bf16 a[88:91], a[196:199], a[120:123], a[88:91]
    v_mfma_f32_16x16x32_bf16 a[92:95], a[196:199], a[124:127], a[92:95]
    s_waitcnt lgkmcnt(0)
    v_mfma_f32_16x16x32_bf16 v[32:35], a[160:163], a[128:131], v[32:35]
    ds_read_b64_tr_b16 a[180:181], v6 offset:30784
    v_mfma_f32_16x16x32_bf16 v[36:39], a[160:163], a[132:135], v[36:39]
    s_add_u32 m0, s59, 0x10000
    v_mfma_f32_16x16x32_bf16 v[40:43], a[160:163], a[136:139], v[40:43]
    v_mfma_f32_16x16x32_bf16 v[44:47], a[160:163], a[140:143], v[44:47]
    ds_read_b64_tr_b16 a[182:183], v6 offset:32064
    v_mfma_f32_16x16x32_bf16 v[48:51], a[160:163], a[144:147], v[48:51]
    buffer_load_dwordx4 v13, s[12:15], s43 offen offset:0 nt lds
    v_mfma_f32_16x16x32_bf16 v[52:55], a[160:163], a[148:151], v[52:55]
    v_mfma_f32_16x16x32_bf16 v[56:59], a[160:163], a[152:155], v[56:59]
    v_mfma_f32_16x16x32_bf16 v[60:63], a[160:163], a[156:159], v[60:63]
    ds_read_b64_tr_b16 a[184:185], v8 offset:20576
    v_mfma_f32_16x16x32_bf16 v[92:95], a[164:167], a[156:159], v[92:95]
    buffer_load_dwordx4 v14, s[12:15], s43 offen offset:1024 nt lds
    v_mfma_f32_16x16x32_bf16 v[88:91], a[164:167], a[152:155], v[88:91]
    v_mfma_f32_16x16x32_bf16 v[84:87], a[164:167], a[148:151], v[84:87]
    ds_read_b64_tr_b16 a[186:187], v8 offset:21856
    v_mfma_f32_16x16x32_bf16 v[80:83], a[164:167], a[144:147], v[80:83]
    v_mfma_f32_16x16x32_bf16 v[76:79], a[164:167], a[140:143], v[76:79]
    buffer_load_dwordx4 v15, s[12:15], s43 offen offset:2048 nt lds
    v_mfma_f32_16x16x32_bf16 v[72:75], a[164:167], a[136:139], v[72:75]
    ds_read_b64_tr_b16 a[188:189], v8 offset:30816
    v_mfma_f32_16x16x32_bf16 v[68:71], a[164:167], a[132:135], v[68:71]
    v_mfma_f32_16x16x32_bf16 v[64:67], a[164:167], a[128:131], v[64:67]
    v_mfma_f32_16x16x32_bf16 v[96:99], a[168:171], a[128:131], v[96:99]
    buffer_load_dwordx4 v16, s[12:15], s43 offen offset:3072 nt lds
    v_mfma_f32_16x16x32_bf16 v[100:103], a[168:171], a[132:135], v[100:103]
    ds_read_b64_tr_b16 a[190:191], v8 offset:32096
    v_mfma_f32_16x16x32_bf16 v[104:107], a[168:171], a[136:139], v[104:107]
    v_mfma_f32_16x16x32_bf16 v[108:111], a[168:171], a[140:143], v[108:111]
    v_mfma_f32_16x16x32_bf16 v[112:115], a[168:171], a[144:147], v[112:115]
    ds_read_b64_tr_b16 a[192:193], v10 offset:20480
    v_mfma_f32_16x16x32_bf16 v[116:119], a[168:171], a[148:151], v[116:119]
    s_add_u32 s62, s62, 1
    v_mfma_f32_16x16x32_bf16 v[120:123], a[168:171], a[152:155], v[120:123]
    v_mfma_f32_16x16x32_bf16 v[124:127], a[168:171], a[156:159], v[124:127]
    ds_read_b64_tr_b16 a[194:195], v10 offset:21760
    v_mfma_f32_16x16x32_bf16 v[156:159], a[172:175], a[156:159], v[156:159]
    v_mfma_f32_16x16x32_bf16 v[152:155], a[172:175], a[152:155], v[152:155]
    s_and_b32 s62, s62, 31
    v_mfma_f32_16x16x32_bf16 v[148:151], a[172:175], a[148:151], v[148:151]
    v_mfma_f32_16x16x32_bf16 v[144:147], a[172:175], a[144:147], v[144:147]
    ds_read_b64_tr_b16 a[196:197], v10 offset:30720
    v_mfma_f32_16x16x32_bf16 v[140:143], a[172:175], a[140:143], v[140:143]
    v_mfma_f32_16x16x32_bf16 v[136:139], a[172:175], a[136:139], v[136:139]
    s_add_u32 m0, s59, 0x11000
    v_mfma_f32_16x16x32_bf16 v[132:135], a[172:175], a[132:135], v[132:135]
    ds_read_b64_tr_b16 a[198:199], v10 offset:32000
    v_mfma_f32_16x16x32_bf16 v[128:131], a[172:175], a[128:131], v[128:131]
    v_mfma_f32_16x16x32_bf16 v[160:163], a[176:179], a[128:131], v[160:163]
    v_mfma_f32_16x16x32_bf16 v[164:167], a[176:179], a[132:135], v[164:167]
    buffer_load_dwordx4 v17, s[12:15], s43 offen offset:0 nt lds
    v_mfma_f32_16x16x32_bf16 v[168:171], a[176:179], a[136:139], v[168:171]
    v_mfma_f32_16x16x32_bf16 v[172:175], a[176:179], a[140:143], v[172:175]
    v_mfma_f32_16x16x32_bf16 v[176:179], a[176:179], a[144:147], v[176:179]
    s_cmp_eq_u32 s48, s66
    s_cbranch_scc1 L_cs0B5
    L_cs0B5b:
    v_mfma_f32_16x16x32_bf16 v[180:183], a[176:179], a[148:151], v[180:183]
    s_mul_i32 s43, s62, 229376
    v_mfma_f32_16x16x32_bf16 v[184:187], a[176:179], a[152:155], v[184:187]
    v_mfma_f32_16x16x32_bf16 v[188:191], a[176:179], a[156:159], v[188:191]
    s_waitcnt vmcnt(10) lgkmcnt(0)
    s_barrier
    v_mfma_f32_16x16x32_bf16 v[192:195], a[180:183], a[128:131], v[192:195]
    ds_read_b64_tr_b16 a[160:161], v7 offset:0
    v_mfma_f32_16x16x32_bf16 v[196:199], a[180:183], a[132:135], v[196:199]
    s_add_u32 m0, s58, 0x0
    v_mfma_f32_16x16x32_bf16 v[200:203], a[180:183], a[136:139], v[200:203]
    ds_read_b64_tr_b16 a[162:163], v7 offset:1280
    v_mfma_f32_16x16x32_bf16 v[204:207], a[180:183], a[140:143], v[204:207]
    v_mfma_f32_16x16x32_bf16 v[208:211], a[180:183], a[144:147], v[208:211]
    ds_read_b128 a[96:99], v4 offset:32768
    v_mfma_f32_16x16x32_bf16 v[212:215], a[180:183], a[148:151], v[212:215]
    ds_read_b128 a[100:103], v4 offset:34816
    v_mfma_f32_16x16x32_bf16 v[216:219], a[180:183], a[152:155], v[216:219]
    v_mfma_f32_16x16x32_bf16 v[220:223], a[180:183], a[156:159], v[220:223]
    ds_read_b128 a[104:107], v4 offset:36864
    v_mfma_f32_16x16x32_bf16 v[252:255], a[184:187], a[156:159], v[252:255]
    v_mfma_f32_16x16x32_bf16 v[248:251], a[184:187], a[152:155], v[248:251]
    ds_read_b128 a[108:111], v4 offset:38912
    v_mfma_f32_16x16x32_bf16 v[244:247], a[184:187], a[148:151], v[244:247]
    buffer_load_dwordx4 v21, s[8:11], s40 offen offset:0 lds
    v_mfma_f32_16x16x32_bf16 v[240:243], a[184:187], a[144:147], v[240:243]
    ds_read_b128 a[112:115], v4 offset:40960
    v_mfma_f32_16x16x32_bf16 v[236:239], a[184:187], a[140:143], v[236:239]
    ds_read_b128 a[116:119], v4 offset:43008
    v_mfma_f32_16x16x32_bf16 v[232:235], a[184:187], a[136:139], v[232:235]
    v_mfma_f32_16x16x32_bf16 v[228:231], a[184:187], a[132:135], v[228:231]
    ds_read_b128 a[120:123], v4 offset:45056
    v_mfma_f32_16x16x32_bf16 v[224:227], a[184:187], a[128:131], v[224:227]
    v_mfma_f32_16x16x32_bf16 a[0:3], a[188:191], a[128:131], a[0:3]
    ds_read_b128 a[124:127], v4 offset:47104
    v_mfma_f32_16x16x32_bf16 a[4:7], a[188:191], a[132:135], a[4:7]
    v_mfma_f32_16x16x32_bf16 a[8:11], a[188:191], a[136:139], a[8:11]
    ds_read_b64_tr_b16 a[164:165], v7 offset:10240
    v_mfma_f32_16x16x32_bf16 a[12:15], a[188:191], a[140:143], a[12:15]
    ds_read_b64_tr_b16 a[166:167], v7 offset:11520
    v_mfma_f32_16x16x32_bf16 a[16:19], a[188:191], a[144:147], a[16:19]
    buffer_load_dwordx4 v22, s[8:11], s40 offen offset:1024 lds
    v_mfma_f32_16x16x32_bf16 a[20:23], a[188:191], a[148:151], a[20:23]
    ds_read_b64_tr_b16 a[168:169], v9 offset:32
    v_mfma_f32_16x16x32_bf16 a[24:27], a[188:191], a[152:155], a[24:27]
    v_mfma_f32_16x16x32_bf16 a[28:31], a[188:191], a[156:159], a[28:31]
    ds_read_b64_tr_b16 a[170:171], v9 offset:1312
    v_mfma_f32_16x16x32_bf16 a[60:63], a[192:195], a[156:159], a[60:63]
    v_mfma_f32_16x16x32_bf16 a[56:59], a[192:195], a[152:155], a[56:59]
    ds_read_b64_tr_b16 a[172:173], v9 offset:10272
    v_mfma_f32_16x16x32_bf16 a[52:55], a[192:195], a[148:151], a[52:55]
    ds_read_b64_tr_b16 a[174:175], v9 offset:11552
    v_mfma_f32_16x16x32_bf16 a[48:51], a[192:195], a[144:147], a[48:51]
    v_mfma_f32_16x16x32_bf16 a[44:47], a[192:195], a[140:143], a[44:47]
    ds_read_b64_tr_b16 a[176:177], v7 offset:64
    v_mfma_f32_16x16x32_bf16 a[40:43], a[192:195], a[136:139], a[40:43]
    buffer_load_dwordx4 v23, s[8:11], s40 offen offset:2048 lds
    v_mfma_f32_16x16x32_bf16 a[36:39], a[192:195], a[132:135], a[36:39]
    ds_read_b64_tr_b16 a[178:179], v7 offset:1344
    v_mfma_f32_16x16x32_bf16 a[32:35], a[192:195], a[128:131], a[32:35]
    v_mfma_f32_16x16x32_bf16 a[64:67], a[196:199], a[128:131], a[64:67]
    v_mfma_f32_16x16x32_bf16 a[68:71], a[196:199], a[132:135], a[68:71]
    v_mfma_f32_16x16x32_bf16 a[72:75], a[196:199], a[136:139], a[72:75]
    buffer_load_dwordx4 v24, s[8:11], s40 offen offset:3072 lds
    v_mfma_f32_16x16x32_bf16 a[76:79], a[196:199], a[140:143], a[76:79]
    v_mfma_f32_16x16x32_bf16 a[80:83], a[196:199], a[144:147], a[80:83]
    s_cmp_eq_u32 s48, s67
    s_cbranch_scc1 L_cs1B5
    L_cs1B5b:
    v_mfma_f32_16x16x32_bf16 a[84:87], a[196:199], a[148:151], a[84:87]
    v_mfma_f32_16x16x32_bf16 a[88:91], a[196:199], a[152:155], a[88:91]
    v_mfma_f32_16x16x32_bf16 a[92:95], a[196:199], a[156:159], a[92:95]
    s_waitcnt lgkmcnt(0)
L_loopB_2:
    v_mfma_f32_16x16x32_bf16 v[32:35], a[160:163], a[96:99], v[32:35]
    ds_read_b64_tr_b16 a[180:181], v7 offset:10304
    v_mfma_f32_16x16x32_bf16 v[36:39], a[160:163], a[100:103], v[36:39]
    s_add_u32 m0, s58, 0x1000
    v_mfma_f32_16x16x32_bf16 v[40:43], a[160:163], a[104:107], v[40:43]
    v_mfma_f32_16x16x32_bf16 v[44:47], a[160:163], a[108:111], v[44:47]
    ds_read_b64_tr_b16 a[182:183], v7 offset:11584
    v_mfma_f32_16x16x32_bf16 v[48:51], a[160:163], a[112:115], v[48:51]
    buffer_load_dwordx4 v21, s[8:11], s41 offen offset:0 lds
    v_mfma_f32_16x16x32_bf16 v[52:55], a[160:163], a[116:119], v[52:55]
    v_mfma_f32_16x16x32_bf16 v[56:59], a[160:163], a[120:123], v[56:59]
    v_mfma_f32_16x16x32_bf16 v[60:63], a[160:163], a[124:127], v[60:63]
    ds_read_b64_tr_b16 a[184:185], v9 offset:96
    v_mfma_f32_16x16x32_bf16 v[92:95], a[164:167], a[124:127], v[92:95]
    buffer_load_dwordx4 v22, s[8:11], s41 offen offset:1024 lds
    v_mfma_f32_16x16x32_bf16 v[88:91], a[164:167], a[120:123], v[88:91]
    v_mfma_f32_16x16x32_bf16 v[84:87], a[164:167], a[116:119], v[84:87]
    ds_read_b64_tr_b16 a[186:187], v9 offset:1376
    v_mfma_f32_16x16x32_bf16 v[80:83], a[164:167], a[112:115], v[80:83]
    s_add_u32 s63, s63, 128
    v_mfma_f32_16x16x32_bf16 v[76:79], a[164:167], a[108:111], v[76:79]
    v_mfma_f32_16x16x32_bf16 v[72:75], a[164:167], a[104:107], v[72:75]
    ds_read_b64_tr_b16 a[188:189], v9 offset:10336
    v_mfma_f32_16x16x32_bf16 v[68:71], a[164:167], a[100:103], v[68:71]
    v_mfma_f32_16x16x32_bf16 v[64:67], a[164:167], a[96:99], v[64:67]
    s_and_b32 s63, s63, 2047
    v_mfma_f32_16x16x32_bf16 v[96:99], a[168:171], a[96:99], v[96:99]
    v_mfma_f32_16x16x32_bf16 v[100:103], a[168:171], a[100:103], v[100:103]
    ds_read_b64_tr_b16 a[190:191], v9 offset:11616
    v_mfma_f32_16x16x32_bf16 v[104:107], a[168:171], a[104:107], v[104:107]
    v_mfma_f32_16x16x32_bf16 v[108:111], a[168:171], a[108:111], v[108:111]
    buffer_load_dwordx4 v23, s[8:11], s41 offen offset:2048 lds
    v_mfma_f32_16x16x32_bf16 v[112:115], a[168:171], a[112:115], v[112:115]
    ds_read_b64_tr_b16 a[192:193], v11 offset:0
    v_mfma_f32_16x16x32_bf16 v[116:119], a[168:171], a[116:119], v[116:119]
    v_mfma_f32_16x16x32_bf16 v[120:123], a[168:171], a[120:123], v[120:123]
    s_add_u32 s40, s64, s63
    v_mfma_f32_16x16x32_bf16 v[124:127], a[168:171], a[124:127], v[124:127]
    ds_read_b64_tr_b16 a[194:195], v11 offset:1280
    v_mfma_f32_16x16x32_bf16 v[156:159], a[172:175], a[124:127], v[156:159]
    v_mfma_f32_16x16x32_bf16 v[152:155], a[172:175], a[120:123], v[152:155]
    v_mfma_f32_16x16x32_bf16 v[148:151], a[172:175], a[116:119], v[148:151]
    buffer_load_dwordx4 v24, s[8:11], s41 offen offset:3072 lds
    v_mfma_f32_16x16x32_bf16 v[144:147], a[172:175], a[112:115], v[144:147]
    ds_read_b64_tr_b16 a[196:197], v11 offset:10240
    v_mfma_f32_16x16x32_bf16 v[140:143], a[172:175], a[108:111], v[140:143]
    v_mfma_f32_16x16x32_bf16 v[136:139], a[172:175], a[104:107], v[136:139]
    v_mfma_f32_16x16x32_bf16 v[132:135], a[172:175], a[100:103], v[132:135]
    ds_read_b64_tr_b16 a[198:199], v11 offset:11520
    v_mfma_f32_16x16x32_bf16 v[128:131], a[172:175], a[96:99], v[128:131]
    s_add_u32 s41, s40, 0x10000
    v_mfma_f32_16x16x32_bf16 v[160:163], a[176:179], a[96:99], v[160:163]
    v_mfma_f32_16x16x32_bf16 v[164:167], a[176:179], a[100:103], v[164:167]
    buffer_load_dword v19, v18, s[36:39], s60 offen
    v_mfma_f32_16x16x32_bf16 v[168:171], a[176:179], a[104:107], v[168:171]
    v_mfma_f32_16x16x32_bf16 v[172:175], a[176:179], a[108:111], v[172:175]
    v_mfma_f32_16x16x32_bf16 v[176:179], a[176:179], a[112:115], v[176:179]
    s_cmp_eq_u32 s48, s66
    s_cbranch_scc1 L_cs0B6
    L_cs0B6b:
    v_mfma_f32_16x16x32_bf16 v[180:183], a[176:179], a[116:119], v[180:183]
    s_add_u32 s60, s60, s61
    v_mfma_f32_16x16x32_bf16 v[184:187], a[176:179], a[120:123], v[184:187]
    v_mfma_f32_16x16x32_bf16 v[188:191], a[176:179], a[124:127], v[188:191]
    s_waitcnt vmcnt(13) lgkmcnt(0)
    s_barrier
    v_mfma_f32_16x16x32_bf16 v[192:195], a[180:183], a[96:99], v[192:195]
    ds_read_b64_tr_b16 a[160:161], v7 offset:20480
    v_mfma_f32_16x16x32_bf16 v[196:199], a[180:183], a[100:103], v[196:199]
    s_add_u32 m0, s59, 0x15000
    v_mfma_f32_16x16x32_bf16 v[200:203], a[180:183], a[104:107], v[200:203]
    ds_read_b64_tr_b16 a[162:163], v7 offset:21760
    v_mfma_f32_16x16x32_bf16 v[204:207], a[180:183], a[108:111], v[204:207]
    v_mfma_f32_16x16x32_bf16 v[208:211], a[180:183], a[112:115], v[208:211]
    ds_read_b128 a[128:131], v5 offset:32768
    v_mfma_f32_16x16x32_bf16 v[212:215], a[180:183], a[116:119], v[212:215]
    ds_read_b128 a[132:135], v5 offset:34816
    v_mfma_f32_16x16x32_bf16 v[216:219], a[180:183], a[120:123], v[216:219]
    buffer_load_dwordx4 v13, s[12:15], s43 offen offset:0 nt lds
    v_mfma_f32_16x16x32_bf16 v[220:223], a[180:183], a[124:127], v[220:223]
    ds_read_b128 a[136:139], v5 offset:36864
    v_mfma_f32_16x16x32_bf16 v[252:255], a[184:187], a[124:127], v[252:255]
    v_mfma_f32_16x16x32_bf16 v[248:251], a[184:187], a[120:123], v[248:251]
    ds_read_b128 a[140:143], v5 offset:38912
    v_mfma_f32_16x16x32_bf16 v[244:247], a[184:187], a[116:119], v[244:247]
    buffer_load_dwordx4 v14, s[12:15], s43 offen offset:1024 nt lds
    v_mfma_f32_16x16x32_bf16 v[240:243], a[184:187], a[112:115], v[240:243]
    ds_read_b128 a[144:147], v5 offset:40960
    v_mfma_f32_16x16x32_bf16 v[236:239], a[184:187], a[108:111], v[236:239]
    ds_read_b128 a[148:151], v5 offset:43008
    v_mfma_f32_16x16x32_bf16 v[232:235], a[184:187], a[104:107], v[232:235]
    v_mfma_f32_16x16x32_bf16 v[228:231], a[184:187], a[100:103], v[228:231]
    ds_read_b128 a[152:155], v5 offset:45056
    v_mfma_f32_16x16x32_bf16 v[224:227], a[184:187], a[96:99], v[224:227]
    buffer_load_dwordx4 v15, s[12:15], s43 offen offset:2048 nt lds
    v_mfma_f32_16x16x32_bf16 a[0:3], a[188:191], a[96:99], a[0:3]
    ds_read_b128 a[156:159], v5 offset:47104
    v_mfma_f32_16x16x32_bf16 a[4:7], a[188:191], a[100:103], a[4:7]
    v_mfma_f32_16x16x32_bf16 a[8:11], a[188:191], a[104:107], a[8:11]
    ds_read_b64_tr_b16 a[164:165], v7 offset:30720
    v_mfma_f32_16x16x32_bf16 a[12:15], a[188:191], a[108:111], a[12:15]
    ds_read_b64_tr_b16 a[166:167], v7 offset:32000
    v_mfma_f32_16x16x32_bf16 a[16:19], a[188:191], a[112:115], a[16:19]
    buffer_load_dwordx4 v16, s[12:15], s43 offen offset:3072 nt lds
    v_mfma_f32_16x16x32_bf16 a[20:23], a[188:191], a[116:119], a[20:23]
    ds_read_b64_tr_b16 a[168:169], v9 offset:20512
    v_mfma_f32_16x16x32_bf16 a[24:27], a[188:191], a[120:123], a[24:27]
    v_mfma_f32_16x16x32_bf16 a[28:31], a[188:191], a[124:127], a[28:31]
    ds_read_b64_tr_b16 a[170:171], v9 offset:21792
    v_mfma_f32_16x16x32_bf16 a[60:63], a[192:195], a[124:127], a[60:63]
    s_add_u32 s62, s62, 1
    v_mfma_f32_16x16x32_bf16 a[56:59], a[192:195], a[120:123], a[56:59]
    ds_read_b64_tr_b16 a[172:173], v9 offset:30752
    v_mfma_f32_16x16x32_bf16 a[52:55], a[192:195], a[116:119], a[52:55]
    ds_read_b64_tr_b16 a[174:175], v9 offset:32032
    v_mfma_f32_16x16x32_bf16 a[48:51], a[192:195], a[112:115], a[48:51]
    v_mfma_f32_16x16x32_bf16 a[44:47], a[192:195], a[108:111], a[44:47]
    ds_read_b64_tr_b16 a[176:177], v7 offset:20544
    v_mfma_f32_16x16x32_bf16 a[40:43], a[192:195], a[104:107], a[40:43]
    s_and_b32 s62, s62, 31
    v_mfma_f32_16x16x32_bf16 a[36:39], a[192:195], a[100:103], a[36:39]
    ds_read_b64_tr_b16 a[178:179], v7 offset:21824
    v_mfma_f32_16x16x32_bf16 a[32:35], a[192:195], a[96:99], a[32:35]
    v_mfma_f32_16x16x32_bf16 a[64:67], a[196:199], a[96:99], a[64:67]
    s_add_u32 m0, s59, 0x16000
    v_mfma_f32_16x16x32_bf16 a[68:71], a[196:199], a[100:103], a[68:71]
    v_mfma_f32_16x16x32_bf16 a[72:75], a[196:199], a[104:107], a[72:75]
    buffer_load_dwordx4 v17, s[12:15], s43 offen offset:0 nt lds
    v_mfma_f32_16x16x32_bf16 a[76:79], a[196:199], a[108:111], a[76:79]
    v_mfma_f32_16x16x32_bf16 a[80:83], a[196:199], a[112:115], a[80:83]
    s_cmp_eq_u32 s48, s67
    s_cbranch_scc1 L_cs1B6
    L_cs1B6b:
    v_mfma_f32_16x16x32_bf16 a[84:87], a[196:199], a[116:119], a[84:87]
    s_mul_i32 s43, s62, 229376
    v_mfma_f32_16x16x32_bf16 a[88:91], a[196:199], a[120:123], a[88:91]
    v_mfma_f32_16x16x32_bf16 a[92:95], a[196:199], a[124:127], a[92:95]
    s_waitcnt lgkmcnt(0)
    v_mfma_f32_16x16x32_bf16 v[32:35], a[160:163], a[128:131], v[32:35]
    ds_read_b64_tr_b16 a[180:181], v7 offset:30784
    v_mfma_f32_16x16x32_bf16 v[36:39], a[160:163], a[132:135], v[36:39]
    s_add_u32 m0, s59, 0x1a000
    v_mfma_f32_16x16x32_bf16 v[40:43], a[160:163], a[136:139], v[40:43]
    v_mfma_f32_16x16x32_bf16 v[44:47], a[160:163], a[140:143], v[44:47]
    ds_read_b64_tr_b16 a[182:183], v7 offset:32064
    v_mfma_f32_16x16x32_bf16 v[48:51], a[160:163], a[144:147], v[48:51]
    buffer_load_dwordx4 v13, s[12:15], s43 offen offset:0 nt lds
    v_mfma_f32_16x16x32_bf16 v[52:55], a[160:163], a[148:151], v[52:55]
    v_mfma_f32_16x16x32_bf16 v[56:59], a[160:163], a[152:155], v[56:59]
    v_mfma_f32_16x16x32_bf16 v[60:63], a[160:163], a[156:159], v[60:63]
    ds_read_b64_tr_b16 a[184:185], v9 offset:20576
    v_mfma_f32_16x16x32_bf16 v[92:95], a[164:167], a[156:159], v[92:95]
    buffer_load_dwordx4 v14, s[12:15], s43 offen offset:1024 nt lds
    v_mfma_f32_16x16x32_bf16 v[88:91], a[164:167], a[152:155], v[88:91]
    v_mfma_f32_16x16x32_bf16 v[84:87], a[164:167], a[148:151], v[84:87]
    ds_read_b64_tr_b16 a[186:187], v9 offset:21856
    v_mfma_f32_16x16x32_bf16 v[80:83], a[164:167], a[144:147], v[80:83]
    v_mfma_f32_16x16x32_bf16 v[76:79], a[164:167], a[140:143], v[76:79]
    buffer_load_dwordx4 v15, s[12:15], s43 offen offset:2048 nt lds
    v_mfma_f32_16x16x32_bf16 v[72:75], a[164:167], a[136:139], v[72:75]
    ds_read_b64_tr_b16 a[188:189], v9 offset:30816
    v_mfma_f32_16x16x32_bf16 v[68:71], a[164:167], a[132:135], v[68:71]
    v_mfma_f32_16x16x32_bf16 v[64:67], a[164:167], a[128:131], v[64:67]
    v_mfma_f32_16x16x32_bf16 v[96:99], a[168:171], a[128:131], v[96:99]
    buffer_load_dwordx4 v16, s[12:15], s43 offen offset:3072 nt lds
    v_mfma_f32_16x16x32_bf16 v[100:103], a[168:171], a[132:135], v[100:103]
    ds_read_b64_tr_b16 a[190:191], v9 offset:32096
    v_mfma_f32_16x16x32_bf16 v[104:107], a[168:171], a[136:139], v[104:107]
    v_mfma_f32_16x16x32_bf16 v[108:111], a[168:171], a[140:143], v[108:111]
    v_mfma_f32_16x16x32_bf16 v[112:115], a[168:171], a[144:147], v[112:115]
    ds_read_b64_tr_b16 a[192:193], v11 offset:20480
    v_mfma_f32_16x16x32_bf16 v[116:119], a[168:171], a[148:151], v[116:119]
    s_add_u32 s62, s62, 1
    v_mfma_f32_16x16x32_bf16 v[120:123], a[168:171], a[152:155], v[120:123]
    v_mfma_f32_16x16x32_bf16 v[124:127], a[168:171], a[156:159], v[124:127]
    ds_read_b64_tr_b16 a[194:195], v11 offset:21760
    v_mfma_f32_16x16x32_bf16 v[156:159], a[172:175], a[156:159], v[156:159]
    v_mfma_f32_16x16x32_bf16 v[152:155], a[172:175], a[152:155], v[152:155]
    s_and_b32 s62, s62, 31
    v_mfma_f32_16x16x32_bf16 v[148:151], a[172:175], a[148:151], v[148:151]
    v_mfma_f32_16x16x32_bf16 v[144:147], a[172:175], a[144:147], v[144:147]
    ds_read_b64_tr_b16 a[196:197], v11 offset:30720
    v_mfma_f32_16x16x32_bf16 v[140:143], a[172:175], a[140:143], v[140:143]
    v_mfma_f32_16x16x32_bf16 v[136:139], a[172:175], a[136:139], v[136:139]
    s_add_u32 m0, s59, 0x1b000
    v_mfma_f32_16x16x32_bf16 v[132:135], a[172:175], a[132:135], v[132:135]
    ds_read_b64_tr_b16 a[198:199], v11 offset:32000
    v_mfma_f32_16x16x32_bf16 v[128:131], a[172:175], a[128:131], v[128:131]
    v_mfma_f32_16x16x32_bf16 v[160:163], a[176:179], a[128:131], v[160:163]
    v_mfma_f32_16x16x32_bf16 v[164:167], a[176:179], a[132:135], v[164:167]
    buffer_load_dwordx4 v17, s[12:15], s43 offen offset:0 nt lds
    v_mfma_f32_16x16x32_bf16 v[168:171], a[176:179], a[136:139], v[168:171]
    v_mfma_f32_16x16x32_bf16 v[172:175], a[176:179], a[140:143], v[172:175]
    v_mfma_f32_16x16x32_bf16 v[176:179], a[176:179], a[144:147], v[176:179]
    s_cmp_eq_u32 s48, s66
    s_cbranch_scc1 L_cs0B7
    L_cs0B7b:
    v_mfma_f32_16x16x32_bf16 v[180:183], a[176:179], a[148:151], v[180:183]
    s_mul_i32 s43, s62, 229376
    v_mfma_f32_16x16x32_bf16 v[184:187], a[176:179], a[152:155], v[184:187]
    v_mfma_f32_16x16x32_bf16 v[188:191], a[176:179], a[156:159], v[188:191]
    s_waitcnt vmcnt(10) lgkmcnt(0)
    s_barrier
    v_mfma_f32_16x16x32_bf16 v[192:195], a[180:183], a[128:131], v[192:195]
    ds_read_b64_tr_b16 a[160:161], v6 offset:0
    v_mfma_f32_16x16x32_bf16 v[196:199], a[180:183], a[132:135], v[196:199]
    s_add_u32 m0, s58, 0x8000
    v_mfma_f32_16x16x32_bf16 v[200:203], a[180:183], a[136:139], v[200:203]
    ds_read_b64_tr_b16 a[162:163], v6 offset:1280
    v_mfma_f32_16x16x32_bf16 v[204:207], a[180:183], a[140:143], v[204:207]
    v_mfma_f32_16x16x32_bf16 v[208:211], a[180:183], a[144:147], v[208:211]
    ds_read_b128 a[96:99], v4 offset:0
    v_mfma_f32_16x16x32_bf16 v[212:215], a[180:183], a[148:151], v[212:215]
    ds_read_b128 a[100:103], v4 offset:2048
    v_mfma_f32_16x16x32_bf16 v[216:219], a[180:183], a[152:155], v[216:219]
    v_mfma_f32_16x16x32_bf16 v[220:223], a[180:183], a[156:159], v[220:223]
    ds_read_b128 a[104:107], v4 offset:4096
    v_mfma_f32_16x16x32_bf16 v[252:255], a[184:187], a[156:159], v[252:255]
    v_mfma_f32_16x16x32_bf16 v[248:251], a[184:187], a[152:155], v[248:251]
    ds_read_b128 a[108:111], v4 offset:6144
    v_mfma_f32_16x16x32_bf16 v[244:247], a[184:187], a[148:151], v[244:247]
    buffer_load_dwordx4 v21, s[8:11], s40 offen offset:0 lds
    v_mfma_f32_16x16x32_bf16 v[240:243], a[184:187], a[144:147], v[240:243]
    ds_read_b128 a[112:115], v4 offset:8192
    v_mfma_f32_16x16x32_bf16 v[236:239], a[184:187], a[140:143], v[236:239]
    ds_read_b128 a[116:119], v4 offset:10240
    v_mfma_f32_16x16x32_bf16 v[232:235], a[184:187], a[136:139], v[232:235]
    v_mfma_f32_16x16x32_bf16 v[228:231], a[184:187], a[132:135], v[228:231]
    ds_read_b128 a[120:123], v4 offset:12288
    v_mfma_f32_16x16x32_bf16 v[224:227], a[184:187], a[128:131], v[224:227]
    v_mfma_f32_16x16x32_bf16 a[0:3], a[188:191], a[128:131], a[0:3]
    ds_read_b128 a[124:127], v4 offset:14336
    v_mfma_f32_16x16x32_bf16 a[4:7], a[188:191], a[132:135], a[4:7]
    v_mfma_f32_16x16x32_bf16 a[8:11], a[188:191], a[136:139], a[8:11]
    ds_read_b64_tr_b16 a[164:165], v6 offset:10240
    v_mfma_f32_16x16x32_bf16 a[12:15], a[188:191], a[140:143], a[12:15]
    ds_read_b64_tr_b16 a[166:167], v6 offset:11520
    v_mfma_f32_16x16x32_bf16 a[16:19], a[188:191], a[144:147], a[16:19]
    buffer_load_dwordx4 v22, s[8:11], s40 offen offset:1024 lds
    v_mfma_f32_16x16x32_bf16 a[20:23], a[188:191], a[148:151], a[20:23]
    ds_read_b64_tr_b16 a[168:169], v8 offset:32
    v_mfma_f32_16x16x32_bf16 a[24:27], a[188:191], a[152:155], a[24:27]
    v_mfma_f32_16x16x32_bf16 a[28:31], a[188:191], a[156:159], a[28:31]
    ds_read_b64_tr_b16 a[170:171], v8 offset:1312
    v_mfma_f32_16x16x32_bf16 a[60:63], a[192:195], a[156:159], a[60:63]
    v_mfma_f32_16x16x32_bf16 a[56:59], a[192:195], a[152:155], a[56:59]
    ds_read_b64_tr_b16 a[172:173], v8 offset:10272
    v_mfma_f32_16x16x32_bf16 a[52:55], a[192:195], a[148:151], a[52:55]
    ds_read_b64_tr_b16 a[174:175], v8 offset:11552
    v_mfma_f32_16x16x32_bf16 a[48:51], a[192:195], a[144:147], a[48:51]
    v_mfma_f32_16x16x32_bf16 a[44:47], a[192:195], a[140:143], a[44:47]
    ds_read_b64_tr_b16 a[176:177], v6 offset:64
    v_mfma_f32_16x16x32_bf16 a[40:43], a[192:195], a[136:139], a[40:43]
    buffer_load_dwordx4 v23, s[8:11], s40 offen offset:2048 lds
    v_mfma_f32_16x16x32_bf16 a[36:39], a[192:195], a[132:135], a[36:39]
    ds_read_b64_tr_b16 a[178:179], v6 offset:1344
    v_mfma_f32_16x16x32_bf16 a[32:35], a[192:195], a[128:131], a[32:35]
    v_mfma_f32_16x16x32_bf16 a[64:67], a[196:199], a[128:131], a[64:67]
    v_mfma_f32_16x16x32_bf16 a[68:71], a[196:199], a[132:135], a[68:71]
    v_mfma_f32_16x16x32_bf16 a[72:75], a[196:199], a[136:139], a[72:75]
    buffer_load_dwordx4 v24, s[8:11], s40 offen offset:3072 lds
    v_mfma_f32_16x16x32_bf16 a[76:79], a[196:199], a[140:143], a[76:79]
    v_mfma_f32_16x16x32_bf16 a[80:83], a[196:199], a[144:147], a[80:83]
    s_cmp_eq_u32 s48, s67
    s_cbranch_scc1 L_cs1B7
    L_cs1B7b:
    v_mfma_f32_16x16x32_bf16 a[84:87], a[196:199], a[148:151], a[84:87]
    v_mfma_f32_16x16x32_bf16 a[88:91], a[196:199], a[152:155], a[88:91]
    v_mfma_f32_16x16x32_bf16 a[92:95], a[196:199], a[156:159], a[92:95]
    s_sub_u32 s48, s48, 1
    s_waitcnt lgkmcnt(0)
    s_cbranch_scc0 L_loopB
L_tailB:
    v_mfma_f32_16x16x32_bf16 v[32:35], a[160:163], a[96:99], v[32:35]
    ds_read_b64_tr_b16 a[180:181], v6 offset:10304
    v_mfma_f32_16x16x32_bf16 v[36:39], a[160:163], a[100:103], v[36:39]
    s_add_u32 m0, s58, 0x9000
    v_mfma_f32_16x16x32_bf16 v[40:43], a[160:163], a[104:107], v[40:43]
    s_lshl_b32 s52, s56, 1
    v_mfma_f32_16x16x32_bf16 v[44:47], a[160:163], a[108:111], v[44:47]
    ds_read_b64_tr_b16 a[182:183], v6 offset:11584
    v_mfma_f32_16x16x32_bf16 v[48:51], a[160:163], a[112:115], v[48:51]
    s_add_u32 s52, s52, s55
    v_mfma_f32_16x16x32_bf16 v[52:55], a[160:163], a[116:119], v[52:55]
    buffer_load_dwordx4 v21, s[8:11], s41 offen offset:0 lds
    v_mfma_f32_16x16x32_bf16 v[56:59], a[160:163], a[120:123], v[56:59]
    s_lshl_b32 s52, s52, 1
    v_mfma_f32_16x16x32_bf16 v[60:63], a[160:163], a[124:127], v[60:63]
    ds_read_b64_tr_b16 a[184:185], v8 offset:96
    v_mfma_f32_16x16x32_bf16 v[92:95], a[164:167], a[124:127], v[92:95]
    s_add_u32 s52, s52, s54
    v_mfma_f32_16x16x32_bf16 v[88:91], a[164:167], a[120:123], v[88:91]
    buffer_load_dwordx4 v22, s[8:11], s41 offen offset:1024 lds
    v_mfma_f32_16x16x32_bf16 v[84:87], a[164:167], a[116:119], v[84:87]
    ds_read_b64_tr_b16 a[186:187], v8 offset:1376
    v_mfma_f32_16x16x32_bf16 v[80:83], a[164:167], a[112:115], v[80:83]
    s_mul_i32 s52, s52, 5120
    v_mfma_f32_16x16x32_bf16 v[76:79], a[164:167], a[108:111], v[76:79]
    s_mul_i32 s53, s50, 0x88
    v_mfma_f32_16x16x32_bf16 v[72:75], a[164:167], a[104:107], v[72:75]
    ds_read_b64_tr_b16 a[188:189], v8 offset:10336
    v_mfma_f32_16x16x32_bf16 v[68:71], a[164:167], a[100:103], v[68:71]
    s_and_b32 s53, s53, 0x308
    v_mfma_f32_16x16x32_bf16 v[64:67], a[164:167], a[96:99], v[64:67]
    s_add_u32 s63, s63, 128
    v_mfma_f32_16x16x32_bf16 v[96:99], a[168:171], a[96:99], v[96:99]
    s_add_u32 s52, s52, s53
    v_mfma_f32_16x16x32_bf16 v[100:103], a[168:171], a[100:103], v[100:103]
    ds_read_b64_tr_b16 a[190:191], v8 offset:11616
    v_mfma_f32_16x16x32_bf16 v[104:107], a[168:171], a[104:107], v[104:107]
    s_add_u32 s52, s52, 0x110000
    v_mfma_f32_16x16x32_bf16 v[108:111], a[168:171], a[108:111], v[108:111]
    s_and_b32 s63, s63, 2047
    v_mfma_f32_16x16x32_bf16 v[112:115], a[168:171], a[112:115], v[112:115]
    ds_read_b64_tr_b16 a[192:193], v10 offset:0
    v_mfma_f32_16x16x32_bf16 v[116:119], a[168:171], a[116:119], v[116:119]
    v_lshrrev_b32 v28, 4, v2
    v_mfma_f32_16x16x32_bf16 v[120:123], a[168:171], a[120:123], v[120:123]
    v_lshl_or_b32 v25, v28, 22, v12
    v_mfma_f32_16x16x32_bf16 v[124:127], a[168:171], a[124:127], v[124:127]
    ds_read_b64_tr_b16 a[194:195], v10 offset:1280
    v_mfma_f32_16x16x32_bf16 v[156:159], a[172:175], a[124:127], v[156:159]
    buffer_load_dwordx4 v23, s[8:11], s41 offen offset:2048 lds
    v_mfma_f32_16x16x32_bf16 v[152:155], a[172:175], a[120:123], v[152:155]
    v_accvgpr_read_b32 v28, a200
    v_mfma_f32_16x16x32_bf16 v[148:151], a[172:175], a[116:119], v[148:151]
    v_cvt_pk_bf16_f32 v29, v28, v28
    v_mfma_f32_16x16x32_bf16 v[144:147], a[172:175], a[112:115], v[144:147]
    ds_read_b64_tr_b16 a[196:197], v10 offset:10240
    v_mfma_f32_16x16x32_bf16 v[140:143], a[172:175], a[108:111], v[140:143]
    v_lshlrev_b32 v29, 16, v29
    v_mfma_f32_16x16x32_bf16 v[136:139], a[172:175], a[104:107], v[136:139]
    s_add_u32 s40, s64, s63
    v_mfma_f32_16x16x32_bf16 v[132:135], a[172:175], a[100:103], v[132:135]
    ds_read_b64_tr_b16 a[198:199], v10 offset:11520
    v_mfma_f32_16x16x32_bf16 v[128:131], a[172:175], a[96:99], v[128:131]
    v_sub_f32 v30, v28, v29
    v_mfma_f32_16x16x32_bf16 v[160:163], a[176:179], a[96:99], v[160:163]
    v_cvt_pk_bf16_f32 v26, v28, v30
    v_mfma_f32_16x16x32_bf16 v[164:167], a[176:179], a[100:103], v[164:167]
    buffer_load_dwordx4 v24, s[8:11], s41 offen offset:3072 lds
    v_mfma_f32_16x16x32_bf16 v[168:171], a[176:179], a[104:107], v[168:171]
    v_and_b32 v29, 0xffff0000, v26
    v_mfma_f32_16x16x32_bf16 v[172:175], a[176:179], a[108:111], v[172:175]
    v_sub_f32 v30, v30, v29
    v_mfma_f32_16x16x32_bf16 v[176:179], a[176:179], a[112:115], v[176:179]
    s_add_u32 s41, s40, 0x10000
    v_mfma_f32_16x16x32_bf16 v[180:183], a[176:179], a[116:119], v[180:183]
    v_cvt_pk_bf16_f32 v27, v30, 0
    v_mfma_f32_16x16x32_bf16 v[184:187], a[176:179], a[120:123], v[184:187]
    buffer_store_dwordx2 v[26:27], v25, s[44:47], s52 offen offset:0 sc1
    v_mfma_f32_16x16x32_bf16 v[188:191], a[176:179], a[124:127], v[188:191]
    v_accvgpr_read_b32 v28, a204
    s_waitcnt vmcnt(14) lgkmcnt(0)
    s_barrier
    v_mfma_f32_16x16x32_bf16 v[192:195], a[180:183], a[96:99], v[192:195]
    ds_read_b64_tr_b16 a[160:161], v6 offset:20480
    v_mfma_f32_16x16x32_bf16 v[196:199], a[180:183], a[100:103], v[196:199]
    s_add_u32 m0, s59, 0x1f000
    v_mfma_f32_16x16x32_bf16 v[200:203], a[180:183], a[104:107], v[200:203]
    ds_read_b64_tr_b16 a[162:163], v6 offset:21760
    v_mfma_f32_16x16x32_bf16 v[204:207], a[180:183], a[108:111], v[204:207]
    v_cvt_pk_bf16_f32 v29, v28, v28
    v_mfma_f32_16x16x32_bf16 v[208:211], a[180:183], a[112:115], v[208:211]
    ds_read_b128 a[128:131], v5 offset:0
    v_mfma_f32_16x16x32_bf16 v[212:215], a[180:183], a[116:119], v[212:215]
    ds_read_b128 a[132:135], v5 offset:2048
    v_mfma_f32_16x16x32_bf16 v[216:219], a[180:183], a[120:123], v[216:219]
    buffer_load_dwordx4 v13, s[12:15], s43 offen offset:0 nt lds
    v_mfma_f32_16x16x32_bf16 v[220:223], a[180:183], a[124:127], v[220:223]
    ds_read_b128 a[136:139], v5 offset:4096
    v_mfma_f32_16x16x32_bf16 v[252:255], a[184:187], a[124:127], v[252:255]
    v_lshlrev_b32 v29, 16, v29
    v_mfma_f32_16x16x32_bf16 v[248:251], a[184:187], a[120:123], v[248:251]
    ds_read_b128 a[140:143], v5 offset:6144
    v_mfma_f32_16x16x32_bf16 v[244:247], a[184:187], a[116:119], v[244:247]
    buffer_load_dwordx4 v14, s[12:15], s43 offen offset:1024 nt lds
    v_mfma_f32_16x16x32_bf16 v[240:243], a[184:187], a[112:115], v[240:243]
    ds_read_b128 a[144:147], v5 offset:8192
    v_mfma_f32_16x16x32_bf16 v[236:239], a[184:187], a[108:111], v[236:239]
    ds_read_b128 a[148:151], v5 offset:10240
    v_mfma_f32_16x16x32_bf16 v[232:235], a[184:187], a[104:107], v[232:235]
    v_sub_f32 v30, v28, v29
    v_mfma_f32_16x16x32_bf16 v[228:231], a[184:187], a[100:103], v[228:231]
    ds_read_b128 a[152:155], v5 offset:12288
    v_mfma_f32_16x16x32_bf16 v[224:227], a[184:187], a[96:99], v[224:227]
    buffer_load_dwordx4 v15, s[12:15], s43 offen offset:2048 nt lds
    v_mfma_f32_16x16x32_bf16 a[0:3], a[188:191], a[96:99], a[0:3]
    ds_read_b128 a[156:159], v5 offset:14336
    v_mfma_f32_16x16x32_bf16 a[4:7], a[188:191], a[100:103], a[4:7]
    v_cvt_pk_bf16_f32 v0, v28, v30
    v_mfma_f32_16x16x32_bf16 a[8:11], a[188:191], a[104:107], a[8:11]
    ds_read_b64_tr_b16 a[164:165], v6 offset:30720
    v_mfma_f32_16x16x32_bf16 a[12:15], a[188:191], a[108:111], a[12:15]
    ds_read_b64_tr_b16 a[166:167], v6 offset:32000
    v_mfma_f32_16x16x32_bf16 a[16:19], a[188:191], a[112:115], a[16:19]
    buffer_load_dwordx4 v16, s[12:15], s43 offen offset:3072 nt lds
    v_mfma_f32_16x16x32_bf16 a[20:23], a[188:191], a[116:119], a[20:23]
    ds_read_b64_tr_b16 a[168:169], v8 offset:20512
    v_mfma_f32_16x16x32_bf16 a[24:27], a[188:191], a[120:123], a[24:27]
    v_and_b32 v29, 0xffff0000, v0
    v_mfma_f32_16x16x32_bf16 a[28:31], a[188:191], a[124:127], a[28:31]
    ds_read_b64_tr_b16 a[170:171], v8 offset:21792
    v_mfma_f32_16x16x32_bf16 a[60:63], a[192:195], a[124:127], a[60:63]
    v_sub_f32 v30, v30, v29
    v_mfma_f32_16x16x32_bf16 a[56:59], a[192:195], a[120:123], a[56:59]
    ds_read_b64_tr_b16 a[172:173], v8 offset:30752
    v_mfma_f32_16x16x32_bf16 a[52:55], a[192:195], a[116:119], a[52:55]
    ds_read_b64_tr_b16 a[174:175], v8 offset:32032
    v_mfma_f32_16x16x32_bf16 a[48:51], a[192:195], a[112:115], a[48:51]
    s_add_u32 s62, s62, 1
    v_mfma_f32_16x16x32_bf16 a[44:47], a[192:195], a[108:111], a[44:47]
    ds_read_b64_tr_b16 a[176:177], v6 offset:20544
    v_mfma_f32_16x16x32_bf16 a[40:43], a[192:195], a[104:107], a[40:43]
    v_cvt_pk_bf16_f32 v1, v30, 0
    v_mfma_f32_16x16x32_bf16 a[36:39], a[192:195], a[100:103], a[36:39]
    ds_read_b64_tr_b16 a[178:179], v6 offset:21824
    v_mfma_f32_16x16x32_bf16 a[32:35], a[192:195], a[96:99], a[32:35]
    s_and_b32 s62, s62, 31
    v_mfma_f32_16x16x32_bf16 a[64:67], a[196:199], a[96:99], a[64:67]
    buffer_store_dwordx2 v[0:1], v25, s[44:47], s52 offen offset:1024 sc1
    v_mfma_f32_16x16x32_bf16 a[68:71], a[196:199], a[100:103], a[68:71]
    s_add_u32 m0, s59, 0x20000
    v_mfma_f32_16x16x32_bf16 a[72:75], a[196:199], a[104:107], a[72:75]
    v_accvgpr_read_b32 v28, a208
    v_mfma_f32_16x16x32_bf16 a[76:79], a[196:199], a[108:111], a[76:79]
    buffer_load_dwordx4 v17, s[12:15], s43 offen offset:0 nt lds
    v_mfma_f32_16x16x32_bf16 a[80:83], a[196:199], a[112:115], a[80:83]
    v_cvt_pk_bf16_f32 v29, v28, v28
    v_mfma_f32_16x16x32_bf16 a[84:87], a[196:199], a[116:119], a[84:87]
    s_mul_i32 s43, s62, 229376
    v_mfma_f32_16x16x32_bf16 a[88:91], a[196:199], a[120:123], a[88:91]
    v_lshlrev_b32 v29, 16, v29
    v_mfma_f32_16x16x32_bf16 a[92:95], a[196:199], a[124:127], a[92:95]
    v_sub_f32 v30, v28, v29
    s_waitcnt lgkmcnt(0)
    v_mfma_f32_16x16x32_bf16 v[32:35], a[160:163], a[128:131], v[32:35]
    ds_read_b64_tr_b16 a[180:181], v6 offset:30784
    v_mfma_f32_16x16x32_bf16 v[36:39], a[160:163], a[132:135], v[36:39]
    s_add_u32 m0, s59, 0x10000
    v_mfma_f32_16x16x32_bf16 v[40:43], a[160:163], a[136:139], v[40:43]
    v_cvt_pk_bf16_f32 v26, v28, v30
    v_mfma_f32_16x16x32_bf16 v[44:47], a[160:163], a[140:143], v[44:47]
    ds_read_b64_tr_b16 a[182:183], v6 offset:32064
    v_mfma_f32_16x16x32_bf16 v[48:51], a[160:163], a[144:147], v[48:51]
    v_and_b32 v29, 0xffff0000, v26
    v_mfma_f32_16x16x32_bf16 v[52:55], a[160:163], a[148:151], v[52:55]
    buffer_load_dwordx4 v13, s[12:15], s43 offen offset:0 nt lds
    v_mfma_f32_16x16x32_bf16 v[56:59], a[160:163], a[152:155], v[56:59]
    v_sub_f32 v30, v30, v29
    v_mfma_f32_16x16x32_bf16 v[60:63], a[160:163], a[156:159], v[60:63]
    ds_read_b64_tr_b16 a[184:185], v8 offset:20576
    v_mfma_f32_16x16x32_bf16 v[92:95], a[164:167], a[156:159], v[92:95]
    v_cvt_pk_bf16_f32 v27, v30, 0
    v_mfma_f32_16x16x32_bf16 v[88:91], a[164:167], a[152:155], v[88:91]
    buffer_load_dwordx4 v14, s[12:15], s43 offen offset:1024 nt lds
    v_mfma_f32_16x16x32_bf16 v[84:87], a[164:167], a[148:151], v[84:87]
    ds_read_b64_tr_b16 a[186:187], v8 offset:21856
    v_mfma_f32_16x16x32_bf16 v[80:83], a[164:167], a[144:147], v[80:83]
    v_mfma_f32_16x16x32_bf16 v[76:79], a[164:167], a[140:143], v[76:79]
    v_mfma_f32_16x16x32_bf16 v[72:75], a[164:167], a[136:139], v[72:75]
    ds_read_b64_tr_b16 a[188:189], v8 offset:30816
    v_mfma_f32_16x16x32_bf16 v[68:71], a[164:167], a[132:135], v[68:71]
    buffer_load_dwordx4 v15, s[12:15], s43 offen offset:2048 nt lds
    v_mfma_f32_16x16x32_bf16 v[64:67], a[164:167], a[128:131], v[64:67]
    v_mfma_f32_16x16x32_bf16 v[96:99], a[168:171], a[128:131], v[96:99]
    v_mfma_f32_16x16x32_bf16 v[100:103], a[168:171], a[132:135], v[100:103]
    ds_read_b64_tr_b16 a[190:191], v8 offset:32096
    v_mfma_f32_16x16x32_bf16 v[104:107], a[168:171], a[136:139], v[104:107]
    buffer_load_dwordx4 v16, s[12:15], s43 offen offset:3072 nt lds
    v_mfma_f32_16x16x32_bf16 v[108:111], a[168:171], a[140:143], v[108:111]
    v_mfma_f32_16x16x32_bf16 v[112:115], a[168:171], a[144:147], v[112:115]
    ds_read_b64_tr_b16 a[192:193], v10 offset:20480
    v_mfma_f32_16x16x32_bf16 v[116:119], a[168:171], a[148:151], v[116:119]
    buffer_store_dwordx2 v[26:27], v25, s[44:47], s52 offen offset:2048 sc1
    v_mfma_f32_16x16x32_bf16 v[120:123], a[168:171], a[152:155], v[120:123]
    s_add_u32 s62, s62, 1
    v_mfma_f32_16x16x32_bf16 v[124:127], a[168:171], a[156:159], v[124:127]
    ds_read_b64_tr_b16 a[194:195], v10 offset:21760
    v_mfma_f32_16x16x32_bf16 v[156:159], a[172:175], a[156:159], v[156:159]
    v_accvgpr_read_b32 v28, a212
    v_mfma_f32_16x16x32_bf16 v[152:155], a[172:175], a[152:155], v[152:155]
    v_cvt_pk_bf16_f32 v29, v28, v28
    v_mfma_f32_16x16x32_bf16 v[148:151], a[172:175], a[148:151], v[148:151]
    s_and_b32 s62, s62, 31
    v_mfma_f32_16x16x32_bf16 v[144:147], a[172:175], a[144:147], v[144:147]
    ds_read_b64_tr_b16 a[196:197], v10 offset:30720
    v_mfma_f32_16x16x32_bf16 v[140:143], a[172:175], a[140:143], v[140:143]
    v_lshlrev_b32 v29, 16, v29
    v_mfma_f32_16x16x32_bf16 v[136:139], a[172:175], a[136:139], v[136:139]
    v_sub_f32 v30, v28, v29
    v_mfma_f32_16x16x32_bf16 v[132:135], a[172:175], a[132:135], v[132:135]
    ds_read_b64_tr_b16 a[198:199], v10 offset:32000
    v_mfma_f32_16x16x32_bf16 v[128:131], a[172:175], a[128:131], v[128:131]
    s_add_u32 m0, s59, 0x11000
    v_mfma_f32_16x16x32_bf16 v[160:163], a[176:179], a[128:131], v[160:163]
    v_cvt_pk_bf16_f32 v0, v28, v30
    v_mfma_f32_16x16x32_bf16 v[164:167], a[176:179], a[132:135], v[164:167]
    v_and_b32 v29, 0xffff0000, v0
    v_mfma_f32_16x16x32_bf16 v[168:171], a[176:179], a[136:139], v[168:171]
    buffer_load_dwordx4 v17, s[12:15], s43 offen offset:0 nt lds
    v_mfma_f32_16x16x32_bf16 v[172:175], a[176:179], a[140:143], v[172:175]
    v_sub_f32 v30, v30, v29
    v_mfma_f32_16x16x32_bf16 v[176:179], a[176:179], a[144:147], v[176:179]
    v_cvt_pk_bf16_f32 v1, v30, 0
    v_mfma_f32_16x16x32_bf16 v[180:183], a[176:179], a[148:151], v[180:183]
    s_mul_i32 s43, s62, 229376
    v_mfma_f32_16x16x32_bf16 v[184:187], a[176:179], a[152:155], v[184:187]
    buffer_store_dwordx2 v[0:1], v25, s[44:47], s52 offen offset:3072 sc1
    v_mfma_f32_16x16x32_bf16 v[188:191], a[176:179], a[156:159], v[188:191]
    s_add_u32 s52, s52, 4096
    s_waitcnt vmcnt(14) lgkmcnt(0)
    s_barrier
    v_mfma_f32_16x16x32_bf16 v[192:195], a[180:183], a[128:131], v[192:195]
    ds_read_b64_tr_b16 a[160:161], v7 offset:0
    v_mfma_f32_16x16x32_bf16 v[196:199], a[180:183], a[132:135], v[196:199]
    s_add_u32 m0, s58, 0x0
    v_mfma_f32_16x16x32_bf16 v[200:203], a[180:183], a[136:139], v[200:203]
    ds_read_b64_tr_b16 a[162:163], v7 offset:1280
    v_mfma_f32_16x16x32_bf16 v[204:207], a[180:183], a[140:143], v[204:207]
    v_accvgpr_read_b32 v28, a216
    v_mfma_f32_16x16x32_bf16 v[208:211], a[180:183], a[144:147], v[208:211]
    ds_read_b128 a[96:99], v4 offset:32768
    v_mfma_f32_16x16x32_bf16 v[212:215], a[180:183], a[148:151], v[212:215]
    ds_read_b128 a[100:103], v4 offset:34816
    v_mfma_f32_16x16x32_bf16 v[216:219], a[180:183], a[152:155], v[216:219]
    v_cvt_pk_bf16_f32 v29, v28, v28
    v_mfma_f32_16x16x32_bf16 v[220:223], a[180:183], a[156:159], v[220:223]
    ds_read_b128 a[104:107], v4 offset:36864
    v_mfma_f32_16x16x32_bf16 v[252:255], a[184:187], a[156:159], v[252:255]
    v_lshlrev_b32 v29, 16, v29
    v_mfma_f32_16x16x32_bf16 v[248:251], a[184:187], a[152:155], v[248:251]
    ds_read_b128 a[108:111], v4 offset:38912
    v_mfma_f32_16x16x32_bf16 v[244:247], a[184:187], a[148:151], v[244:247]
    buffer_load_dwordx4 v21, s[8:11], s40 offen offset:0 lds
    v_mfma_f32_16x16x32_bf16 v[240:243], a[184:187], a[144:147], v[240:243]
    ds_read_b128 a[112:115], v4 offset:40960
    v_mfma_f32_16x16x32_bf16 v[236:239], a[184:187], a[140:143], v[236:239]
    ds_read_b128 a[116:119], v4 offset:43008
    v_mfma_f32_16x16x32_bf16 v[232:235], a[184:187], a[136:139], v[232:235]
    v_sub_f32 v30, v28, v29
    v_mfma_f32_16x16x32_bf16 v[228:231], a[184:187], a[132:135], v[228:231]
    ds_read_b128 a[120:123], v4 offset:45056
    v_mfma_f32_16x16x32_bf16 v[224:227], a[184:187], a[128:131], v[224:227]
    v_cvt_pk_bf16_f32 v26, v28, v30
    v_mfma_f32_16x16x32_bf16 a[0:3], a[188:191], a[128:131], a[0:3]
    ds_read_b128 a[124:127], v4 offset:47104
    v_mfma_f32_16x16x32_bf16 a[4:7], a[188:191], a[132:135], a[4:7]
    v_and_b32 v29, 0xffff0000, v26
    v_mfma_f32_16x16x32_bf16 a[8:11], a[188:191], a[136:139], a[8:11]
    ds_read_b64_tr_b16 a[164:165], v7 offset:10240
    v_mfma_f32_16x16x32_bf16 a[12:15], a[188:191], a[140:143], a[12:15]
    ds_read_b64_tr_b16 a[166:167], v7 offset:11520
    v_mfma_f32_16x16x32_bf16 a[16:19], a[188:191], a[144:147], a[16:19]
    buffer_load_dwordx4 v22, s[8:11], s40 offen offset:1024 lds
    v_mfma_f32_16x16x32_bf16 a[20:23], a[188:191], a[148:151], a[20:23]
    ds_read_b64_tr_b16 a[168:169], v9 offset:32
    v_mfma_f32_16x16x32_bf16 a[24:27], a[188:191], a[152:155], a[24:27]
    v_sub_f32 v30, v30, v29
    v_mfma_f32_16x16x32_bf16 a[28:31], a[188:191], a[156:159], a[28:31]
    ds_read_b64_tr_b16 a[170:171], v9 offset:1312
    v_mfma_f32_16x16x32_bf16 a[60:63], a[192:195], a[156:159], a[60:63]
    v_cvt_pk_bf16_f32 v27, v30, 0
    v_mfma_f32_16x16x32_bf16 a[56:59], a[192:195], a[152:155], a[56:59]
    ds_read_b64_tr_b16 a[172:173], v9 offset:10272
    v_mfma_f32_16x16x32_bf16 a[52:55], a[192:195], a[148:151], a[52:55]
    ds_read_b64_tr_b16 a[174:175], v9 offset:11552
    v_mfma_f32_16x16x32_bf16 a[48:51], a[192:195], a[144:147], a[48:51]
    buffer_store_dwordx2 v[26:27], v25, s[44:47], s52 offen offset:0 sc1
    v_mfma_f32_16x16x32_bf16 a[44:47], a[192:195], a[140:143], a[44:47]
    ds_read_b64_tr_b16 a[176:177], v7 offset:64
    v_mfma_f32_16x16x32_bf16 a[40:43], a[192:195], a[136:139], a[40:43]
    s_lshl_b32 s52, s50, 5
    v_mfma_f32_16x16x32_bf16 a[36:39], a[192:195], a[132:135], a[36:39]
    ds_read_b64_tr_b16 a[178:179], v7 offset:1344
    v_mfma_f32_16x16x32_bf16 a[32:35], a[192:195], a[128:131], a[32:35]
    buffer_load_dwordx4 v23, s[8:11], s40 offen offset:2048 lds
    v_mfma_f32_16x16x32_bf16 a[64:67], a[196:199], a[128:131], a[64:67]
    s_add_u32 s52, s52, s56
    v_mfma_f32_16x16x32_bf16 a[68:71], a[196:199], a[132:135], a[68:71]
    s_lshl_b32 s52, s52, 2
    v_mfma_f32_16x16x32_bf16 a[72:75], a[196:199], a[136:139], a[72:75]
    s_add_u32 s52, s52, s49
    v_mfma_f32_16x16x32_bf16 a[76:79], a[196:199], a[140:143], a[76:79]
    buffer_load_dwordx4 v24, s[8:11], s40 offen offset:3072 lds
    v_mfma_f32_16x16x32_bf16 a[80:83], a[196:199], a[144:147], a[80:83]
    s_lshl_b32 s52, s52, 2
    v_mfma_f32_16x16x32_bf16 a[84:87], a[196:199], a[148:151], a[84:87]
    s_add_u32 s52, s52, 0x1e0000
    v_mfma_f32_16x16x32_bf16 a[88:91], a[196:199], a[152:155], a[88:91]
    buffer_store_dword v3, v31, s[44:47], s52 offen sc1
    v_mfma_f32_16x16x32_bf16 a[92:95], a[196:199], a[156:159], a[92:95]
    s_add_u32 s32, s6, 0x800000
    s_addc_u32 s33, s7, 0
    s_waitcnt lgkmcnt(0)
    v_mfma_f32_16x16x32_bf16 v[32:35], a[160:163], a[96:99], v[32:35]
    ds_read_b64_tr_b16 a[180:181], v7 offset:10304
    v_mfma_f32_16x16x32_bf16 v[36:39], a[160:163], a[100:103], v[36:39]
    s_add_u32 m0, s58, 0x1000
    v_mfma_f32_16x16x32_bf16 v[40:43], a[160:163], a[104:107], v[40:43]
    s_and_b32 s33, s33, 0xffff
    v_mfma_f32_16x16x32_bf16 v[44:47], a[160:163], a[108:111], v[44:47]
    ds_read_b64_tr_b16 a[182:183], v7 offset:11584
    v_mfma_f32_16x16x32_bf16 v[48:51], a[160:163], a[112:115], v[48:51]
    s_mov_b32 s34, 0x1200000
    v_mfma_f32_16x16x32_bf16 v[52:55], a[160:163], a[116:119], v[52:55]
    buffer_load_dwordx4 v21, s[8:11], s41 offen offset:0 lds
    v_mfma_f32_16x16x32_bf16 v[56:59], a[160:163], a[120:123], v[56:59]
    s_mov_b32 s35, 0x20000
    v_mfma_f32_16x16x32_bf16 v[60:63], a[160:163], a[124:127], v[60:63]
    ds_read_b64_tr_b16 a[184:185], v9 offset:96
    v_mfma_f32_16x16x32_bf16 v[92:95], a[164:167], a[124:127], v[92:95]
    s_lshl_b32 s52, s56, 3
    v_mfma_f32_16x16x32_bf16 v[88:91], a[164:167], a[120:123], v[88:91]
    buffer_load_dwordx4 v22, s[8:11], s41 offen offset:1024 lds
    v_mfma_f32_16x16x32_bf16 v[84:87], a[164:167], a[116:119], v[84:87]
    ds_read_b64_tr_b16 a[186:187], v9 offset:1376
    v_mfma_f32_16x16x32_bf16 v[80:83], a[164:167], a[112:115], v[80:83]
    s_add_u32 s52, s52, s50
    v_mfma_f32_16x16x32_bf16 v[76:79], a[164:167], a[108:111], v[76:79]
    s_lshl_b32 s52, s52, 2
    v_mfma_f32_16x16x32_bf16 v[72:75], a[164:167], a[104:107], v[72:75]
    ds_read_b64_tr_b16 a[188:189], v9 offset:10336
    v_mfma_f32_16x16x32_bf16 v[68:71], a[164:167], a[100:103], v[68:71]
    s_add_u32 s52, s52, s49
    v_mfma_f32_16x16x32_bf16 v[64:67], a[164:167], a[96:99], v[64:67]
    s_add_u32 s63, s63, 128
    v_mfma_f32_16x16x32_bf16 v[96:99], a[168:171], a[96:99], v[96:99]
    s_lshl_b32 s52, s52, 2
    v_mfma_f32_16x16x32_bf16 v[100:103], a[168:171], a[100:103], v[100:103]
    ds_read_b64_tr_b16 a[190:191], v9 offset:11616
    v_mfma_f32_16x16x32_bf16 v[104:107], a[168:171], a[104:107], v[104:107]
    s_add_u32 s52, s52, 0x1e1000
    v_mfma_f32_16x16x32_bf16 v[108:111], a[168:171], a[108:111], v[108:111]
    s_and_b32 s63, s63, 2047
    v_mfma_f32_16x16x32_bf16 v[112:115], a[168:171], a[112:115], v[112:115]
    ds_read_b64_tr_b16 a[192:193], v11 offset:0
    v_mfma_f32_16x16x32_bf16 v[116:119], a[168:171], a[116:119], v[116:119]
    s_and_b32 s68, s2, 1
    v_mfma_f32_16x16x32_bf16 v[120:123], a[168:171], a[120:123], v[120:123]
    s_lshl_b32 s68, s68, 2
    v_mfma_f32_16x16x32_bf16 v[124:127], a[168:171], a[124:127], v[124:127]
    ds_read_b64_tr_b16 a[194:195], v11 offset:1280
    v_mfma_f32_16x16x32_bf16 v[156:159], a[172:175], a[124:127], v[156:159]
    buffer_load_dwordx4 v23, s[8:11], s41 offen offset:2048 lds
    v_mfma_f32_16x16x32_bf16 v[152:155], a[172:175], a[120:123], v[152:155]
    s_lshr_b32 s53, s2, 6
    v_mfma_f32_16x16x32_bf16 v[148:151], a[172:175], a[116:119], v[148:151]
    s_add_u32 s69, s68, s53
    v_mfma_f32_16x16x32_bf16 v[144:147], a[172:175], a[112:115], v[144:147]
    ds_read_b64_tr_b16 a[196:197], v11 offset:10240
    v_mfma_f32_16x16x32_bf16 v[140:143], a[172:175], a[108:111], v[140:143]
    s_lshl_b32 s68, s69, 8
    v_mfma_f32_16x16x32_bf16 v[136:139], a[172:175], a[104:107], v[136:139]
    s_add_u32 s40, s64, s63
    v_mfma_f32_16x16x32_bf16 v[132:135], a[172:175], a[100:103], v[132:135]
    ds_read_b64_tr_b16 a[198:199], v11 offset:11520
    v_mfma_f32_16x16x32_bf16 v[128:131], a[172:175], a[96:99], v[128:131]
    s_lshl_b32 s70, s49, 13
    v_mfma_f32_16x16x32_bf16 v[160:163], a[176:179], a[96:99], v[160:163]
    s_lshl_b32 s72, s49, 3
    v_mfma_f32_16x16x32_bf16 v[164:167], a[176:179], a[100:103], v[164:167]
    buffer_load_dwordx4 v24, s[8:11], s41 offen offset:3072 lds
    v_mfma_f32_16x16x32_bf16 v[168:171], a[176:179], a[104:107], v[168:171]
    s_bfe_u32 s67, s2, 0x10001
    v_mfma_f32_16x16x32_bf16 v[172:175], a[176:179], a[108:111], v[172:175]
    s_lshl_b32 s67, s67, 3
    v_mfma_f32_16x16x32_bf16 v[176:179], a[176:179], a[112:115], v[176:179]
    s_add_u32 s41, s40, 0x10000
    v_mfma_f32_16x16x32_bf16 v[180:183], a[176:179], a[116:119], v[180:183]
    s_add_u32 s67, s67, s50
    v_mfma_f32_16x16x32_bf16 v[184:187], a[176:179], a[120:123], v[184:187]
    s_waitcnt vmcnt(7)
    buffer_store_dword v3, v31, s[44:47], s52 offen sc1
    v_mfma_f32_16x16x32_bf16 v[188:191], a[176:179], a[124:127], v[188:191]
    s_lshl_b32 s53, s67, 3
    s_waitcnt vmcnt(8) lgkmcnt(0)
    s_barrier
    v_mfma_f32_16x16x32_bf16 v[192:195], a[180:183], a[96:99], v[192:195]
    ds_read_b64_tr_b16 a[160:161], v7 offset:20480
    v_mfma_f32_16x16x32_bf16 v[196:199], a[180:183], a[100:103], v[196:199]
    s_add_u32 m0, s59, 0x15000
    v_mfma_f32_16x16x32_bf16 v[200:203], a[180:183], a[104:107], v[200:203]
    ds_read_b64_tr_b16 a[162:163], v7 offset:21760
    v_mfma_f32_16x16x32_bf16 v[204:207], a[180:183], a[108:111], v[204:207]
    s_add_u32 s69, s69, s53
    v_mfma_f32_16x16x32_bf16 v[208:211], a[180:183], a[112:115], v[208:211]
    ds_read_b128 a[128:131], v5 offset:32768
    v_mfma_f32_16x16x32_bf16 v[212:215], a[180:183], a[116:119], v[212:215]
    ds_read_b128 a[132:135], v5 offset:34816
    v_mfma_f32_16x16x32_bf16 v[216:219], a[180:183], a[120:123], v[216:219]
    buffer_load_dwordx4 v13, s[12:15], s43 offen offset:0 nt lds
    v_mfma_f32_16x16x32_bf16 v[220:223], a[180:183], a[124:127], v[220:223]
    ds_read_b128 a[136:139], v5 offset:36864
    v_mfma_f32_16x16x32_bf16 v[252:255], a[184:187], a[124:127], v[252:255]
    s_and_b32 s73, s72, 8
    v_mfma_f32_16x16x32_bf16 v[248:251], a[184:187], a[120:123], v[248:251]
    ds_read_b128 a[140:143], v5 offset:38912
    v_mfma_f32_16x16x32_bf16 v[244:247], a[184:187], a[116:119], v[244:247]
    buffer_load_dwordx4 v14, s[12:15], s43 offen offset:1024 nt lds
    v_mfma_f32_16x16x32_bf16 v[240:243], a[184:187], a[112:115], v[240:243]
    ds_read_b128 a[144:147], v5 offset:40960
    v_mfma_f32_16x16x32_bf16 v[236:239], a[184:187], a[108:111], v[236:239]
    ds_read_b128 a[148:151], v5 offset:43008
    v_mfma_f32_16x16x32_bf16 v[232:235], a[184:187], a[104:107], v[232:235]
    s_add_u32 s71, s70, 0x18000
    v_mfma_f32_16x16x32_bf16 v[228:231], a[184:187], a[100:103], v[228:231]
    ds_read_b128 a[152:155], v5 offset:45056
    v_mfma_f32_16x16x32_bf16 v[224:227], a[184:187], a[96:99], v[224:227]
    buffer_load_dwordx4 v15, s[12:15], s43 offen offset:2048 nt lds
    v_mfma_f32_16x16x32_bf16 a[0:3], a[188:191], a[96:99], a[0:3]
    ds_read_b128 a[156:159], v5 offset:47104
    v_mfma_f32_16x16x32_bf16 a[4:7], a[188:191], a[100:103], a[4:7]
    s_lshl_b32 s76, s67, 8
    v_mfma_f32_16x16x32_bf16 a[8:11], a[188:191], a[104:107], a[8:11]
    ds_read_b64_tr_b16 a[164:165], v7 offset:30720
    v_mfma_f32_16x16x32_bf16 a[12:15], a[188:191], a[108:111], a[12:15]
    ds_read_b64_tr_b16 a[166:167], v7 offset:32000
    v_mfma_f32_16x16x32_bf16 a[16:19], a[188:191], a[112:115], a[16:19]
    buffer_load_dwordx4 v16, s[12:15], s43 offen offset:3072 nt lds
    v_mfma_f32_16x16x32_bf16 a[20:23], a[188:191], a[116:119], a[20:23]
    ds_read_b64_tr_b16 a[168:169], v9 offset:20512
    v_mfma_f32_16x16x32_bf16 a[24:27], a[188:191], a[120:123], a[24:27]
    s_lshl_b32 s53, s69, 3
    v_mfma_f32_16x16x32_bf16 a[28:31], a[188:191], a[124:127], a[28:31]
    ds_read_b64_tr_b16 a[170:171], v9 offset:21792
    v_mfma_f32_16x16x32_bf16 a[60:63], a[192:195], a[124:127], a[60:63]
    s_add_u32 s53, s53, s49
    v_mfma_f32_16x16x32_bf16 a[56:59], a[192:195], a[120:123], a[56:59]
    ds_read_b64_tr_b16 a[172:173], v9 offset:30752
    v_mfma_f32_16x16x32_bf16 a[52:55], a[192:195], a[116:119], a[52:55]
    ds_read_b64_tr_b16 a[174:175], v9 offset:32032
    v_mfma_f32_16x16x32_bf16 a[48:51], a[192:195], a[112:115], a[48:51]
    s_add_u32 s62, s62, 1
    v_mfma_f32_16x16x32_bf16 a[44:47], a[192:195], a[108:111], a[44:47]
    ds_read_b64_tr_b16 a[176:177], v7 offset:20544
    v_mfma_f32_16x16x32_bf16 a[40:43], a[192:195], a[104:107], a[40:43]
    s_add_u32 s53, s53, 0
    v_mfma_f32_16x16x32_bf16 a[36:39], a[192:195], a[100:103], a[36:39]
    ds_read_b64_tr_b16 a[178:179], v7 offset:21824
    v_mfma_f32_16x16x32_bf16 a[32:35], a[192:195], a[96:99], a[32:35]
    s_and_b32 s62, s62, 31
    v_mfma_f32_16x16x32_bf16 a[64:67], a[196:199], a[96:99], a[64:67]
    s_lshl_b32 s77, s53, 13
    v_mfma_f32_16x16x32_bf16 a[68:71], a[196:199], a[100:103], a[68:71]
    s_add_u32 m0, s59, 0x16000
    v_mfma_f32_16x16x32_bf16 a[72:75], a[196:199], a[104:107], a[72:75]
    s_lshl_b32 s78, s69, 7
    v_mfma_f32_16x16x32_bf16 a[76:79], a[196:199], a[108:111], a[76:79]
    buffer_load_dwordx4 v17, s[12:15], s43 offen offset:0 nt lds
    v_mfma_f32_16x16x32_bf16 a[80:83], a[196:199], a[112:115], a[80:83]
    s_lshl_b32 s53, s49, 2
    v_mfma_f32_16x16x32_bf16 a[84:87], a[196:199], a[116:119], a[84:87]
    s_mul_i32 s43, s62, 229376
    v_mfma_f32_16x16x32_bf16 a[88:91], a[196:199], a[120:123], a[88:91]
    s_add_u32 s78, s78, s53
    v_mfma_f32_16x16x32_bf16 a[92:95], a[196:199], a[124:127], a[92:95]
    s_add_u32 s78, s78, 0x1e6000
    s_waitcnt lgkmcnt(0)
    v_mfma_f32_16x16x32_bf16 v[32:35], a[160:163], a[128:131], v[32:35]
    ds_read_b64_tr_b16 a[180:181], v7 offset:30784
    v_mfma_f32_16x16x32_bf16 v[36:39], a[160:163], a[132:135], v[36:39]
    s_add_u32 m0, s59, 0x1a000
    v_mfma_f32_16x16x32_bf16 v[40:43], a[160:163], a[136:139], v[40:43]
    s_add_u32 s36, s6, 0x1c00000
    s_addc_u32 s37, s7, 0
    v_mfma_f32_16x16x32_bf16 v[44:47], a[160:163], a[140:143], v[44:47]
    ds_read_b64_tr_b16 a[182:183], v7 offset:32064
    v_mfma_f32_16x16x32_bf16 v[48:51], a[160:163], a[144:147], v[48:51]
    s_and_b32 s37, s37, 0xffff
    v_mfma_f32_16x16x32_bf16 v[52:55], a[160:163], a[148:151], v[52:55]
    buffer_load_dwordx4 v13, s[12:15], s43 offen offset:0 nt lds
    v_mfma_f32_16x16x32_bf16 v[56:59], a[160:163], a[152:155], v[56:59]
    s_mov_b32 s38, 0x800000
    v_mfma_f32_16x16x32_bf16 v[60:63], a[160:163], a[156:159], v[60:63]
    ds_read_b64_tr_b16 a[184:185], v9 offset:20576
    v_mfma_f32_16x16x32_bf16 v[92:95], a[164:167], a[156:159], v[92:95]
    s_mov_b32 s39, 0x20000
    v_mfma_f32_16x16x32_bf16 v[88:91], a[164:167], a[152:155], v[88:91]
    buffer_load_dwordx4 v14, s[12:15], s43 offen offset:1024 nt lds
    v_mfma_f32_16x16x32_bf16 v[84:87], a[164:167], a[148:151], v[84:87]
    ds_read_b64_tr_b16 a[186:187], v9 offset:21856
    v_mfma_f32_16x16x32_bf16 v[80:83], a[164:167], a[144:147], v[80:83]
    s_mov_b32 s53, 0x3020100
    v_mfma_f32_16x16x32_bf16 v[76:79], a[164:167], a[140:143], v[76:79]
    v_writelane_b32 v18, s53, 4
    v_mfma_f32_16x16x32_bf16 v[72:75], a[164:167], a[136:139], v[72:75]
    ds_read_b64_tr_b16 a[188:189], v9 offset:30816
    v_mfma_f32_16x16x32_bf16 v[68:71], a[164:167], a[132:135], v[68:71]
    buffer_load_dwordx4 v15, s[12:15], s43 offen offset:2048 nt lds
    v_mfma_f32_16x16x32_bf16 v[64:67], a[164:167], a[128:131], v[64:67]
    s_mov_b32 s53, 0x7060504
    v_mfma_f32_16x16x32_bf16 v[96:99], a[168:171], a[128:131], v[96:99]
    v_writelane_b32 v18, s53, 5
    v_mfma_f32_16x16x32_bf16 v[100:103], a[168:171], a[132:135], v[100:103]
    ds_read_b64_tr_b16 a[190:191], v9 offset:32096
    v_mfma_f32_16x16x32_bf16 v[104:107], a[168:171], a[136:139], v[104:107]
    buffer_load_dwordx4 v16, s[12:15], s43 offen offset:3072 nt lds
    v_mfma_f32_16x16x32_bf16 v[108:111], a[168:171], a[140:143], v[108:111]
    s_mov_b32 s53, 0xb0a0908
    v_mfma_f32_16x16x32_bf16 v[112:115], a[168:171], a[144:147], v[112:115]
    ds_read_b64_tr_b16 a[192:193], v11 offset:20480
    v_mfma_f32_16x16x32_bf16 v[116:119], a[168:171], a[148:151], v[116:119]
    v_writelane_b32 v18, s53, 6
    v_mfma_f32_16x16x32_bf16 v[120:123], a[168:171], a[152:155], v[120:123]
    s_add_u32 s62, s62, 1
    v_mfma_f32_16x16x32_bf16 v[124:127], a[168:171], a[156:159], v[124:127]
    ds_read_b64_tr_b16 a[194:195], v11 offset:21760
    v_mfma_f32_16x16x32_bf16 v[156:159], a[172:175], a[156:159], v[156:159]
    s_mov_b32 s53, 0xf0e0d0c
    v_mfma_f32_16x16x32_bf16 v[152:155], a[172:175], a[152:155], v[152:155]
    v_writelane_b32 v18, s53, 7
    v_mfma_f32_16x16x32_bf16 v[148:151], a[172:175], a[148:151], v[148:151]
    s_and_b32 s62, s62, 31
    v_mfma_f32_16x16x32_bf16 v[144:147], a[172:175], a[144:147], v[144:147]
    ds_read_b64_tr_b16 a[196:197], v11 offset:30720
    v_mfma_f32_16x16x32_bf16 v[140:143], a[172:175], a[140:143], v[140:143]
    s_mov_b32 s53, 0x26242221
    v_mfma_f32_16x16x32_bf16 v[136:139], a[172:175], a[136:139], v[136:139]
    v_writelane_b32 v18, s53, 8
    v_mfma_f32_16x16x32_bf16 v[132:135], a[172:175], a[132:135], v[132:135]
    ds_read_b64_tr_b16 a[198:199], v11 offset:32000
    v_mfma_f32_16x16x32_bf16 v[128:131], a[172:175], a[128:131], v[128:131]
    s_add_u32 m0, s59, 0x1b000
    v_mfma_f32_16x16x32_bf16 v[160:163], a[176:179], a[128:131], v[160:163]
    s_mov_b32 s53, 0x2c2b2927
    v_mfma_f32_16x16x32_bf16 v[164:167], a[176:179], a[132:135], v[164:167]
    v_writelane_b32 v18, s53, 9
    v_mfma_f32_16x16x32_bf16 v[168:171], a[176:179], a[136:139], v[168:171]
    buffer_load_dwordx4 v17, s[12:15], s43 offen offset:0 nt lds
    v_mfma_f32_16x16x32_bf16 v[172:175], a[176:179], a[140:143], v[172:175]
    s_mov_b32 s53, 0x3331302e
    v_mfma_f32_16x16x32_bf16 v[176:179], a[176:179], a[144:147], v[176:179]
    v_writelane_b32 v18, s53, 10
    v_mfma_f32_16x16x32_bf16 v[180:183], a[176:179], a[148:151], v[180:183]
    s_mul_i32 s43, s62, 229376
    v_mfma_f32_16x16x32_bf16 v[184:187], a[176:179], a[152:155], v[184:187]
    s_mov_b32 s53, 0x3a383635
    v_mfma_f32_16x16x32_bf16 v[188:191], a[176:179], a[156:159], v[188:191]
    v_writelane_b32 v18, s53, 11
    s_waitcnt vmcnt(11) lgkmcnt(0)
    s_barrier
    v_mfma_f32_16x16x32_bf16 v[192:195], a[180:183], a[128:131], v[192:195]
    ds_read_b64_tr_b16 a[160:161], v6 offset:0
    v_mfma_f32_16x16x32_bf16 v[196:199], a[180:183], a[132:135], v[196:199]
    s_add_u32 m0, s58, 0x8000
    v_mfma_f32_16x16x32_bf16 v[200:203], a[180:183], a[136:139], v[200:203]
    ds_read_b64_tr_b16 a[162:163], v6 offset:1280
    v_mfma_f32_16x16x32_bf16 v[204:207], a[180:183], a[140:143], v[204:207]
    s_mov_b32 s53, 0x403f3d3b
    v_mfma_f32_16x16x32_bf16 v[208:211], a[180:183], a[144:147], v[208:211]
    ds_read_b128 a[96:99], v4 offset:0
    v_mfma_f32_16x16x32_bf16 v[212:215], a[180:183], a[148:151], v[212:215]
    ds_read_b128 a[100:103], v4 offset:2048
    v_mfma_f32_16x16x32_bf16 v[216:219], a[180:183], a[152:155], v[216:219]
    v_writelane_b32 v18, s53, 12
    v_mfma_f32_16x16x32_bf16 v[220:223], a[180:183], a[156:159], v[220:223]
    ds_read_b128 a[104:107], v4 offset:4096
    v_mfma_f32_16x16x32_bf16 v[252:255], a[184:187], a[156:159], v[252:255]
    s_mov_b32 s53, 0x47454442
    v_mfma_f32_16x16x32_bf16 v[248:251], a[184:187], a[152:155], v[248:251]
    ds_read_b128 a[108:111], v4 offset:6144
    v_mfma_f32_16x16x32_bf16 v[244:247], a[184:187], a[148:151], v[244:247]
    buffer_load_dwordx4 v21, s[8:11], s40 offen offset:0 lds
    v_mfma_f32_16x16x32_bf16 v[240:243], a[184:187], a[144:147], v[240:243]
    ds_read_b128 a[112:115], v4 offset:8192
    v_mfma_f32_16x16x32_bf16 v[236:239], a[184:187], a[140:143], v[236:239]
    ds_read_b128 a[116:119], v4 offset:10240
    v_mfma_f32_16x16x32_bf16 v[232:235], a[184:187], a[136:139], v[232:235]
    v_writelane_b32 v18, s53, 13
    v_mfma_f32_16x16x32_bf16 v[228:231], a[184:187], a[132:135], v[228:231]
    ds_read_b128 a[120:123], v4 offset:12288
    v_mfma_f32_16x16x32_bf16 v[224:227], a[184:187], a[128:131], v[224:227]
    s_mov_b32 s53, 0x4e4c4a49
    v_mfma_f32_16x16x32_bf16 a[0:3], a[188:191], a[128:131], a[0:3]
    ds_read_b128 a[124:127], v4 offset:14336
    v_mfma_f32_16x16x32_bf16 a[4:7], a[188:191], a[132:135], a[4:7]
    v_writelane_b32 v18, s53, 14
    v_mfma_f32_16x16x32_bf16 a[8:11], a[188:191], a[136:139], a[8:11]
    ds_read_b64_tr_b16 a[164:165], v6 offset:10240
    v_mfma_f32_16x16x32_bf16 a[12:15], a[188:191], a[140:143], a[12:15]
    ds_read_b64_tr_b16 a[166:167], v6 offset:11520
    v_mfma_f32_16x16x32_bf16 a[16:19], a[188:191], a[144:147], a[16:19]
    buffer_load_dwordx4 v22, s[8:11], s40 offen offset:1024 lds
    v_mfma_f32_16x16x32_bf16 a[20:23], a[188:191], a[148:151], a[20:23]
    ds_read_b64_tr_b16 a[168:169], v8 offset:32
    v_mfma_f32_16x16x32_bf16 a[24:27], a[188:191], a[152:155], a[24:27]
    s_mov_b32 s79, 6
    v_mfma_f32_16x16x32_bf16 a[28:31], a[188:191], a[156:159], a[28:31]
    ds_read_b64_tr_b16 a[170:171], v8 offset:1312
    v_mfma_f32_16x16x32_bf16 a[60:63], a[192:195], a[156:159], a[60:63]
    s_lshl_b32 s66, s50, 1
    v_mfma_f32_16x16x32_bf16 a[56:59], a[192:195], a[152:155], a[56:59]
    ds_read_b64_tr_b16 a[172:173], v8 offset:10272
    v_mfma_f32_16x16x32_bf16 a[52:55], a[192:195], a[148:151], a[52:55]
    ds_read_b64_tr_b16 a[174:175], v8 offset:11552
    v_mfma_f32_16x16x32_bf16 a[48:51], a[192:195], a[144:147], a[48:51]
    s_add_u32 s66, s66, s54
    v_mfma_f32_16x16x32_bf16 a[44:47], a[192:195], a[140:143], a[44:47]
    ds_read_b64_tr_b16 a[176:177], v6 offset:64
    v_mfma_f32_16x16x32_bf16 a[40:43], a[192:195], a[136:139], a[40:43]
    s_mul_i32 s65, s66, 1179648
    v_mfma_f32_16x16x32_bf16 a[36:39], a[192:195], a[132:135], a[36:39]
    ds_read_b64_tr_b16 a[178:179], v6 offset:1344
    v_mfma_f32_16x16x32_bf16 a[32:35], a[192:195], a[128:131], a[32:35]
    buffer_load_dwordx4 v23, s[8:11], s40 offen offset:2048 lds
    v_mfma_f32_16x16x32_bf16 a[64:67], a[196:199], a[128:131], a[64:67]
    s_lshl_b32 s61, s66, 12
    v_mfma_f32_16x16x32_bf16 a[68:71], a[196:199], a[132:135], a[68:71]
    s_add_u32 s61, s61, 0x1c0000
    v_mfma_f32_16x16x32_bf16 a[72:75], a[196:199], a[136:139], a[72:75]
    s_lshl_b32 s60, s66, 9
    v_mfma_f32_16x16x32_bf16 a[76:79], a[196:199], a[140:143], a[76:79]
    buffer_load_dwordx4 v24, s[8:11], s40 offen offset:3072 lds
    v_mfma_f32_16x16x32_bf16 a[80:83], a[196:199], a[144:147], a[80:83]
    s_add_u32 s60, s60, 0x1d0000
    v_mfma_f32_16x16x32_bf16 a[84:87], a[196:199], a[148:151], a[84:87]
    s_lshl_b32 s66, s66, 8
    v_mfma_f32_16x16x32_bf16 a[88:91], a[196:199], a[152:155], a[88:91]
    s_lshl_b32 s52, s56, 3
    v_mfma_f32_16x16x32_bf16 a[92:95], a[196:199], a[156:159], a[92:95]
    s_add_u32 s66, s66, s52
    s_waitcnt lgkmcnt(0)
    v_mfma_f32_16x16x32_bf16 v[32:35], a[160:163], a[96:99], v[32:35]
    ds_read_b64_tr_b16 a[180:181], v6 offset:10304
    v_mfma_f32_16x16x32_bf16 v[36:39], a[160:163], a[100:103], v[36:39]
    s_add_u32 m0, s58, 0x9000
    v_mfma_f32_16x16x32_bf16 v[40:43], a[160:163], a[104:107], v[40:43]
    s_lshl_b32 s52, s55, 2
    v_mfma_f32_16x16x32_bf16 v[44:47], a[160:163], a[108:111], v[44:47]
    ds_read_b64_tr_b16 a[182:183], v6 offset:11584
    v_mfma_f32_16x16x32_bf16 v[48:51], a[160:163], a[112:115], v[48:51]
    s_add_u32 s66, s66, s52
    v_mfma_f32_16x16x32_bf16 v[52:55], a[160:163], a[116:119], v[52:55]
    buffer_load_dwordx4 v21, s[8:11], s41 offen offset:0 lds
    v_mfma_f32_16x16x32_bf16 v[56:59], a[160:163], a[120:123], v[56:59]
    v_mfma_f32_16x16x32_bf16 v[60:63], a[160:163], a[124:127], v[60:63]
    ds_read_b64_tr_b16 a[184:185], v8 offset:96
    v_mfma_f32_16x16x32_bf16 v[92:95], a[164:167], a[124:127], v[92:95]
    v_mfma_f32_16x16x32_bf16 v[88:91], a[164:167], a[120:123], v[88:91]
    buffer_load_dwordx4 v22, s[8:11], s41 offen offset:1024 lds
    v_mfma_f32_16x16x32_bf16 v[84:87], a[164:167], a[116:119], v[84:87]
    ds_read_b64_tr_b16 a[186:187], v8 offset:1376
    v_mfma_f32_16x16x32_bf16 v[80:83], a[164:167], a[112:115], v[80:83]
    v_mfma_f32_16x16x32_bf16 v[76:79], a[164:167], a[108:111], v[76:79]
    v_mfma_f32_16x16x32_bf16 v[72:75], a[164:167], a[104:107], v[72:75]
    ds_read_b64_tr_b16 a[188:189], v8 offset:10336
    v_mfma_f32_16x16x32_bf16 v[68:71], a[164:167], a[100:103], v[68:71]
    v_mfma_f32_16x16x32_bf16 v[64:67], a[164:167], a[96:99], v[64:67]
    s_add_u32 s63, s63, 128
    v_mfma_f32_16x16x32_bf16 v[96:99], a[168:171], a[96:99], v[96:99]
    v_mfma_f32_16x16x32_bf16 v[100:103], a[168:171], a[100:103], v[100:103]
    ds_read_b64_tr_b16 a[190:191], v8 offset:11616
    v_mfma_f32_16x16x32_bf16 v[104:107], a[168:171], a[104:107], v[104:107]
    v_mfma_f32_16x16x32_bf16 v[108:111], a[168:171], a[108:111], v[108:111]
    s_and_b32 s63, s63, 2047
    v_mfma_f32_16x16x32_bf16 v[112:115], a[168:171], a[112:115], v[112:115]
    ds_read_b64_tr_b16 a[192:193], v10 offset:0
    v_mfma_f32_16x16x32_bf16 v[116:119], a[168:171], a[116:119], v[116:119]
    v_mfma_f32_16x16x32_bf16 v[120:123], a[168:171], a[120:123], v[120:123]
    v_mfma_f32_16x16x32_bf16 v[124:127], a[168:171], a[124:127], v[124:127]
    ds_read_b64_tr_b16 a[194:195], v10 offset:1280
    v_mfma_f32_16x16x32_bf16 v[156:159], a[172:175], a[124:127], v[156:159]
    buffer_load_dwordx4 v23, s[8:11], s41 offen offset:2048 lds
    v_mfma_f32_16x16x32_bf16 v[152:155], a[172:175], a[120:123], v[152:155]
    v_mfma_f32_16x16x32_bf16 v[148:151], a[172:175], a[116:119], v[148:151]
    v_mfma_f32_16x16x32_bf16 v[144:147], a[172:175], a[112:115], v[144:147]
    ds_read_b64_tr_b16 a[196:197], v10 offset:10240
    v_mfma_f32_16x16x32_bf16 v[140:143], a[172:175], a[108:111], v[140:143]
    v_mfma_f32_16x16x32_bf16 v[136:139], a[172:175], a[104:107], v[136:139]
    s_add_u32 s40, s64, s63
    v_mfma_f32_16x16x32_bf16 v[132:135], a[172:175], a[100:103], v[132:135]
    ds_read_b64_tr_b16 a[198:199], v10 offset:11520
    v_mfma_f32_16x16x32_bf16 v[128:131], a[172:175], a[96:99], v[128:131]
    v_mfma_f32_16x16x32_bf16 v[160:163], a[176:179], a[96:99], v[160:163]
    v_mfma_f32_16x16x32_bf16 v[164:167], a[176:179], a[100:103], v[164:167]
    buffer_load_dwordx4 v24, s[8:11], s41 offen offset:3072 lds
    v_mfma_f32_16x16x32_bf16 v[168:171], a[176:179], a[104:107], v[168:171]
    v_mfma_f32_16x16x32_bf16 v[172:175], a[176:179], a[108:111], v[172:175]
    v_mfma_f32_16x16x32_bf16 v[176:179], a[176:179], a[112:115], v[176:179]
    s_add_u32 s41, s40, 0x10000
    v_mfma_f32_16x16x32_bf16 v[180:183], a[176:179], a[116:119], v[180:183]
    v_mfma_f32_16x16x32_bf16 v[184:187], a[176:179], a[120:123], v[184:187]
    v_mfma_f32_16x16x32_bf16 v[188:191], a[176:179], a[124:127], v[188:191]
    s_waitcnt vmcnt(13) lgkmcnt(0)
    s_barrier
    v_mfma_f32_16x16x32_bf16 v[192:195], a[180:183], a[96:99], v[192:195]
    ds_read_b64_tr_b16 a[160:161], v6 offset:20480
    v_mfma_f32_16x16x32_bf16 v[196:199], a[180:183], a[100:103], v[196:199]
    s_add_u32 m0, s59, 0x1f000
    v_mfma_f32_16x16x32_bf16 v[200:203], a[180:183], a[104:107], v[200:203]
    ds_read_b64_tr_b16 a[162:163], v6 offset:21760
    v_mfma_f32_16x16x32_bf16 v[204:207], a[180:183], a[108:111], v[204:207]
    s_lshl_b32 s52, s50, 1
    v_mfma_f32_16x16x32_bf16 v[208:211], a[180:183], a[112:115], v[208:211]
    ds_read_b128 a[128:131], v5 offset:0
    v_mfma_f32_16x16x32_bf16 v[212:215], a[180:183], a[116:119], v[212:215]
    ds_read_b128 a[132:135], v5 offset:2048
    v_mfma_f32_16x16x32_bf16 v[216:219], a[180:183], a[120:123], v[216:219]
    buffer_load_dwordx4 v13, s[12:15], s43 offen offset:0 nt lds
    v_mfma_f32_16x16x32_bf16 v[220:223], a[180:183], a[124:127], v[220:223]
    ds_read_b128 a[136:139], v5 offset:4096
    v_mfma_f32_16x16x32_bf16 v[252:255], a[184:187], a[124:127], v[252:255]
    s_add_u32 s52, s52, s54
    v_mfma_f32_16x16x32_bf16 v[248:251], a[184:187], a[120:123], v[248:251]
    ds_read_b128 a[140:143], v5 offset:6144
    v_mfma_f32_16x16x32_bf16 v[244:247], a[184:187], a[116:119], v[244:247]
    buffer_load_dwordx4 v14, s[12:15], s43 offen offset:1024 nt lds
    v_mfma_f32_16x16x32_bf16 v[240:243], a[184:187], a[112:115], v[240:243]
    ds_read_b128 a[144:147], v5 offset:8192
    v_mfma_f32_16x16x32_bf16 v[236:239], a[184:187], a[108:111], v[236:239]
    ds_read_b128 a[148:151], v5 offset:10240
    v_mfma_f32_16x16x32_bf16 v[232:235], a[184:187], a[104:107], v[232:235]
    s_lshl_b32 s52, s52, 8
    v_mfma_f32_16x16x32_bf16 v[228:231], a[184:187], a[100:103], v[228:231]
    ds_read_b128 a[152:155], v5 offset:12288
    v_mfma_f32_16x16x32_bf16 v[224:227], a[184:187], a[96:99], v[224:227]
    buffer_load_dwordx4 v15, s[12:15], s43 offen offset:2048 nt lds
    v_mfma_f32_16x16x32_bf16 a[0:3], a[188:191], a[96:99], a[0:3]
    ds_read_b128 a[156:159], v5 offset:14336
    v_mfma_f32_16x16x32_bf16 a[4:7], a[188:191], a[100:103], a[4:7]
    s_add_u32 s52, s52, 0x1e0000
    v_mfma_f32_16x16x32_bf16 a[8:11], a[188:191], a[104:107], a[8:11]
    ds_read_b64_tr_b16 a[164:165], v6 offset:30720
    v_mfma_f32_16x16x32_bf16 a[12:15], a[188:191], a[108:111], a[12:15]
    ds_read_b64_tr_b16 a[166:167], v6 offset:32000
    v_mfma_f32_16x16x32_bf16 a[16:19], a[188:191], a[112:115], a[16:19]
    buffer_load_dwordx4 v16, s[12:15], s43 offen offset:3072 nt lds
    v_mfma_f32_16x16x32_bf16 a[20:23], a[188:191], a[116:119], a[20:23]
    ds_read_b64_tr_b16 a[168:169], v8 offset:20512
    v_mfma_f32_16x16x32_bf16 a[24:27], a[188:191], a[120:123], a[24:27]
    v_lshlrev_b32 v25, 2, v2
    v_mfma_f32_16x16x32_bf16 a[28:31], a[188:191], a[124:127], a[28:31]
    ds_read_b64_tr_b16 a[170:171], v8 offset:21792
    v_mfma_f32_16x16x32_bf16 a[60:63], a[192:195], a[124:127], a[60:63]
    buffer_load_dword v26, v25, s[44:47], s52 offen sc1
    v_mfma_f32_16x16x32_bf16 a[56:59], a[192:195], a[120:123], a[56:59]
    ds_read_b64_tr_b16 a[172:173], v8 offset:30752
    v_mfma_f32_16x16x32_bf16 a[52:55], a[192:195], a[116:119], a[52:55]
    ds_read_b64_tr_b16 a[174:175], v8 offset:32032
    v_mfma_f32_16x16x32_bf16 a[48:51], a[192:195], a[112:115], a[48:51]
    s_add_u32 s62, s62, 1
    v_mfma_f32_16x16x32_bf16 a[44:47], a[192:195], a[108:111], a[44:47]
    ds_read_b64_tr_b16 a[176:177], v6 offset:20544
    v_mfma_f32_16x16x32_bf16 a[40:43], a[192:195], a[104:107], a[40:43]
    s_lshl_b32 s53, s56, 4
    v_mfma_f32_16x16x32_bf16 a[36:39], a[192:195], a[100:103], a[36:39]
    ds_read_b64_tr_b16 a[178:179], v6 offset:21824
    v_mfma_f32_16x16x32_bf16 a[32:35], a[192:195], a[96:99], a[32:35]
    s_and_b32 s62, s62, 31
    v_mfma_f32_16x16x32_bf16 a[64:67], a[196:199], a[96:99], a[64:67]
    s_add_u32 s53, s53, s55
    v_mfma_f32_16x16x32_bf16 a[68:71], a[196:199], a[100:103], a[68:71]
    s_add_u32 m0, s59, 0x20000
    v_mfma_f32_16x16x32_bf16 a[72:75], a[196:199], a[104:107], a[72:75]
    s_lshl_b32 s53, s53, 3
    v_mfma_f32_16x16x32_bf16 a[76:79], a[196:199], a[108:111], a[76:79]
    buffer_load_dwordx4 v17, s[12:15], s43 offen offset:0 nt lds
    v_mfma_f32_16x16x32_bf16 a[80:83], a[196:199], a[112:115], a[80:83]
    s_add_u32 s53, s53, 0x1e1000
    v_mfma_f32_16x16x32_bf16 a[84:87], a[196:199], a[116:119], a[84:87]
    s_mul_i32 s43, s62, 229376
    v_mfma_f32_16x16x32_bf16 a[88:91], a[196:199], a[120:123], a[88:91]
    v_bfe_u32 v27, v2, 1, 3
    v_mfma_f32_16x16x32_bf16 a[92:95], a[196:199], a[124:127], a[92:95]
    v_and_b32 v28, 1, v2
    s_waitcnt lgkmcnt(0)
    v_mfma_f32_16x16x32_bf16 v[32:35], a[160:163], a[128:131], v[32:35]
    ds_read_b64_tr_b16 a[180:181], v6 offset:30784
    v_mfma_f32_16x16x32_bf16 v[36:39], a[160:163], a[132:135], v[36:39]
    v_lshlrev_b32 v27, 4, v27
    v_mfma_f32_16x16x32_bf16 v[40:43], a[160:163], a[136:139], v[40:43]
    v_lshl_add_u32 v27, v28, 2, v27
    v_mfma_f32_16x16x32_bf16 v[44:47], a[160:163], a[140:143], v[44:47]
    ds_read_b64_tr_b16 a[182:183], v6 offset:32064
    v_mfma_f32_16x16x32_bf16 v[48:51], a[160:163], a[144:147], v[48:51]
    buffer_load_dword v28, v27, s[44:47], s53 offen sc1
    v_mfma_f32_16x16x32_bf16 v[52:55], a[160:163], a[148:151], v[52:55]
    s_mov_b32 s16, s80
    v_mfma_f32_16x16x32_bf16 v[56:59], a[160:163], a[152:155], v[56:59]
    s_and_b32 s17, s81, 0xffff
    v_mfma_f32_16x16x32_bf16 v[60:63], a[160:163], a[156:159], v[60:63]
    ds_read_b64_tr_b16 a[184:185], v8 offset:20576
    v_mfma_f32_16x16x32_bf16 v[92:95], a[164:167], a[156:159], v[92:95]
    s_mov_b32 s18, 0x700000
    v_mfma_f32_16x16x32_bf16 v[88:91], a[164:167], a[152:155], v[88:91]
    s_mov_b32 s19, 0x20000
    v_mfma_f32_16x16x32_bf16 v[84:87], a[164:167], a[148:151], v[84:87]
    ds_read_b64_tr_b16 a[186:187], v8 offset:21856
    v_mfma_f32_16x16x32_bf16 v[80:83], a[164:167], a[144:147], v[80:83]
    v_lshrrev_b32 v29, 4, v2
    v_mfma_f32_16x16x32_bf16 v[76:79], a[164:167], a[140:143], v[76:79]
    v_and_b32 v30, 15, v2
    v_mfma_f32_16x16x32_bf16 v[72:75], a[164:167], a[136:139], v[72:75]
    ds_read_b64_tr_b16 a[188:189], v8 offset:30816
    v_mfma_f32_16x16x32_bf16 v[68:71], a[164:167], a[132:135], v[68:71]
    v_lshlrev_b32 v21, 1, v29
    v_mfma_f32_16x16x32_bf16 v[64:67], a[164:167], a[128:131], v[64:67]
    v_xor_b32 v30, v30, v21
    v_mfma_f32_16x16x32_bf16 v[96:99], a[168:171], a[128:131], v[96:99]
    v_lshlrev_b32 v29, 11, v29
    v_mfma_f32_16x16x32_bf16 v[100:103], a[168:171], a[132:135], v[100:103]
    ds_read_b64_tr_b16 a[190:191], v8 offset:32096
    v_mfma_f32_16x16x32_bf16 v[104:107], a[168:171], a[136:139], v[104:107]
    v_lshl_add_u32 v29, v30, 4, v29
    v_mfma_f32_16x16x32_bf16 v[108:111], a[168:171], a[140:143], v[108:111]
    v_add_u32 v13, s68, v29
    v_mfma_f32_16x16x32_bf16 v[112:115], a[168:171], a[144:147], v[112:115]
    ds_read_b64_tr_b16 a[192:193], v10 offset:20480
    v_mfma_f32_16x16x32_bf16 v[116:119], a[168:171], a[148:151], v[116:119]
    v_xor_b32 v14, 128, v13
    v_mfma_f32_16x16x32_bf16 v[120:123], a[168:171], a[152:155], v[120:123]
    v_add_u32 v15, 14336, v13
    v_mfma_f32_16x16x32_bf16 v[124:127], a[168:171], a[156:159], v[124:127]
    ds_read_b64_tr_b16 a[194:195], v10 offset:21760
    v_mfma_f32_16x16x32_bf16 v[156:159], a[172:175], a[156:159], v[156:159]
    v_add_u32 v16, 21504, v14
    v_mfma_f32_16x16x32_bf16 v[152:155], a[172:175], a[152:155], v[152:155]
    v_add_u32 v14, 7168, v14
    v_mfma_f32_16x16x32_bf16 v[148:151], a[172:175], a[148:151], v[148:151]
    s_waitcnt vmcnt(0)
    v_mfma_f32_16x16x32_bf16 v[144:147], a[172:175], a[144:147], v[144:147]
    ds_read_b64_tr_b16 a[196:197], v10 offset:30720
    v_mfma_f32_16x16x32_bf16 v[140:143], a[172:175], a[140:143], v[140:143]
    v_cmp_ne_u32 vcc, v3, v26
    v_mfma_f32_16x16x32_bf16 v[136:139], a[172:175], a[136:139], v[136:139]
    v_mfma_f32_16x16x32_bf16 v[132:135], a[172:175], a[132:135], v[132:135]
    ds_read_b64_tr_b16 a[198:199], v10 offset:32000
    v_mfma_f32_16x16x32_bf16 v[128:131], a[172:175], a[128:131], v[128:131]
    v_mfma_f32_16x16x32_bf16 v[160:163], a[176:179], a[128:131], v[160:163]
    v_mfma_f32_16x16x32_bf16 v[164:167], a[176:179], a[132:135], v[164:167]
    v_mfma_f32_16x16x32_bf16 v[168:171], a[176:179], a[136:139], v[168:171]
    s_cbranch_vccnz L_pollSTB
    L_pollSTBb:
    v_mfma_f32_16x16x32_bf16 v[172:175], a[176:179], a[140:143], v[172:175]
    v_cmp_ne_u32 vcc, v3, v28
    v_mfma_f32_16x16x32_bf16 v[176:179], a[176:179], a[144:147], v[176:179]
    v_mfma_f32_16x16x32_bf16 v[180:183], a[176:179], a[148:151], v[180:183]
    v_mfma_f32_16x16x32_bf16 v[184:187], a[176:179], a[152:155], v[184:187]
    v_mfma_f32_16x16x32_bf16 v[188:191], a[176:179], a[156:159], v[188:191]
    s_waitcnt vmcnt(0) lgkmcnt(0)
    s_barrier
    v_mfma_f32_16x16x32_bf16 v[192:195], a[180:183], a[128:131], v[192:195]
    ds_read_b64_tr_b16 a[160:161], v7 offset:0
    v_mfma_f32_16x16x32_bf16 v[196:199], a[180:183], a[132:135], v[196:199]
    s_cbranch_vccnz L_pollCSB
    L_pollCSBb:
    v_mfma_f32_16x16x32_bf16 v[200:203], a[180:183], a[136:139], v[200:203]
    ds_read_b64_tr_b16 a[162:163], v7 offset:1280
    v_mfma_f32_16x16x32_bf16 v[204:207], a[180:183], a[140:143], v[204:207]
    s_lshl_b32 s52, s56, 1
    v_mfma_f32_16x16x32_bf16 v[208:211], a[180:183], a[144:147], v[208:211]
    ds_read_b128 a[96:99], v4 offset:32768
    v_mfma_f32_16x16x32_bf16 v[212:215], a[180:183], a[148:151], v[212:215]
    ds_read_b128 a[100:103], v4 offset:34816
    v_mfma_f32_16x16x32_bf16 v[216:219], a[180:183], a[152:155], v[216:219]
    s_add_u32 s52, s52, s55
    v_mfma_f32_16x16x32_bf16 v[220:223], a[180:183], a[156:159], v[220:223]
    ds_read_b128 a[104:107], v4 offset:36864
    v_mfma_f32_16x16x32_bf16 v[252:255], a[184:187], a[156:159], v[252:255]
    s_mul_i32 s52, s52, 10240
    v_mfma_f32_16x16x32_bf16 v[248:251], a[184:187], a[152:155], v[248:251]
    ds_read_b128 a[108:111], v4 offset:38912
    v_mfma_f32_16x16x32_bf16 v[244:247], a[184:187], a[148:151], v[244:247]
    s_add_u32 s52, s52, 0x110000
    v_mfma_f32_16x16x32_bf16 v[240:243], a[184:187], a[144:147], v[240:243]
    ds_read_b128 a[112:115], v4 offset:40960
    v_mfma_f32_16x16x32_bf16 v[236:239], a[184:187], a[140:143], v[236:239]
    ds_read_b128 a[116:119], v4 offset:43008
    v_mfma_f32_16x16x32_bf16 v[232:235], a[184:187], a[136:139], v[232:235]
    v_and_b32 v25, 15, v2
    v_mfma_f32_16x16x32_bf16 v[228:231], a[184:187], a[132:135], v[228:231]
    ds_read_b128 a[120:123], v4 offset:45056
    v_mfma_f32_16x16x32_bf16 v[224:227], a[184:187], a[128:131], v[224:227]
    v_and_b32 v1, 48, v2
    v_mfma_f32_16x16x32_bf16 a[0:3], a[188:191], a[128:131], a[0:3]
    ds_read_b128 a[124:127], v4 offset:47104
    v_mfma_f32_16x16x32_bf16 a[4:7], a[188:191], a[132:135], a[4:7]
    v_lshlrev_b32 v0, 5, v25
    v_mfma_f32_16x16x32_bf16 a[8:11], a[188:191], a[136:139], a[8:11]
    ds_read_b64_tr_b16 a[164:165], v7 offset:10240
    v_mfma_f32_16x16x32_bf16 a[12:15], a[188:191], a[140:143], a[12:15]
    ds_read_b64_tr_b16 a[166:167], v7 offset:11520
    v_mfma_f32_16x16x32_bf16 a[16:19], a[188:191], a[144:147], a[16:19]
    buffer_load_dwordx4 a[200:203], v12, s[44:47], s52 offen offset:0 sc1
    v_mfma_f32_16x16x32_bf16 a[20:23], a[188:191], a[148:151], a[20:23]
    ds_read_b64_tr_b16 a[168:169], v9 offset:32
    v_mfma_f32_16x16x32_bf16 a[24:27], a[188:191], a[152:155], a[24:27]
    s_mul_i32 s53, s67, 1179648
    v_mfma_f32_16x16x32_bf16 a[28:31], a[188:191], a[156:159], a[28:31]
    ds_read_b64_tr_b16 a[170:171], v9 offset:1312
    v_mfma_f32_16x16x32_bf16 a[60:63], a[192:195], a[156:159], a[60:63]
    buffer_load_dwordx4 a[204:207], v12, s[44:47], s52 offen offset:1024 sc1
    v_mfma_f32_16x16x32_bf16 a[56:59], a[192:195], a[152:155], a[56:59]
    ds_read_b64_tr_b16 a[172:173], v9 offset:10272
    v_mfma_f32_16x16x32_bf16 a[52:55], a[192:195], a[148:151], a[52:55]
    ds_read_b64_tr_b16 a[174:175], v9 offset:11552
    v_mfma_f32_16x16x32_bf16 a[48:51], a[192:195], a[144:147], a[48:51]
    buffer_load_dwordx4 a[208:211], v12, s[44:47], s52 offen offset:2048 sc1
    v_mfma_f32_16x16x32_bf16 a[44:47], a[192:195], a[140:143], a[44:47]
    ds_read_b64_tr_b16 a[176:177], v7 offset:64
    v_mfma_f32_16x16x32_bf16 a[40:43], a[192:195], a[136:139], a[40:43]
    s_add_u32 s53, s53, 0x800000
    v_mfma_f32_16x16x32_bf16 a[36:39], a[192:195], a[132:135], a[36:39]
    ds_read_b64_tr_b16 a[178:179], v7 offset:1344
    v_mfma_f32_16x16x32_bf16 a[32:35], a[192:195], a[128:131], a[32:35]
    buffer_load_dwordx4 a[212:215], v12, s[44:47], s52 offen offset:3072 sc1
    v_mfma_f32_16x16x32_bf16 a[64:67], a[196:199], a[128:131], a[64:67]
    s_add_u32 s52, s52, 4096
    v_mfma_f32_16x16x32_bf16 a[68:71], a[196:199], a[132:135], a[68:71]
    s_add_u32 s12, s6, s53
    s_addc_u32 s13, s7, 0
    v_mfma_f32_16x16x32_bf16 a[72:75], a[196:199], a[136:139], a[72:75]
    buffer_load_dwordx4 a[216:219], v12, s[44:47], s52 offen offset:0 sc1
    v_mfma_f32_16x16x32_bf16 a[76:79], a[196:199], a[140:143], a[76:79]
    s_and_b32 s13, s13, 0xffff
    v_mfma_f32_16x16x32_bf16 a[80:83], a[196:199], a[144:147], a[80:83]
    s_mov_b32 s14, 0x120000
    v_mfma_f32_16x16x32_bf16 a[84:87], a[196:199], a[148:151], a[84:87]
    buffer_load_dwordx4 a[220:223], v12, s[44:47], s52 offen offset:1024 sc1
    v_mfma_f32_16x16x32_bf16 a[88:91], a[196:199], a[152:155], a[88:91]
    s_mov_b32 s15, 0x20000
    v_mfma_f32_16x16x32_bf16 a[92:95], a[196:199], a[156:159], a[92:95]
    s_mov_b32 s20, s74
    s_waitcnt lgkmcnt(0)
    v_mfma_f32_16x16x32_bf16 v[32:35], a[160:163], a[96:99], v[32:35]
    ds_read_b64_tr_b16 a[180:181], v7 offset:10304
    v_mfma_f32_16x16x32_bf16 v[36:39], a[160:163], a[100:103], v[36:39]
    buffer_load_dwordx4 a[224:227], v12, s[44:47], s52 offen offset:2048 sc1
    v_mfma_f32_16x16x32_bf16 v[40:43], a[160:163], a[104:107], v[40:43]
    s_and_b32 s21, s75, 0xffff
    v_mfma_f32_16x16x32_bf16 v[44:47], a[160:163], a[108:111], v[44:47]
    ds_read_b64_tr_b16 a[182:183], v7 offset:11584
    v_mfma_f32_16x16x32_bf16 v[48:51], a[160:163], a[112:115], v[48:51]
    buffer_load_dwordx4 a[228:231], v12, s[44:47], s52 offen offset:3072 sc1
    v_mfma_f32_16x16x32_bf16 v[52:55], a[160:163], a[116:119], v[52:55]
    s_add_u32 s52, s52, 4096
    v_mfma_f32_16x16x32_bf16 v[56:59], a[160:163], a[120:123], v[56:59]
    s_mov_b32 s22, 0x200000
    v_mfma_f32_16x16x32_bf16 v[60:63], a[160:163], a[124:127], v[60:63]
    ds_read_b64_tr_b16 a[184:185], v9 offset:96
    v_mfma_f32_16x16x32_bf16 v[92:95], a[164:167], a[124:127], v[92:95]
    buffer_load_dwordx4 a[232:235], v12, s[44:47], s52 offen offset:0 sc1
    v_mfma_f32_16x16x32_bf16 v[88:91], a[164:167], a[120:123], v[88:91]
    s_mov_b32 s23, 0x20000
    v_mfma_f32_16x16x32_bf16 v[84:87], a[164:167], a[116:119], v[84:87]
    ds_read_b64_tr_b16 a[186:187], v9 offset:1376
    v_mfma_f32_16x16x32_bf16 v[80:83], a[164:167], a[112:115], v[80:83]
    buffer_load_dwordx4 a[236:239], v12, s[44:47], s52 offen offset:1024 sc1
    v_mfma_f32_16x16x32_bf16 v[76:79], a[164:167], a[108:111], v[76:79]
    s_mov_b32 s24, s82
    v_mfma_f32_16x16x32_bf16 v[72:75], a[164:167], a[104:107], v[72:75]
    ds_read_b64_tr_b16 a[188:189], v9 offset:10336
    v_mfma_f32_16x16x32_bf16 v[68:71], a[164:167], a[100:103], v[68:71]
    buffer_load_dwordx2 a[240:241], v0, s[44:47], s61 offen offset:16 sc1
    v_mfma_f32_16x16x32_bf16 v[64:67], a[164:167], a[96:99], v[64:67]
    s_and_b32 s25, s83, 0xffff
    v_mfma_f32_16x16x32_bf16 v[96:99], a[168:171], a[96:99], v[96:99]
    s_mov_b32 s26, 0x400000
    v_mfma_f32_16x16x32_bf16 v[100:103], a[168:171], a[100:103], v[100:103]
    ds_read_b64_tr_b16 a[190:191], v9 offset:11616
    v_mfma_f32_16x16x32_bf16 v[104:107], a[168:171], a[104:107], v[104:107]
    buffer_load_dwordx2 a[242:243], v0, s[44:47], s61 offen offset:528 sc1
    v_mfma_f32_16x16x32_bf16 v[108:111], a[168:171], a[108:111], v[108:111]
    s_mov_b32 s27, 0x20000
    v_mfma_f32_16x16x32_bf16 v[112:115], a[168:171], a[112:115], v[112:115]
    ds_read_b64_tr_b16 a[192:193], v11 offset:0
    v_mfma_f32_16x16x32_bf16 v[116:119], a[168:171], a[116:119], v[116:119]
    buffer_load_dwordx2 a[244:245], v0, s[44:47], s61 offen offset:1040 sc1
    v_mfma_f32_16x16x32_bf16 v[120:123], a[168:171], a[120:123], v[120:123]
    s_add_u32 s68, s68, 0
    v_mfma_f32_16x16x32_bf16 v[124:127], a[168:171], a[124:127], v[124:127]
    ds_read_b64_tr_b16 a[194:195], v11 offset:1280
    v_mfma_f32_16x16x32_bf16 v[156:159], a[172:175], a[124:127], v[156:159]
    buffer_load_dwordx2 a[246:247], v0, s[44:47], s61 offen offset:1552 sc1
    v_mfma_f32_16x16x32_bf16 v[152:155], a[172:175], a[120:123], v[152:155]
    v_and_b32 v30, 7, v2
    v_mfma_f32_16x16x32_bf16 v[148:151], a[172:175], a[116:119], v[148:151]
    v_xor_b32 v30, v30, v21
    v_mfma_f32_16x16x32_bf16 v[144:147], a[172:175], a[112:115], v[144:147]
    ds_read_b64_tr_b16 a[196:197], v11 offset:10240
    v_mfma_f32_16x16x32_bf16 v[140:143], a[172:175], a[108:111], v[140:143]
    buffer_load_dwordx2 a[248:249], v0, s[44:47], s61 offen offset:2064 sc1
    v_mfma_f32_16x16x32_bf16 v[136:139], a[172:175], a[104:107], v[136:139]
    v_lshrrev_b32 v29, 3, v2
    v_mfma_f32_16x16x32_bf16 v[132:135], a[172:175], a[100:103], v[132:135]
    ds_read_b64_tr_b16 a[198:199], v11 offset:11520
    v_mfma_f32_16x16x32_bf16 v[128:131], a[172:175], a[96:99], v[128:131]
    buffer_load_dwordx2 a[250:251], v0, s[44:47], s61 offen offset:2576 sc1
    v_mfma_f32_16x16x32_bf16 v[160:163], a[176:179], a[96:99], v[160:163]
    v_lshlrev_b32 v29, 11, v29
    v_mfma_f32_16x16x32_bf16 v[164:167], a[176:179], a[100:103], v[164:167]
    v_lshl_add_u32 v29, v30, 4, v29
    v_mfma_f32_16x16x32_bf16 v[168:171], a[176:179], a[104:107], v[168:171]
    buffer_load_dwordx2 a[252:253], v0, s[44:47], s61 offen offset:3088 sc1
    v_mfma_f32_16x16x32_bf16 v[172:175], a[176:179], a[108:111], v[172:175]
    s_lshl_b32 s53, s49, 16
    v_mfma_f32_16x16x32_bf16 v[176:179], a[176:179], a[112:115], v[176:179]
    s_add_u32 s53, s53, s68
    v_mfma_f32_16x16x32_bf16 v[180:183], a[176:179], a[116:119], v[180:183]
    buffer_load_dwordx2 a[254:255], v0, s[44:47], s61 offen offset:3600 sc1
    v_mfma_f32_16x16x32_bf16 v[184:187], a[176:179], a[120:123], v[184:187]
    v_add_u32 v17, s53, v29
    v_mfma_f32_16x16x32_bf16 v[188:191], a[176:179], a[124:127], v[188:191]
    s_lshl_b32 s53, s49, 11
    s_waitcnt vmcnt(18) lgkmcnt(0)
    s_barrier
    v_mfma_f32_16x16x32_bf16 v[192:195], a[180:183], a[96:99], v[192:195]
    ds_read_b64_tr_b16 a[160:161], v7 offset:20480
    v_mfma_f32_16x16x32_bf16 v[196:199], a[180:183], a[100:103], v[196:199]
    s_add_u32 m0, s70, 0
    v_mfma_f32_16x16x32_bf16 v[200:203], a[180:183], a[104:107], v[200:203]
    ds_read_b64_tr_b16 a[162:163], v7 offset:21760
    v_mfma_f32_16x16x32_bf16 v[204:207], a[180:183], a[108:111], v[204:207]
    s_lshr_b32 s59, 0x28252320, s72
    v_mfma_f32_16x16x32_bf16 v[208:211], a[180:183], a[112:115], v[208:211]
    ds_read_b128 a[128:131], v5 offset:32768
    v_mfma_f32_16x16x32_bf16 v[212:215], a[180:183], a[116:119], v[212:215]
    ds_read_b128 a[132:135], v5 offset:34816
    v_mfma_f32_16x16x32_bf16 v[216:219], a[180:183], a[120:123], v[216:219]
    v_add_u32 v21, s53, v12
    v_mfma_f32_16x16x32_bf16 v[220:223], a[180:183], a[124:127], v[220:223]
    ds_read_b128 a[136:139], v5 offset:36864
    v_mfma_f32_16x16x32_bf16 v[252:255], a[184:187], a[124:127], v[252:255]
    s_and_b32 s59, s59, 255
    v_mfma_f32_16x16x32_bf16 v[248:251], a[184:187], a[120:123], v[248:251]
    ds_read_b128 a[140:143], v5 offset:38912
    v_mfma_f32_16x16x32_bf16 v[244:247], a[184:187], a[116:119], v[244:247]
    s_lshl_b32 s59, s59, 16
    v_mfma_f32_16x16x32_bf16 v[240:243], a[184:187], a[112:115], v[240:243]
    ds_read_b128 a[144:147], v5 offset:40960
    v_mfma_f32_16x16x32_bf16 v[236:239], a[184:187], a[108:111], v[236:239]
    ds_read_b128 a[148:151], v5 offset:43008
    v_mfma_f32_16x16x32_bf16 v[232:235], a[184:187], a[104:107], v[232:235]
    v_xor_b32 v22, 0x800, v21
    v_mfma_f32_16x16x32_bf16 v[228:231], a[184:187], a[100:103], v[228:231]
    ds_read_b128 a[152:155], v5 offset:45056
    v_mfma_f32_16x16x32_bf16 v[224:227], a[184:187], a[96:99], v[224:227]
    buffer_load_dwordx4 v13, s[16:19], s59 offen offset:0 lds
    v_mfma_f32_16x16x32_bf16 a[0:3], a[188:191], a[96:99], a[0:3]
    ds_read_b128 a[156:159], v5 offset:47104
    v_mfma_f32_16x16x32_bf16 a[4:7], a[188:191], a[100:103], a[4:7]
    buffer_load_dwordx4 v14, s[16:19], s59 offen offset:1024 lds
    v_mfma_f32_16x16x32_bf16 a[8:11], a[188:191], a[104:107], a[8:11]
    ds_read_b64_tr_b16 a[164:165], v7 offset:30720
    v_mfma_f32_16x16x32_bf16 a[12:15], a[188:191], a[108:111], a[12:15]
    ds_read_b64_tr_b16 a[166:167], v7 offset:32000
    v_mfma_f32_16x16x32_bf16 a[16:19], a[188:191], a[112:115], a[16:19]
    s_mov_b32 s64, 0xfffe0000
    v_mfma_f32_16x16x32_bf16 a[20:23], a[188:191], a[116:119], a[20:23]
    ds_read_b64_tr_b16 a[168:169], v9 offset:20512
    v_mfma_f32_16x16x32_bf16 a[24:27], a[188:191], a[120:123], a[24:27]
    buffer_load_dwordx4 v15, s[16:19], s59 offen offset:2048 lds
    v_mfma_f32_16x16x32_bf16 a[28:31], a[188:191], a[124:127], a[28:31]
    ds_read_b64_tr_b16 a[170:171], v9 offset:21792
    v_mfma_f32_16x16x32_bf16 a[60:63], a[192:195], a[124:127], a[60:63]
    s_mov_b32 s63, 0
    v_mfma_f32_16x16x32_bf16 a[56:59], a[192:195], a[120:123], a[56:59]
    ds_read_b64_tr_b16 a[172:173], v9 offset:30752
    v_mfma_f32_16x16x32_bf16 a[52:55], a[192:195], a[116:119], a[52:55]
    ds_read_b64_tr_b16 a[174:175], v9 offset:32032
    v_mfma_f32_16x16x32_bf16 a[48:51], a[192:195], a[112:115], a[48:51]
    buffer_load_dwordx4 v16, s[16:19], s59 offen offset:3072 lds
    v_mfma_f32_16x16x32_bf16 a[44:47], a[192:195], a[108:111], a[44:47]
    ds_read_b64_tr_b16 a[176:177], v7 offset:20544
    v_mfma_f32_16x16x32_bf16 a[40:43], a[192:195], a[104:107], a[40:43]
    s_add_u32 m0, s70, 4096
    v_mfma_f32_16x16x32_bf16 a[36:39], a[192:195], a[100:103], a[36:39]
    ds_read_b64_tr_b16 a[178:179], v7 offset:21824
    v_mfma_f32_16x16x32_bf16 a[32:35], a[192:195], a[96:99], a[32:35]
    s_mov_b32 s41, 3
    v_mfma_f32_16x16x32_bf16 a[64:67], a[196:199], a[96:99], a[64:67]
    s_add_u32 s59, s59, 32768
    v_mfma_f32_16x16x32_bf16 a[68:71], a[196:199], a[100:103], a[68:71]
    buffer_load_dwordx4 v13, s[16:19], s59 offen offset:0 lds
    v_mfma_f32_16x16x32_bf16 a[72:75], a[196:199], a[104:107], a[72:75]
    v_mfma_f32_16x16x32_bf16 a[76:79], a[196:199], a[108:111], a[76:79]
    buffer_load_dwordx4 v14, s[16:19], s59 offen offset:1024 lds
    v_mfma_f32_16x16x32_bf16 a[80:83], a[196:199], a[112:115], a[80:83]
    buffer_load_dwordx4 v15, s[16:19], s59 offen offset:2048 lds
    v_mfma_f32_16x16x32_bf16 a[84:87], a[196:199], a[116:119], a[84:87]
    v_mfma_f32_16x16x32_bf16 a[88:91], a[196:199], a[120:123], a[88:91]
    buffer_load_dwordx4 v16, s[16:19], s59 offen offset:3072 lds
    v_mfma_f32_16x16x32_bf16 a[92:95], a[196:199], a[124:127], a[92:95]
    s_waitcnt lgkmcnt(0)
    v_mfma_f32_16x16x32_bf16 v[32:35], a[160:163], a[128:131], v[32:35]
    ds_read_b64_tr_b16 a[180:181], v7 offset:30784
    v_mfma_f32_16x16x32_bf16 v[36:39], a[160:163], a[132:135], v[36:39]
    buffer_load_dwordx4 a[96:99], v0, s[44:47], s61 offen offset:0 sc1
    v_mfma_f32_16x16x32_bf16 v[40:43], a[160:163], a[136:139], v[40:43]
    v_mfma_f32_16x16x32_bf16 v[44:47], a[160:163], a[140:143], v[44:47]
    ds_read_b64_tr_b16 a[182:183], v7 offset:32064
    v_mfma_f32_16x16x32_bf16 v[48:51], a[160:163], a[144:147], v[48:51]
    v_mfma_f32_16x16x32_bf16 v[52:55], a[160:163], a[148:151], v[52:55]
    buffer_load_dwordx4 a[100:103], v0, s[44:47], s61 offen offset:512 sc1
    v_mfma_f32_16x16x32_bf16 v[56:59], a[160:163], a[152:155], v[56:59]
    v_mfma_f32_16x16x32_bf16 v[60:63], a[160:163], a[156:159], v[60:63]
    ds_read_b64_tr_b16 a[184:185], v9 offset:20576
    v_mfma_f32_16x16x32_bf16 v[92:95], a[164:167], a[156:159], v[92:95]
    v_mfma_f32_16x16x32_bf16 v[88:91], a[164:167], a[152:155], v[88:91]
    v_mfma_f32_16x16x32_bf16 v[84:87], a[164:167], a[148:151], v[84:87]
    ds_read_b64_tr_b16 a[186:187], v9 offset:21856
    v_mfma_f32_16x16x32_bf16 v[80:83], a[164:167], a[144:147], v[80:83]
    buffer_load_dwordx4 a[104:107], v0, s[44:47], s61 offen offset:1024 sc1
    v_mfma_f32_16x16x32_bf16 v[76:79], a[164:167], a[140:143], v[76:79]
    v_mfma_f32_16x16x32_bf16 v[72:75], a[164:167], a[136:139], v[72:75]
    ds_read_b64_tr_b16 a[188:189], v9 offset:30816
    v_mfma_f32_16x16x32_bf16 v[68:71], a[164:167], a[132:135], v[68:71]
    v_mfma_f32_16x16x32_bf16 v[64:67], a[164:167], a[128:131], v[64:67]
    v_mfma_f32_16x16x32_bf16 v[96:99], a[168:171], a[128:131], v[96:99]
    buffer_load_dwordx4 a[108:111], v0, s[44:47], s61 offen offset:1536 sc1
    v_mfma_f32_16x16x32_bf16 v[100:103], a[168:171], a[132:135], v[100:103]
    ds_read_b64_tr_b16 a[190:191], v9 offset:32096
    v_mfma_f32_16x16x32_bf16 v[104:107], a[168:171], a[136:139], v[104:107]
    v_mfma_f32_16x16x32_bf16 v[108:111], a[168:171], a[140:143], v[108:111]
    v_mfma_f32_16x16x32_bf16 v[112:115], a[168:171], a[144:147], v[112:115]
    ds_read_b64_tr_b16 a[192:193], v11 offset:20480
    v_mfma_f32_16x16x32_bf16 v[116:119], a[168:171], a[148:151], v[116:119]
    v_mfma_f32_16x16x32_bf16 v[120:123], a[168:171], a[152:155], v[120:123]
    buffer_load_dwordx4 a[112:115], v0, s[44:47], s61 offen offset:2048 sc1
    v_mfma_f32_16x16x32_bf16 v[124:127], a[168:171], a[156:159], v[124:127]
    ds_read_b64_tr_b16 a[194:195], v11 offset:21760
    v_mfma_f32_16x16x32_bf16 v[156:159], a[172:175], a[156:159], v[156:159]
    v_mfma_f32_16x16x32_bf16 v[152:155], a[172:175], a[152:155], v[152:155]
    v_mfma_f32_16x16x32_bf16 v[148:151], a[172:175], a[148:151], v[148:151]
    buffer_load_dwordx4 a[116:119], v0, s[44:47], s61 offen offset:2560 sc1
    v_mfma_f32_16x16x32_bf16 v[144:147], a[172:175], a[144:147], v[144:147]
    ds_read_b64_tr_b16 a[196:197], v11 offset:30720
    v_mfma_f32_16x16x32_bf16 v[140:143], a[172:175], a[140:143], v[140:143]
    v_mfma_f32_16x16x32_bf16 v[136:139], a[172:175], a[136:139], v[136:139]
    v_mfma_f32_16x16x32_bf16 v[132:135], a[172:175], a[132:135], v[132:135]
    ds_read_b64_tr_b16 a[198:199], v11 offset:32000
    v_mfma_f32_16x16x32_bf16 v[128:131], a[172:175], a[128:131], v[128:131]
    v_mfma_f32_16x16x32_bf16 v[160:163], a[176:179], a[128:131], v[160:163]
    buffer_load_dwordx4 a[120:123], v0, s[44:47], s61 offen offset:3072 sc1
    v_mfma_f32_16x16x32_bf16 v[164:167], a[176:179], a[132:135], v[164:167]
    v_mfma_f32_16x16x32_bf16 v[168:171], a[176:179], a[136:139], v[168:171]
    v_mfma_f32_16x16x32_bf16 v[172:175], a[176:179], a[140:143], v[172:175]
    v_mfma_f32_16x16x32_bf16 v[176:179], a[176:179], a[144:147], v[176:179]
    buffer_load_dwordx4 a[124:127], v0, s[44:47], s61 offen offset:3584 sc1
    v_mfma_f32_16x16x32_bf16 v[180:183], a[176:179], a[148:151], v[180:183]
    v_mfma_f32_16x16x32_bf16 v[184:187], a[176:179], a[152:155], v[184:187]
    v_mfma_f32_16x16x32_bf16 v[188:191], a[176:179], a[156:159], v[188:191]
    s_waitcnt vmcnt(34) lgkmcnt(0)
    s_barrier
    v_mfma_f32_16x16x32_bf16 v[192:195], a[180:183], a[128:131], v[192:195]
    s_add_u32 m0, s70, 32768
    v_mfma_f32_16x16x32_bf16 v[196:199], a[180:183], a[132:135], v[196:199]
    v_mfma_f32_16x16x32_bf16 v[200:203], a[180:183], a[136:139], v[200:203]
    s_lshr_b32 s59, 0x322f2d2a, s72
    v_mfma_f32_16x16x32_bf16 v[204:207], a[180:183], a[140:143], v[204:207]
    v_mfma_f32_16x16x32_bf16 v[208:211], a[180:183], a[144:147], v[208:211]
    v_mfma_f32_16x16x32_bf16 v[212:215], a[180:183], a[148:151], v[212:215]
    s_and_b32 s59, s59, 255
    v_mfma_f32_16x16x32_bf16 v[216:219], a[180:183], a[152:155], v[216:219]
    v_mfma_f32_16x16x32_bf16 v[220:223], a[180:183], a[156:159], v[220:223]
    v_mfma_f32_16x16x32_bf16 v[252:255], a[184:187], a[156:159], v[252:255]
    s_lshl_b32 s59, s59, 16
    v_mfma_f32_16x16x32_bf16 v[248:251], a[184:187], a[152:155], v[248:251]
    v_mfma_f32_16x16x32_bf16 v[244:247], a[184:187], a[148:151], v[244:247]
    v_mfma_f32_16x16x32_bf16 v[240:243], a[184:187], a[144:147], v[240:243]
    buffer_load_dwordx4 v13, s[16:19], s59 offen offset:0 lds
    v_mfma_f32_16x16x32_bf16 v[236:239], a[184:187], a[140:143], v[236:239]
    v_mfma_f32_16x16x32_bf16 v[232:235], a[184:187], a[136:139], v[232:235]
    v_mfma_f32_16x16x32_bf16 v[228:231], a[184:187], a[132:135], v[228:231]
    buffer_load_dwordx4 v14, s[16:19], s59 offen offset:1024 lds
    v_mfma_f32_16x16x32_bf16 v[224:227], a[184:187], a[128:131], v[224:227]
    v_mfma_f32_16x16x32_bf16 a[0:3], a[188:191], a[128:131], a[0:3]
    v_mfma_f32_16x16x32_bf16 a[4:7], a[188:191], a[132:135], a[4:7]
    buffer_load_dwordx4 v15, s[16:19], s59 offen offset:2048 lds
    v_mfma_f32_16x16x32_bf16 a[8:11], a[188:191], a[136:139], a[8:11]
    v_mfma_f32_16x16x32_bf16 a[12:15], a[188:191], a[140:143], a[12:15]
    v_mfma_f32_16x16x32_bf16 a[16:19], a[188:191], a[144:147], a[16:19]
    buffer_load_dwordx4 v16, s[16:19], s59 offen offset:3072 lds
    v_mfma_f32_16x16x32_bf16 a[20:23], a[188:191], a[148:151], a[20:23]
    v_mfma_f32_16x16x32_bf16 a[24:27], a[188:191], a[152:155], a[24:27]
    s_add_u32 m0, s70, 36864
    v_mfma_f32_16x16x32_bf16 a[28:31], a[188:191], a[156:159], a[28:31]
    v_mfma_f32_16x16x32_bf16 a[60:63], a[192:195], a[156:159], a[60:63]
    v_mfma_f32_16x16x32_bf16 a[56:59], a[192:195], a[152:155], a[56:59]
    s_add_u32 s59, s59, 32768
    v_mfma_f32_16x16x32_bf16 a[52:55], a[192:195], a[148:151], a[52:55]
    v_mfma_f32_16x16x32_bf16 a[48:51], a[192:195], a[144:147], a[48:51]
    v_mfma_f32_16x16x32_bf16 a[44:47], a[192:195], a[140:143], a[44:47]
    buffer_load_dwordx4 v13, s[16:19], s59 offen offset:0 lds
    v_mfma_f32_16x16x32_bf16 a[40:43], a[192:195], a[136:139], a[40:43]
    v_mfma_f32_16x16x32_bf16 a[36:39], a[192:195], a[132:135], a[36:39]
    v_mfma_f32_16x16x32_bf16 a[32:35], a[192:195], a[128:131], a[32:35]
    buffer_load_dwordx4 v14, s[16:19], s59 offen offset:1024 lds
    v_mfma_f32_16x16x32_bf16 a[64:67], a[196:199], a[128:131], a[64:67]
    v_mfma_f32_16x16x32_bf16 a[68:71], a[196:199], a[132:135], a[68:71]
    v_mfma_f32_16x16x32_bf16 a[72:75], a[196:199], a[136:139], a[72:75]
    buffer_load_dwordx4 v15, s[16:19], s59 offen offset:2048 lds
    v_mfma_f32_16x16x32_bf16 a[76:79], a[196:199], a[140:143], a[76:79]
    v_mfma_f32_16x16x32_bf16 a[80:83], a[196:199], a[144:147], a[80:83]
    v_mfma_f32_16x16x32_bf16 a[84:87], a[196:199], a[148:151], a[84:87]
    buffer_load_dwordx4 v16, s[16:19], s59 offen offset:3072 lds
    v_mfma_f32_16x16x32_bf16 a[88:91], a[196:199], a[152:155], a[88:91]
    v_mfma_f32_16x16x32_bf16 a[92:95], a[196:199], a[156:159], a[92:95]
    s_waitcnt lgkmcnt(0)
    s_waitcnt vmcnt(8)
    v_add_u32 v23, 4096, v12
    v_mfma_f32_16x16x32_bf16 v[32:35], a[200:203], a[96:99], v[32:35]
    v_mfma_f32_16x16x32_bf16 v[64:67], a[204:207], a[96:99], v[64:67]
    v_mfma_f32_16x16x32_bf16 v[96:99], a[208:211], a[96:99], v[96:99]
    v_mfma_f32_16x16x32_bf16 v[128:131], a[212:215], a[96:99], v[128:131]
    v_mfma_f32_16x16x32_bf16 v[36:39], a[200:203], a[100:103], v[36:39]
    v_mfma_f32_16x16x32_bf16 v[68:71], a[204:207], a[100:103], v[68:71]
    v_mfma_f32_16x16x32_bf16 v[100:103], a[208:211], a[100:103], v[100:103]
    v_mfma_f32_16x16x32_bf16 v[132:135], a[212:215], a[100:103], v[132:135]
    s_mul_i32 s52, s51, 5
    s_add_u32 s52, s52, 34
    s_lshl_b32 s52, s52, 13
    s_add_u32 s58, s65, s52
    s_mul_i32 s52, s55, 24576
    s_add_u32 s61, s52, s58
    s_sub_u32 s61, s61, 16384
    s_add_u32 s60, s61, 8192
    s_add_u32 s52, s70, 0x20000
    v_add_u32 v1, s52, v12
    v_xor_b32 v0, 0x4000, v1
    s_lshl_b32 s52, s55, 12
    s_add_u32 s58, s58, s52
    s_cmp_lg_u32 s55, 0
    s_cselect_b64 s[42:43], -1, 0
    v_accvgpr_read_b32 v24, a240
    v_mfma_f32_16x16x32_bf16 v[40:43], a[200:203], a[104:107], v[40:43]
    v_accvgpr_read_b32 v25, a241
    v_pk_mul_f32 v[64:65], v[32:33], v[64:65]
    v_pk_mul_f32 v[66:67], v[34:35], v[66:67]
    v_pk_mul_f32 v[32:33], v[32:33], v[24:25] op_sel:[0,0] op_sel_hi:[1,0]
    v_pk_mul_f32 v[34:35], v[34:35], v[24:25] op_sel:[0,0] op_sel_hi:[1,0]
    v_pk_mul_f32 v[128:129], v[96:97], v[128:129]
    v_pk_mul_f32 v[130:131], v[98:99], v[130:131]
    v_pk_mul_f32 v[96:97], v[96:97], v[24:25] op_sel:[0,0] op_sel_hi:[1,0]
    v_pk_mul_f32 v[98:99], v[98:99], v[24:25] op_sel:[0,0] op_sel_hi:[1,0]
    v_exp_f32 v32, v32
    v_exp_f32 v33, v33
    v_mfma_f32_16x16x32_bf16 v[72:75], a[204:207], a[104:107], v[72:75]
    v_exp_f32 v34, v34
    v_exp_f32 v35, v35
    v_exp_f32 v96, v96
    v_mfma_f32_16x16x32_bf16 v[104:107], a[208:211], a[104:107], v[104:107]
    s_add_u32 m0, s70, 65536
    s_lshr_b32 s59, 0x3c393734, s72
    s_and_b32 s59, s59, 255
    s_lshl_b32 s59, s59, 16
    buffer_load_dwordx4 v13, s[16:19], s59 offen offset:0 lds
    v_exp_f32 v97, v97
    v_exp_f32 v98, v98
    v_exp_f32 v99, v99
    v_mfma_f32_16x16x32_bf16 v[136:139], a[212:215], a[104:107], v[136:139]
    v_pk_fma_f32 v[32:33], v[32:33], v[24:25], v[24:25] op_sel:[0,1,1] op_sel_hi:[1,1,1]
    v_pk_fma_f32 v[34:35], v[34:35], v[24:25], v[24:25] op_sel:[0,1,1] op_sel_hi:[1,1,1]
    v_pk_fma_f32 v[96:97], v[96:97], v[24:25], v[24:25] op_sel:[0,1,1] op_sel_hi:[1,1,1]
    v_pk_fma_f32 v[98:99], v[98:99], v[24:25], v[24:25] op_sel:[0,1,1] op_sel_hi:[1,1,1]
    v_rcp_f32 v32, v32
    v_rcp_f32 v33, v33
    v_mfma_f32_16x16x32_bf16 v[44:47], a[200:203], a[108:111], v[44:47]
    v_rcp_f32 v34, v34
    v_rcp_f32 v35, v35
    v_rcp_f32 v96, v96
    v_mfma_f32_16x16x32_bf16 v[76:79], a[204:207], a[108:111], v[76:79]
    buffer_load_dwordx4 v14, s[16:19], s59 offen offset:1024 lds
    v_rcp_f32 v97, v97
    v_rcp_f32 v98, v98
    v_rcp_f32 v99, v99
    v_mfma_f32_16x16x32_bf16 v[108:111], a[208:211], a[108:111], v[108:111]
    v_pk_mul_f32 v[64:65], v[64:65], v[32:33]
    v_pk_mul_f32 v[66:67], v[66:67], v[34:35]
    v_pk_mul_f32 v[128:129], v[128:129], v[96:97]
    v_pk_mul_f32 v[130:131], v[130:131], v[98:99]
    v_cvt_pk_bf16_f32 v32, v64, v65
    v_cvt_pk_bf16_f32 v33, v66, v67
    v_mfma_f32_16x16x32_bf16 v[140:143], a[212:215], a[108:111], v[140:143]
    v_cvt_pk_bf16_f32 v34, v128, v129
    v_cvt_pk_bf16_f32 v35, v130, v131
    buffer_store_dwordx4 v[32:35], v12, s[32:35], s61 offen offset:0 sc1
    v_accvgpr_read_b32 v24, a242
    v_mfma_f32_16x16x32_bf16 v[48:51], a[200:203], a[112:115], v[48:51]
    buffer_load_dwordx4 v15, s[16:19], s59 offen offset:2048 lds
    v_accvgpr_read_b32 v25, a243
    v_pk_mul_f32 v[68:69], v[36:37], v[68:69]
    v_pk_mul_f32 v[70:71], v[38:39], v[70:71]
    v_pk_mul_f32 v[36:37], v[36:37], v[24:25] op_sel:[0,0] op_sel_hi:[1,0]
    v_pk_mul_f32 v[38:39], v[38:39], v[24:25] op_sel:[0,0] op_sel_hi:[1,0]
    v_pk_mul_f32 v[132:133], v[100:101], v[132:133]
    v_pk_mul_f32 v[134:135], v[102:103], v[134:135]
    v_pk_mul_f32 v[100:101], v[100:101], v[24:25] op_sel:[0,0] op_sel_hi:[1,0]
    v_pk_mul_f32 v[102:103], v[102:103], v[24:25] op_sel:[0,0] op_sel_hi:[1,0]
    v_exp_f32 v36, v36
    v_exp_f32 v37, v37
    v_mfma_f32_16x16x32_bf16 v[80:83], a[204:207], a[112:115], v[80:83]
    v_exp_f32 v38, v38
    v_exp_f32 v39, v39
    v_exp_f32 v100, v100
    v_mfma_f32_16x16x32_bf16 v[112:115], a[208:211], a[112:115], v[112:115]
    v_exp_f32 v101, v101
    v_exp_f32 v102, v102
    v_exp_f32 v103, v103
    v_mfma_f32_16x16x32_bf16 v[144:147], a[212:215], a[112:115], v[144:147]
    buffer_load_dwordx4 v16, s[16:19], s59 offen offset:3072 lds
    v_pk_fma_f32 v[36:37], v[36:37], v[24:25], v[24:25] op_sel:[0,1,1] op_sel_hi:[1,1,1]
    v_pk_fma_f32 v[38:39], v[38:39], v[24:25], v[24:25] op_sel:[0,1,1] op_sel_hi:[1,1,1]
    v_pk_fma_f32 v[100:101], v[100:101], v[24:25], v[24:25] op_sel:[0,1,1] op_sel_hi:[1,1,1]
    v_pk_fma_f32 v[102:103], v[102:103], v[24:25], v[24:25] op_sel:[0,1,1] op_sel_hi:[1,1,1]
    v_rcp_f32 v36, v36
    v_rcp_f32 v37, v37
    v_mfma_f32_16x16x32_bf16 v[52:55], a[200:203], a[116:119], v[52:55]
    v_rcp_f32 v38, v38
    v_rcp_f32 v39, v39
    v_rcp_f32 v100, v100
    v_mfma_f32_16x16x32_bf16 v[84:87], a[204:207], a[116:119], v[84:87]
    v_rcp_f32 v101, v101
    v_rcp_f32 v102, v102
    v_rcp_f32 v103, v103
    v_mfma_f32_16x16x32_bf16 v[116:119], a[208:211], a[116:119], v[116:119]
    s_add_u32 m0, s70, 69632
    s_add_u32 s59, s59, 32768
    buffer_load_dwordx4 v13, s[16:19], s59 offen offset:0 lds
    v_pk_mul_f32 v[68:69], v[68:69], v[36:37]
    v_pk_mul_f32 v[70:71], v[70:71], v[38:39]
    v_pk_mul_f32 v[132:133], v[132:133], v[100:101]
    v_pk_mul_f32 v[134:135], v[134:135], v[102:103]
    v_cvt_pk_bf16_f32 v36, v68, v69
    v_cvt_pk_bf16_f32 v37, v70, v71
    v_mfma_f32_16x16x32_bf16 v[148:151], a[212:215], a[116:119], v[148:151]
    v_cvt_pk_bf16_f32 v38, v132, v133
    v_cvt_pk_bf16_f32 v39, v134, v135
    buffer_store_dwordx4 v[36:39], v12, s[32:35], s61 offen offset:1024 sc1
    v_accvgpr_read_b32 v24, a244
    v_mfma_f32_16x16x32_bf16 v[56:59], a[200:203], a[120:123], v[56:59]
    v_accvgpr_read_b32 v25, a245
    v_pk_mul_f32 v[72:73], v[40:41], v[72:73]
    v_pk_mul_f32 v[74:75], v[42:43], v[74:75]
    v_pk_mul_f32 v[40:41], v[40:41], v[24:25] op_sel:[0,0] op_sel_hi:[1,0]
    v_pk_mul_f32 v[42:43], v[42:43], v[24:25] op_sel:[0,0] op_sel_hi:[1,0]
    v_pk_mul_f32 v[136:137], v[104:105], v[136:137]
    v_pk_mul_f32 v[138:139], v[106:107], v[138:139]
    v_pk_mul_f32 v[104:105], v[104:105], v[24:25] op_sel:[0,0] op_sel_hi:[1,0]
    v_pk_mul_f32 v[106:107], v[106:107], v[24:25] op_sel:[0,0] op_sel_hi:[1,0]
    v_exp_f32 v40, v40
    v_exp_f32 v41, v41
    v_mfma_f32_16x16x32_bf16 v[88:91], a[204:207], a[120:123], v[88:91]
    buffer_load_dwordx4 v14, s[16:19], s59 offen offset:1024 lds
    v_exp_f32 v42, v42
    v_exp_f32 v43, v43
    v_exp_f32 v104, v104
    v_mfma_f32_16x16x32_bf16 v[120:123], a[208:211], a[120:123], v[120:123]
    v_exp_f32 v105, v105
    v_exp_f32 v106, v106
    v_exp_f32 v107, v107
    v_mfma_f32_16x16x32_bf16 v[152:155], a[212:215], a[120:123], v[152:155]
    v_pk_fma_f32 v[40:41], v[40:41], v[24:25], v[24:25] op_sel:[0,1,1] op_sel_hi:[1,1,1]
    v_pk_fma_f32 v[42:43], v[42:43], v[24:25], v[24:25] op_sel:[0,1,1] op_sel_hi:[1,1,1]
    v_pk_fma_f32 v[104:105], v[104:105], v[24:25], v[24:25] op_sel:[0,1,1] op_sel_hi:[1,1,1]
    v_pk_fma_f32 v[106:107], v[106:107], v[24:25], v[24:25] op_sel:[0,1,1] op_sel_hi:[1,1,1]
    v_rcp_f32 v40, v40
    v_rcp_f32 v41, v41
    v_mfma_f32_16x16x32_bf16 v[60:63], a[200:203], a[124:127], v[60:63]
    buffer_load_dwordx4 v15, s[16:19], s59 offen offset:2048 lds
    v_rcp_f32 v42, v42
    v_rcp_f32 v43, v43
    v_rcp_f32 v104, v104
    v_mfma_f32_16x16x32_bf16 v[92:95], a[204:207], a[124:127], v[92:95]
    v_rcp_f32 v105, v105
    v_rcp_f32 v106, v106
    v_rcp_f32 v107, v107
    v_mfma_f32_16x16x32_bf16 v[124:127], a[208:211], a[124:127], v[124:127]
    v_pk_mul_f32 v[72:73], v[72:73], v[40:41]
    v_pk_mul_f32 v[74:75], v[74:75], v[42:43]
    v_pk_mul_f32 v[136:137], v[136:137], v[104:105]
    v_pk_mul_f32 v[138:139], v[138:139], v[106:107]
    v_cvt_pk_bf16_f32 v40, v72, v73
    v_cvt_pk_bf16_f32 v41, v74, v75
    v_mfma_f32_16x16x32_bf16 v[156:159], a[212:215], a[124:127], v[156:159]
    buffer_load_dwordx4 v16, s[16:19], s59 offen offset:3072 lds
    v_cvt_pk_bf16_f32 v42, v136, v137
    v_cvt_pk_bf16_f32 v43, v138, v139
    buffer_store_dwordx4 v[40:43], v12, s[32:35], s61 offen offset:2048 sc1
    v_accvgpr_read_b32 v24, a246
    v_mfma_f32_16x16x32_bf16 a[32:35], a[232:235], a[96:99], a[32:35]
    v_accvgpr_read_b32 v25, a247
    v_pk_mul_f32 v[76:77], v[44:45], v[76:77]
    v_pk_mul_f32 v[78:79], v[46:47], v[78:79]
    v_pk_mul_f32 v[44:45], v[44:45], v[24:25] op_sel:[0,0] op_sel_hi:[1,0]
    v_pk_mul_f32 v[46:47], v[46:47], v[24:25] op_sel:[0,0] op_sel_hi:[1,0]
    v_pk_mul_f32 v[140:141], v[108:109], v[140:141]
    v_pk_mul_f32 v[142:143], v[110:111], v[142:143]
    v_pk_mul_f32 v[108:109], v[108:109], v[24:25] op_sel:[0,0] op_sel_hi:[1,0]
    v_pk_mul_f32 v[110:111], v[110:111], v[24:25] op_sel:[0,0] op_sel_hi:[1,0]
    v_exp_f32 v44, v44
    v_exp_f32 v45, v45
    v_mfma_f32_16x16x32_bf16 a[64:67], a[236:239], a[96:99], a[64:67]
    v_exp_f32 v46, v46
    v_exp_f32 v47, v47
    v_exp_f32 v108, v108
    v_mfma_f32_16x16x32_bf16 a[36:39], a[232:235], a[100:103], a[36:39]
    s_add_u32 m0, s70, 98304
    s_lshr_b32 s59, 0x4643413e, s72
    s_and_b32 s59, s59, 255
    s_lshl_b32 s59, s59, 16
    buffer_load_dwordx4 v13, s[16:19], s59 offen offset:0 lds
    v_exp_f32 v109, v109
    v_exp_f32 v110, v110
    v_exp_f32 v111, v111
    v_mfma_f32_16x16x32_bf16 a[68:71], a[236:239], a[100:103], a[68:71]
    v_pk_fma_f32 v[44:45], v[44:45], v[24:25], v[24:25] op_sel:[0,1,1] op_sel_hi:[1,1,1]
    v_pk_fma_f32 v[46:47], v[46:47], v[24:25], v[24:25] op_sel:[0,1,1] op_sel_hi:[1,1,1]
    v_pk_fma_f32 v[108:109], v[108:109], v[24:25], v[24:25] op_sel:[0,1,1] op_sel_hi:[1,1,1]
    v_pk_fma_f32 v[110:111], v[110:111], v[24:25], v[24:25] op_sel:[0,1,1] op_sel_hi:[1,1,1]
    v_rcp_f32 v44, v44
    v_rcp_f32 v45, v45
    v_mfma_f32_16x16x32_bf16 a[40:43], a[232:235], a[104:107], a[40:43]
    v_rcp_f32 v46, v46
    v_rcp_f32 v47, v47
    v_rcp_f32 v108, v108
    v_mfma_f32_16x16x32_bf16 a[72:75], a[236:239], a[104:107], a[72:75]
    buffer_load_dwordx4 v14, s[16:19], s59 offen offset:1024 lds
    v_rcp_f32 v109, v109
    v_rcp_f32 v110, v110
    v_rcp_f32 v111, v111
    v_mfma_f32_16x16x32_bf16 a[44:47], a[232:235], a[108:111], a[44:47]
    v_pk_mul_f32 v[76:77], v[76:77], v[44:45]
    v_pk_mul_f32 v[78:79], v[78:79], v[46:47]
    v_pk_mul_f32 v[140:141], v[140:141], v[108:109]
    v_pk_mul_f32 v[142:143], v[142:143], v[110:111]
    v_cvt_pk_bf16_f32 v44, v76, v77
    v_cvt_pk_bf16_f32 v45, v78, v79
    v_mfma_f32_16x16x32_bf16 a[76:79], a[236:239], a[108:111], a[76:79]
    v_cvt_pk_bf16_f32 v46, v140, v141
    v_cvt_pk_bf16_f32 v47, v142, v143
    buffer_store_dwordx4 v[44:47], v12, s[32:35], s61 offen offset:3072 sc1
    v_accvgpr_read_b32 v24, a248
    v_mfma_f32_16x16x32_bf16 a[48:51], a[232:235], a[112:115], a[48:51]
    buffer_load_dwordx4 v15, s[16:19], s59 offen offset:2048 lds
    v_accvgpr_read_b32 v25, a249
    v_pk_mul_f32 v[80:81], v[48:49], v[80:81]
    v_pk_mul_f32 v[82:83], v[50:51], v[82:83]
    v_pk_mul_f32 v[48:49], v[48:49], v[24:25] op_sel:[0,0] op_sel_hi:[1,0]
    v_pk_mul_f32 v[50:51], v[50:51], v[24:25] op_sel:[0,0] op_sel_hi:[1,0]
    v_pk_mul_f32 v[144:145], v[112:113], v[144:145]
    v_pk_mul_f32 v[146:147], v[114:115], v[146:147]
    v_pk_mul_f32 v[112:113], v[112:113], v[24:25] op_sel:[0,0] op_sel_hi:[1,0]
    v_pk_mul_f32 v[114:115], v[114:115], v[24:25] op_sel:[0,0] op_sel_hi:[1,0]
    v_exp_f32 v48, v48
    v_exp_f32 v49, v49
    v_mfma_f32_16x16x32_bf16 a[80:83], a[236:239], a[112:115], a[80:83]
    v_exp_f32 v50, v50
    v_exp_f32 v51, v51
    v_exp_f32 v112, v112
    v_mfma_f32_16x16x32_bf16 a[52:55], a[232:235], a[116:119], a[52:55]
    v_exp_f32 v113, v113
    v_exp_f32 v114, v114
    v_exp_f32 v115, v115
    v_mfma_f32_16x16x32_bf16 a[84:87], a[236:239], a[116:119], a[84:87]
    buffer_load_dwordx4 v16, s[16:19], s59 offen offset:3072 lds
    v_pk_fma_f32 v[48:49], v[48:49], v[24:25], v[24:25] op_sel:[0,1,1] op_sel_hi:[1,1,1]
    v_pk_fma_f32 v[50:51], v[50:51], v[24:25], v[24:25] op_sel:[0,1,1] op_sel_hi:[1,1,1]
    v_pk_fma_f32 v[112:113], v[112:113], v[24:25], v[24:25] op_sel:[0,1,1] op_sel_hi:[1,1,1]
    v_pk_fma_f32 v[114:115], v[114:115], v[24:25], v[24:25] op_sel:[0,1,1] op_sel_hi:[1,1,1]
    v_rcp_f32 v48, v48
    v_rcp_f32 v49, v49
    v_mfma_f32_16x16x32_bf16 a[56:59], a[232:235], a[120:123], a[56:59]
    v_rcp_f32 v50, v50
    v_rcp_f32 v51, v51
    v_rcp_f32 v112, v112
    v_mfma_f32_16x16x32_bf16 a[88:91], a[236:239], a[120:123], a[88:91]
    v_rcp_f32 v113, v113
    v_rcp_f32 v114, v114
    v_rcp_f32 v115, v115
    v_mfma_f32_16x16x32_bf16 a[60:63], a[232:235], a[124:127], a[60:63]
    s_add_u32 m0, s70, 102400
    s_add_u32 s59, s59, 32768
    buffer_load_dwordx4 v13, s[16:19], s59 offen offset:0 lds
    v_pk_mul_f32 v[80:81], v[80:81], v[48:49]
    v_pk_mul_f32 v[82:83], v[82:83], v[50:51]
    v_pk_mul_f32 v[144:145], v[144:145], v[112:113]
    v_pk_mul_f32 v[146:147], v[146:147], v[114:115]
    v_cvt_pk_bf16_f32 v48, v80, v81
    v_cvt_pk_bf16_f32 v49, v82, v83
    v_mfma_f32_16x16x32_bf16 a[92:95], a[236:239], a[124:127], a[92:95]
    v_cvt_pk_bf16_f32 v50, v144, v145
    v_cvt_pk_bf16_f32 v51, v146, v147
    buffer_store_dwordx4 v[48:51], v23, s[32:35], s61 offen offset:0 sc1
    v_accvgpr_read_b32 v24, a250
    v_mfma_f32_16x16x32_bf16 v[160:163], a[216:219], a[96:99], v[160:163]
    v_accvgpr_read_b32 v25, a251
    v_pk_mul_f32 v[84:85], v[52:53], v[84:85]
    v_pk_mul_f32 v[86:87], v[54:55], v[86:87]
    v_pk_mul_f32 v[52:53], v[52:53], v[24:25] op_sel:[0,0] op_sel_hi:[1,0]
    v_pk_mul_f32 v[54:55], v[54:55], v[24:25] op_sel:[0,0] op_sel_hi:[1,0]
    v_pk_mul_f32 v[148:149], v[116:117], v[148:149]
    v_pk_mul_f32 v[150:151], v[118:119], v[150:151]
    v_pk_mul_f32 v[116:117], v[116:117], v[24:25] op_sel:[0,0] op_sel_hi:[1,0]
    v_pk_mul_f32 v[118:119], v[118:119], v[24:25] op_sel:[0,0] op_sel_hi:[1,0]
    v_exp_f32 v52, v52
    v_exp_f32 v53, v53
    v_mfma_f32_16x16x32_bf16 v[192:195], a[220:223], a[96:99], v[192:195]
    buffer_load_dwordx4 v14, s[16:19], s59 offen offset:1024 lds
    v_exp_f32 v54, v54
    v_exp_f32 v55, v55
    v_exp_f32 v116, v116
    v_mfma_f32_16x16x32_bf16 v[224:227], a[224:227], a[96:99], v[224:227]
    v_exp_f32 v117, v117
    v_exp_f32 v118, v118
    v_exp_f32 v119, v119
    v_mfma_f32_16x16x32_bf16 a[0:3], a[228:231], a[96:99], a[0:3]
    v_pk_fma_f32 v[52:53], v[52:53], v[24:25], v[24:25] op_sel:[0,1,1] op_sel_hi:[1,1,1]
    v_pk_fma_f32 v[54:55], v[54:55], v[24:25], v[24:25] op_sel:[0,1,1] op_sel_hi:[1,1,1]
    v_pk_fma_f32 v[116:117], v[116:117], v[24:25], v[24:25] op_sel:[0,1,1] op_sel_hi:[1,1,1]
    v_pk_fma_f32 v[118:119], v[118:119], v[24:25], v[24:25] op_sel:[0,1,1] op_sel_hi:[1,1,1]
    v_rcp_f32 v52, v52
    v_rcp_f32 v53, v53
    v_mfma_f32_16x16x32_bf16 v[164:167], a[216:219], a[100:103], v[164:167]
    buffer_load_dwordx4 v15, s[16:19], s59 offen offset:2048 lds
    v_rcp_f32 v54, v54
    v_rcp_f32 v55, v55
    v_rcp_f32 v116, v116
    v_mfma_f32_16x16x32_bf16 v[196:199], a[220:223], a[100:103], v[196:199]
    v_rcp_f32 v117, v117
    v_rcp_f32 v118, v118
    v_rcp_f32 v119, v119
    v_mfma_f32_16x16x32_bf16 v[228:231], a[224:227], a[100:103], v[228:231]
    v_pk_mul_f32 v[84:85], v[84:85], v[52:53]
    v_pk_mul_f32 v[86:87], v[86:87], v[54:55]
    v_pk_mul_f32 v[148:149], v[148:149], v[116:117]
    v_pk_mul_f32 v[150:151], v[150:151], v[118:119]
    v_cvt_pk_bf16_f32 v52, v84, v85
    v_cvt_pk_bf16_f32 v53, v86, v87
    v_mfma_f32_16x16x32_bf16 a[4:7], a[228:231], a[100:103], a[4:7]
    buffer_load_dwordx4 v16, s[16:19], s59 offen offset:3072 lds
    v_cvt_pk_bf16_f32 v54, v148, v149
    v_cvt_pk_bf16_f32 v55, v150, v151
    buffer_store_dwordx4 v[52:55], v23, s[32:35], s61 offen offset:1024 sc1
    v_accvgpr_read_b32 v24, a252
    v_mfma_f32_16x16x32_bf16 v[168:171], a[216:219], a[104:107], v[168:171]
    v_accvgpr_read_b32 v25, a253
    v_pk_mul_f32 v[88:89], v[56:57], v[88:89]
    v_pk_mul_f32 v[90:91], v[58:59], v[90:91]
    v_pk_mul_f32 v[56:57], v[56:57], v[24:25] op_sel:[0,0] op_sel_hi:[1,0]
    v_pk_mul_f32 v[58:59], v[58:59], v[24:25] op_sel:[0,0] op_sel_hi:[1,0]
    v_pk_mul_f32 v[152:153], v[120:121], v[152:153]
    v_pk_mul_f32 v[154:155], v[122:123], v[154:155]
    v_pk_mul_f32 v[120:121], v[120:121], v[24:25] op_sel:[0,0] op_sel_hi:[1,0]
    v_pk_mul_f32 v[122:123], v[122:123], v[24:25] op_sel:[0,0] op_sel_hi:[1,0]
    v_exp_f32 v56, v56
    v_exp_f32 v57, v57
    v_mfma_f32_16x16x32_bf16 v[200:203], a[220:223], a[104:107], v[200:203]
    v_exp_f32 v58, v58
    v_exp_f32 v59, v59
    v_exp_f32 v120, v120
    v_mfma_f32_16x16x32_bf16 v[232:235], a[224:227], a[104:107], v[232:235]
    v_exp_f32 v121, v121
    v_exp_f32 v122, v122
    v_exp_f32 v123, v123
    v_mfma_f32_16x16x32_bf16 a[8:11], a[228:231], a[104:107], a[8:11]
    v_pk_fma_f32 v[56:57], v[56:57], v[24:25], v[24:25] op_sel:[0,1,1] op_sel_hi:[1,1,1]
    v_pk_fma_f32 v[58:59], v[58:59], v[24:25], v[24:25] op_sel:[0,1,1] op_sel_hi:[1,1,1]
    v_pk_fma_f32 v[120:121], v[120:121], v[24:25], v[24:25] op_sel:[0,1,1] op_sel_hi:[1,1,1]
    v_pk_fma_f32 v[122:123], v[122:123], v[24:25], v[24:25] op_sel:[0,1,1] op_sel_hi:[1,1,1]
    v_rcp_f32 v56, v56
    v_rcp_f32 v57, v57
    v_mfma_f32_16x16x32_bf16 v[172:175], a[216:219], a[108:111], v[172:175]
    v_rcp_f32 v58, v58
    v_rcp_f32 v59, v59
    v_rcp_f32 v120, v120
    v_mfma_f32_16x16x32_bf16 v[204:207], a[220:223], a[108:111], v[204:207]
    v_rcp_f32 v121, v121
    v_rcp_f32 v122, v122
    v_rcp_f32 v123, v123
    v_mfma_f32_16x16x32_bf16 v[236:239], a[224:227], a[108:111], v[236:239]
    v_pk_mul_f32 v[88:89], v[88:89], v[56:57]
    v_pk_mul_f32 v[90:91], v[90:91], v[58:59]
    v_pk_mul_f32 v[152:153], v[152:153], v[120:121]
    v_pk_mul_f32 v[154:155], v[154:155], v[122:123]
    v_cvt_pk_bf16_f32 v56, v88, v89
    v_cvt_pk_bf16_f32 v57, v90, v91
    v_mfma_f32_16x16x32_bf16 a[12:15], a[228:231], a[108:111], a[12:15]
    v_cvt_pk_bf16_f32 v58, v152, v153
    v_cvt_pk_bf16_f32 v59, v154, v155
    buffer_store_dwordx4 v[56:59], v23, s[32:35], s61 offen offset:2048 sc1
    v_accvgpr_read_b32 v24, a254
    v_mfma_f32_16x16x32_bf16 v[176:179], a[216:219], a[112:115], v[176:179]
    v_accvgpr_read_b32 v25, a255
    v_pk_mul_f32 v[92:93], v[60:61], v[92:93]
    v_pk_mul_f32 v[94:95], v[62:63], v[94:95]
    v_pk_mul_f32 v[60:61], v[60:61], v[24:25] op_sel:[0,0] op_sel_hi:[1,0]
    v_pk_mul_f32 v[62:63], v[62:63], v[24:25] op_sel:[0,0] op_sel_hi:[1,0]
    v_pk_mul_f32 v[156:157], v[124:125], v[156:157]
    v_pk_mul_f32 v[158:159], v[126:127], v[158:159]
    v_pk_mul_f32 v[124:125], v[124:125], v[24:25] op_sel:[0,0] op_sel_hi:[1,0]
    v_pk_mul_f32 v[126:127], v[126:127], v[24:25] op_sel:[0,0] op_sel_hi:[1,0]
    v_exp_f32 v60, v60
    v_exp_f32 v61, v61
    v_mfma_f32_16x16x32_bf16 v[208:211], a[220:223], a[112:115], v[208:211]
    v_exp_f32 v62, v62
    v_exp_f32 v63, v63
    v_exp_f32 v124, v124
    v_mfma_f32_16x16x32_bf16 v[240:243], a[224:227], a[112:115], v[240:243]
    v_exp_f32 v125, v125
    v_exp_f32 v126, v126
    v_exp_f32 v127, v127
    v_mfma_f32_16x16x32_bf16 a[16:19], a[228:231], a[112:115], a[16:19]
    v_pk_fma_f32 v[60:61], v[60:61], v[24:25], v[24:25] op_sel:[0,1,1] op_sel_hi:[1,1,1]
    v_pk_fma_f32 v[62:63], v[62:63], v[24:25], v[24:25] op_sel:[0,1,1] op_sel_hi:[1,1,1]
    v_pk_fma_f32 v[124:125], v[124:125], v[24:25], v[24:25] op_sel:[0,1,1] op_sel_hi:[1,1,1]
    v_pk_fma_f32 v[126:127], v[126:127], v[24:25], v[24:25] op_sel:[0,1,1] op_sel_hi:[1,1,1]
    v_rcp_f32 v60, v60
    v_rcp_f32 v61, v61
    v_mfma_f32_16x16x32_bf16 v[180:183], a[216:219], a[116:119], v[180:183]
    v_rcp_f32 v62, v62
    v_rcp_f32 v63, v63
    v_rcp_f32 v124, v124
    v_mfma_f32_16x16x32_bf16 v[212:215], a[220:223], a[116:119], v[212:215]
    v_rcp_f32 v125, v125
    v_rcp_f32 v126, v126
    v_rcp_f32 v127, v127
    v_mfma_f32_16x16x32_bf16 v[244:247], a[224:227], a[116:119], v[244:247]
    v_pk_mul_f32 v[92:93], v[92:93], v[60:61]
    v_pk_mul_f32 v[94:95], v[94:95], v[62:63]
    v_pk_mul_f32 v[156:157], v[156:157], v[124:125]
    v_pk_mul_f32 v[158:159], v[158:159], v[126:127]
    v_cvt_pk_bf16_f32 v60, v92, v93
    v_cvt_pk_bf16_f32 v61, v94, v95
    v_mfma_f32_16x16x32_bf16 a[20:23], a[228:231], a[116:119], a[20:23]
    v_cvt_pk_bf16_f32 v62, v156, v157
    v_cvt_pk_bf16_f32 v63, v158, v159
    buffer_store_dwordx4 v[60:63], v23, s[32:35], s61 offen offset:3072 sc1
    v_accvgpr_read_b32 v96, a32
    v_mfma_f32_16x16x32_bf16 v[184:187], a[216:219], a[120:123], v[184:187]
    v_accvgpr_read_b32 v97, a33
    v_accvgpr_read_b32 v98, a34
    v_accvgpr_read_b32 v99, a35
    v_mfma_f32_16x16x32_bf16 v[216:219], a[220:223], a[120:123], v[216:219]
    v_accvgpr_read_b32 v128, a64
    v_accvgpr_read_b32 v129, a65
    v_accvgpr_read_b32 v130, a66
    v_mfma_f32_16x16x32_bf16 v[248:251], a[224:227], a[120:123], v[248:251]
    v_accvgpr_read_b32 v131, a67
    v_accvgpr_read_b32 v24, a240
    v_accvgpr_read_b32 v25, a241
    v_mfma_f32_16x16x32_bf16 a[24:27], a[228:231], a[120:123], a[24:27]
    v_accvgpr_read_b32 v100, a36
    v_accvgpr_read_b32 v101, a37
    v_accvgpr_read_b32 v102, a38
    v_mfma_f32_16x16x32_bf16 v[188:191], a[216:219], a[124:127], v[188:191]
    v_accvgpr_read_b32 v103, a39
    v_accvgpr_read_b32 v132, a68
    v_accvgpr_read_b32 v133, a69
    v_mfma_f32_16x16x32_bf16 v[220:223], a[220:223], a[124:127], v[220:223]
    v_accvgpr_read_b32 v134, a70
    v_accvgpr_read_b32 v135, a71
    v_accvgpr_read_b32 v26, a242
    v_mfma_f32_16x16x32_bf16 v[252:255], a[224:227], a[124:127], v[252:255]
    v_accvgpr_read_b32 v27, a243
    v_pk_mul_f32 v[128:129], v[96:97], v[128:129]
    v_pk_mul_f32 v[130:131], v[98:99], v[130:131]
    v_pk_mul_f32 v[96:97], v[96:97], v[24:25] op_sel:[0,0] op_sel_hi:[1,0]
    v_pk_mul_f32 v[98:99], v[98:99], v[24:25] op_sel:[0,0] op_sel_hi:[1,0]
    v_pk_mul_f32 v[132:133], v[100:101], v[132:133]
    v_pk_mul_f32 v[134:135], v[102:103], v[134:135]
    v_pk_mul_f32 v[100:101], v[100:101], v[26:27] op_sel:[0,0] op_sel_hi:[1,0]
    v_pk_mul_f32 v[102:103], v[102:103], v[26:27] op_sel:[0,0] op_sel_hi:[1,0]
    v_exp_f32 v96, v96
    v_exp_f32 v97, v97
    v_mfma_f32_16x16x32_bf16 a[28:31], a[228:231], a[124:127], a[28:31]
    v_exp_f32 v98, v98
    v_exp_f32 v99, v99
    v_exp_f32 v100, v100
    v_exp_f32 v101, v101
    v_exp_f32 v102, v102
    v_exp_f32 v103, v103
    v_pk_fma_f32 v[96:97], v[96:97], v[24:25], v[24:25] op_sel:[0,1,1] op_sel_hi:[1,1,1]
    v_pk_fma_f32 v[98:99], v[98:99], v[24:25], v[24:25] op_sel:[0,1,1] op_sel_hi:[1,1,1]
    v_pk_fma_f32 v[100:101], v[100:101], v[26:27], v[26:27] op_sel:[0,1,1] op_sel_hi:[1,1,1]
    v_pk_fma_f32 v[102:103], v[102:103], v[26:27], v[26:27] op_sel:[0,1,1] op_sel_hi:[1,1,1]
    v_rcp_f32 v96, v96
    v_rcp_f32 v97, v97
    v_rcp_f32 v98, v98
    v_rcp_f32 v99, v99
    v_rcp_f32 v100, v100
    v_rcp_f32 v101, v101
    v_rcp_f32 v102, v102
    v_rcp_f32 v103, v103
    v_pk_mul_f32 v[128:129], v[128:129], v[96:97]
    v_pk_mul_f32 v[130:131], v[130:131], v[98:99]
    v_pk_mul_f32 v[132:133], v[132:133], v[100:101]
    v_pk_mul_f32 v[134:135], v[134:135], v[102:103]
    v_cvt_pk_bf16_f32 v64, v128, v129
    v_cvt_pk_bf16_f32 v65, v130, v131
    v_cvt_pk_bf16_f32 v66, v132, v133
    v_cvt_pk_bf16_f32 v67, v134, v135
    v_accvgpr_read_b32 v104, a40
    v_accvgpr_read_b32 v105, a41
    v_accvgpr_read_b32 v106, a42
    v_accvgpr_read_b32 v107, a43
    v_accvgpr_read_b32 v136, a72
    v_accvgpr_read_b32 v137, a73
    v_accvgpr_read_b32 v138, a74
    v_accvgpr_read_b32 v139, a75
    v_accvgpr_read_b32 v24, a244
    v_accvgpr_read_b32 v25, a245
    v_accvgpr_read_b32 v108, a44
    v_accvgpr_read_b32 v109, a45
    v_accvgpr_read_b32 v110, a46
    v_accvgpr_read_b32 v111, a47
    v_accvgpr_read_b32 v140, a76
    v_accvgpr_read_b32 v141, a77
    v_accvgpr_read_b32 v142, a78
    v_accvgpr_read_b32 v143, a79
    v_accvgpr_read_b32 v26, a246
    v_accvgpr_read_b32 v27, a247
    v_pk_mul_f32 v[136:137], v[104:105], v[136:137]
    v_pk_mul_f32 v[138:139], v[106:107], v[138:139]
    v_pk_mul_f32 v[104:105], v[104:105], v[24:25] op_sel:[0,0] op_sel_hi:[1,0]
    v_pk_mul_f32 v[106:107], v[106:107], v[24:25] op_sel:[0,0] op_sel_hi:[1,0]
    v_pk_mul_f32 v[140:141], v[108:109], v[140:141]
    v_pk_mul_f32 v[142:143], v[110:111], v[142:143]
    v_pk_mul_f32 v[108:109], v[108:109], v[26:27] op_sel:[0,0] op_sel_hi:[1,0]
    v_pk_mul_f32 v[110:111], v[110:111], v[26:27] op_sel:[0,0] op_sel_hi:[1,0]
    v_exp_f32 v104, v104
    v_exp_f32 v105, v105
    v_exp_f32 v106, v106
    v_exp_f32 v107, v107
    v_exp_f32 v108, v108
    v_exp_f32 v109, v109
    v_exp_f32 v110, v110
    v_exp_f32 v111, v111
    v_pk_fma_f32 v[104:105], v[104:105], v[24:25], v[24:25] op_sel:[0,1,1] op_sel_hi:[1,1,1]
    v_pk_fma_f32 v[106:107], v[106:107], v[24:25], v[24:25] op_sel:[0,1,1] op_sel_hi:[1,1,1]
    v_pk_fma_f32 v[108:109], v[108:109], v[26:27], v[26:27] op_sel:[0,1,1] op_sel_hi:[1,1,1]
    v_pk_fma_f32 v[110:111], v[110:111], v[26:27], v[26:27] op_sel:[0,1,1] op_sel_hi:[1,1,1]
    v_rcp_f32 v104, v104
    v_rcp_f32 v105, v105
    v_rcp_f32 v106, v106
    v_rcp_f32 v107, v107
    v_rcp_f32 v108, v108
    v_rcp_f32 v109, v109
    v_rcp_f32 v110, v110
    v_rcp_f32 v111, v111
    v_pk_mul_f32 v[136:137], v[136:137], v[104:105]
    v_pk_mul_f32 v[138:139], v[138:139], v[106:107]
    v_pk_mul_f32 v[140:141], v[140:141], v[108:109]
    v_pk_mul_f32 v[142:143], v[142:143], v[110:111]
    v_cvt_pk_bf16_f32 v68, v136, v137
    v_cvt_pk_bf16_f32 v69, v138, v139
    v_cvt_pk_bf16_f32 v70, v140, v141
    v_cvt_pk_bf16_f32 v71, v142, v143
    v_accvgpr_read_b32 v112, a48
    v_accvgpr_read_b32 v113, a49
    v_accvgpr_read_b32 v114, a50
    v_accvgpr_read_b32 v115, a51
    v_accvgpr_read_b32 v144, a80
    v_accvgpr_read_b32 v145, a81
    v_accvgpr_read_b32 v146, a82
    v_accvgpr_read_b32 v147, a83
    v_accvgpr_read_b32 v24, a248
    v_accvgpr_read_b32 v25, a249
    v_accvgpr_read_b32 v116, a52
    v_accvgpr_read_b32 v117, a53
    v_accvgpr_read_b32 v118, a54
    v_accvgpr_read_b32 v119, a55
    v_accvgpr_read_b32 v148, a84
    v_accvgpr_read_b32 v149, a85
    v_accvgpr_read_b32 v150, a86
    v_accvgpr_read_b32 v151, a87
    v_accvgpr_read_b32 v26, a250
    v_accvgpr_read_b32 v27, a251
    v_pk_mul_f32 v[144:145], v[112:113], v[144:145]
    v_pk_mul_f32 v[146:147], v[114:115], v[146:147]
    v_pk_mul_f32 v[112:113], v[112:113], v[24:25] op_sel:[0,0] op_sel_hi:[1,0]
    v_pk_mul_f32 v[114:115], v[114:115], v[24:25] op_sel:[0,0] op_sel_hi:[1,0]
    v_pk_mul_f32 v[148:149], v[116:117], v[148:149]
    v_pk_mul_f32 v[150:151], v[118:119], v[150:151]
    v_pk_mul_f32 v[116:117], v[116:117], v[26:27] op_sel:[0,0] op_sel_hi:[1,0]
    v_pk_mul_f32 v[118:119], v[118:119], v[26:27] op_sel:[0,0] op_sel_hi:[1,0]
    v_exp_f32 v112, v112
    v_exp_f32 v113, v113
    v_exp_f32 v114, v114
    v_exp_f32 v115, v115
    v_exp_f32 v116, v116
    v_exp_f32 v117, v117
    v_exp_f32 v118, v118
    v_exp_f32 v119, v119
    v_pk_fma_f32 v[112:113], v[112:113], v[24:25], v[24:25] op_sel:[0,1,1] op_sel_hi:[1,1,1]
    v_pk_fma_f32 v[114:115], v[114:115], v[24:25], v[24:25] op_sel:[0,1,1] op_sel_hi:[1,1,1]
    v_pk_fma_f32 v[116:117], v[116:117], v[26:27], v[26:27] op_sel:[0,1,1] op_sel_hi:[1,1,1]
    v_pk_fma_f32 v[118:119], v[118:119], v[26:27], v[26:27] op_sel:[0,1,1] op_sel_hi:[1,1,1]
    v_rcp_f32 v112, v112
    v_rcp_f32 v113, v113
    v_rcp_f32 v114, v114
    v_rcp_f32 v115, v115
    v_rcp_f32 v116, v116
    v_rcp_f32 v117, v117
    v_rcp_f32 v118, v118
    v_rcp_f32 v119, v119
    v_pk_mul_f32 v[144:145], v[144:145], v[112:113]
    v_pk_mul_f32 v[146:147], v[146:147], v[114:115]
    v_pk_mul_f32 v[148:149], v[148:149], v[116:117]
    v_pk_mul_f32 v[150:151], v[150:151], v[118:119]
    v_cvt_pk_bf16_f32 v72, v144, v145
    v_cvt_pk_bf16_f32 v73, v146, v147
    v_cvt_pk_bf16_f32 v74, v148, v149
    v_cvt_pk_bf16_f32 v75, v150, v151
    v_accvgpr_read_b32 v120, a56
    v_accvgpr_read_b32 v121, a57
    v_accvgpr_read_b32 v122, a58
    v_accvgpr_read_b32 v123, a59
    v_accvgpr_read_b32 v152, a88
    v_accvgpr_read_b32 v153, a89
    v_accvgpr_read_b32 v154, a90
    v_accvgpr_read_b32 v155, a91
    v_accvgpr_read_b32 v24, a252
    v_accvgpr_read_b32 v25, a253
    v_accvgpr_read_b32 v124, a60
    v_accvgpr_read_b32 v125, a61
    v_accvgpr_read_b32 v126, a62
    v_accvgpr_read_b32 v127, a63
    v_accvgpr_read_b32 v156, a92
    v_accvgpr_read_b32 v157, a93
    v_accvgpr_read_b32 v158, a94
    v_accvgpr_read_b32 v159, a95
    v_accvgpr_read_b32 v26, a254
    v_accvgpr_read_b32 v27, a255
    v_pk_mul_f32 v[152:153], v[120:121], v[152:153]
    v_pk_mul_f32 v[154:155], v[122:123], v[154:155]
    v_pk_mul_f32 v[120:121], v[120:121], v[24:25] op_sel:[0,0] op_sel_hi:[1,0]
    v_pk_mul_f32 v[122:123], v[122:123], v[24:25] op_sel:[0,0] op_sel_hi:[1,0]
    v_pk_mul_f32 v[156:157], v[124:125], v[156:157]
    v_pk_mul_f32 v[158:159], v[126:127], v[158:159]
    v_pk_mul_f32 v[124:125], v[124:125], v[26:27] op_sel:[0,0] op_sel_hi:[1,0]
    v_pk_mul_f32 v[126:127], v[126:127], v[26:27] op_sel:[0,0] op_sel_hi:[1,0]
    v_exp_f32 v120, v120
    v_exp_f32 v121, v121
    v_exp_f32 v122, v122
    v_exp_f32 v123, v123
    v_exp_f32 v124, v124
    v_exp_f32 v125, v125
    v_exp_f32 v126, v126
    v_exp_f32 v127, v127
    v_pk_fma_f32 v[120:121], v[120:121], v[24:25], v[24:25] op_sel:[0,1,1] op_sel_hi:[1,1,1]
    v_pk_fma_f32 v[122:123], v[122:123], v[24:25], v[24:25] op_sel:[0,1,1] op_sel_hi:[1,1,1]
    v_pk_fma_f32 v[124:125], v[124:125], v[26:27], v[26:27] op_sel:[0,1,1] op_sel_hi:[1,1,1]
    v_pk_fma_f32 v[126:127], v[126:127], v[26:27], v[26:27] op_sel:[0,1,1] op_sel_hi:[1,1,1]
    v_rcp_f32 v120, v120
    v_rcp_f32 v121, v121
    v_rcp_f32 v122, v122
    v_rcp_f32 v123, v123
    v_rcp_f32 v124, v124
    v_rcp_f32 v125, v125
    v_rcp_f32 v126, v126
    v_rcp_f32 v127, v127
    v_pk_mul_f32 v[152:153], v[152:153], v[120:121]
    v_pk_mul_f32 v[154:155], v[154:155], v[122:123]
    v_pk_mul_f32 v[156:157], v[156:157], v[124:125]
    v_pk_mul_f32 v[158:159], v[158:159], v[126:127]
    v_cvt_pk_bf16_f32 v76, v152, v153
    v_cvt_pk_bf16_f32 v77, v154, v155
    v_cvt_pk_bf16_f32 v78, v156, v157
    v_cvt_pk_bf16_f32 v79, v158, v159
    s_waitcnt vmcnt(0)
    s_add_u32 s48, s66, 0x1e3000
    buffer_store_dword v3, v31, s[44:47], s48 offen sc1
    v_cndmask_b32 v80, v72, v64, s[42:43]
    v_cndmask_b32 v81, v73, v65, s[42:43]
    v_cndmask_b32 v82, v74, v66, s[42:43]
    v_cndmask_b32 v83, v75, v67, s[42:43]
    v_cndmask_b32 v84, v76, v68, s[42:43]
    v_cndmask_b32 v85, v77, v69, s[42:43]
    v_cndmask_b32 v86, v78, v70, s[42:43]
    v_cndmask_b32 v87, v79, v71, s[42:43]
    v_cndmask_b32 v64, v64, v72, s[42:43]
    v_cndmask_b32 v65, v65, v73, s[42:43]
    v_cndmask_b32 v66, v66, v74, s[42:43]
    v_cndmask_b32 v67, v67, v75, s[42:43]
    v_cndmask_b32 v68, v68, v76, s[42:43]
    v_cndmask_b32 v69, v69, v77, s[42:43]
    v_cndmask_b32 v70, v70, v78, s[42:43]
    v_cndmask_b32 v71, v71, v79, s[42:43]
    ds_write_b128 v0, v[80:83] offset:0
    ds_write_b128 v0, v[84:87] offset:1024
    v_accvgpr_read_b32 v24, a240
    v_accvgpr_read_b32 v25, a241
    v_accvgpr_read_b32 v128, a0
    v_accvgpr_read_b32 v129, a1
    v_accvgpr_read_b32 v130, a2
    v_accvgpr_read_b32 v131, a3
    v_pk_mul_f32 v[192:193], v[160:161], v[192:193]
    v_pk_mul_f32 v[194:195], v[162:163], v[194:195]
    v_pk_mul_f32 v[160:161], v[160:161], v[24:25] op_sel:[0,0] op_sel_hi:[1,0]
    v_pk_mul_f32 v[162:163], v[162:163], v[24:25] op_sel:[0,0] op_sel_hi:[1,0]
    v_pk_mul_f32 v[128:129], v[224:225], v[128:129]
    v_pk_mul_f32 v[130:131], v[226:227], v[130:131]
    v_pk_mul_f32 v[224:225], v[224:225], v[24:25] op_sel:[0,0] op_sel_hi:[1,0]
    v_pk_mul_f32 v[226:227], v[226:227], v[24:25] op_sel:[0,0] op_sel_hi:[1,0]
    v_exp_f32 v160, v160
    v_exp_f32 v161, v161
    v_exp_f32 v162, v162
    v_exp_f32 v163, v163
    v_exp_f32 v224, v224
    v_exp_f32 v225, v225
    v_exp_f32 v226, v226
    v_exp_f32 v227, v227
    v_pk_fma_f32 v[160:161], v[160:161], v[24:25], v[24:25] op_sel:[0,1,1] op_sel_hi:[1,1,1]
    v_pk_fma_f32 v[162:163], v[162:163], v[24:25], v[24:25] op_sel:[0,1,1] op_sel_hi:[1,1,1]
    v_pk_fma_f32 v[224:225], v[224:225], v[24:25], v[24:25] op_sel:[0,1,1] op_sel_hi:[1,1,1]
    v_pk_fma_f32 v[226:227], v[226:227], v[24:25], v[24:25] op_sel:[0,1,1] op_sel_hi:[1,1,1]
    v_rcp_f32 v160, v160
    v_rcp_f32 v161, v161
    v_rcp_f32 v162, v162
    v_rcp_f32 v163, v163
    v_rcp_f32 v224, v224
    v_rcp_f32 v225, v225
    v_rcp_f32 v226, v226
    v_rcp_f32 v227, v227
    v_pk_mul_f32 v[192:193], v[192:193], v[160:161]
    v_pk_mul_f32 v[194:195], v[194:195], v[162:163]
    v_pk_mul_f32 v[128:129], v[128:129], v[224:225]
    v_pk_mul_f32 v[130:131], v[130:131], v[226:227]
    v_cvt_pk_bf16_f32 v160, v192, v193
    v_cvt_pk_bf16_f32 v161, v194, v195
    v_cvt_pk_bf16_f32 v162, v128, v129
    v_cvt_pk_bf16_f32 v163, v130, v131
    buffer_store_dwordx4 v[160:163], v12, s[32:35], s60 offen offset:0 sc1
    v_accvgpr_read_b32 v24, a242
    v_accvgpr_read_b32 v25, a243
    v_accvgpr_read_b32 v132, a4
    v_accvgpr_read_b32 v133, a5
    v_accvgpr_read_b32 v134, a6
    v_accvgpr_read_b32 v135, a7
    v_pk_mul_f32 v[196:197], v[164:165], v[196:197]
    v_pk_mul_f32 v[198:199], v[166:167], v[198:199]
    v_pk_mul_f32 v[164:165], v[164:165], v[24:25] op_sel:[0,0] op_sel_hi:[1,0]
    v_pk_mul_f32 v[166:167], v[166:167], v[24:25] op_sel:[0,0] op_sel_hi:[1,0]
    v_pk_mul_f32 v[132:133], v[228:229], v[132:133]
    v_pk_mul_f32 v[134:135], v[230:231], v[134:135]
    v_pk_mul_f32 v[228:229], v[228:229], v[24:25] op_sel:[0,0] op_sel_hi:[1,0]
    v_pk_mul_f32 v[230:231], v[230:231], v[24:25] op_sel:[0,0] op_sel_hi:[1,0]
    v_exp_f32 v164, v164
    v_exp_f32 v165, v165
    v_exp_f32 v166, v166
    v_exp_f32 v167, v167
    v_exp_f32 v228, v228
    v_exp_f32 v229, v229
    v_exp_f32 v230, v230
    v_exp_f32 v231, v231
    v_pk_fma_f32 v[164:165], v[164:165], v[24:25], v[24:25] op_sel:[0,1,1] op_sel_hi:[1,1,1]
    v_pk_fma_f32 v[166:167], v[166:167], v[24:25], v[24:25] op_sel:[0,1,1] op_sel_hi:[1,1,1]
    v_pk_fma_f32 v[228:229], v[228:229], v[24:25], v[24:25] op_sel:[0,1,1] op_sel_hi:[1,1,1]
    v_pk_fma_f32 v[230:231], v[230:231], v[24:25], v[24:25] op_sel:[0,1,1] op_sel_hi:[1,1,1]
    v_rcp_f32 v164, v164
    v_rcp_f32 v165, v165
    v_rcp_f32 v166, v166
    v_rcp_f32 v167, v167
    v_rcp_f32 v228, v228
    v_rcp_f32 v229, v229
    v_rcp_f32 v230, v230
    v_rcp_f32 v231, v231
    v_pk_mul_f32 v[196:197], v[196:197], v[164:165]
    v_pk_mul_f32 v[198:199], v[198:199], v[166:167]
    v_pk_mul_f32 v[132:133], v[132:133], v[228:229]
    v_pk_mul_f32 v[134:135], v[134:135], v[230:231]
    v_cvt_pk_bf16_f32 v164, v196, v197
    v_cvt_pk_bf16_f32 v165, v198, v199
    v_cvt_pk_bf16_f32 v166, v132, v133
    v_cvt_pk_bf16_f32 v167, v134, v135
    buffer_store_dwordx4 v[164:167], v12, s[32:35], s60 offen offset:1024 sc1
    s_waitcnt lgkmcnt(0)
    s_barrier
    ds_read_b128 v[80:83], v1 offset:0
    ds_read_b128 v[84:87], v1 offset:1024
    v_accvgpr_read_b32 v24, a244
    v_accvgpr_read_b32 v25, a245
    v_accvgpr_read_b32 v136, a8
    v_accvgpr_read_b32 v137, a9
    v_accvgpr_read_b32 v138, a10
    v_accvgpr_read_b32 v139, a11
    v_pk_mul_f32 v[200:201], v[168:169], v[200:201]
    v_pk_mul_f32 v[202:203], v[170:171], v[202:203]
    v_pk_mul_f32 v[168:169], v[168:169], v[24:25] op_sel:[0,0] op_sel_hi:[1,0]
    v_pk_mul_f32 v[170:171], v[170:171], v[24:25] op_sel:[0,0] op_sel_hi:[1,0]
    v_pk_mul_f32 v[136:137], v[232:233], v[136:137]
    v_pk_mul_f32 v[138:139], v[234:235], v[138:139]
    v_pk_mul_f32 v[232:233], v[232:233], v[24:25] op_sel:[0,0] op_sel_hi:[1,0]
    v_pk_mul_f32 v[234:235], v[234:235], v[24:25] op_sel:[0,0] op_sel_hi:[1,0]
    v_exp_f32 v168, v168
    v_exp_f32 v169, v169
    v_exp_f32 v170, v170
    v_exp_f32 v171, v171
    v_exp_f32 v232, v232
    v_exp_f32 v233, v233
    v_exp_f32 v234, v234
    v_exp_f32 v235, v235
    v_pk_fma_f32 v[168:169], v[168:169], v[24:25], v[24:25] op_sel:[0,1,1] op_sel_hi:[1,1,1]
    v_pk_fma_f32 v[170:171], v[170:171], v[24:25], v[24:25] op_sel:[0,1,1] op_sel_hi:[1,1,1]
    v_pk_fma_f32 v[232:233], v[232:233], v[24:25], v[24:25] op_sel:[0,1,1] op_sel_hi:[1,1,1]
    v_pk_fma_f32 v[234:235], v[234:235], v[24:25], v[24:25] op_sel:[0,1,1] op_sel_hi:[1,1,1]
    v_rcp_f32 v168, v168
    v_rcp_f32 v169, v169
    v_rcp_f32 v170, v170
    v_rcp_f32 v171, v171
    v_rcp_f32 v232, v232
    v_rcp_f32 v233, v233
    v_rcp_f32 v234, v234
    v_rcp_f32 v235, v235
    v_pk_mul_f32 v[200:201], v[200:201], v[168:169]
    v_pk_mul_f32 v[202:203], v[202:203], v[170:171]
    v_pk_mul_f32 v[136:137], v[136:137], v[232:233]
    v_pk_mul_f32 v[138:139], v[138:139], v[234:235]
    v_cvt_pk_bf16_f32 v168, v200, v201
    v_cvt_pk_bf16_f32 v169, v202, v203
    v_cvt_pk_bf16_f32 v170, v136, v137
    v_cvt_pk_bf16_f32 v171, v138, v139
    buffer_store_dwordx4 v[168:171], v12, s[32:35], s60 offen offset:2048 sc1
    s_waitcnt lgkmcnt(0)
    v_cndmask_b32 v96, v64, v80, s[42:43]
    v_cndmask_b32 v98, v80, v64, s[42:43]
    v_cndmask_b32 v97, v65, v81, s[42:43]
    v_cndmask_b32 v99, v81, v65, s[42:43]
    buffer_store_dwordx4 v[96:99], v12, s[32:35], s58 offen offset:0 sc1
    v_cndmask_b32 v100, v66, v82, s[42:43]
    v_cndmask_b32 v102, v82, v66, s[42:43]
    v_cndmask_b32 v101, v67, v83, s[42:43]
    v_cndmask_b32 v103, v83, v67, s[42:43]
    buffer_store_dwordx4 v[100:103], v12, s[32:35], s58 offen offset:1024 sc1
    v_cndmask_b32 v104, v68, v84, s[42:43]
    v_cndmask_b32 v106, v84, v68, s[42:43]
    v_cndmask_b32 v105, v69, v85, s[42:43]
    v_cndmask_b32 v107, v85, v69, s[42:43]
    buffer_store_dwordx4 v[104:107], v12, s[32:35], s58 offen offset:2048 sc1
    v_cndmask_b32 v108, v70, v86, s[42:43]
    v_cndmask_b32 v110, v86, v70, s[42:43]
    v_cndmask_b32 v109, v71, v87, s[42:43]
    v_cndmask_b32 v111, v87, v71, s[42:43]
    buffer_store_dwordx4 v[108:111], v12, s[32:35], s58 offen offset:3072 sc1
    v_accvgpr_read_b32 v24, a246
    s_add_u32 m0, s70, 131072
    s_lshr_b32 s59, 0x3020100, s72
    s_and_b32 s59, s59, 255
    s_lshl_b32 s59, s59, 16
    buffer_load_dwordx4 v13, s[16:19], s59 offen offset:0 lds
    v_accvgpr_read_b32 v25, a247
    v_accvgpr_read_b32 v140, a12
    v_accvgpr_read_b32 v141, a13
    v_accvgpr_read_b32 v142, a14
    v_accvgpr_read_b32 v143, a15
    v_pk_mul_f32 v[204:205], v[172:173], v[204:205]
    v_pk_mul_f32 v[206:207], v[174:175], v[206:207]
    v_pk_mul_f32 v[172:173], v[172:173], v[24:25] op_sel:[0,0] op_sel_hi:[1,0]
    v_pk_mul_f32 v[174:175], v[174:175], v[24:25] op_sel:[0,0] op_sel_hi:[1,0]
    v_pk_mul_f32 v[140:141], v[236:237], v[140:141]
    v_pk_mul_f32 v[142:143], v[238:239], v[142:143]
    v_pk_mul_f32 v[236:237], v[236:237], v[24:25] op_sel:[0,0] op_sel_hi:[1,0]
    v_pk_mul_f32 v[238:239], v[238:239], v[24:25] op_sel:[0,0] op_sel_hi:[1,0]
    v_exp_f32 v172, v172
    v_exp_f32 v173, v173
    buffer_load_dwordx4 v14, s[16:19], s59 offen offset:1024 lds
    v_exp_f32 v174, v174
    v_exp_f32 v175, v175
    v_exp_f32 v236, v236
    v_exp_f32 v237, v237
    v_exp_f32 v238, v238
    v_exp_f32 v239, v239
    v_pk_fma_f32 v[172:173], v[172:173], v[24:25], v[24:25] op_sel:[0,1,1] op_sel_hi:[1,1,1]
    v_pk_fma_f32 v[174:175], v[174:175], v[24:25], v[24:25] op_sel:[0,1,1] op_sel_hi:[1,1,1]
    v_pk_fma_f32 v[236:237], v[236:237], v[24:25], v[24:25] op_sel:[0,1,1] op_sel_hi:[1,1,1]
    v_pk_fma_f32 v[238:239], v[238:239], v[24:25], v[24:25] op_sel:[0,1,1] op_sel_hi:[1,1,1]
    v_rcp_f32 v172, v172
    v_rcp_f32 v173, v173
    buffer_load_dwordx4 v15, s[16:19], s59 offen offset:2048 lds
    v_rcp_f32 v174, v174
    v_rcp_f32 v175, v175
    v_rcp_f32 v236, v236
    v_rcp_f32 v237, v237
    v_rcp_f32 v238, v238
    v_rcp_f32 v239, v239
    v_pk_mul_f32 v[204:205], v[204:205], v[172:173]
    v_pk_mul_f32 v[206:207], v[206:207], v[174:175]
    v_pk_mul_f32 v[140:141], v[140:141], v[236:237]
    v_pk_mul_f32 v[142:143], v[142:143], v[238:239]
    v_cvt_pk_bf16_f32 v172, v204, v205
    v_cvt_pk_bf16_f32 v173, v206, v207
    buffer_load_dwordx4 v16, s[16:19], s59 offen offset:3072 lds
    v_cvt_pk_bf16_f32 v174, v140, v141
    v_cvt_pk_bf16_f32 v175, v142, v143
    buffer_store_dwordx4 v[172:175], v12, s[32:35], s60 offen offset:3072 sc1
    v_max_u32 v28, 32, v2
    v_min_u32 v28, 47, v28
    v_lshlrev_b32 v28, 2, v28
    s_add_u32 s53, s76, 0x1e3000
    buffer_load_dword v29, v28, s[44:47], s53 offen sc1
    v_accvgpr_read_b32 v24, a248
    v_accvgpr_read_b32 v25, a249
    v_accvgpr_read_b32 v144, a16
    v_accvgpr_read_b32 v145, a17
    v_accvgpr_read_b32 v146, a18
    v_accvgpr_read_b32 v147, a19
    v_pk_mul_f32 v[208:209], v[176:177], v[208:209]
    v_pk_mul_f32 v[210:211], v[178:179], v[210:211]
    v_pk_mul_f32 v[176:177], v[176:177], v[24:25] op_sel:[0,0] op_sel_hi:[1,0]
    v_pk_mul_f32 v[178:179], v[178:179], v[24:25] op_sel:[0,0] op_sel_hi:[1,0]
    v_pk_mul_f32 v[144:145], v[240:241], v[144:145]
    v_pk_mul_f32 v[146:147], v[242:243], v[146:147]
    v_pk_mul_f32 v[240:241], v[240:241], v[24:25] op_sel:[0,0] op_sel_hi:[1,0]
    v_pk_mul_f32 v[242:243], v[242:243], v[24:25] op_sel:[0,0] op_sel_hi:[1,0]
    v_exp_f32 v176, v176
    v_exp_f32 v177, v177
    s_add_u32 m0, s70, 135168
    s_add_u32 s59, s59, 32768
    buffer_load_dwordx4 v13, s[16:19], s59 offen offset:0 lds
    v_exp_f32 v178, v178
    v_exp_f32 v179, v179
    v_exp_f32 v240, v240
    v_exp_f32 v241, v241
    v_exp_f32 v242, v242
    v_exp_f32 v243, v243
    v_pk_fma_f32 v[176:177], v[176:177], v[24:25], v[24:25] op_sel:[0,1,1] op_sel_hi:[1,1,1]
    v_pk_fma_f32 v[178:179], v[178:179], v[24:25], v[24:25] op_sel:[0,1,1] op_sel_hi:[1,1,1]
    v_pk_fma_f32 v[240:241], v[240:241], v[24:25], v[24:25] op_sel:[0,1,1] op_sel_hi:[1,1,1]
    v_pk_fma_f32 v[242:243], v[242:243], v[24:25], v[24:25] op_sel:[0,1,1] op_sel_hi:[1,1,1]
    v_rcp_f32 v176, v176
    v_rcp_f32 v177, v177
    buffer_load_dwordx4 v14, s[16:19], s59 offen offset:1024 lds
    v_rcp_f32 v178, v178
    v_rcp_f32 v179, v179
    v_rcp_f32 v240, v240
    v_rcp_f32 v241, v241
    v_rcp_f32 v242, v242
    v_rcp_f32 v243, v243
    v_pk_mul_f32 v[208:209], v[208:209], v[176:177]
    v_pk_mul_f32 v[210:211], v[210:211], v[178:179]
    v_pk_mul_f32 v[144:145], v[144:145], v[240:241]
    v_pk_mul_f32 v[146:147], v[146:147], v[242:243]
    v_cvt_pk_bf16_f32 v176, v208, v209
    v_cvt_pk_bf16_f32 v177, v210, v211
    buffer_load_dwordx4 v15, s[16:19], s59 offen offset:2048 lds
    v_cvt_pk_bf16_f32 v178, v144, v145
    v_cvt_pk_bf16_f32 v179, v146, v147
    v_accvgpr_read_b32 v24, a250
    v_accvgpr_read_b32 v25, a251
    v_accvgpr_read_b32 v148, a20
    v_accvgpr_read_b32 v149, a21
    v_accvgpr_read_b32 v150, a22
    v_accvgpr_read_b32 v151, a23
    v_pk_mul_f32 v[212:213], v[180:181], v[212:213]
    v_pk_mul_f32 v[214:215], v[182:183], v[214:215]
    v_pk_mul_f32 v[180:181], v[180:181], v[24:25] op_sel:[0,0] op_sel_hi:[1,0]
    v_pk_mul_f32 v[182:183], v[182:183], v[24:25] op_sel:[0,0] op_sel_hi:[1,0]
    v_pk_mul_f32 v[148:149], v[244:245], v[148:149]
    v_pk_mul_f32 v[150:151], v[246:247], v[150:151]
    v_pk_mul_f32 v[244:245], v[244:245], v[24:25] op_sel:[0,0] op_sel_hi:[1,0]
    v_pk_mul_f32 v[246:247], v[246:247], v[24:25] op_sel:[0,0] op_sel_hi:[1,0]
    v_exp_f32 v180, v180
    v_exp_f32 v181, v181
    buffer_load_dwordx4 v16, s[16:19], s59 offen offset:3072 lds
    v_exp_f32 v182, v182
    v_exp_f32 v183, v183
    v_exp_f32 v244, v244
    v_exp_f32 v245, v245
    v_exp_f32 v246, v246
    v_exp_f32 v247, v247
    v_pk_fma_f32 v[180:181], v[180:181], v[24:25], v[24:25] op_sel:[0,1,1] op_sel_hi:[1,1,1]
    v_pk_fma_f32 v[182:183], v[182:183], v[24:25], v[24:25] op_sel:[0,1,1] op_sel_hi:[1,1,1]
    v_pk_fma_f32 v[244:245], v[244:245], v[24:25], v[24:25] op_sel:[0,1,1] op_sel_hi:[1,1,1]
    v_pk_fma_f32 v[246:247], v[246:247], v[24:25], v[24:25] op_sel:[0,1,1] op_sel_hi:[1,1,1]
    v_rcp_f32 v180, v180
    v_rcp_f32 v181, v181
    v_rcp_f32 v182, v182
    v_rcp_f32 v183, v183
    v_rcp_f32 v244, v244
    v_rcp_f32 v245, v245
    v_rcp_f32 v246, v246
    v_rcp_f32 v247, v247
    v_pk_mul_f32 v[212:213], v[212:213], v[180:181]
    v_pk_mul_f32 v[214:215], v[214:215], v[182:183]
    v_pk_mul_f32 v[148:149], v[148:149], v[244:245]
    v_pk_mul_f32 v[150:151], v[150:151], v[246:247]
    v_cvt_pk_bf16_f32 v180, v212, v213
    v_cvt_pk_bf16_f32 v181, v214, v215
    v_cvt_pk_bf16_f32 v182, v148, v149
    v_cvt_pk_bf16_f32 v183, v150, v151
    s_waitcnt vmcnt(4)
    s_mov_b32 s48, 0x20000
L_pollH1B:
    v_cmp_ne_u32 vcc, v3, v29
    s_sub_u32 s48, s48, 1
    s_nop 3
    s_cbranch_vccz L_pollH1B_d
    s_cmp_eq_u32 s48, 0
    s_cbranch_scc1 L_pollH1B_d
    s_sleep 1
    buffer_load_dword v29, v28, s[44:47], s53 offen sc1
    s_waitcnt vmcnt(0)
    s_branch L_pollH1B
L_pollH1B_d:
    v_accvgpr_read_b32 v24, a252
    s_lshr_b32 s40, 0x28252320, s73
    s_and_b32 s40, s40, 255
    s_lshl_b32 s40, s40, 13
    buffer_load_dwordx4 a[96:99], v21, s[12:15], s40 offen offset:0 sc1
    v_accvgpr_read_b32 v25, a253
    v_accvgpr_read_b32 v152, a24
    v_accvgpr_read_b32 v153, a25
    buffer_load_dwordx4 a[100:103], v21, s[12:15], s40 offen offset:1024 sc1
    v_accvgpr_read_b32 v154, a26
    v_accvgpr_read_b32 v155, a27
    v_pk_mul_f32 v[216:217], v[184:185], v[216:217]
    v_pk_mul_f32 v[218:219], v[186:187], v[218:219]
    v_pk_mul_f32 v[184:185], v[184:185], v[24:25] op_sel:[0,0] op_sel_hi:[1,0]
    v_pk_mul_f32 v[186:187], v[186:187], v[24:25] op_sel:[0,0] op_sel_hi:[1,0]
    v_pk_mul_f32 v[152:153], v[248:249], v[152:153]
    v_pk_mul_f32 v[154:155], v[250:251], v[154:155]
    v_pk_mul_f32 v[248:249], v[248:249], v[24:25] op_sel:[0,0] op_sel_hi:[1,0]
    v_pk_mul_f32 v[250:251], v[250:251], v[24:25] op_sel:[0,0] op_sel_hi:[1,0]
    v_exp_f32 v184, v184
    v_exp_f32 v185, v185
    buffer_load_dwordx4 a[104:107], v22, s[12:15], s40 offen offset:0 sc1
    v_exp_f32 v186, v186
    v_exp_f32 v187, v187
    v_exp_f32 v248, v248
    buffer_load_dwordx4 a[108:111], v22, s[12:15], s40 offen offset:1024 sc1
    v_exp_f32 v249, v249
    v_exp_f32 v250, v250
    v_exp_f32 v251, v251
    s_lshr_b32 s40, 0x2825, s73
    s_and_b32 s40, s40, 255
    s_lshl_b32 s40, s40, 13
    buffer_load_dwordx4 a[112:115], v21, s[12:15], s40 offen offset:0 sc1
    v_pk_fma_f32 v[184:185], v[184:185], v[24:25], v[24:25] op_sel:[0,1,1] op_sel_hi:[1,1,1]
    v_pk_fma_f32 v[186:187], v[186:187], v[24:25], v[24:25] op_sel:[0,1,1] op_sel_hi:[1,1,1]
    v_pk_fma_f32 v[248:249], v[248:249], v[24:25], v[24:25] op_sel:[0,1,1] op_sel_hi:[1,1,1]
    v_pk_fma_f32 v[250:251], v[250:251], v[24:25], v[24:25] op_sel:[0,1,1] op_sel_hi:[1,1,1]
    v_rcp_f32 v184, v184
    v_rcp_f32 v185, v185
    buffer_load_dwordx4 a[116:119], v21, s[12:15], s40 offen offset:1024 sc1
    v_rcp_f32 v186, v186
    v_rcp_f32 v187, v187
    v_rcp_f32 v248, v248
    buffer_load_dwordx4 a[120:123], v22, s[12:15], s40 offen offset:0 sc1
    v_rcp_f32 v249, v249
    v_rcp_f32 v250, v250
    v_rcp_f32 v251, v251
    buffer_load_dwordx4 a[124:127], v22, s[12:15], s40 offen offset:1024 sc1
    v_pk_mul_f32 v[216:217], v[216:217], v[184:185]
    v_pk_mul_f32 v[218:219], v[218:219], v[186:187]
    v_pk_mul_f32 v[152:153], v[152:153], v[248:249]
    v_pk_mul_f32 v[154:155], v[154:155], v[250:251]
    v_cvt_pk_bf16_f32 v184, v216, v217
    v_cvt_pk_bf16_f32 v185, v218, v219
    s_lshr_b32 s40, 0x322f2d2a, s73
    s_and_b32 s40, s40, 255
    s_lshl_b32 s40, s40, 13
    buffer_load_dwordx4 a[128:131], v21, s[12:15], s40 offen offset:0 sc1
    v_cvt_pk_bf16_f32 v186, v152, v153
    v_cvt_pk_bf16_f32 v187, v154, v155
    v_lshrrev_b32 v26, 2, v2
    v_and_b32 v27, 7, v26
    v_lshlrev_b32 v26, 8, v26
    v_lshl_add_u32 v26, v27, 5, v26
    v_and_b32 v27, 3, v2
    v_lshl_add_u32 v26, v27, 3, v26
    s_lshl_b32 s52, s73, 10
    v_add_u32 v26, s52, v26
    v_xor_b32 v4, 0, v26
    v_xor_b32 v5, 32, v26
    v_xor_b32 v6, 64, v26
    v_xor_b32 v7, 96, v26
    v_xor_b32 v8, 128, v26
    v_xor_b32 v9, 160, v26
    v_xor_b32 v10, 192, v26
    v_xor_b32 v11, 224, v26
    s_lshr_b32 s30, 0x322f2d2a, s73
    s_mov_b32 s51, 0x3c393734
    s_mov_b32 s31, 0x4643413e
    ds_read_b64_tr_b16 a[160:161], v4 offset:0
    ds_read_b64_tr_b16 a[162:163], v4 offset:4096
    ds_read_b64_tr_b16 a[164:165], v5 offset:0
    ds_read_b64_tr_b16 a[166:167], v5 offset:4096
    ds_read_b64_tr_b16 a[168:169], v6 offset:0
    ds_read_b64_tr_b16 a[170:171], v6 offset:4096
    ds_read_b64_tr_b16 a[172:173], v7 offset:0
    ds_read_b64_tr_b16 a[174:175], v7 offset:4096
    ds_read_b64_tr_b16 a[176:177], v8 offset:0
    ds_read_b64_tr_b16 a[178:179], v8 offset:4096
    ds_read_b64_tr_b16 a[180:181], v9 offset:0
    ds_read_b64_tr_b16 a[182:183], v9 offset:4096
    ds_read_b64_tr_b16 a[184:185], v10 offset:0
    ds_read_b64_tr_b16 a[186:187], v10 offset:4096
    ds_read_b64_tr_b16 a[188:189], v11 offset:0
    ds_read_b64_tr_b16 a[190:191], v11 offset:4096
    v_accvgpr_read_b32 v24, a254
    buffer_load_dwordx4 a[132:135], v21, s[12:15], s40 offen offset:1024 sc1
    v_accvgpr_read_b32 v25, a255
    v_accvgpr_read_b32 v156, a28
    v_accvgpr_read_b32 v157, a29
    buffer_load_dwordx4 a[136:139], v22, s[12:15], s40 offen offset:0 sc1
    v_accvgpr_read_b32 v158, a30
    v_accvgpr_read_b32 v159, a31
    v_pk_mul_f32 v[220:221], v[188:189], v[220:221]
    v_pk_mul_f32 v[222:223], v[190:191], v[222:223]
    v_pk_mul_f32 v[188:189], v[188:189], v[24:25] op_sel:[0,0] op_sel_hi:[1,0]
    v_pk_mul_f32 v[190:191], v[190:191], v[24:25] op_sel:[0,0] op_sel_hi:[1,0]
    v_pk_mul_f32 v[156:157], v[252:253], v[156:157]
    v_pk_mul_f32 v[158:159], v[254:255], v[158:159]
    v_pk_mul_f32 v[252:253], v[252:253], v[24:25] op_sel:[0,0] op_sel_hi:[1,0]
    v_pk_mul_f32 v[254:255], v[254:255], v[24:25] op_sel:[0,0] op_sel_hi:[1,0]
    v_exp_f32 v188, v188
    v_exp_f32 v189, v189
    buffer_load_dwordx4 a[140:143], v22, s[12:15], s40 offen offset:1024 sc1
    v_exp_f32 v190, v190
    v_exp_f32 v191, v191
    v_exp_f32 v252, v252
    buffer_store_dwordx4 v[176:179], v23, s[32:35], s60 offen offset:0 sc1
    v_exp_f32 v253, v253
    v_exp_f32 v254, v254
    v_exp_f32 v255, v255
    buffer_store_dwordx4 v[180:183], v23, s[32:35], s60 offen offset:1024 sc1
    v_pk_fma_f32 v[188:189], v[188:189], v[24:25], v[24:25] op_sel:[0,1,1] op_sel_hi:[1,1,1]
    v_pk_fma_f32 v[190:191], v[190:191], v[24:25], v[24:25] op_sel:[0,1,1] op_sel_hi:[1,1,1]
    v_pk_fma_f32 v[252:253], v[252:253], v[24:25], v[24:25] op_sel:[0,1,1] op_sel_hi:[1,1,1]
    v_pk_fma_f32 v[254:255], v[254:255], v[24:25], v[24:25] op_sel:[0,1,1] op_sel_hi:[1,1,1]
    v_rcp_f32 v188, v188
    v_rcp_f32 v189, v189
    buffer_store_dwordx4 v[184:187], v23, s[32:35], s60 offen offset:2048 sc1
    v_rcp_f32 v190, v190
    v_rcp_f32 v191, v191
    v_rcp_f32 v252, v252
    v_rcp_f32 v253, v253
    v_rcp_f32 v254, v254
    v_rcp_f32 v255, v255
    v_pk_mul_f32 v[220:221], v[220:221], v[188:189]
    v_pk_mul_f32 v[222:223], v[222:223], v[190:191]
    v_pk_mul_f32 v[156:157], v[156:157], v[252:253]
    v_pk_mul_f32 v[158:159], v[158:159], v[254:255]
    v_cvt_pk_bf16_f32 v188, v220, v221
    v_cvt_pk_bf16_f32 v189, v222, v223
    v_cvt_pk_bf16_f32 v190, v156, v157
    v_cvt_pk_bf16_f32 v191, v158, v159
    buffer_store_dwordx4 v[188:191], v23, s[32:35], s60 offen offset:3072 sc1
    v_max_u32 v28, 0, v2
    v_min_u32 v28, 15, v28
    v_lshlrev_b32 v28, 2, v28
    s_add_u32 s53, s76, 0x1e4000
    s_waitcnt vmcnt(12)
    s_waitcnt lgkmcnt(12)
    v_mfma_f32_16x16x32_bf16 v[128:131], a[160:163], a[96:99], 0
    v_mfma_f32_16x16x32_bf16 v[160:163], a[160:163], a[100:103], 0
    v_mfma_f32_16x16x32_bf16 v[192:195], a[160:163], a[104:107], 0
    v_mfma_f32_16x16x32_bf16 v[224:227], a[160:163], a[108:111], 0
    ds_read_b64_tr_b16 a[160:161], v4 offset:16384
    ds_read_b64_tr_b16 a[162:163], v4 offset:20480
    v_mfma_f32_16x16x32_bf16 v[132:135], a[164:167], a[96:99], 0
    s_bfe_u32 s40, s30, 0x80010
    v_mfma_f32_16x16x32_bf16 v[164:167], a[164:167], a[100:103], 0
    s_lshl_b32 s40, s40, 13
    v_mfma_f32_16x16x32_bf16 v[196:199], a[164:167], a[104:107], 0
    buffer_load_dwordx4 a[144:147], v21, s[12:15], s40 offen offset:0 sc1
    v_mfma_f32_16x16x32_bf16 v[228:231], a[164:167], a[108:111], 0
    ds_read_b64_tr_b16 a[164:165], v5 offset:16384
    ds_read_b64_tr_b16 a[166:167], v5 offset:20480
    s_waitcnt lgkmcnt(12)
    v_mfma_f32_16x16x32_bf16 v[136:139], a[168:171], a[96:99], 0
    v_mfma_f32_16x16x32_bf16 v[168:171], a[168:171], a[100:103], 0
    s_lshr_b32 s30, s51, s73
    v_mfma_f32_16x16x32_bf16 v[200:203], a[168:171], a[104:107], 0
    v_mfma_f32_16x16x32_bf16 v[232:235], a[168:171], a[108:111], 0
    ds_read_b64_tr_b16 a[168:169], v6 offset:16384
    ds_read_b64_tr_b16 a[170:171], v6 offset:20480
    v_mfma_f32_16x16x32_bf16 v[140:143], a[172:175], a[96:99], 0
    s_mov_b32 s51, s31
    v_mfma_f32_16x16x32_bf16 v[172:175], a[172:175], a[100:103], 0
    s_add_u32 s41, s41, 1
    v_mfma_f32_16x16x32_bf16 v[204:207], a[172:175], a[104:107], 0
    buffer_load_dwordx4 a[148:151], v21, s[12:15], s40 offen offset:1024 sc1
    v_mfma_f32_16x16x32_bf16 v[236:239], a[172:175], a[108:111], 0
    ds_read_b64_tr_b16 a[172:173], v7 offset:16384
    ds_read_b64_tr_b16 a[174:175], v7 offset:20480
    s_waitcnt lgkmcnt(12)
    v_mfma_f32_16x16x32_bf16 v[144:147], a[176:179], a[96:99], 0
    v_mfma_f32_16x16x32_bf16 v[176:179], a[176:179], a[100:103], 0
    v_readlane_b32 s31, v18, s41
    v_mfma_f32_16x16x32_bf16 v[208:211], a[176:179], a[104:107], 0
    v_mfma_f32_16x16x32_bf16 v[240:243], a[176:179], a[108:111], 0
    ds_read_b64_tr_b16 a[176:177], v8 offset:16384
    ds_read_b64_tr_b16 a[178:179], v8 offset:20480
    v_mfma_f32_16x16x32_bf16 v[148:151], a[180:183], a[96:99], 0
    s_cmp_eq_u32 s63, 0x20000
    s_cselect_b32 s62, s64, 0x8000
    v_mfma_f32_16x16x32_bf16 v[180:183], a[180:183], a[100:103], 0
    v_mfma_f32_16x16x32_bf16 v[212:215], a[180:183], a[104:107], 0
    buffer_load_dwordx4 a[152:155], v22, s[12:15], s40 offen offset:0 sc1
    v_mfma_f32_16x16x32_bf16 v[244:247], a[180:183], a[108:111], 0
    ds_read_b64_tr_b16 a[180:181], v9 offset:16384
    ds_read_b64_tr_b16 a[182:183], v9 offset:20480
    s_waitcnt lgkmcnt(12)
    v_mfma_f32_16x16x32_bf16 v[152:155], a[184:187], a[96:99], 0
    s_add_u32 s63, s63, s62
    v_mfma_f32_16x16x32_bf16 v[184:187], a[184:187], a[100:103], 0
    v_mfma_f32_16x16x32_bf16 v[216:219], a[184:187], a[104:107], 0
    v_mfma_f32_16x16x32_bf16 v[248:251], a[184:187], a[108:111], 0
    ds_read_b64_tr_b16 a[184:185], v10 offset:16384
    ds_read_b64_tr_b16 a[186:187], v10 offset:20480
    v_mfma_f32_16x16x32_bf16 v[156:159], a[188:191], a[96:99], 0
    v_mfma_f32_16x16x32_bf16 v[188:191], a[188:191], a[100:103], 0
    v_mfma_f32_16x16x32_bf16 v[220:223], a[188:191], a[104:107], 0
    buffer_load_dwordx4 a[156:159], v22, s[12:15], s40 offen offset:1024 sc1
    v_mfma_f32_16x16x32_bf16 v[252:255], a[188:191], a[108:111], 0
    ds_read_b64_tr_b16 a[188:189], v11 offset:16384
    ds_read_b64_tr_b16 a[190:191], v11 offset:20480
    s_waitcnt vmcnt(12)
    s_barrier
    s_waitcnt lgkmcnt(12)
    v_mfma_f32_16x16x32_bf16 v[128:131], a[160:163], a[112:115], v[128:131]
    v_add_u32 v4, s62, v4
    v_mfma_f32_16x16x32_bf16 v[160:163], a[160:163], a[116:119], v[160:163]
    v_mfma_f32_16x16x32_bf16 v[192:195], a[160:163], a[120:123], v[192:195]
    v_mfma_f32_16x16x32_bf16 v[224:227], a[160:163], a[124:127], v[224:227]
    ds_read_b64_tr_b16 a[160:161], v4 offset:0
    ds_read_b64_tr_b16 a[162:163], v4 offset:4096
    v_mfma_f32_16x16x32_bf16 v[132:135], a[164:167], a[112:115], v[132:135]
    s_bfe_u32 s40, s30, 0x80000
    v_add_u32 v5, s62, v5
    v_mfma_f32_16x16x32_bf16 v[164:167], a[164:167], a[116:119], v[164:167]
    s_lshl_b32 s40, s40, 13
    v_mfma_f32_16x16x32_bf16 v[196:199], a[164:167], a[120:123], v[196:199]
    buffer_load_dwordx4 a[96:99], v21, s[12:15], s40 offen offset:0 sc1
    v_mfma_f32_16x16x32_bf16 v[228:231], a[164:167], a[124:127], v[228:231]
    ds_read_b64_tr_b16 a[164:165], v5 offset:0
    ds_read_b64_tr_b16 a[166:167], v5 offset:4096
    s_waitcnt lgkmcnt(12)
    v_mfma_f32_16x16x32_bf16 v[136:139], a[168:171], a[112:115], v[136:139]
    v_add_u32 v6, s62, v6
    v_mfma_f32_16x16x32_bf16 v[168:171], a[168:171], a[116:119], v[168:171]
    v_mfma_f32_16x16x32_bf16 v[200:203], a[168:171], a[120:123], v[200:203]
    v_mfma_f32_16x16x32_bf16 v[232:235], a[168:171], a[124:127], v[232:235]
    ds_read_b64_tr_b16 a[168:169], v6 offset:0
    ds_read_b64_tr_b16 a[170:171], v6 offset:4096
    v_mfma_f32_16x16x32_bf16 v[140:143], a[172:175], a[112:115], v[140:143]
    v_add_u32 v7, s62, v7
    v_mfma_f32_16x16x32_bf16 v[172:175], a[172:175], a[116:119], v[172:175]
    v_mfma_f32_16x16x32_bf16 v[204:207], a[172:175], a[120:123], v[204:207]
    buffer_load_dwordx4 a[100:103], v21, s[12:15], s40 offen offset:1024 sc1
    v_mfma_f32_16x16x32_bf16 v[236:239], a[172:175], a[124:127], v[236:239]
    ds_read_b64_tr_b16 a[172:173], v7 offset:0
    ds_read_b64_tr_b16 a[174:175], v7 offset:4096
    s_waitcnt lgkmcnt(12)
    v_mfma_f32_16x16x32_bf16 v[144:147], a[176:179], a[112:115], v[144:147]
    v_add_u32 v8, s62, v8
    v_mfma_f32_16x16x32_bf16 v[176:179], a[176:179], a[116:119], v[176:179]
    v_mfma_f32_16x16x32_bf16 v[208:211], a[176:179], a[120:123], v[208:211]
    v_mfma_f32_16x16x32_bf16 v[240:243], a[176:179], a[124:127], v[240:243]
    ds_read_b64_tr_b16 a[176:177], v8 offset:0
    ds_read_b64_tr_b16 a[178:179], v8 offset:4096
    v_mfma_f32_16x16x32_bf16 v[148:151], a[180:183], a[112:115], v[148:151]
    v_add_u32 v9, s62, v9
    v_mfma_f32_16x16x32_bf16 v[180:183], a[180:183], a[116:119], v[180:183]
    v_mfma_f32_16x16x32_bf16 v[212:215], a[180:183], a[120:123], v[212:215]
    buffer_load_dwordx4 a[104:107], v22, s[12:15], s40 offen offset:0 sc1
    v_mfma_f32_16x16x32_bf16 v[244:247], a[180:183], a[124:127], v[244:247]
    ds_read_b64_tr_b16 a[180:181], v9 offset:0
    ds_read_b64_tr_b16 a[182:183], v9 offset:4096
    s_waitcnt lgkmcnt(12)
    v_mfma_f32_16x16x32_bf16 v[152:155], a[184:187], a[112:115], v[152:155]
    v_add_u32 v10, s62, v10
    v_mfma_f32_16x16x32_bf16 v[184:187], a[184:187], a[116:119], v[184:187]
    s_cmp_ge_u32 s71, 0x20000
    s_cselect_b32 s52, s64, 0x8000
    v_mfma_f32_16x16x32_bf16 v[216:219], a[184:187], a[120:123], v[216:219]
    v_mfma_f32_16x16x32_bf16 v[248:251], a[184:187], a[124:127], v[248:251]
    ds_read_b64_tr_b16 a[184:185], v10 offset:0
    ds_read_b64_tr_b16 a[186:187], v10 offset:4096
    v_mfma_f32_16x16x32_bf16 v[156:159], a[188:191], a[112:115], v[156:159]
    v_add_u32 v11, s62, v11
    v_mfma_f32_16x16x32_bf16 v[188:191], a[188:191], a[116:119], v[188:191]
    s_add_u32 s71, s71, s52
    v_mfma_f32_16x16x32_bf16 v[220:223], a[188:191], a[120:123], v[220:223]
    buffer_load_dwordx4 a[108:111], v22, s[12:15], s40 offen offset:1024 sc1
    v_mfma_f32_16x16x32_bf16 v[252:255], a[188:191], a[124:127], v[252:255]
    ds_read_b64_tr_b16 a[188:189], v11 offset:0
    ds_read_b64_tr_b16 a[190:191], v11 offset:4096
    s_waitcnt vmcnt(12)
    s_waitcnt lgkmcnt(12)
    v_mfma_f32_16x16x32_bf16 v[128:131], a[160:163], a[128:131], v[128:131]
    v_mfma_f32_16x16x32_bf16 v[160:163], a[160:163], a[132:135], v[160:163]
    v_mfma_f32_16x16x32_bf16 v[192:195], a[160:163], a[136:139], v[192:195]
    v_mfma_f32_16x16x32_bf16 v[224:227], a[160:163], a[140:143], v[224:227]
    ds_read_b64_tr_b16 a[160:161], v4 offset:16384
    ds_read_b64_tr_b16 a[162:163], v4 offset:20480
    v_mfma_f32_16x16x32_bf16 v[132:135], a[164:167], a[128:131], v[132:135]
    s_bfe_u32 s40, s30, 0x80010
    v_mfma_f32_16x16x32_bf16 v[164:167], a[164:167], a[132:135], v[164:167]
    s_lshl_b32 s40, s40, 13
    v_mfma_f32_16x16x32_bf16 v[196:199], a[164:167], a[136:139], v[196:199]
    buffer_load_dwordx4 a[112:115], v21, s[12:15], s40 offen offset:0 sc1
    v_mfma_f32_16x16x32_bf16 v[228:231], a[164:167], a[140:143], v[228:231]
    ds_read_b64_tr_b16 a[164:165], v5 offset:16384
    ds_read_b64_tr_b16 a[166:167], v5 offset:20480
    s_waitcnt lgkmcnt(12)
    v_mfma_f32_16x16x32_bf16 v[136:139], a[168:171], a[128:131], v[136:139]
    buffer_load_dword v29, v28, s[44:47], s53 offen sc1
    v_mfma_f32_16x16x32_bf16 v[168:171], a[168:171], a[132:135], v[168:171]
    s_lshr_b32 s30, s51, s73
    v_mfma_f32_16x16x32_bf16 v[200:203], a[168:171], a[136:139], v[200:203]
    v_mfma_f32_16x16x32_bf16 v[232:235], a[168:171], a[140:143], v[232:235]
    ds_read_b64_tr_b16 a[168:169], v6 offset:16384
    ds_read_b64_tr_b16 a[170:171], v6 offset:20480
    v_mfma_f32_16x16x32_bf16 v[140:143], a[172:175], a[128:131], v[140:143]
    s_mov_b32 s51, s31
    v_mfma_f32_16x16x32_bf16 v[172:175], a[172:175], a[132:135], v[172:175]
    s_add_u32 s41, s41, 1
    v_mfma_f32_16x16x32_bf16 v[204:207], a[172:175], a[136:139], v[204:207]
    buffer_load_dwordx4 a[116:119], v21, s[12:15], s40 offen offset:1024 sc1
    v_mfma_f32_16x16x32_bf16 v[236:239], a[172:175], a[140:143], v[236:239]
    ds_read_b64_tr_b16 a[172:173], v7 offset:16384
    ds_read_b64_tr_b16 a[174:175], v7 offset:20480
    s_waitcnt lgkmcnt(12)
    v_mfma_f32_16x16x32_bf16 v[144:147], a[176:179], a[128:131], v[144:147]
    v_mfma_f32_16x16x32_bf16 v[176:179], a[176:179], a[132:135], v[176:179]
    v_readlane_b32 s31, v18, s41
    v_mfma_f32_16x16x32_bf16 v[208:211], a[176:179], a[136:139], v[208:211]
    v_mfma_f32_16x16x32_bf16 v[240:243], a[176:179], a[140:143], v[240:243]
    ds_read_b64_tr_b16 a[176:177], v8 offset:16384
    ds_read_b64_tr_b16 a[178:179], v8 offset:20480
    v_mfma_f32_16x16x32_bf16 v[148:151], a[180:183], a[128:131], v[148:151]
    s_cmp_eq_u32 s63, 0x20000
    s_cselect_b32 s62, s64, 0x8000
    v_mfma_f32_16x16x32_bf16 v[180:183], a[180:183], a[132:135], v[180:183]
    v_mfma_f32_16x16x32_bf16 v[212:215], a[180:183], a[136:139], v[212:215]
    buffer_load_dwordx4 a[120:123], v22, s[12:15], s40 offen offset:0 sc1
    v_mfma_f32_16x16x32_bf16 v[244:247], a[180:183], a[140:143], v[244:247]
    ds_read_b64_tr_b16 a[180:181], v9 offset:16384
    ds_read_b64_tr_b16 a[182:183], v9 offset:20480
    s_waitcnt lgkmcnt(12)
    v_mfma_f32_16x16x32_bf16 v[152:155], a[184:187], a[128:131], v[152:155]
    s_add_u32 s63, s63, s62
    v_mfma_f32_16x16x32_bf16 v[184:187], a[184:187], a[132:135], v[184:187]
    v_mfma_f32_16x16x32_bf16 v[216:219], a[184:187], a[136:139], v[216:219]
    v_mfma_f32_16x16x32_bf16 v[248:251], a[184:187], a[140:143], v[248:251]
    ds_read_b64_tr_b16 a[184:185], v10 offset:16384
    ds_read_b64_tr_b16 a[186:187], v10 offset:20480
    v_mfma_f32_16x16x32_bf16 v[156:159], a[188:191], a[128:131], v[156:159]
    v_mfma_f32_16x16x32_bf16 v[188:191], a[188:191], a[132:135], v[188:191]
    v_mfma_f32_16x16x32_bf16 v[220:223], a[188:191], a[136:139], v[220:223]
    buffer_load_dwordx4 a[124:127], v22, s[12:15], s40 offen offset:1024 sc1
    v_mfma_f32_16x16x32_bf16 v[252:255], a[188:191], a[140:143], v[252:255]
    ds_read_b64_tr_b16 a[188:189], v11 offset:16384
    ds_read_b64_tr_b16 a[190:191], v11 offset:20480
    s_waitcnt vmcnt(9)
    s_barrier
    s_waitcnt lgkmcnt(12)
    v_mfma_f32_16x16x32_bf16 v[128:131], a[160:163], a[144:147], v[128:131]
    v_add_u32 v4, s62, v4
    v_mfma_f32_16x16x32_bf16 v[160:163], a[160:163], a[148:151], v[160:163]
    v_mfma_f32_16x16x32_bf16 v[192:195], a[160:163], a[152:155], v[192:195]
    v_mfma_f32_16x16x32_bf16 v[224:227], a[160:163], a[156:159], v[224:227]
    ds_read_b64_tr_b16 a[160:161], v4 offset:0
    ds_read_b64_tr_b16 a[162:163], v4 offset:4096
    v_mfma_f32_16x16x32_bf16 v[132:135], a[164:167], a[144:147], v[132:135]
    s_bfe_u32 s40, s30, 0x80000
    v_add_u32 v5, s62, v5
    v_mfma_f32_16x16x32_bf16 v[164:167], a[164:167], a[148:151], v[164:167]
    s_lshl_b32 s40, s40, 13
    v_mfma_f32_16x16x32_bf16 v[196:199], a[164:167], a[152:155], v[196:199]
    buffer_load_dwordx4 a[128:131], v21, s[12:15], s40 offen offset:0 sc1
    v_mfma_f32_16x16x32_bf16 v[228:231], a[164:167], a[156:159], v[228:231]
    ds_read_b64_tr_b16 a[164:165], v5 offset:0
    ds_read_b64_tr_b16 a[166:167], v5 offset:4096
    s_waitcnt lgkmcnt(12)
    v_mfma_f32_16x16x32_bf16 v[136:139], a[168:171], a[144:147], v[136:139]
    v_add_u32 v6, s62, v6
    v_mfma_f32_16x16x32_bf16 v[168:171], a[168:171], a[148:151], v[168:171]
    v_mfma_f32_16x16x32_bf16 v[200:203], a[168:171], a[152:155], v[200:203]
    v_mfma_f32_16x16x32_bf16 v[232:235], a[168:171], a[156:159], v[232:235]
    ds_read_b64_tr_b16 a[168:169], v6 offset:0
    ds_read_b64_tr_b16 a[170:171], v6 offset:4096
    v_mfma_f32_16x16x32_bf16 v[140:143], a[172:175], a[144:147], v[140:143]
    v_add_u32 v7, s62, v7
    v_mfma_f32_16x16x32_bf16 v[172:175], a[172:175], a[148:151], v[172:175]
    v_mfma_f32_16x16x32_bf16 v[204:207], a[172:175], a[152:155], v[204:207]
    buffer_load_dwordx4 a[132:135], v21, s[12:15], s40 offen offset:1024 sc1
    v_mfma_f32_16x16x32_bf16 v[236:239], a[172:175], a[156:159], v[236:239]
    ds_read_b64_tr_b16 a[172:173], v7 offset:0
    ds_read_b64_tr_b16 a[174:175], v7 offset:4096
    s_waitcnt lgkmcnt(12)
    v_mfma_f32_16x16x32_bf16 v[144:147], a[176:179], a[144:147], v[144:147]
    v_add_u32 v8, s62, v8
    v_mfma_f32_16x16x32_bf16 v[176:179], a[176:179], a[148:151], v[176:179]
    v_mfma_f32_16x16x32_bf16 v[208:211], a[176:179], a[152:155], v[208:211]
    v_mfma_f32_16x16x32_bf16 v[240:243], a[176:179], a[156:159], v[240:243]
    ds_read_b64_tr_b16 a[176:177], v8 offset:0
    ds_read_b64_tr_b16 a[178:179], v8 offset:4096
    v_mfma_f32_16x16x32_bf16 v[148:151], a[180:183], a[144:147], v[148:151]
    v_add_u32 v9, s62, v9
    v_mfma_f32_16x16x32_bf16 v[180:183], a[180:183], a[148:151], v[180:183]
    v_mfma_f32_16x16x32_bf16 v[212:215], a[180:183], a[152:155], v[212:215]
    buffer_load_dwordx4 a[136:139], v22, s[12:15], s40 offen offset:0 sc1
    v_mfma_f32_16x16x32_bf16 v[244:247], a[180:183], a[156:159], v[244:247]
    ds_read_b64_tr_b16 a[180:181], v9 offset:0
    ds_read_b64_tr_b16 a[182:183], v9 offset:4096
    s_waitcnt lgkmcnt(12)
    v_mfma_f32_16x16x32_bf16 v[152:155], a[184:187], a[144:147], v[152:155]
    v_add_u32 v10, s62, v10
    v_mfma_f32_16x16x32_bf16 v[184:187], a[184:187], a[148:151], v[184:187]
    s_cmp_ge_u32 s71, 0x20000
    s_cselect_b32 s52, s64, 0x8000
    v_mfma_f32_16x16x32_bf16 v[216:219], a[184:187], a[152:155], v[216:219]
    v_mfma_f32_16x16x32_bf16 v[248:251], a[184:187], a[156:159], v[248:251]
    ds_read_b64_tr_b16 a[184:185], v10 offset:0
    ds_read_b64_tr_b16 a[186:187], v10 offset:4096
    v_mfma_f32_16x16x32_bf16 v[156:159], a[188:191], a[144:147], v[156:159]
    v_add_u32 v11, s62, v11
    v_mfma_f32_16x16x32_bf16 v[188:191], a[188:191], a[148:151], v[188:191]
    s_add_u32 s71, s71, s52
    v_mfma_f32_16x16x32_bf16 v[220:223], a[188:191], a[152:155], v[220:223]
    buffer_load_dwordx4 a[140:143], v22, s[12:15], s40 offen offset:1024 sc1
    v_mfma_f32_16x16x32_bf16 v[252:255], a[188:191], a[156:159], v[252:255]
    ds_read_b64_tr_b16 a[188:189], v11 offset:0
    ds_read_b64_tr_b16 a[190:191], v11 offset:4096
    s_waitcnt vmcnt(7)
    s_mov_b32 s48, 0x20000
L_pollCAB:
    v_cmp_ne_u32 vcc, v3, v29
    s_sub_u32 s48, s48, 1
    s_nop 3
    s_cbranch_vccz L_pollCAB_d
    s_cmp_eq_u32 s48, 0
    s_cbranch_scc1 L_pollCAB_d
    s_sleep 1
    buffer_load_dword v29, v28, s[44:47], s53 offen sc1
    s_waitcnt vmcnt(0)
    s_branch L_pollCAB
L_pollCAB_d:
    s_waitcnt vmcnt(7)
    s_add_u32 s48, s66, 0x1e4000
    buffer_store_dword v3, v31, s[44:47], s48 offen sc1
    s_waitcnt vmcnt(8)
    s_waitcnt lgkmcnt(12)
    v_mfma_f32_16x16x32_bf16 v[128:131], a[160:163], a[96:99], v[128:131]
    s_lshr_b32 s59, s31, s72
    s_mov_b32 m0, s71
    v_mfma_f32_16x16x32_bf16 v[160:163], a[160:163], a[100:103], v[160:163]
    s_and_b32 s59, s59, 255
    s_lshl_b32 s59, s59, 16
    v_mfma_f32_16x16x32_bf16 v[192:195], a[160:163], a[104:107], v[192:195]
    buffer_load_dwordx4 v13, s[16:19], s59 offen offset:0 lds
    v_mfma_f32_16x16x32_bf16 v[224:227], a[160:163], a[108:111], v[224:227]
    ds_read_b64_tr_b16 a[160:161], v4 offset:16384
    ds_read_b64_tr_b16 a[162:163], v4 offset:20480
    v_mfma_f32_16x16x32_bf16 v[132:135], a[164:167], a[96:99], v[132:135]
    s_bfe_u32 s40, s30, 0x80010
    v_mfma_f32_16x16x32_bf16 v[164:167], a[164:167], a[100:103], v[164:167]
    s_lshl_b32 s40, s40, 13
    v_mfma_f32_16x16x32_bf16 v[196:199], a[164:167], a[104:107], v[196:199]
    buffer_load_dwordx4 a[144:147], v21, s[12:15], s40 offen offset:0 sc1
    v_mfma_f32_16x16x32_bf16 v[228:231], a[164:167], a[108:111], v[228:231]
    ds_read_b64_tr_b16 a[164:165], v5 offset:16384
    ds_read_b64_tr_b16 a[166:167], v5 offset:20480
    s_waitcnt lgkmcnt(12)
    v_mfma_f32_16x16x32_bf16 v[136:139], a[168:171], a[96:99], v[136:139]
    v_mfma_f32_16x16x32_bf16 v[168:171], a[168:171], a[100:103], v[168:171]
    s_lshr_b32 s30, s51, s73
    v_mfma_f32_16x16x32_bf16 v[200:203], a[168:171], a[104:107], v[200:203]
    buffer_load_dwordx4 v14, s[16:19], s59 offen offset:1024 lds
    v_mfma_f32_16x16x32_bf16 v[232:235], a[168:171], a[108:111], v[232:235]
    ds_read_b64_tr_b16 a[168:169], v6 offset:16384
    ds_read_b64_tr_b16 a[170:171], v6 offset:20480
    v_mfma_f32_16x16x32_bf16 v[140:143], a[172:175], a[96:99], v[140:143]
    s_mov_b32 s51, s31
    v_mfma_f32_16x16x32_bf16 v[172:175], a[172:175], a[100:103], v[172:175]
    s_add_u32 s41, s41, 1
    v_mfma_f32_16x16x32_bf16 v[204:207], a[172:175], a[104:107], v[204:207]
    buffer_load_dwordx4 a[148:151], v21, s[12:15], s40 offen offset:1024 sc1
    v_mfma_f32_16x16x32_bf16 v[236:239], a[172:175], a[108:111], v[236:239]
    ds_read_b64_tr_b16 a[172:173], v7 offset:16384
    ds_read_b64_tr_b16 a[174:175], v7 offset:20480
    s_waitcnt lgkmcnt(12)
    v_mfma_f32_16x16x32_bf16 v[144:147], a[176:179], a[96:99], v[144:147]
    v_mfma_f32_16x16x32_bf16 v[176:179], a[176:179], a[100:103], v[176:179]
    v_readlane_b32 s31, v18, s41
    v_mfma_f32_16x16x32_bf16 v[208:211], a[176:179], a[104:107], v[208:211]
    buffer_load_dwordx4 v15, s[16:19], s59 offen offset:2048 lds
    v_mfma_f32_16x16x32_bf16 v[240:243], a[176:179], a[108:111], v[240:243]
    ds_read_b64_tr_b16 a[176:177], v8 offset:16384
    ds_read_b64_tr_b16 a[178:179], v8 offset:20480
    v_mfma_f32_16x16x32_bf16 v[148:151], a[180:183], a[96:99], v[148:151]
    s_cmp_eq_u32 s63, 0x20000
    s_cselect_b32 s62, s64, 0x8000
    v_mfma_f32_16x16x32_bf16 v[180:183], a[180:183], a[100:103], v[180:183]
    v_mfma_f32_16x16x32_bf16 v[212:215], a[180:183], a[104:107], v[212:215]
    buffer_load_dwordx4 a[152:155], v22, s[12:15], s40 offen offset:0 sc1
    v_mfma_f32_16x16x32_bf16 v[244:247], a[180:183], a[108:111], v[244:247]
    ds_read_b64_tr_b16 a[180:181], v9 offset:16384
    ds_read_b64_tr_b16 a[182:183], v9 offset:20480
    s_waitcnt lgkmcnt(12)
    v_mfma_f32_16x16x32_bf16 v[152:155], a[184:187], a[96:99], v[152:155]
    s_add_u32 s63, s63, s62
    v_mfma_f32_16x16x32_bf16 v[184:187], a[184:187], a[100:103], v[184:187]
    v_mfma_f32_16x16x32_bf16 v[216:219], a[184:187], a[104:107], v[216:219]
    buffer_load_dwordx4 v16, s[16:19], s59 offen offset:3072 lds
    v_mfma_f32_16x16x32_bf16 v[248:251], a[184:187], a[108:111], v[248:251]
    ds_read_b64_tr_b16 a[184:185], v10 offset:16384
    ds_read_b64_tr_b16 a[186:187], v10 offset:20480
    v_mfma_f32_16x16x32_bf16 v[156:159], a[188:191], a[96:99], v[156:159]
    v_mfma_f32_16x16x32_bf16 v[188:191], a[188:191], a[100:103], v[188:191]
    v_mfma_f32_16x16x32_bf16 v[220:223], a[188:191], a[104:107], v[220:223]
    buffer_load_dwordx4 a[156:159], v22, s[12:15], s40 offen offset:1024 sc1
    v_mfma_f32_16x16x32_bf16 v[252:255], a[188:191], a[108:111], v[252:255]
    ds_read_b64_tr_b16 a[188:189], v11 offset:16384
    ds_read_b64_tr_b16 a[190:191], v11 offset:20480
    s_waitcnt vmcnt(13)
    s_barrier
    s_waitcnt lgkmcnt(12)
    v_mfma_f32_16x16x32_bf16 v[128:131], a[160:163], a[112:115], v[128:131]
    s_add_u32 m0, s71, 4096
    v_add_u32 v4, s62, v4
    v_mfma_f32_16x16x32_bf16 v[160:163], a[160:163], a[116:119], v[160:163]
    s_add_u32 s59, s59, 32768
    v_mfma_f32_16x16x32_bf16 v[192:195], a[160:163], a[120:123], v[192:195]
    buffer_load_dwordx4 v13, s[16:19], s59 offen offset:0 lds
    v_mfma_f32_16x16x32_bf16 v[224:227], a[160:163], a[124:127], v[224:227]
    ds_read_b64_tr_b16 a[160:161], v4 offset:0
    ds_read_b64_tr_b16 a[162:163], v4 offset:4096
    v_mfma_f32_16x16x32_bf16 v[132:135], a[164:167], a[112:115], v[132:135]
    s_bfe_u32 s40, s30, 0x80000
    v_add_u32 v5, s62, v5
    v_mfma_f32_16x16x32_bf16 v[164:167], a[164:167], a[116:119], v[164:167]
    s_lshl_b32 s40, s40, 13
    v_mfma_f32_16x16x32_bf16 v[196:199], a[164:167], a[120:123], v[196:199]
    buffer_load_dwordx4 a[96:99], v21, s[12:15], s40 offen offset:0 sc1
    v_mfma_f32_16x16x32_bf16 v[228:231], a[164:167], a[124:127], v[228:231]
    ds_read_b64_tr_b16 a[164:165], v5 offset:0
    ds_read_b64_tr_b16 a[166:167], v5 offset:4096
    s_waitcnt lgkmcnt(12)
    v_mfma_f32_16x16x32_bf16 v[136:139], a[168:171], a[112:115], v[136:139]
    v_add_u32 v6, s62, v6
    v_mfma_f32_16x16x32_bf16 v[168:171], a[168:171], a[116:119], v[168:171]
    v_mfma_f32_16x16x32_bf16 v[200:203], a[168:171], a[120:123], v[200:203]
    buffer_load_dwordx4 v14, s[16:19], s59 offen offset:1024 lds
    v_mfma_f32_16x16x32_bf16 v[232:235], a[168:171], a[124:127], v[232:235]
    ds_read_b64_tr_b16 a[168:169], v6 offset:0
    ds_read_b64_tr_b16 a[170:171], v6 offset:4096
    v_mfma_f32_16x16x32_bf16 v[140:143], a[172:175], a[112:115], v[140:143]
    v_add_u32 v7, s62, v7
    v_mfma_f32_16x16x32_bf16 v[172:175], a[172:175], a[116:119], v[172:175]
    v_mfma_f32_16x16x32_bf16 v[204:207], a[172:175], a[120:123], v[204:207]
    buffer_load_dwordx4 a[100:103], v21, s[12:15], s40 offen offset:1024 sc1
    v_mfma_f32_16x16x32_bf16 v[236:239], a[172:175], a[124:127], v[236:239]
    ds_read_b64_tr_b16 a[172:173], v7 offset:0
    ds_read_b64_tr_b16 a[174:175], v7 offset:4096
    s_waitcnt lgkmcnt(12)
    v_mfma_f32_16x16x32_bf16 v[144:147], a[176:179], a[112:115], v[144:147]
    v_add_u32 v8, s62, v8
    v_mfma_f32_16x16x32_bf16 v[176:179], a[176:179], a[116:119], v[176:179]
    v_mfma_f32_16x16x32_bf16 v[208:211], a[176:179], a[120:123], v[208:211]
    buffer_load_dwordx4 v15, s[16:19], s59 offen offset:2048 lds
    v_mfma_f32_16x16x32_bf16 v[240:243], a[176:179], a[124:127], v[240:243]
    ds_read_b64_tr_b16 a[176:177], v8 offset:0
    ds_read_b64_tr_b16 a[178:179], v8 offset:4096
    v_mfma_f32_16x16x32_bf16 v[148:151], a[180:183], a[112:115], v[148:151]
    v_add_u32 v9, s62, v9
    v_mfma_f32_16x16x32_bf16 v[180:183], a[180:183], a[116:119], v[180:183]
    v_mfma_f32_16x16x32_bf16 v[212:215], a[180:183], a[120:123], v[212:215]
    buffer_load_dwordx4 a[104:107], v22, s[12:15], s40 offen offset:0 sc1
    v_mfma_f32_16x16x32_bf16 v[244:247], a[180:183], a[124:127], v[244:247]
    ds_read_b64_tr_b16 a[180:181], v9 offset:0
    ds_read_b64_tr_b16 a[182:183], v9 offset:4096
    s_waitcnt lgkmcnt(12)
    v_mfma_f32_16x16x32_bf16 v[152:155], a[184:187], a[112:115], v[152:155]
    v_add_u32 v10, s62, v10
    v_mfma_f32_16x16x32_bf16 v[184:187], a[184:187], a[116:119], v[184:187]
    s_cmp_ge_u32 s71, 0x20000
    s_cselect_b32 s52, s64, 0x8000
    v_mfma_f32_16x16x32_bf16 v[216:219], a[184:187], a[120:123], v[216:219]
    buffer_load_dwordx4 v16, s[16:19], s59 offen offset:3072 lds
    v_mfma_f32_16x16x32_bf16 v[248:251], a[184:187], a[124:127], v[248:251]
    ds_read_b64_tr_b16 a[184:185], v10 offset:0
    ds_read_b64_tr_b16 a[186:187], v10 offset:4096
    v_mfma_f32_16x16x32_bf16 v[156:159], a[188:191], a[112:115], v[156:159]
    v_add_u32 v11, s62, v11
    v_mfma_f32_16x16x32_bf16 v[188:191], a[188:191], a[116:119], v[188:191]
    s_add_u32 s71, s71, s52
    v_mfma_f32_16x16x32_bf16 v[220:223], a[188:191], a[120:123], v[220:223]
    buffer_load_dwordx4 a[108:111], v22, s[12:15], s40 offen offset:1024 sc1
    v_mfma_f32_16x16x32_bf16 v[252:255], a[188:191], a[124:127], v[252:255]
    ds_read_b64_tr_b16 a[188:189], v11 offset:0
    ds_read_b64_tr_b16 a[190:191], v11 offset:4096
L_endB:
L_common:
    s_mov_b32 s48, 2
    s_call_b64 s[28:29], L_loop2_1
    v_max_u32 v28, 32, v2
    v_min_u32 v28, 63, v28
    v_lshlrev_b32 v28, 2, v28
    s_add_u32 s53, s76, 0x1e4000
    buffer_load_dword v29, v28, s[44:47], s53 offen sc1
    s_mov_b32 s48, 1
    s_call_b64 s[28:29], L_loop2_1
    s_waitcnt vmcnt(16)
    s_mov_b32 s48, 0x20000
L_pollH2:
    v_cmp_ne_u32 vcc, v3, v29
    s_sub_u32 s48, s48, 1
    s_nop 3
    s_cbranch_vccz L_pollH2_d
    s_cmp_eq_u32 s48, 0
    s_cbranch_scc1 L_pollH2_d
    s_sleep 1
    buffer_load_dword v29, v28, s[44:47], s53 offen sc1
    s_waitcnt vmcnt(0)
    s_branch L_pollH2
L_pollH2_d:
    s_mov_b32 s48, s79
    s_call_b64 s[28:29], L_loop2_0
    v_max_u32 v28, 0, v2
    v_min_u32 v28, 31, v28
    v_lshlrev_b32 v28, 2, v28
    s_add_u32 s53, s76, 0x1e5000
    s_waitcnt vmcnt(16)
    s_waitcnt lgkmcnt(12)
    v_mfma_f32_16x16x32_bf16 v[128:131], a[160:163], a[96:99], v[128:131]
    s_add_u32 m0, s71, 0
    v_mfma_f32_16x16x32_bf16 v[160:163], a[160:163], a[100:103], v[160:163]
    s_mov_b32 s59, 0x0
    v_mfma_f32_16x16x32_bf16 v[192:195], a[160:163], a[104:107], v[192:195]
    buffer_load_dwordx4 v17, s[20:23], s59 offen lds
    v_mfma_f32_16x16x32_bf16 v[224:227], a[160:163], a[108:111], v[224:227]
    ds_read_b64_tr_b16 a[160:161], v4 offset:16384
    ds_read_b64_tr_b16 a[162:163], v4 offset:20480
    v_mfma_f32_16x16x32_bf16 v[132:135], a[164:167], a[96:99], v[132:135]
    s_bfe_u32 s40, s30, 0x80010
    v_mfma_f32_16x16x32_bf16 v[164:167], a[164:167], a[100:103], v[164:167]
    s_lshl_b32 s40, s40, 13
    v_mfma_f32_16x16x32_bf16 v[196:199], a[164:167], a[104:107], v[196:199]
    buffer_load_dwordx4 a[144:147], v21, s[12:15], s40 offen offset:0 sc1
    v_mfma_f32_16x16x32_bf16 v[228:231], a[164:167], a[108:111], v[228:231]
    ds_read_b64_tr_b16 a[164:165], v5 offset:16384
    ds_read_b64_tr_b16 a[166:167], v5 offset:20480
    s_waitcnt lgkmcnt(12)
    v_mfma_f32_16x16x32_bf16 v[136:139], a[168:171], a[96:99], v[136:139]
    buffer_load_dword v29, v28, s[44:47], s53 offen sc1
    v_mfma_f32_16x16x32_bf16 v[168:171], a[168:171], a[100:103], v[168:171]
    s_lshr_b32 s30, s51, s73
    v_mfma_f32_16x16x32_bf16 v[200:203], a[168:171], a[104:107], v[200:203]
    v_mfma_f32_16x16x32_bf16 v[232:235], a[168:171], a[108:111], v[232:235]
    ds_read_b64_tr_b16 a[168:169], v6 offset:16384
    ds_read_b64_tr_b16 a[170:171], v6 offset:20480
    v_mfma_f32_16x16x32_bf16 v[140:143], a[172:175], a[96:99], v[140:143]
    s_mov_b32 s51, s31
    v_lshrrev_b32 v32, 2, v2
    v_and_b32 v33, 3, v2
    v_mfma_f32_16x16x32_bf16 v[172:175], a[172:175], a[100:103], v[172:175]
    s_add_u32 s41, s41, 1
    v_mfma_f32_16x16x32_bf16 v[204:207], a[172:175], a[104:107], v[204:207]
    buffer_load_dwordx4 a[148:151], v21, s[12:15], s40 offen offset:1024 sc1
    v_mfma_f32_16x16x32_bf16 v[236:239], a[172:175], a[108:111], v[236:239]
    ds_read_b64_tr_b16 a[172:173], v7 offset:16384
    ds_read_b64_tr_b16 a[174:175], v7 offset:20480
    s_waitcnt lgkmcnt(12)
    v_mfma_f32_16x16x32_bf16 v[144:147], a[176:179], a[96:99], v[144:147]
    s_add_u32 m0, s71, 1024
    v_lshlrev_b32 v32, 7, v32
    v_lshl_add_u32 v32, v33, 3, v32
    v_mfma_f32_16x16x32_bf16 v[176:179], a[176:179], a[100:103], v[176:179]
    s_mov_b32 s59, 0x4000
    v_readlane_b32 s31, v18, s41
    v_mfma_f32_16x16x32_bf16 v[208:211], a[176:179], a[104:107], v[208:211]
    buffer_load_dwordx4 v17, s[20:23], s59 offen lds
    v_mfma_f32_16x16x32_bf16 v[240:243], a[176:179], a[108:111], v[240:243]
    ds_read_b64_tr_b16 a[176:177], v8 offset:16384
    ds_read_b64_tr_b16 a[178:179], v8 offset:20480
    v_mfma_f32_16x16x32_bf16 v[148:151], a[180:183], a[96:99], v[148:151]
    s_cmp_eq_u32 s63, 0x20000
    s_cselect_b32 s62, s64, 0x8000
    v_bfe_u32 v33, v2, 3, 2
    v_lshl_add_u32 v32, v33, 5, v32
    v_mfma_f32_16x16x32_bf16 v[180:183], a[180:183], a[100:103], v[180:183]
    v_mfma_f32_16x16x32_bf16 v[212:215], a[180:183], a[104:107], v[212:215]
    buffer_load_dwordx4 a[152:155], v22, s[12:15], s40 offen offset:0 sc1
    v_mfma_f32_16x16x32_bf16 v[244:247], a[180:183], a[108:111], v[244:247]
    ds_read_b64_tr_b16 a[180:181], v9 offset:16384
    ds_read_b64_tr_b16 a[182:183], v9 offset:20480
    s_waitcnt lgkmcnt(12)
    v_mfma_f32_16x16x32_bf16 v[152:155], a[184:187], a[96:99], v[152:155]
    s_add_u32 s63, s63, s62
    v_xor_b32 v24, 0, v32
    v_xor_b32 v25, 32, v32
    v_mfma_f32_16x16x32_bf16 v[184:187], a[184:187], a[100:103], v[184:187]
    v_mfma_f32_16x16x32_bf16 v[216:219], a[184:187], a[104:107], v[216:219]
    v_mfma_f32_16x16x32_bf16 v[248:251], a[184:187], a[108:111], v[248:251]
    ds_read_b64_tr_b16 a[184:185], v10 offset:16384
    ds_read_b64_tr_b16 a[186:187], v10 offset:20480
    v_mfma_f32_16x16x32_bf16 v[156:159], a[188:191], a[96:99], v[156:159]
    v_xor_b32 v26, 64, v32
    v_xor_b32 v27, 96, v32
    v_mfma_f32_16x16x32_bf16 v[188:191], a[188:191], a[100:103], v[188:191]
    v_mfma_f32_16x16x32_bf16 v[220:223], a[188:191], a[104:107], v[220:223]
    buffer_load_dwordx4 a[156:159], v22, s[12:15], s40 offen offset:1024 sc1
    v_mfma_f32_16x16x32_bf16 v[252:255], a[188:191], a[108:111], v[252:255]
    ds_read_b64_tr_b16 a[188:189], v11 offset:16384
    ds_read_b64_tr_b16 a[190:191], v11 offset:20480
    s_waitcnt vmcnt(15)
    s_barrier
    s_waitcnt lgkmcnt(12)
    v_mfma_f32_16x16x32_bf16 v[128:131], a[160:163], a[112:115], v[128:131]
    s_add_u32 m0, s71, 2048
    v_add_u32 v4, s62, v4
    v_mfma_f32_16x16x32_bf16 v[160:163], a[160:163], a[116:119], v[160:163]
    s_mov_b32 s59, 0x8000
    v_mfma_f32_16x16x32_bf16 v[192:195], a[160:163], a[120:123], v[192:195]
    buffer_load_dwordx4 v17, s[20:23], s59 offen lds
    v_mfma_f32_16x16x32_bf16 v[224:227], a[160:163], a[124:127], v[224:227]
    ds_read_b64_tr_b16 a[160:161], v4 offset:0
    ds_read_b64_tr_b16 a[162:163], v4 offset:4096
    v_mfma_f32_16x16x32_bf16 v[132:135], a[164:167], a[112:115], v[132:135]
    s_bfe_u32 s40, s30, 0x80000
    v_add_u32 v5, s62, v5
    v_mfma_f32_16x16x32_bf16 v[164:167], a[164:167], a[116:119], v[164:167]
    s_lshl_b32 s40, s40, 13
    v_mfma_f32_16x16x32_bf16 v[196:199], a[164:167], a[120:123], v[196:199]
    buffer_load_dwordx4 a[96:99], v21, s[12:15], s40 offen offset:0 sc1
    v_mfma_f32_16x16x32_bf16 v[228:231], a[164:167], a[124:127], v[228:231]
    ds_read_b64_tr_b16 a[164:165], v5 offset:0
    ds_read_b64_tr_b16 a[166:167], v5 offset:4096
    s_waitcnt lgkmcnt(12)
    v_mfma_f32_16x16x32_bf16 v[136:139], a[168:171], a[112:115], v[136:139]
    v_add_u32 v6, s62, v6
    v_mfma_f32_16x16x32_bf16 v[168:171], a[168:171], a[116:119], v[168:171]
    s_lshl_b32 s61, s67, 2
    s_add_u32 s61, s61, s49
    v_mfma_f32_16x16x32_bf16 v[200:203], a[168:171], a[120:123], v[200:203]
    v_mfma_f32_16x16x32_bf16 v[232:235], a[168:171], a[124:127], v[232:235]
    ds_read_b64_tr_b16 a[168:169], v6 offset:0
    ds_read_b64_tr_b16 a[170:171], v6 offset:4096
    v_mfma_f32_16x16x32_bf16 v[140:143], a[172:175], a[112:115], v[140:143]
    v_add_u32 v7, s62, v7
    v_mfma_f32_16x16x32_bf16 v[172:175], a[172:175], a[116:119], v[172:175]
    s_lshl_b32 s61, s61, 16
    s_add_u32 s61, s61, s68
    v_mfma_f32_16x16x32_bf16 v[204:207], a[172:175], a[120:123], v[204:207]
    buffer_load_dwordx4 a[100:103], v21, s[12:15], s40 offen offset:1024 sc1
    v_mfma_f32_16x16x32_bf16 v[236:239], a[172:175], a[124:127], v[236:239]
    ds_read_b64_tr_b16 a[172:173], v7 offset:0
    ds_read_b64_tr_b16 a[174:175], v7 offset:4096
    s_waitcnt lgkmcnt(12)
    v_mfma_f32_16x16x32_bf16 v[144:147], a[176:179], a[112:115], v[144:147]
    s_add_u32 m0, s71, 3072
    v_add_u32 v8, s62, v8
    v_mfma_f32_16x16x32_bf16 v[176:179], a[176:179], a[116:119], v[176:179]
    s_mov_b32 s59, 0xc000
    v_and_b32 v32, 15, v2
    v_lshlrev_b32 v32, 11, v32
    v_mfma_f32_16x16x32_bf16 v[208:211], a[176:179], a[120:123], v[208:211]
    buffer_load_dwordx4 v17, s[20:23], s59 offen lds
    v_mfma_f32_16x16x32_bf16 v[240:243], a[176:179], a[124:127], v[240:243]
    ds_read_b64_tr_b16 a[176:177], v8 offset:0
    ds_read_b64_tr_b16 a[178:179], v8 offset:4096
    v_mfma_f32_16x16x32_bf16 v[148:151], a[180:183], a[112:115], v[148:151]
    v_add_u32 v9, s62, v9
    v_mfma_f32_16x16x32_bf16 v[180:183], a[180:183], a[116:119], v[180:183]
    v_bfe_u32 v33, v2, 4, 1
    v_lshl_add_u32 v32, v33, 5, v32
    v_mfma_f32_16x16x32_bf16 v[212:215], a[180:183], a[120:123], v[212:215]
    buffer_load_dwordx4 a[104:107], v22, s[12:15], s40 offen offset:0 sc1
    v_mfma_f32_16x16x32_bf16 v[244:247], a[180:183], a[124:127], v[244:247]
    ds_read_b64_tr_b16 a[180:181], v9 offset:0
    ds_read_b64_tr_b16 a[182:183], v9 offset:4096
    s_waitcnt lgkmcnt(12)
    v_mfma_f32_16x16x32_bf16 v[152:155], a[184:187], a[112:115], v[152:155]
    v_add_u32 v10, s62, v10
    v_mfma_f32_16x16x32_bf16 v[184:187], a[184:187], a[116:119], v[184:187]
    s_cmp_ge_u32 s71, 0x20000
    s_cselect_b32 s52, s64, 0x8000
    v_lshrrev_b32 v33, 5, v2
    v_lshl_add_u32 v32, v33, 4, v32
    v_mfma_f32_16x16x32_bf16 v[216:219], a[184:187], a[120:123], v[216:219]
    v_mfma_f32_16x16x32_bf16 v[248:251], a[184:187], a[124:127], v[248:251]
    ds_read_b64_tr_b16 a[184:185], v10 offset:0
    ds_read_b64_tr_b16 a[186:187], v10 offset:4096
    v_mfma_f32_16x16x32_bf16 v[156:159], a[188:191], a[112:115], v[156:159]
    v_add_u32 v11, s62, v11
    v_mfma_f32_16x16x32_bf16 v[188:191], a[188:191], a[116:119], v[188:191]
    s_add_u32 s71, s71, s52
    v_add_u32 v0, s61, v32
    v_add_u32 v1, 0x8000, v0
    v_mfma_f32_16x16x32_bf16 v[220:223], a[188:191], a[120:123], v[220:223]
    buffer_load_dwordx4 a[108:111], v22, s[12:15], s40 offen offset:1024 sc1
    v_mfma_f32_16x16x32_bf16 v[252:255], a[188:191], a[124:127], v[252:255]
    ds_read_b64_tr_b16 a[188:189], v11 offset:0
    ds_read_b64_tr_b16 a[190:191], v11 offset:4096
    s_waitcnt vmcnt(10)
    s_mov_b32 s48, 0x20000
L_pollO:
    v_cmp_ne_u32 vcc, v3, v29
    s_sub_u32 s48, s48, 1
    s_nop 3
    s_cbranch_vccz L_pollO_d
    s_cmp_eq_u32 s48, 0
    s_cbranch_scc1 L_pollO_d
    s_sleep 1
    buffer_load_dword v29, v28, s[44:47], s53 offen sc1
    s_waitcnt vmcnt(0)
    s_branch L_pollO
L_pollO_d:
    s_or_b32 s52, s2, s49
    s_cmp_lg_u32 s52, 0
    s_cselect_b32 s52, 0x400000, 0
    s_add_u32 s52, s52, 0x1ec000
    buffer_store_dword v3, v31, s[44:47], s52 offen sc1
    s_waitcnt vmcnt(11)
    s_waitcnt lgkmcnt(12)
    v_mfma_f32_16x16x32_bf16 v[128:131], a[160:163], a[128:131], v[128:131]
    s_add_u32 m0, s71, 0
    v_mfma_f32_16x16x32_bf16 v[160:163], a[160:163], a[132:135], v[160:163]
    s_mov_b32 s59, 0x40000
    v_mfma_f32_16x16x32_bf16 v[192:195], a[160:163], a[136:139], v[192:195]
    buffer_load_dwordx4 v17, s[20:23], s59 offen lds
    v_mfma_f32_16x16x32_bf16 v[224:227], a[160:163], a[140:143], v[224:227]
    ds_read_b64_tr_b16 a[160:161], v4 offset:16384
    ds_read_b64_tr_b16 a[162:163], v4 offset:20480
    v_mfma_f32_16x16x32_bf16 v[132:135], a[164:167], a[128:131], v[132:135]
    s_bfe_u32 s40, s30, 0x80010
    v_mfma_f32_16x16x32_bf16 v[164:167], a[164:167], a[132:135], v[164:167]
    s_lshl_b32 s40, s40, 13
    v_mfma_f32_16x16x32_bf16 v[196:199], a[164:167], a[136:139], v[196:199]
    buffer_load_dwordx4 a[112:115], v21, s[12:15], s40 offen offset:0 sc1
    v_mfma_f32_16x16x32_bf16 v[228:231], a[164:167], a[140:143], v[228:231]
    ds_read_b64_tr_b16 a[164:165], v5 offset:16384
    ds_read_b64_tr_b16 a[166:167], v5 offset:20480
    s_waitcnt lgkmcnt(12)
    v_mfma_f32_16x16x32_bf16 v[136:139], a[168:171], a[128:131], v[136:139]
    v_mfma_f32_16x16x32_bf16 v[168:171], a[168:171], a[132:135], v[168:171]
    s_lshr_b32 s30, s51, s73
    v_mfma_f32_16x16x32_bf16 v[200:203], a[168:171], a[136:139], v[200:203]
    v_mfma_f32_16x16x32_bf16 v[232:235], a[168:171], a[140:143], v[232:235]
    ds_read_b64_tr_b16 a[168:169], v6 offset:16384
    ds_read_b64_tr_b16 a[170:171], v6 offset:20480
    v_mfma_f32_16x16x32_bf16 v[140:143], a[172:175], a[128:131], v[140:143]
    s_mov_b32 s51, s31
    v_mfma_f32_16x16x32_bf16 v[172:175], a[172:175], a[132:135], v[172:175]
    s_add_u32 s41, s41, 1
    v_mfma_f32_16x16x32_bf16 v[204:207], a[172:175], a[136:139], v[204:207]
    buffer_load_dwordx4 a[116:119], v21, s[12:15], s40 offen offset:1024 sc1
    v_mfma_f32_16x16x32_bf16 v[236:239], a[172:175], a[140:143], v[236:239]
    ds_read_b64_tr_b16 a[172:173], v7 offset:16384
    ds_read_b64_tr_b16 a[174:175], v7 offset:20480
    s_waitcnt lgkmcnt(12)
    v_mfma_f32_16x16x32_bf16 v[144:147], a[176:179], a[128:131], v[144:147]
    s_add_u32 m0, s71, 1024
    v_mfma_f32_16x16x32_bf16 v[176:179], a[176:179], a[132:135], v[176:179]
    s_mov_b32 s59, 0x44000
    v_readlane_b32 s31, v18, s41
    v_mfma_f32_16x16x32_bf16 v[208:211], a[176:179], a[136:139], v[208:211]
    buffer_load_dwordx4 v17, s[20:23], s59 offen lds
    v_mfma_f32_16x16x32_bf16 v[240:243], a[176:179], a[140:143], v[240:243]
    ds_read_b64_tr_b16 a[176:177], v8 offset:16384
    ds_read_b64_tr_b16 a[178:179], v8 offset:20480
    v_mfma_f32_16x16x32_bf16 v[148:151], a[180:183], a[128:131], v[148:151]
    s_cmp_eq_u32 s63, 0x20000
    s_cselect_b32 s62, s64, 0x8000
    v_mfma_f32_16x16x32_bf16 v[180:183], a[180:183], a[132:135], v[180:183]
    v_mfma_f32_16x16x32_bf16 v[212:215], a[180:183], a[136:139], v[212:215]
    buffer_load_dwordx4 a[120:123], v22, s[12:15], s40 offen offset:0 sc1
    v_mfma_f32_16x16x32_bf16 v[244:247], a[180:183], a[140:143], v[244:247]
    ds_read_b64_tr_b16 a[180:181], v9 offset:16384
    ds_read_b64_tr_b16 a[182:183], v9 offset:20480
    s_waitcnt lgkmcnt(12)
    v_mfma_f32_16x16x32_bf16 v[152:155], a[184:187], a[128:131], v[152:155]
    s_add_u32 s63, s63, s62
    v_mfma_f32_16x16x32_bf16 v[184:187], a[184:187], a[132:135], v[184:187]
    v_mfma_f32_16x16x32_bf16 v[216:219], a[184:187], a[136:139], v[216:219]
    v_mfma_f32_16x16x32_bf16 v[248:251], a[184:187], a[140:143], v[248:251]
    ds_read_b64_tr_b16 a[184:185], v10 offset:16384
    ds_read_b64_tr_b16 a[186:187], v10 offset:20480
    v_mfma_f32_16x16x32_bf16 v[156:159], a[188:191], a[128:131], v[156:159]
    v_mfma_f32_16x16x32_bf16 v[188:191], a[188:191], a[132:135], v[188:191]
    v_mfma_f32_16x16x32_bf16 v[220:223], a[188:191], a[136:139], v[220:223]
    buffer_load_dwordx4 a[124:127], v22, s[12:15], s40 offen offset:1024 sc1
    v_mfma_f32_16x16x32_bf16 v[252:255], a[188:191], a[140:143], v[252:255]
    ds_read_b64_tr_b16 a[188:189], v11 offset:16384
    ds_read_b64_tr_b16 a[190:191], v11 offset:20480
    s_waitcnt vmcnt(13)
    s_barrier
    s_waitcnt lgkmcnt(12)
    v_mfma_f32_16x16x32_bf16 v[128:131], a[160:163], a[144:147], v[128:131]
    s_add_u32 m0, s71, 2048
    v_add_u32 v4, s62, v4
    v_mfma_f32_16x16x32_bf16 v[160:163], a[160:163], a[148:151], v[160:163]
    s_mov_b32 s59, 0x48000
    v_mfma_f32_16x16x32_bf16 v[192:195], a[160:163], a[152:155], v[192:195]
    buffer_load_dwordx4 v17, s[20:23], s59 offen lds
    v_mfma_f32_16x16x32_bf16 v[224:227], a[160:163], a[156:159], v[224:227]
    ds_read_b64_tr_b16 a[160:161], v4 offset:0
    ds_read_b64_tr_b16 a[162:163], v4 offset:4096
    v_mfma_f32_16x16x32_bf16 v[132:135], a[164:167], a[144:147], v[132:135]
    v_add_u32 v5, s62, v5
    v_mfma_f32_16x16x32_bf16 v[164:167], a[164:167], a[148:151], v[164:167]
    s_mov_b32 s40, 0xe0000
    v_mfma_f32_16x16x32_bf16 v[196:199], a[164:167], a[152:155], v[196:199]
    buffer_load_dwordx4 a[128:131], v21, s[12:15], s40 offen offset:0 sc1
    v_mfma_f32_16x16x32_bf16 v[228:231], a[164:167], a[156:159], v[228:231]
    ds_read_b64_tr_b16 a[164:165], v5 offset:0
    ds_read_b64_tr_b16 a[166:167], v5 offset:4096
    s_waitcnt lgkmcnt(12)
    v_mfma_f32_16x16x32_bf16 v[136:139], a[168:171], a[144:147], v[136:139]
    v_add_u32 v6, s62, v6
    v_mfma_f32_16x16x32_bf16 v[168:171], a[168:171], a[148:151], v[168:171]
    v_mfma_f32_16x16x32_bf16 v[200:203], a[168:171], a[152:155], v[200:203]
    v_mfma_f32_16x16x32_bf16 v[232:235], a[168:171], a[156:159], v[232:235]
    ds_read_b64_tr_b16 a[168:169], v6 offset:0
    ds_read_b64_tr_b16 a[170:171], v6 offset:4096
    v_mfma_f32_16x16x32_bf16 v[140:143], a[172:175], a[144:147], v[140:143]
    v_add_u32 v7, s62, v7
    v_mfma_f32_16x16x32_bf16 v[172:175], a[172:175], a[148:151], v[172:175]
    v_mfma_f32_16x16x32_bf16 v[204:207], a[172:175], a[152:155], v[204:207]
    buffer_load_dwordx4 a[132:135], v21, s[12:15], s40 offen offset:1024 sc1
    v_mfma_f32_16x16x32_bf16 v[236:239], a[172:175], a[156:159], v[236:239]
    ds_read_b64_tr_b16 a[172:173], v7 offset:0
    ds_read_b64_tr_b16 a[174:175], v7 offset:4096
    s_waitcnt lgkmcnt(12)
    v_mfma_f32_16x16x32_bf16 v[144:147], a[176:179], a[144:147], v[144:147]
    s_add_u32 m0, s71, 3072
    v_add_u32 v8, s62, v8
    v_mfma_f32_16x16x32_bf16 v[176:179], a[176:179], a[148:151], v[176:179]
    s_mov_b32 s59, 0x4c000
    v_mfma_f32_16x16x32_bf16 v[208:211], a[176:179], a[152:155], v[208:211]
    buffer_load_dwordx4 v17, s[20:23], s59 offen lds
    v_mfma_f32_16x16x32_bf16 v[240:243], a[176:179], a[156:159], v[240:243]
    ds_read_b64_tr_b16 a[176:177], v8 offset:0
    ds_read_b64_tr_b16 a[178:179], v8 offset:4096
    v_mfma_f32_16x16x32_bf16 v[148:151], a[180:183], a[144:147], v[148:151]
    v_add_u32 v9, s62, v9
    v_mfma_f32_16x16x32_bf16 v[180:183], a[180:183], a[148:151], v[180:183]
    s_mov_b32 s40, 0xe2000
    v_mfma_f32_16x16x32_bf16 v[212:215], a[180:183], a[152:155], v[212:215]
    buffer_load_dwordx4 a[136:139], v21, s[12:15], s40 offen offset:0 sc1
    v_mfma_f32_16x16x32_bf16 v[244:247], a[180:183], a[156:159], v[244:247]
    ds_read_b64_tr_b16 a[180:181], v9 offset:0
    ds_read_b64_tr_b16 a[182:183], v9 offset:4096
    s_waitcnt lgkmcnt(12)
    v_mfma_f32_16x16x32_bf16 v[152:155], a[184:187], a[144:147], v[152:155]
    v_add_u32 v10, s62, v10
    v_mfma_f32_16x16x32_bf16 v[184:187], a[184:187], a[148:151], v[184:187]
    s_cmp_ge_u32 s71, 0x20000
    s_cselect_b32 s52, s64, 0x8000
    v_mfma_f32_16x16x32_bf16 v[216:219], a[184:187], a[152:155], v[216:219]
    v_mfma_f32_16x16x32_bf16 v[248:251], a[184:187], a[156:159], v[248:251]
    ds_read_b64_tr_b16 a[184:185], v10 offset:0
    ds_read_b64_tr_b16 a[186:187], v10 offset:4096
    v_mfma_f32_16x16x32_bf16 v[156:159], a[188:191], a[144:147], v[156:159]
    v_add_u32 v11, s62, v11
    v_mfma_f32_16x16x32_bf16 v[188:191], a[188:191], a[148:151], v[188:191]
    s_add_u32 s71, s71, s52
    v_mfma_f32_16x16x32_bf16 v[220:223], a[188:191], a[152:155], v[220:223]
    buffer_load_dwordx4 a[140:143], v21, s[12:15], s40 offen offset:1024 sc1
    v_mfma_f32_16x16x32_bf16 v[252:255], a[188:191], a[156:159], v[252:255]
    ds_read_b64_tr_b16 a[188:189], v11 offset:0
    ds_read_b64_tr_b16 a[190:191], v11 offset:4096
    s_waitcnt vmcnt(13)
    s_waitcnt lgkmcnt(12)
    v_mfma_f32_16x16x32_bf16 v[128:131], a[160:163], a[96:99], v[128:131]
    s_add_u32 m0, s71, 0
    v_mfma_f32_16x16x32_bf16 v[160:163], a[160:163], a[100:103], v[160:163]
    s_mov_b32 s59, 0x80000
    v_mfma_f32_16x16x32_bf16 v[192:195], a[160:163], a[104:107], v[192:195]
    buffer_load_dwordx4 v17, s[20:23], s59 offen lds
    v_mfma_f32_16x16x32_bf16 v[224:227], a[160:163], a[108:111], v[224:227]
    ds_read_b64_tr_b16 a[160:161], v4 offset:16384
    ds_read_b64_tr_b16 a[162:163], v4 offset:20480
    v_mfma_f32_16x16x32_bf16 v[132:135], a[164:167], a[96:99], v[132:135]
    v_mfma_f32_16x16x32_bf16 v[164:167], a[164:167], a[100:103], v[164:167]
    s_mov_b32 s40, 0xe4000
    v_mfma_f32_16x16x32_bf16 v[196:199], a[164:167], a[104:107], v[196:199]
    buffer_load_dwordx4 a[144:147], v21, s[12:15], s40 offen offset:0 sc1
    v_mfma_f32_16x16x32_bf16 v[228:231], a[164:167], a[108:111], v[228:231]
    ds_read_b64_tr_b16 a[164:165], v5 offset:16384
    ds_read_b64_tr_b16 a[166:167], v5 offset:20480
    s_waitcnt lgkmcnt(12)
    v_mfma_f32_16x16x32_bf16 v[136:139], a[168:171], a[96:99], v[136:139]
    v_mfma_f32_16x16x32_bf16 v[168:171], a[168:171], a[100:103], v[168:171]
    s_lshr_b32 s30, s51, s73
    v_mfma_f32_16x16x32_bf16 v[200:203], a[168:171], a[104:107], v[200:203]
    v_mfma_f32_16x16x32_bf16 v[232:235], a[168:171], a[108:111], v[232:235]
    ds_read_b64_tr_b16 a[168:169], v6 offset:16384
    ds_read_b64_tr_b16 a[170:171], v6 offset:20480
    v_mfma_f32_16x16x32_bf16 v[140:143], a[172:175], a[96:99], v[140:143]
    s_mov_b32 s51, s31
    v_mfma_f32_16x16x32_bf16 v[172:175], a[172:175], a[100:103], v[172:175]
    s_add_u32 s41, s41, 1
    v_mfma_f32_16x16x32_bf16 v[204:207], a[172:175], a[104:107], v[204:207]
    buffer_load_dwordx4 a[148:151], v21, s[12:15], s40 offen offset:1024 sc1
    v_mfma_f32_16x16x32_bf16 v[236:239], a[172:175], a[108:111], v[236:239]
    ds_read_b64_tr_b16 a[172:173], v7 offset:16384
    ds_read_b64_tr_b16 a[174:175], v7 offset:20480
    s_waitcnt lgkmcnt(12)
    v_mfma_f32_16x16x32_bf16 v[144:147], a[176:179], a[96:99], v[144:147]
    s_add_u32 m0, s71, 1024
    v_mfma_f32_16x16x32_bf16 v[176:179], a[176:179], a[100:103], v[176:179]
    s_mov_b32 s59, 0x84000
    v_readlane_b32 s31, v18, s41
    v_mfma_f32_16x16x32_bf16 v[208:211], a[176:179], a[104:107], v[208:211]
    buffer_load_dwordx4 v17, s[20:23], s59 offen lds
    v_mfma_f32_16x16x32_bf16 v[240:243], a[176:179], a[108:111], v[240:243]
    ds_read_b64_tr_b16 a[176:177], v8 offset:16384
    ds_read_b64_tr_b16 a[178:179], v8 offset:20480
    v_mfma_f32_16x16x32_bf16 v[148:151], a[180:183], a[96:99], v[148:151]
    s_cmp_eq_u32 s63, 0x20000
    s_cselect_b32 s62, s64, 0x8000
    v_mfma_f32_16x16x32_bf16 v[180:183], a[180:183], a[100:103], v[180:183]
    s_mov_b32 s40, 0xe6000
    v_mfma_f32_16x16x32_bf16 v[212:215], a[180:183], a[104:107], v[212:215]
    buffer_load_dwordx4 a[152:155], v21, s[12:15], s40 offen offset:0 sc1
    v_mfma_f32_16x16x32_bf16 v[244:247], a[180:183], a[108:111], v[244:247]
    ds_read_b64_tr_b16 a[180:181], v9 offset:16384
    ds_read_b64_tr_b16 a[182:183], v9 offset:20480
    s_waitcnt lgkmcnt(12)
    v_mfma_f32_16x16x32_bf16 v[152:155], a[184:187], a[96:99], v[152:155]
    s_add_u32 s63, s63, s62
    v_mfma_f32_16x16x32_bf16 v[184:187], a[184:187], a[100:103], v[184:187]
    v_mfma_f32_16x16x32_bf16 v[216:219], a[184:187], a[104:107], v[216:219]
    v_mfma_f32_16x16x32_bf16 v[248:251], a[184:187], a[108:111], v[248:251]
    ds_read_b64_tr_b16 a[184:185], v10 offset:16384
    ds_read_b64_tr_b16 a[186:187], v10 offset:20480
    v_mfma_f32_16x16x32_bf16 v[156:159], a[188:191], a[96:99], v[156:159]
    v_mfma_f32_16x16x32_bf16 v[188:191], a[188:191], a[100:103], v[188:191]
    v_mfma_f32_16x16x32_bf16 v[220:223], a[188:191], a[104:107], v[220:223]
    buffer_load_dwordx4 a[156:159], v21, s[12:15], s40 offen offset:1024 sc1
    v_mfma_f32_16x16x32_bf16 v[252:255], a[188:191], a[108:111], v[252:255]
    ds_read_b64_tr_b16 a[188:189], v11 offset:16384
    ds_read_b64_tr_b16 a[190:191], v11 offset:20480
    s_waitcnt vmcnt(12)
    s_barrier
    s_waitcnt lgkmcnt(12)
    v_mfma_f32_16x16x32_bf16 v[128:131], a[160:163], a[112:115], v[128:131]
    s_add_u32 m0, s71, 2048
    v_add_u32 v24, s63, v24
    v_mfma_f32_16x16x32_bf16 v[160:163], a[160:163], a[116:119], v[160:163]
    s_mov_b32 s59, 0x88000
    v_mfma_f32_16x16x32_bf16 v[192:195], a[160:163], a[120:123], v[192:195]
    buffer_load_dwordx4 v17, s[20:23], s59 offen lds
    v_mfma_f32_16x16x32_bf16 v[224:227], a[160:163], a[124:127], v[224:227]
    ds_read_b64_tr_b16 a[160:161], v24 offset:0
    ds_read_b64_tr_b16 a[162:163], v24 offset:2048
    v_mfma_f32_16x16x32_bf16 v[132:135], a[164:167], a[112:115], v[132:135]
    v_add_u32 v25, s63, v25
    v_mfma_f32_16x16x32_bf16 v[164:167], a[164:167], a[116:119], v[164:167]
    s_mov_b32 s40, 0xe8000
    v_mfma_f32_16x16x32_bf16 v[196:199], a[164:167], a[120:123], v[196:199]
    buffer_load_dwordx4 a[96:99], v21, s[12:15], s40 offen offset:0 sc1
    v_mfma_f32_16x16x32_bf16 v[228:231], a[164:167], a[124:127], v[228:231]
    ds_read_b64_tr_b16 a[164:165], v25 offset:0
    ds_read_b64_tr_b16 a[166:167], v25 offset:2048
    s_waitcnt lgkmcnt(12)
    v_mfma_f32_16x16x32_bf16 v[136:139], a[168:171], a[112:115], v[136:139]
    v_add_u32 v26, s63, v26
    v_mfma_f32_16x16x32_bf16 v[168:171], a[168:171], a[116:119], v[168:171]
    v_mfma_f32_16x16x32_bf16 v[200:203], a[168:171], a[120:123], v[200:203]
    v_mfma_f32_16x16x32_bf16 v[232:235], a[168:171], a[124:127], v[232:235]
    ds_read_b64_tr_b16 a[168:169], v26 offset:0
    ds_read_b64_tr_b16 a[170:171], v26 offset:2048
    v_mfma_f32_16x16x32_bf16 v[140:143], a[172:175], a[112:115], v[140:143]
    v_add_u32 v27, s63, v27
    v_mfma_f32_16x16x32_bf16 v[172:175], a[172:175], a[116:119], v[172:175]
    v_mfma_f32_16x16x32_bf16 v[204:207], a[172:175], a[120:123], v[204:207]
    buffer_load_dwordx4 a[100:103], v21, s[12:15], s40 offen offset:1024 sc1
    v_mfma_f32_16x16x32_bf16 v[236:239], a[172:175], a[124:127], v[236:239]
    ds_read_b64_tr_b16 a[172:173], v27 offset:0
    ds_read_b64_tr_b16 a[174:175], v27 offset:2048
    s_waitcnt lgkmcnt(12)
    v_mfma_f32_16x16x32_bf16 v[144:147], a[176:179], a[112:115], v[144:147]
    s_add_u32 m0, s71, 3072
    v_mfma_f32_16x16x32_bf16 v[176:179], a[176:179], a[116:119], v[176:179]
    s_mov_b32 s59, 0x8c000
    v_mfma_f32_16x16x32_bf16 v[208:211], a[176:179], a[120:123], v[208:211]
    buffer_load_dwordx4 v17, s[20:23], s59 offen lds
    v_mfma_f32_16x16x32_bf16 v[240:243], a[176:179], a[124:127], v[240:243]
    ds_read_b64_tr_b16 a[176:177], v24 offset:8192
    ds_read_b64_tr_b16 a[178:179], v24 offset:10240
    v_mfma_f32_16x16x32_bf16 v[148:151], a[180:183], a[112:115], v[148:151]
    v_mfma_f32_16x16x32_bf16 v[180:183], a[180:183], a[116:119], v[180:183]
    s_mov_b32 s40, 0xea000
    v_mfma_f32_16x16x32_bf16 v[212:215], a[180:183], a[120:123], v[212:215]
    buffer_load_dwordx4 a[104:107], v21, s[12:15], s40 offen offset:0 sc1
    v_mfma_f32_16x16x32_bf16 v[244:247], a[180:183], a[124:127], v[244:247]
    ds_read_b64_tr_b16 a[180:181], v25 offset:8192
    ds_read_b64_tr_b16 a[182:183], v25 offset:10240
    s_waitcnt lgkmcnt(12)
    v_mfma_f32_16x16x32_bf16 v[152:155], a[184:187], a[112:115], v[152:155]
    v_mfma_f32_16x16x32_bf16 v[184:187], a[184:187], a[116:119], v[184:187]
    s_cmp_ge_u32 s71, 0x20000
    s_cselect_b32 s52, s64, 0x8000
    v_mfma_f32_16x16x32_bf16 v[216:219], a[184:187], a[120:123], v[216:219]
    v_mfma_f32_16x16x32_bf16 v[248:251], a[184:187], a[124:127], v[248:251]
    ds_read_b64_tr_b16 a[184:185], v26 offset:8192
    ds_read_b64_tr_b16 a[186:187], v26 offset:10240
    v_mfma_f32_16x16x32_bf16 v[156:159], a[188:191], a[112:115], v[156:159]
    v_mfma_f32_16x16x32_bf16 v[188:191], a[188:191], a[116:119], v[188:191]
    s_add_u32 s71, s71, s52
    v_mfma_f32_16x16x32_bf16 v[220:223], a[188:191], a[120:123], v[220:223]
    buffer_load_dwordx4 a[108:111], v21, s[12:15], s40 offen offset:1024 sc1
    v_mfma_f32_16x16x32_bf16 v[252:255], a[188:191], a[124:127], v[252:255]
    ds_read_b64_tr_b16 a[188:189], v27 offset:8192
    ds_read_b64_tr_b16 a[190:191], v27 offset:10240
    s_sub_u32 s52, s71, s70
    s_cmp_ge_u32 s52, 0x20000
    s_cselect_b32 s53, s64, 0x8000
    s_cmp_lg_u32 s55, 0
    s_cselect_b32 s53, s53, 0
    s_add_u32 s52, s52, s53
    s_lshl_b32 s53, s54, 14
    s_add_u32 s52, s52, s53
    v_add_u32 v28, s52, v12
    v_xor_b32 v29, 0x4000, v28
    s_mov_b32 s40, 0xec000
    buffer_load_dwordx4 a[112:115], v21, s[12:15], s40 offen offset:0 sc1
    buffer_load_dwordx4 a[116:119], v21, s[12:15], s40 offen offset:1024 sc1
    s_barrier
    ds_write_b128 v28, v[208:211] offset:4096
    s_mov_b32 s40, 0xee000
    buffer_load_dwordx4 a[120:123], v21, s[12:15], s40 offen offset:0 sc1
    ds_write_b128 v28, v[212:215] offset:5120
    buffer_load_dwordx4 a[124:127], v21, s[12:15], s40 offen offset:1024 sc1
    ds_write_b128 v28, v[216:219] offset:6144
    s_mov_b32 s40, 0xf0000
    buffer_load_dwordx4 a[0:3], v21, s[12:15], s40 offen offset:0 sc1
    ds_write_b128 v28, v[220:223] offset:7168
    buffer_load_dwordx4 a[4:7], v21, s[12:15], s40 offen offset:1024 sc1
    ds_write_b128 v28, v[240:243] offset:12288
    s_mov_b32 s40, 0xf2000
    buffer_load_dwordx4 a[8:11], v21, s[12:15], s40 offen offset:0 sc1
    ds_write_b128 v28, v[244:247] offset:13312
    buffer_load_dwordx4 a[12:15], v21, s[12:15], s40 offen offset:1024 sc1
    ds_write_b128 v28, v[248:251] offset:14336
    s_mov_b32 s40, 0xf4000
    buffer_load_dwordx4 a[16:19], v21, s[12:15], s40 offen offset:0 sc1
    ds_write_b128 v28, v[252:255] offset:15360
    buffer_load_dwordx4 a[20:23], v21, s[12:15], s40 offen offset:1024 sc1
    ds_write_b128 v28, v[192:195] offset:0
    s_mov_b32 s40, 0xf6000
    buffer_load_dwordx4 a[24:27], v21, s[12:15], s40 offen offset:0 sc1
    ds_write_b128 v28, v[196:199] offset:1024
    buffer_load_dwordx4 a[28:31], v21, s[12:15], s40 offen offset:1024 sc1
    ds_write_b128 v28, v[200:203] offset:2048
    buffer_load_dwordx4 v[96:99], v0, s[8:11], 0 offen offset:0
    ds_write_b128 v28, v[204:207] offset:3072
    buffer_load_dwordx4 v[100:103], v0, s[8:11], 0 offen offset:64
    ds_write_b128 v28, v[224:227] offset:8192
    buffer_load_dwordx4 v[104:107], v1, s[8:11], 0 offen offset:0
    ds_write_b128 v28, v[228:231] offset:9216
    buffer_load_dwordx4 v[108:111], v1, s[8:11], 0 offen offset:64
    ds_write_b128 v28, v[232:235] offset:10240
    ds_write_b128 v28, v[236:239] offset:11264
    s_waitcnt lgkmcnt(0)
    s_barrier
    ds_read_b128 v[48:51], v29 offset:4096
    ds_read_b128 v[52:55], v29 offset:5120
    ds_read_b128 v[56:59], v29 offset:6144
    ds_read_b128 v[60:63], v29 offset:7168
    ds_read_b128 v[80:83], v29 offset:12288
    ds_read_b128 v[84:87], v29 offset:13312
    ds_read_b128 v[88:91], v29 offset:14336
    ds_read_b128 v[92:95], v29 offset:15360
    ds_read_b128 v[32:35], v29 offset:0
    ds_read_b128 v[36:39], v29 offset:1024
    ds_read_b128 v[40:43], v29 offset:2048
    ds_read_b128 v[44:47], v29 offset:3072
    ds_read_b128 v[64:67], v29 offset:8192
    ds_read_b128 v[68:71], v29 offset:9216
    ds_read_b128 v[72:75], v29 offset:10240
    ds_read_b128 v[76:79], v29 offset:11264
    s_waitcnt lgkmcnt(12)
    v_pk_add_f32 v[144:145], v[144:145], v[48:49]
    v_pk_add_f32 v[146:147], v[146:147], v[50:51]
    v_pk_add_f32 v[148:149], v[148:149], v[52:53]
    v_pk_add_f32 v[150:151], v[150:151], v[54:55]
    v_pk_add_f32 v[152:153], v[152:153], v[56:57]
    v_pk_add_f32 v[154:155], v[154:155], v[58:59]
    v_pk_add_f32 v[156:157], v[156:157], v[60:61]
    v_pk_add_f32 v[158:159], v[158:159], v[62:63]
    s_waitcnt lgkmcnt(8)
    v_pk_add_f32 v[176:177], v[176:177], v[80:81]
    v_pk_add_f32 v[178:179], v[178:179], v[82:83]
    v_pk_add_f32 v[180:181], v[180:181], v[84:85]
    v_pk_add_f32 v[182:183], v[182:183], v[86:87]
    v_pk_add_f32 v[184:185], v[184:185], v[88:89]
    v_pk_add_f32 v[186:187], v[186:187], v[90:91]
    v_pk_add_f32 v[188:189], v[188:189], v[92:93]
    v_pk_add_f32 v[190:191], v[190:191], v[94:95]
    v_cvt_pk_bf16_f32 v112, v144, v145
    v_cvt_pk_bf16_f32 v113, v146, v147
    v_cvt_pk_bf16_f32 v114, v148, v149
    v_cvt_pk_bf16_f32 v115, v150, v151
    buffer_store_dwordx4 v[112:115], v12, s[36:39], s77 offen offset:0 sc1
    v_cvt_pk_bf16_f32 v116, v152, v153
    v_cvt_pk_bf16_f32 v117, v154, v155
    v_cvt_pk_bf16_f32 v118, v156, v157
    v_cvt_pk_bf16_f32 v119, v158, v159
    buffer_store_dwordx4 v[116:119], v12, s[36:39], s77 offen offset:1024 sc1
    v_cvt_pk_bf16_f32 v120, v176, v177
    v_cvt_pk_bf16_f32 v121, v178, v179
    v_cvt_pk_bf16_f32 v122, v180, v181
    v_cvt_pk_bf16_f32 v123, v182, v183
    buffer_store_dwordx4 v[120:123], v12, s[36:39], s77 offen offset:2048 sc1
    v_cvt_pk_bf16_f32 v124, v184, v185
    v_cvt_pk_bf16_f32 v125, v186, v187
    v_cvt_pk_bf16_f32 v126, v188, v189
    v_cvt_pk_bf16_f32 v127, v190, v191
    buffer_store_dwordx4 v[124:127], v12, s[36:39], s77 offen offset:3072 sc1
    s_waitcnt lgkmcnt(4)
    v_pk_add_f32 v[128:129], v[128:129], v[32:33]
    v_pk_add_f32 v[130:131], v[130:131], v[34:35]
    v_pk_add_f32 v[132:133], v[132:133], v[36:37]
    v_pk_add_f32 v[134:135], v[134:135], v[38:39]
    v_pk_add_f32 v[136:137], v[136:137], v[40:41]
    v_pk_add_f32 v[138:139], v[138:139], v[42:43]
    v_pk_add_f32 v[140:141], v[140:141], v[44:45]
    v_pk_add_f32 v[142:143], v[142:143], v[46:47]
    s_waitcnt lgkmcnt(0)
    v_pk_add_f32 v[160:161], v[160:161], v[64:65]
    v_pk_add_f32 v[162:163], v[162:163], v[66:67]
    v_pk_add_f32 v[164:165], v[164:165], v[68:69]
    v_pk_add_f32 v[166:167], v[166:167], v[70:71]
    v_pk_add_f32 v[168:169], v[168:169], v[72:73]
    v_pk_add_f32 v[170:171], v[170:171], v[74:75]
    v_pk_add_f32 v[172:173], v[172:173], v[76:77]
    v_pk_add_f32 v[174:175], v[174:175], v[78:79]
    s_barrier
    s_waitcnt vmcnt(35)
    s_waitcnt lgkmcnt(12)
    v_mfma_f32_16x16x32_bf16 v[192:195], a[160:163], a[128:131], 0
    s_cmp_eq_u32 s63, 0x20000
    s_cselect_b32 s62, s64, 0x8000
    v_mfma_f32_16x16x32_bf16 v[208:211], a[160:163], a[132:135], 0
    ds_read_b64_tr_b16 a[160:161], v24 offset:16384
    ds_read_b64_tr_b16 a[162:163], v24 offset:18432
    v_mfma_f32_16x16x32_bf16 v[196:199], a[164:167], a[128:131], 0
    s_add_u32 m0, s71, 0
    s_mov_b32 s59, 0xc0000
    buffer_load_dwordx4 v17, s[20:23], s59 offen lds
    v_mfma_f32_16x16x32_bf16 v[212:215], a[164:167], a[132:135], 0
    ds_read_b64_tr_b16 a[164:165], v25 offset:16384
    ds_read_b64_tr_b16 a[166:167], v25 offset:18432
    s_waitcnt lgkmcnt(12)
    v_mfma_f32_16x16x32_bf16 v[200:203], a[168:171], a[128:131], 0
    s_add_u32 s63, s63, s62
    v_mfma_f32_16x16x32_bf16 v[216:219], a[168:171], a[132:135], 0
    ds_read_b64_tr_b16 a[168:169], v26 offset:16384
    ds_read_b64_tr_b16 a[170:171], v26 offset:18432
    v_mfma_f32_16x16x32_bf16 v[204:207], a[172:175], a[128:131], 0
    v_mfma_f32_16x16x32_bf16 v[220:223], a[172:175], a[132:135], 0
    ds_read_b64_tr_b16 a[172:173], v27 offset:16384
    ds_read_b64_tr_b16 a[174:175], v27 offset:18432
    s_mov_b32 s40, 0xf8000
    buffer_load_dwordx4 a[32:35], v21, s[12:15], s40 offen offset:0 sc1
    buffer_load_dwordx4 a[36:39], v21, s[12:15], s40 offen offset:1024 sc1
    s_waitcnt vmcnt(35)
    s_waitcnt lgkmcnt(12)
    v_mfma_f32_16x16x32_bf16 v[192:195], a[176:179], a[136:139], v[192:195]
    v_mfma_f32_16x16x32_bf16 v[208:211], a[176:179], a[140:143], v[208:211]
    ds_read_b64_tr_b16 a[176:177], v24 offset:24576
    ds_read_b64_tr_b16 a[178:179], v24 offset:26624
    v_mfma_f32_16x16x32_bf16 v[196:199], a[180:183], a[136:139], v[196:199]
    s_add_u32 m0, s71, 1024
    s_mov_b32 s59, 0xc4000
    buffer_load_dwordx4 v17, s[20:23], s59 offen lds
    v_mfma_f32_16x16x32_bf16 v[212:215], a[180:183], a[140:143], v[212:215]
    ds_read_b64_tr_b16 a[180:181], v25 offset:24576
    ds_read_b64_tr_b16 a[182:183], v25 offset:26624
    s_waitcnt lgkmcnt(12)
    v_mfma_f32_16x16x32_bf16 v[200:203], a[184:187], a[136:139], v[200:203]
    v_mfma_f32_16x16x32_bf16 v[216:219], a[184:187], a[140:143], v[216:219]
    ds_read_b64_tr_b16 a[184:185], v26 offset:24576
    ds_read_b64_tr_b16 a[186:187], v26 offset:26624
    v_mfma_f32_16x16x32_bf16 v[204:207], a[188:191], a[136:139], v[204:207]
    v_mfma_f32_16x16x32_bf16 v[220:223], a[188:191], a[140:143], v[220:223]
    ds_read_b64_tr_b16 a[188:189], v27 offset:24576
    ds_read_b64_tr_b16 a[190:191], v27 offset:26624
    s_mov_b32 s40, 0xfa000
    buffer_load_dwordx4 a[40:43], v21, s[12:15], s40 offen offset:0 sc1
    buffer_load_dwordx4 a[44:47], v21, s[12:15], s40 offen offset:1024 sc1
    s_waitcnt vmcnt(35)
    s_barrier
    s_waitcnt lgkmcnt(12)
    v_mfma_f32_16x16x32_bf16 v[192:195], a[160:163], a[144:147], v[192:195]
    v_add_u32 v24, s62, v24
    v_mfma_f32_16x16x32_bf16 v[208:211], a[160:163], a[148:151], v[208:211]
    ds_read_b64_tr_b16 a[160:161], v24 offset:0
    ds_read_b64_tr_b16 a[162:163], v24 offset:2048
    v_mfma_f32_16x16x32_bf16 v[196:199], a[164:167], a[144:147], v[196:199]
    v_add_u32 v25, s62, v25
    s_add_u32 m0, s71, 2048
    s_mov_b32 s59, 0xc8000
    buffer_load_dwordx4 v17, s[20:23], s59 offen lds
    v_mfma_f32_16x16x32_bf16 v[212:215], a[164:167], a[148:151], v[212:215]
    ds_read_b64_tr_b16 a[164:165], v25 offset:0
    ds_read_b64_tr_b16 a[166:167], v25 offset:2048
    s_waitcnt lgkmcnt(12)
    v_mfma_f32_16x16x32_bf16 v[200:203], a[168:171], a[144:147], v[200:203]
    v_add_u32 v26, s62, v26
    v_mfma_f32_16x16x32_bf16 v[216:219], a[168:171], a[148:151], v[216:219]
    ds_read_b64_tr_b16 a[168:169], v26 offset:0
    ds_read_b64_tr_b16 a[170:171], v26 offset:2048
    v_mfma_f32_16x16x32_bf16 v[204:207], a[172:175], a[144:147], v[204:207]
    v_add_u32 v27, s62, v27
    v_mfma_f32_16x16x32_bf16 v[220:223], a[172:175], a[148:151], v[220:223]
    ds_read_b64_tr_b16 a[172:173], v27 offset:0
    ds_read_b64_tr_b16 a[174:175], v27 offset:2048
    s_mov_b32 s40, 0xfc000
    buffer_load_dwordx4 a[48:51], v21, s[12:15], s40 offen offset:0 sc1
    buffer_load_dwordx4 a[52:55], v21, s[12:15], s40 offen offset:1024 sc1
    s_waitcnt vmcnt(35)
    s_waitcnt lgkmcnt(12)
    v_mfma_f32_16x16x32_bf16 v[192:195], a[176:179], a[152:155], v[192:195]
    v_mfma_f32_16x16x32_bf16 v[208:211], a[176:179], a[156:159], v[208:211]
    ds_read_b64_tr_b16 a[176:177], v24 offset:8192
    ds_read_b64_tr_b16 a[178:179], v24 offset:10240
    v_mfma_f32_16x16x32_bf16 v[196:199], a[180:183], a[152:155], v[196:199]
    s_add_u32 m0, s71, 3072
    s_mov_b32 s59, 0xcc000
    buffer_load_dwordx4 v17, s[20:23], s59 offen lds
    v_mfma_f32_16x16x32_bf16 v[212:215], a[180:183], a[156:159], v[212:215]
    ds_read_b64_tr_b16 a[180:181], v25 offset:8192
    ds_read_b64_tr_b16 a[182:183], v25 offset:10240
    s_waitcnt lgkmcnt(12)
    v_mfma_f32_16x16x32_bf16 v[200:203], a[184:187], a[152:155], v[200:203]
    v_mfma_f32_16x16x32_bf16 v[216:219], a[184:187], a[156:159], v[216:219]
    ds_read_b64_tr_b16 a[184:185], v26 offset:8192
    ds_read_b64_tr_b16 a[186:187], v26 offset:10240
    v_mfma_f32_16x16x32_bf16 v[204:207], a[188:191], a[152:155], v[204:207]
    s_cmp_ge_u32 s71, 0x20000
    s_cselect_b32 s52, s64, 0x8000
    s_add_u32 s71, s71, s52
    v_mfma_f32_16x16x32_bf16 v[220:223], a[188:191], a[156:159], v[220:223]
    ds_read_b64_tr_b16 a[188:189], v27 offset:8192
    ds_read_b64_tr_b16 a[190:191], v27 offset:10240
    s_mov_b32 s40, 0xfe000
    buffer_load_dwordx4 a[56:59], v21, s[12:15], s40 offen offset:0 sc1
    buffer_load_dwordx4 a[60:63], v21, s[12:15], s40 offen offset:1024 sc1
    s_waitcnt vmcnt(12)
    buffer_store_dword v3, v31, s[44:47], s78 offen sc1
    s_xor_b32 s78, s78, 16
    s_xor_b32 s77, s77, 0x8000
    v_mov_b32 v28, 0
    s_waitcnt vmcnt(13)
    s_waitcnt lgkmcnt(12)
    v_mfma_f32_16x16x32_bf16 v[192:195], a[160:163], a[96:99], v[192:195]
    s_cmp_eq_u32 s63, 0x20000
    s_cselect_b32 s62, s64, 0x8000
    v_mfma_f32_16x16x32_bf16 v[208:211], a[160:163], a[100:103], v[208:211]
    ds_read_b64_tr_b16 a[160:161], v24 offset:16384
    ds_read_b64_tr_b16 a[162:163], v24 offset:18432
    v_mfma_f32_16x16x32_bf16 v[196:199], a[164:167], a[96:99], v[196:199]
    s_add_u32 m0, s71, 0
    s_mov_b32 s59, 0x100000
    buffer_load_dwordx4 v17, s[20:23], s59 offen lds
    v_mfma_f32_16x16x32_bf16 v[212:215], a[164:167], a[100:103], v[212:215]
    ds_read_b64_tr_b16 a[164:165], v25 offset:16384
    ds_read_b64_tr_b16 a[166:167], v25 offset:18432
    s_waitcnt lgkmcnt(12)
    v_mfma_f32_16x16x32_bf16 v[200:203], a[168:171], a[96:99], v[200:203]
    s_add_u32 s63, s63, s62
    v_mfma_f32_16x16x32_bf16 v[216:219], a[168:171], a[100:103], v[216:219]
    ds_read_b64_tr_b16 a[168:169], v26 offset:16384
    ds_read_b64_tr_b16 a[170:171], v26 offset:18432
    v_mfma_f32_16x16x32_bf16 v[204:207], a[172:175], a[96:99], v[204:207]
    v_mfma_f32_16x16x32_bf16 v[220:223], a[172:175], a[100:103], v[220:223]
    ds_read_b64_tr_b16 a[172:173], v27 offset:16384
    ds_read_b64_tr_b16 a[174:175], v27 offset:18432
    s_mov_b32 s40, 0x100000
    buffer_load_dwordx4 a[128:131], v21, s[12:15], s40 offen offset:0 sc1
    buffer_load_dwordx4 a[132:135], v21, s[12:15], s40 offen offset:1024 sc1
    s_waitcnt vmcnt(16)
    s_waitcnt lgkmcnt(12)
    v_mfma_f32_16x16x32_bf16 v[192:195], a[176:179], a[104:107], v[192:195]
    v_mfma_f32_16x16x32_bf16 v[208:211], a[176:179], a[108:111], v[208:211]
    ds_read_b64_tr_b16 a[176:177], v24 offset:24576
    ds_read_b64_tr_b16 a[178:179], v24 offset:26624
    v_mfma_f32_16x16x32_bf16 v[196:199], a[180:183], a[104:107], v[196:199]
    s_add_u32 m0, s71, 1024
    s_mov_b32 s59, 0x104000
    buffer_load_dwordx4 v17, s[20:23], s59 offen lds
    v_mfma_f32_16x16x32_bf16 v[212:215], a[180:183], a[108:111], v[212:215]
    ds_read_b64_tr_b16 a[180:181], v25 offset:24576
    ds_read_b64_tr_b16 a[182:183], v25 offset:26624
    s_waitcnt lgkmcnt(12)
    v_mfma_f32_16x16x32_bf16 v[200:203], a[184:187], a[104:107], v[200:203]
    v_mfma_f32_16x16x32_bf16 v[216:219], a[184:187], a[108:111], v[216:219]
    ds_read_b64_tr_b16 a[184:185], v26 offset:24576
    ds_read_b64_tr_b16 a[186:187], v26 offset:26624
    v_mfma_f32_16x16x32_bf16 v[204:207], a[188:191], a[104:107], v[204:207]
    v_mfma_f32_16x16x32_bf16 v[220:223], a[188:191], a[108:111], v[220:223]
    ds_read_b64_tr_b16 a[188:189], v27 offset:24576
    ds_read_b64_tr_b16 a[190:191], v27 offset:26624
    s_mov_b32 s40, 0x102000
    buffer_load_dwordx4 a[136:139], v21, s[12:15], s40 offen offset:0 sc1
    buffer_load_dwordx4 a[140:143], v21, s[12:15], s40 offen offset:1024 sc1
    s_waitcnt vmcnt(19)
    s_barrier
    s_waitcnt lgkmcnt(12)
    v_mfma_f32_16x16x32_bf16 v[192:195], a[160:163], a[112:115], v[192:195]
    v_add_u32 v24, s62, v24
    v_mfma_f32_16x16x32_bf16 v[208:211], a[160:163], a[116:119], v[208:211]
    ds_read_b64_tr_b16 a[160:161], v24 offset:0
    ds_read_b64_tr_b16 a[162:163], v24 offset:2048
    v_mfma_f32_16x16x32_bf16 v[196:199], a[164:167], a[112:115], v[196:199]
    v_add_u32 v25, s62, v25
    s_add_u32 m0, s71, 2048
    s_mov_b32 s59, 0x108000
    buffer_load_dwordx4 v17, s[20:23], s59 offen lds
    v_mfma_f32_16x16x32_bf16 v[212:215], a[164:167], a[116:119], v[212:215]
    ds_read_b64_tr_b16 a[164:165], v25 offset:0
    ds_read_b64_tr_b16 a[166:167], v25 offset:2048
    s_waitcnt lgkmcnt(12)
    v_mfma_f32_16x16x32_bf16 v[200:203], a[168:171], a[112:115], v[200:203]
    v_add_u32 v26, s62, v26
    v_mfma_f32_16x16x32_bf16 v[216:219], a[168:171], a[116:119], v[216:219]
    ds_read_b64_tr_b16 a[168:169], v26 offset:0
    ds_read_b64_tr_b16 a[170:171], v26 offset:2048
    v_mfma_f32_16x16x32_bf16 v[204:207], a[172:175], a[112:115], v[204:207]
    v_add_u32 v27, s62, v27
    v_mfma_f32_16x16x32_bf16 v[220:223], a[172:175], a[116:119], v[220:223]
    ds_read_b64_tr_b16 a[172:173], v27 offset:0
    ds_read_b64_tr_b16 a[174:175], v27 offset:2048
    s_mov_b32 s40, 0x104000
    buffer_load_dwordx4 a[144:147], v21, s[12:15], s40 offen offset:0 sc1
    buffer_load_dwordx4 a[148:151], v21, s[12:15], s40 offen offset:1024 sc1
    s_waitcnt vmcnt(22)
    s_waitcnt lgkmcnt(12)
    v_mfma_f32_16x16x32_bf16 v[192:195], a[176:179], a[120:123], v[192:195]
    v_mfma_f32_16x16x32_bf16 v[208:211], a[176:179], a[124:127], v[208:211]
    ds_read_b64_tr_b16 a[176:177], v24 offset:8192
    ds_read_b64_tr_b16 a[178:179], v24 offset:10240
    v_mfma_f32_16x16x32_bf16 v[196:199], a[180:183], a[120:123], v[196:199]
    s_add_u32 m0, s71, 3072
    s_mov_b32 s59, 0x10c000
    buffer_load_dwordx4 v17, s[20:23], s59 offen lds
    v_mfma_f32_16x16x32_bf16 v[212:215], a[180:183], a[124:127], v[212:215]
    ds_read_b64_tr_b16 a[180:181], v25 offset:8192
    ds_read_b64_tr_b16 a[182:183], v25 offset:10240
    s_waitcnt lgkmcnt(12)
    v_mfma_f32_16x16x32_bf16 v[200:203], a[184:187], a[120:123], v[200:203]
    v_mfma_f32_16x16x32_bf16 v[216:219], a[184:187], a[124:127], v[216:219]
    ds_read_b64_tr_b16 a[184:185], v26 offset:8192
    ds_read_b64_tr_b16 a[186:187], v26 offset:10240
    v_mfma_f32_16x16x32_bf16 v[204:207], a[188:191], a[120:123], v[204:207]
    s_cmp_ge_u32 s71, 0x20000
    s_cselect_b32 s52, s64, 0x8000
    s_add_u32 s71, s71, s52
    v_mfma_f32_16x16x32_bf16 v[220:223], a[188:191], a[124:127], v[220:223]
    ds_read_b64_tr_b16 a[188:189], v27 offset:8192
    ds_read_b64_tr_b16 a[190:191], v27 offset:10240
    s_mov_b32 s40, 0x106000
    buffer_load_dwordx4 a[152:155], v21, s[12:15], s40 offen offset:0 sc1
    buffer_load_dwordx4 a[156:159], v21, s[12:15], s40 offen offset:1024 sc1
    s_waitcnt vmcnt(25)
    s_waitcnt lgkmcnt(12)
    v_mfma_f32_16x16x32_bf16 v[192:195], a[160:163], a[0:3], v[192:195]
    s_cmp_eq_u32 s63, 0x20000
    s_cselect_b32 s62, s64, 0x8000
    buffer_load_dword v29, v28, s[44:47], s78 offen sc1
    v_mfma_f32_16x16x32_bf16 v[208:211], a[160:163], a[4:7], v[208:211]
    ds_read_b64_tr_b16 a[160:161], v24 offset:16384
    ds_read_b64_tr_b16 a[162:163], v24 offset:18432
    v_mfma_f32_16x16x32_bf16 v[196:199], a[164:167], a[0:3], v[196:199]
    s_add_u32 m0, s71, 0
    s_mov_b32 s59, 0x140000
    buffer_load_dwordx4 v17, s[20:23], s59 offen lds
    v_mfma_f32_16x16x32_bf16 v[212:215], a[164:167], a[4:7], v[212:215]
    ds_read_b64_tr_b16 a[164:165], v25 offset:16384
    ds_read_b64_tr_b16 a[166:167], v25 offset:18432
    s_waitcnt lgkmcnt(12)
    v_mfma_f32_16x16x32_bf16 v[200:203], a[168:171], a[0:3], v[200:203]
    s_add_u32 s63, s63, s62
    v_mfma_f32_16x16x32_bf16 v[216:219], a[168:171], a[4:7], v[216:219]
    ds_read_b64_tr_b16 a[168:169], v26 offset:16384
    ds_read_b64_tr_b16 a[170:171], v26 offset:18432
    v_mfma_f32_16x16x32_bf16 v[204:207], a[172:175], a[0:3], v[204:207]
    v_mfma_f32_16x16x32_bf16 v[220:223], a[172:175], a[4:7], v[220:223]
    ds_read_b64_tr_b16 a[172:173], v27 offset:16384
    ds_read_b64_tr_b16 a[174:175], v27 offset:18432
    s_mov_b32 s40, 0x108000
    buffer_load_dwordx4 a[96:99], v21, s[12:15], s40 offen offset:0 sc1
    buffer_load_dwordx4 a[100:103], v21, s[12:15], s40 offen offset:1024 sc1
    s_waitcnt vmcnt(29)
    s_waitcnt lgkmcnt(12)
    v_mfma_f32_16x16x32_bf16 v[192:195], a[176:179], a[8:11], v[192:195]
    v_mfma_f32_16x16x32_bf16 v[208:211], a[176:179], a[12:15], v[208:211]
    ds_read_b64_tr_b16 a[176:177], v24 offset:24576
    ds_read_b64_tr_b16 a[178:179], v24 offset:26624
    v_mfma_f32_16x16x32_bf16 v[196:199], a[180:183], a[8:11], v[196:199]
    s_add_u32 m0, s71, 1024
    s_mov_b32 s59, 0x144000
    buffer_load_dwordx4 v17, s[20:23], s59 offen lds
    v_mfma_f32_16x16x32_bf16 v[212:215], a[180:183], a[12:15], v[212:215]
    ds_read_b64_tr_b16 a[180:181], v25 offset:24576
    ds_read_b64_tr_b16 a[182:183], v25 offset:26624
    s_waitcnt lgkmcnt(12)
    v_mfma_f32_16x16x32_bf16 v[200:203], a[184:187], a[8:11], v[200:203]
    v_mfma_f32_16x16x32_bf16 v[216:219], a[184:187], a[12:15], v[216:219]
    ds_read_b64_tr_b16 a[184:185], v26 offset:24576
    ds_read_b64_tr_b16 a[186:187], v26 offset:26624
    v_mfma_f32_16x16x32_bf16 v[204:207], a[188:191], a[8:11], v[204:207]
    v_mfma_f32_16x16x32_bf16 v[220:223], a[188:191], a[12:15], v[220:223]
    ds_read_b64_tr_b16 a[188:189], v27 offset:24576
    ds_read_b64_tr_b16 a[190:191], v27 offset:26624
    s_mov_b32 s40, 0x10a000
    buffer_load_dwordx4 a[104:107], v21, s[12:15], s40 offen offset:0 sc1
    buffer_load_dwordx4 a[108:111], v21, s[12:15], s40 offen offset:1024 sc1
    s_waitcnt vmcnt(22)
    s_barrier
    s_waitcnt lgkmcnt(12)
    v_mfma_f32_16x16x32_bf16 v[192:195], a[160:163], a[16:19], v[192:195]
    v_add_u32 v24, s62, v24
    v_mfma_f32_16x16x32_bf16 v[208:211], a[160:163], a[20:23], v[208:211]
    ds_read_b64_tr_b16 a[160:161], v24 offset:0
    ds_read_b64_tr_b16 a[162:163], v24 offset:2048
    v_mfma_f32_16x16x32_bf16 v[196:199], a[164:167], a[16:19], v[196:199]
    v_add_u32 v25, s62, v25
    s_add_u32 m0, s71, 2048
    s_mov_b32 s59, 0x148000
    buffer_load_dwordx4 v17, s[20:23], s59 offen lds
    v_mfma_f32_16x16x32_bf16 v[212:215], a[164:167], a[20:23], v[212:215]
    ds_read_b64_tr_b16 a[164:165], v25 offset:0
    ds_read_b64_tr_b16 a[166:167], v25 offset:2048
    s_waitcnt lgkmcnt(12)
    v_mfma_f32_16x16x32_bf16 v[200:203], a[168:171], a[16:19], v[200:203]
    v_add_u32 v26, s62, v26
    v_mfma_f32_16x16x32_bf16 v[216:219], a[168:171], a[20:23], v[216:219]
    ds_read_b64_tr_b16 a[168:169], v26 offset:0
    ds_read_b64_tr_b16 a[170:171], v26 offset:2048
    v_mfma_f32_16x16x32_bf16 v[204:207], a[172:175], a[16:19], v[204:207]
    v_add_u32 v27, s62, v27
    v_mfma_f32_16x16x32_bf16 v[220:223], a[172:175], a[20:23], v[220:223]
    ds_read_b64_tr_b16 a[172:173], v27 offset:0
    ds_read_b64_tr_b16 a[174:175], v27 offset:2048
    s_mov_b32 s40, 0x10c000
    buffer_load_dwordx4 a[112:115], v21, s[12:15], s40 offen offset:0 sc1
    buffer_load_dwordx4 a[116:119], v21, s[12:15], s40 offen offset:1024 sc1
    s_waitcnt vmcnt(25)
    s_waitcnt lgkmcnt(12)
    v_mfma_f32_16x16x32_bf16 v[192:195], a[176:179], a[24:27], v[192:195]
    v_mfma_f32_16x16x32_bf16 v[208:211], a[176:179], a[28:31], v[208:211]
    ds_read_b64_tr_b16 a[176:177], v24 offset:8192
    ds_read_b64_tr_b16 a[178:179], v24 offset:10240
    v_mfma_f32_16x16x32_bf16 v[196:199], a[180:183], a[24:27], v[196:199]
    s_add_u32 m0, s71, 3072
    s_mov_b32 s59, 0x14c000
    buffer_load_dwordx4 v17, s[20:23], s59 offen lds
    v_mfma_f32_16x16x32_bf16 v[212:215], a[180:183], a[28:31], v[212:215]
    ds_read_b64_tr_b16 a[180:181], v25 offset:8192
    ds_read_b64_tr_b16 a[182:183], v25 offset:10240
    s_waitcnt lgkmcnt(12)
    v_mfma_f32_16x16x32_bf16 v[200:203], a[184:187], a[24:27], v[200:203]
    v_mfma_f32_16x16x32_bf16 v[216:219], a[184:187], a[28:31], v[216:219]
    ds_read_b64_tr_b16 a[184:185], v26 offset:8192
    ds_read_b64_tr_b16 a[186:187], v26 offset:10240
    v_mfma_f32_16x16x32_bf16 v[204:207], a[188:191], a[24:27], v[204:207]
    s_cmp_ge_u32 s71, 0x20000
    s_cselect_b32 s52, s64, 0x8000
    s_add_u32 s71, s71, s52
    v_mfma_f32_16x16x32_bf16 v[220:223], a[188:191], a[28:31], v[220:223]
    ds_read_b64_tr_b16 a[188:189], v27 offset:8192
    ds_read_b64_tr_b16 a[190:191], v27 offset:10240
    s_mov_b32 s40, 0x10e000
    buffer_load_dwordx4 a[120:123], v21, s[12:15], s40 offen offset:0 sc1
    buffer_load_dwordx4 a[124:127], v21, s[12:15], s40 offen offset:1024 sc1
    s_waitcnt vmcnt(12)
    s_mov_b32 s48, 0x20000
L_pollF:
    v_cmp_ne_u32 vcc, v3, v29
    s_sub_u32 s48, s48, 1
    s_nop 3
    s_cbranch_vccz L_pollF_d
    s_cmp_eq_u32 s48, 0
    s_cbranch_scc1 L_pollF_d
    s_sleep 1
    buffer_load_dword v29, v28, s[44:47], s78 offen sc1
    s_waitcnt vmcnt(0)
    s_branch L_pollF
L_pollF_d:
    s_waitcnt vmcnt(12)
    s_waitcnt lgkmcnt(12)
    v_mfma_f32_16x16x32_bf16 v[192:195], a[160:163], a[32:35], v[192:195]
    s_cmp_eq_u32 s63, 0x20000
    s_cselect_b32 s62, s64, 0x8000
    buffer_load_dwordx4 v[112:115], v12, s[36:39], s77 offen offset:0 sc1
    v_mfma_f32_16x16x32_bf16 v[208:211], a[160:163], a[36:39], v[208:211]
    ds_read_b64_tr_b16 a[160:161], v24 offset:16384
    ds_read_b64_tr_b16 a[162:163], v24 offset:18432
    v_mfma_f32_16x16x32_bf16 v[196:199], a[164:167], a[32:35], v[196:199]
    s_add_u32 m0, s71, 0
    s_mov_b32 s59, 0x180000
    buffer_load_dwordx4 v17, s[20:23], s59 offen lds
    v_mfma_f32_16x16x32_bf16 v[212:215], a[164:167], a[36:39], v[212:215]
    ds_read_b64_tr_b16 a[164:165], v25 offset:16384
    ds_read_b64_tr_b16 a[166:167], v25 offset:18432
    s_waitcnt lgkmcnt(12)
    v_mfma_f32_16x16x32_bf16 v[200:203], a[168:171], a[32:35], v[200:203]
    s_add_u32 s63, s63, s62
    buffer_load_dwordx4 v[116:119], v12, s[36:39], s77 offen offset:1024 sc1
    v_mfma_f32_16x16x32_bf16 v[216:219], a[168:171], a[36:39], v[216:219]
    ds_read_b64_tr_b16 a[168:169], v26 offset:16384
    ds_read_b64_tr_b16 a[170:171], v26 offset:18432
    v_mfma_f32_16x16x32_bf16 v[204:207], a[172:175], a[32:35], v[204:207]
    v_mfma_f32_16x16x32_bf16 v[220:223], a[172:175], a[36:39], v[220:223]
    ds_read_b64_tr_b16 a[172:173], v27 offset:16384
    ds_read_b64_tr_b16 a[174:175], v27 offset:18432
    s_mov_b32 s40, 0x110000
    buffer_load_dwordx4 a[0:3], v21, s[12:15], s40 offen offset:0 sc1
    buffer_load_dwordx4 a[4:7], v21, s[12:15], s40 offen offset:1024 sc1
    s_waitcnt vmcnt(17)
    s_waitcnt lgkmcnt(12)
    v_mfma_f32_16x16x32_bf16 v[192:195], a[176:179], a[40:43], v[192:195]
    buffer_load_dwordx4 v[120:123], v12, s[36:39], s77 offen offset:2048 sc1
    v_mfma_f32_16x16x32_bf16 v[208:211], a[176:179], a[44:47], v[208:211]
    ds_read_b64_tr_b16 a[176:177], v24 offset:24576
    ds_read_b64_tr_b16 a[178:179], v24 offset:26624
    v_mfma_f32_16x16x32_bf16 v[196:199], a[180:183], a[40:43], v[196:199]
    s_add_u32 m0, s71, 1024
    s_mov_b32 s59, 0x184000
    buffer_load_dwordx4 v17, s[20:23], s59 offen lds
    v_mfma_f32_16x16x32_bf16 v[212:215], a[180:183], a[44:47], v[212:215]
    ds_read_b64_tr_b16 a[180:181], v25 offset:24576
    ds_read_b64_tr_b16 a[182:183], v25 offset:26624
    s_waitcnt lgkmcnt(12)
    v_mfma_f32_16x16x32_bf16 v[200:203], a[184:187], a[40:43], v[200:203]
    buffer_load_dwordx4 v[124:127], v12, s[36:39], s77 offen offset:3072 sc1
    v_mfma_f32_16x16x32_bf16 v[216:219], a[184:187], a[44:47], v[216:219]
    ds_read_b64_tr_b16 a[184:185], v26 offset:24576
    ds_read_b64_tr_b16 a[186:187], v26 offset:26624
    v_mfma_f32_16x16x32_bf16 v[204:207], a[188:191], a[40:43], v[204:207]
    v_mfma_f32_16x16x32_bf16 v[220:223], a[188:191], a[44:47], v[220:223]
    ds_read_b64_tr_b16 a[188:189], v27 offset:24576
    ds_read_b64_tr_b16 a[190:191], v27 offset:26624
    s_mov_b32 s40, 0x112000
    buffer_load_dwordx4 a[8:11], v21, s[12:15], s40 offen offset:0 sc1
    buffer_load_dwordx4 a[12:15], v21, s[12:15], s40 offen offset:1024 sc1
    s_waitcnt vmcnt(22)
    s_barrier
    s_waitcnt lgkmcnt(12)
    v_mfma_f32_16x16x32_bf16 v[192:195], a[160:163], a[48:51], v[192:195]
    v_add_u32 v24, s62, v24
    v_mfma_f32_16x16x32_bf16 v[208:211], a[160:163], a[52:55], v[208:211]
    ds_read_b64_tr_b16 a[160:161], v24 offset:0
    ds_read_b64_tr_b16 a[162:163], v24 offset:2048
    v_mfma_f32_16x16x32_bf16 v[196:199], a[164:167], a[48:51], v[196:199]
    v_add_u32 v25, s62, v25
    s_add_u32 m0, s71, 2048
    s_mov_b32 s59, 0x188000
    buffer_load_dwordx4 v17, s[20:23], s59 offen lds
    v_mfma_f32_16x16x32_bf16 v[212:215], a[164:167], a[52:55], v[212:215]
    ds_read_b64_tr_b16 a[164:165], v25 offset:0
    ds_read_b64_tr_b16 a[166:167], v25 offset:2048
    s_waitcnt lgkmcnt(12)
    v_mfma_f32_16x16x32_bf16 v[200:203], a[168:171], a[48:51], v[200:203]
    v_add_u32 v26, s62, v26
    v_mfma_f32_16x16x32_bf16 v[216:219], a[168:171], a[52:55], v[216:219]
    ds_read_b64_tr_b16 a[168:169], v26 offset:0
    ds_read_b64_tr_b16 a[170:171], v26 offset:2048
    v_mfma_f32_16x16x32_bf16 v[204:207], a[172:175], a[48:51], v[204:207]
    v_add_u32 v27, s62, v27
    v_mfma_f32_16x16x32_bf16 v[220:223], a[172:175], a[52:55], v[220:223]
    ds_read_b64_tr_b16 a[172:173], v27 offset:0
    ds_read_b64_tr_b16 a[174:175], v27 offset:2048
    s_mov_b32 s40, 0x114000
    buffer_load_dwordx4 a[16:19], v21, s[12:15], s40 offen offset:0 sc1
    buffer_load_dwordx4 a[20:23], v21, s[12:15], s40 offen offset:1024 sc1
    s_waitcnt vmcnt(25)
    s_waitcnt lgkmcnt(12)
    v_mfma_f32_16x16x32_bf16 v[192:195], a[176:179], a[56:59], v[192:195]
    v_mfma_f32_16x16x32_bf16 v[208:211], a[176:179], a[60:63], v[208:211]
    ds_read_b64_tr_b16 a[176:177], v24 offset:8192
    ds_read_b64_tr_b16 a[178:179], v24 offset:10240
    v_mfma_f32_16x16x32_bf16 v[196:199], a[180:183], a[56:59], v[196:199]
    s_add_u32 m0, s71, 3072
    s_mov_b32 s59, 0x18c000
    buffer_load_dwordx4 v17, s[20:23], s59 offen lds
    v_mfma_f32_16x16x32_bf16 v[212:215], a[180:183], a[60:63], v[212:215]
    ds_read_b64_tr_b16 a[180:181], v25 offset:8192
    ds_read_b64_tr_b16 a[182:183], v25 offset:10240
    s_waitcnt lgkmcnt(12)
    v_mfma_f32_16x16x32_bf16 v[200:203], a[184:187], a[56:59], v[200:203]
    v_mfma_f32_16x16x32_bf16 v[216:219], a[184:187], a[60:63], v[216:219]
    ds_read_b64_tr_b16 a[184:185], v26 offset:8192
    ds_read_b64_tr_b16 a[186:187], v26 offset:10240
    v_mfma_f32_16x16x32_bf16 v[204:207], a[188:191], a[56:59], v[204:207]
    s_cmp_ge_u32 s71, 0x20000
    s_cselect_b32 s52, s64, 0x8000
    s_add_u32 s71, s71, s52
    v_mfma_f32_16x16x32_bf16 v[220:223], a[188:191], a[60:63], v[220:223]
    ds_read_b64_tr_b16 a[188:189], v27 offset:8192
    ds_read_b64_tr_b16 a[190:191], v27 offset:10240
    s_mov_b32 s40, 0x116000
    buffer_load_dwordx4 a[24:27], v21, s[12:15], s40 offen offset:0 sc1
    buffer_load_dwordx4 a[28:31], v21, s[12:15], s40 offen offset:1024 sc1
    s_waitcnt vmcnt(28)
    s_waitcnt lgkmcnt(12)
    v_mfma_f32_16x16x32_bf16 v[192:195], a[160:163], a[128:131], v[192:195]
    s_cmp_eq_u32 s63, 0x20000
    s_cselect_b32 s62, s64, 0x8000
    v_mfma_f32_16x16x32_bf16 v[208:211], a[160:163], a[132:135], v[208:211]
    ds_read_b64_tr_b16 a[160:161], v24 offset:16384
    ds_read_b64_tr_b16 a[162:163], v24 offset:18432
    v_mfma_f32_16x16x32_bf16 v[196:199], a[164:167], a[128:131], v[196:199]
    s_add_u32 m0, s71, 0
    s_mov_b32 s59, 0x1c0000
    buffer_load_dwordx4 v17, s[20:23], s59 offen lds
    v_mfma_f32_16x16x32_bf16 v[212:215], a[164:167], a[132:135], v[212:215]
    ds_read_b64_tr_b16 a[164:165], v25 offset:16384
    ds_read_b64_tr_b16 a[166:167], v25 offset:18432
    s_waitcnt lgkmcnt(12)
    v_mfma_f32_16x16x32_bf16 v[200:203], a[168:171], a[128:131], v[200:203]
    s_add_u32 s63, s63, s62
    v_mfma_f32_16x16x32_bf16 v[216:219], a[168:171], a[132:135], v[216:219]
    ds_read_b64_tr_b16 a[168:169], v26 offset:16384
    ds_read_b64_tr_b16 a[170:171], v26 offset:18432
    v_mfma_f32_16x16x32_bf16 v[204:207], a[172:175], a[128:131], v[204:207]
    v_mfma_f32_16x16x32_bf16 v[220:223], a[172:175], a[132:135], v[220:223]
    ds_read_b64_tr_b16 a[172:173], v27 offset:16384
    ds_read_b64_tr_b16 a[174:175], v27 offset:18432
    s_mov_b32 s40, 0x118000
    buffer_load_dwordx4 a[32:35], v21, s[12:15], s40 offen offset:0 sc1
    buffer_load_dwordx4 a[36:39], v21, s[12:15], s40 offen offset:1024 sc1
    s_waitcnt vmcnt(31)
    s_waitcnt lgkmcnt(12)
    v_mfma_f32_16x16x32_bf16 v[192:195], a[176:179], a[136:139], v[192:195]
    v_mfma_f32_16x16x32_bf16 v[208:211], a[176:179], a[140:143], v[208:211]
    ds_read_b64_tr_b16 a[176:177], v24 offset:24576
    ds_read_b64_tr_b16 a[178:179], v24 offset:26624
    v_mfma_f32_16x16x32_bf16 v[196:199], a[180:183], a[136:139], v[196:199]
    s_add_u32 m0, s71, 1024
    s_mov_b32 s59, 0x1c4000
    buffer_load_dwordx4 v17, s[20:23], s59 offen lds
    v_mfma_f32_16x16x32_bf16 v[212:215], a[180:183], a[140:143], v[212:215]
    ds_read_b64_tr_b16 a[180:181], v25 offset:24576
    ds_read_b64_tr_b16 a[182:183], v25 offset:26624
    s_waitcnt lgkmcnt(12)
    v_mfma_f32_16x16x32_bf16 v[200:203], a[184:187], a[136:139], v[200:203]
    v_mfma_f32_16x16x32_bf16 v[216:219], a[184:187], a[140:143], v[216:219]
    ds_read_b64_tr_b16 a[184:185], v26 offset:24576
    ds_read_b64_tr_b16 a[186:187], v26 offset:26624
    v_mfma_f32_16x16x32_bf16 v[204:207], a[188:191], a[136:139], v[204:207]
    v_mfma_f32_16x16x32_bf16 v[220:223], a[188:191], a[140:143], v[220:223]
    ds_read_b64_tr_b16 a[188:189], v27 offset:24576
    ds_read_b64_tr_b16 a[190:191], v27 offset:26624
    s_mov_b32 s40, 0x11a000
    buffer_load_dwordx4 a[40:43], v21, s[12:15], s40 offen offset:0 sc1
    buffer_load_dwordx4 a[44:47], v21, s[12:15], s40 offen offset:1024 sc1
    s_waitcnt vmcnt(24)
    s_barrier
    s_waitcnt lgkmcnt(12)
    v_mfma_f32_16x16x32_bf16 v[192:195], a[160:163], a[144:147], v[192:195]
    v_add_u32 v24, s62, v24
    v_mfma_f32_16x16x32_bf16 v[208:211], a[160:163], a[148:151], v[208:211]
    ds_read_b64_tr_b16 a[160:161], v24 offset:0
    ds_read_b64_tr_b16 a[162:163], v24 offset:2048
    v_mfma_f32_16x16x32_bf16 v[196:199], a[164:167], a[144:147], v[196:199]
    v_add_u32 v25, s62, v25
    s_add_u32 m0, s71, 2048
    s_mov_b32 s59, 0x1c8000
    buffer_load_dwordx4 v17, s[20:23], s59 offen lds
    v_mfma_f32_16x16x32_bf16 v[212:215], a[164:167], a[148:151], v[212:215]
    ds_read_b64_tr_b16 a[164:165], v25 offset:0
    ds_read_b64_tr_b16 a[166:167], v25 offset:2048
    s_waitcnt lgkmcnt(12)
    v_mfma_f32_16x16x32_bf16 v[200:203], a[168:171], a[144:147], v[200:203]
    v_add_u32 v26, s62, v26
    v_mfma_f32_16x16x32_bf16 v[216:219], a[168:171], a[148:151], v[216:219]
    ds_read_b64_tr_b16 a[168:169], v26 offset:0
    ds_read_b64_tr_b16 a[170:171], v26 offset:2048
    v_mfma_f32_16x16x32_bf16 v[204:207], a[172:175], a[144:147], v[204:207]
    v_add_u32 v27, s62, v27
    v_mfma_f32_16x16x32_bf16 v[220:223], a[172:175], a[148:151], v[220:223]
    ds_read_b64_tr_b16 a[172:173], v27 offset:0
    ds_read_b64_tr_b16 a[174:175], v27 offset:2048
    s_mov_b32 s40, 0x11c000
    buffer_load_dwordx4 a[48:51], v21, s[12:15], s40 offen offset:0 sc1
    buffer_load_dwordx4 a[52:55], v21, s[12:15], s40 offen offset:1024 sc1
    s_waitcnt vmcnt(27)
    s_waitcnt lgkmcnt(12)
    v_mfma_f32_16x16x32_bf16 v[192:195], a[176:179], a[152:155], v[192:195]
    v_mfma_f32_16x16x32_bf16 v[208:211], a[176:179], a[156:159], v[208:211]
    ds_read_b64_tr_b16 a[176:177], v24 offset:8192
    ds_read_b64_tr_b16 a[178:179], v24 offset:10240
    v_mfma_f32_16x16x32_bf16 v[196:199], a[180:183], a[152:155], v[196:199]
    s_add_u32 m0, s71, 3072
    s_mov_b32 s59, 0x1cc000
    buffer_load_dwordx4 v17, s[20:23], s59 offen lds
    v_mfma_f32_16x16x32_bf16 v[212:215], a[180:183], a[156:159], v[212:215]
    ds_read_b64_tr_b16 a[180:181], v25 offset:8192
    ds_read_b64_tr_b16 a[182:183], v25 offset:10240
    s_waitcnt lgkmcnt(12)
    v_mfma_f32_16x16x32_bf16 v[200:203], a[184:187], a[152:155], v[200:203]
    v_mfma_f32_16x16x32_bf16 v[216:219], a[184:187], a[156:159], v[216:219]
    ds_read_b64_tr_b16 a[184:185], v26 offset:8192
    ds_read_b64_tr_b16 a[186:187], v26 offset:10240
    v_mfma_f32_16x16x32_bf16 v[204:207], a[188:191], a[152:155], v[204:207]
    s_cmp_ge_u32 s71, 0x20000
    s_cselect_b32 s52, s64, 0x8000
    s_add_u32 s71, s71, s52
    v_mfma_f32_16x16x32_bf16 v[220:223], a[188:191], a[156:159], v[220:223]
    ds_read_b64_tr_b16 a[188:189], v27 offset:8192
    ds_read_b64_tr_b16 a[190:191], v27 offset:10240
    s_mov_b32 s40, 0x11e000
    buffer_load_dwordx4 a[56:59], v21, s[12:15], s40 offen offset:0 sc1
    buffer_load_dwordx4 a[60:63], v21, s[12:15], s40 offen offset:1024 sc1
    s_waitcnt vmcnt(20)
    s_waitcnt vmcnt(20)
    s_waitcnt lgkmcnt(12)
    v_mfma_f32_16x16x32_bf16 v[192:195], a[160:163], a[96:99], v[192:195]
    s_cmp_eq_u32 s63, 0x20000
    s_cselect_b32 s62, s64, 0x8000
    v_lshlrev_b32 v32, 16, v112
    v_and_b32 v33, 0xffff0000, v112
    v_lshlrev_b32 v34, 16, v113
    v_mfma_f32_16x16x32_bf16 v[208:211], a[160:163], a[100:103], v[208:211]
    v_and_b32 v35, 0xffff0000, v113
    v_lshlrev_b32 v36, 16, v114
    v_and_b32 v37, 0xffff0000, v114
    ds_read_b64_tr_b16 a[160:161], v24 offset:16384
    ds_read_b64_tr_b16 a[162:163], v24 offset:18432
    v_mfma_f32_16x16x32_bf16 v[196:199], a[164:167], a[96:99], v[196:199]
    v_lshlrev_b32 v38, 16, v115
    v_and_b32 v39, 0xffff0000, v115
    v_lshlrev_b32 v40, 16, v116
    v_mfma_f32_16x16x32_bf16 v[212:215], a[164:167], a[100:103], v[212:215]
    v_and_b32 v41, 0xffff0000, v116
    v_lshlrev_b32 v42, 16, v117
    v_and_b32 v43, 0xffff0000, v117
    ds_read_b64_tr_b16 a[164:165], v25 offset:16384
    ds_read_b64_tr_b16 a[166:167], v25 offset:18432
    s_waitcnt lgkmcnt(12)
    v_mfma_f32_16x16x32_bf16 v[200:203], a[168:171], a[96:99], v[200:203]
    s_add_u32 s63, s63, s62
    v_lshlrev_b32 v44, 16, v118
    v_and_b32 v45, 0xffff0000, v118
    v_lshlrev_b32 v46, 16, v119
    v_mfma_f32_16x16x32_bf16 v[216:219], a[168:171], a[100:103], v[216:219]
    v_and_b32 v47, 0xffff0000, v119
    v_lshlrev_b32 v48, 16, v120
    v_and_b32 v49, 0xffff0000, v120
    ds_read_b64_tr_b16 a[168:169], v26 offset:16384
    ds_read_b64_tr_b16 a[170:171], v26 offset:18432
    v_mfma_f32_16x16x32_bf16 v[204:207], a[172:175], a[96:99], v[204:207]
    v_lshlrev_b32 v50, 16, v121
    v_and_b32 v51, 0xffff0000, v121
    v_lshlrev_b32 v52, 16, v122
    v_mfma_f32_16x16x32_bf16 v[220:223], a[172:175], a[100:103], v[220:223]
    v_and_b32 v53, 0xffff0000, v122
    v_lshlrev_b32 v54, 16, v123
    v_and_b32 v55, 0xffff0000, v123
    ds_read_b64_tr_b16 a[172:173], v27 offset:16384
    ds_read_b64_tr_b16 a[174:175], v27 offset:18432
    s_waitcnt vmcnt(20)
    s_waitcnt lgkmcnt(12)
    v_mfma_f32_16x16x32_bf16 v[192:195], a[176:179], a[104:107], v[192:195]
    v_lshlrev_b32 v56, 16, v124
    v_and_b32 v57, 0xffff0000, v124
    v_lshlrev_b32 v58, 16, v125
    v_mfma_f32_16x16x32_bf16 v[208:211], a[176:179], a[108:111], v[208:211]
    v_and_b32 v59, 0xffff0000, v125
    v_lshlrev_b32 v60, 16, v126
    v_and_b32 v61, 0xffff0000, v126
    ds_read_b64_tr_b16 a[176:177], v24 offset:24576
    ds_read_b64_tr_b16 a[178:179], v24 offset:26624
    v_mfma_f32_16x16x32_bf16 v[196:199], a[180:183], a[104:107], v[196:199]
    v_lshlrev_b32 v62, 16, v127
    v_and_b32 v63, 0xffff0000, v127
    v_add_f32 v128, v128, v32
    v_mfma_f32_16x16x32_bf16 v[212:215], a[180:183], a[108:111], v[212:215]
    v_add_f32 v129, v129, v33
    v_add_f32 v130, v130, v34
    v_add_f32 v131, v131, v35
    ds_read_b64_tr_b16 a[180:181], v25 offset:24576
    ds_read_b64_tr_b16 a[182:183], v25 offset:26624
    s_waitcnt lgkmcnt(12)
    v_mfma_f32_16x16x32_bf16 v[200:203], a[184:187], a[104:107], v[200:203]
    v_add_f32 v132, v132, v36
    v_add_f32 v133, v133, v37
    v_add_f32 v134, v134, v38
    v_mfma_f32_16x16x32_bf16 v[216:219], a[184:187], a[108:111], v[216:219]
    v_add_f32 v135, v135, v39
    v_add_f32 v136, v136, v40
    v_add_f32 v137, v137, v41
    ds_read_b64_tr_b16 a[184:185], v26 offset:24576
    ds_read_b64_tr_b16 a[186:187], v26 offset:26624
    v_mfma_f32_16x16x32_bf16 v[204:207], a[188:191], a[104:107], v[204:207]
    v_add_f32 v138, v138, v42
    v_add_f32 v139, v139, v43
    v_add_f32 v140, v140, v44
    v_mfma_f32_16x16x32_bf16 v[220:223], a[188:191], a[108:111], v[220:223]
    v_add_f32 v141, v141, v45
    v_add_f32 v142, v142, v46
    v_add_f32 v143, v143, v47
    ds_read_b64_tr_b16 a[188:189], v27 offset:24576
    ds_read_b64_tr_b16 a[190:191], v27 offset:26624
    s_waitcnt vmcnt(14)
    s_barrier
    s_waitcnt lgkmcnt(12)
    v_mfma_f32_16x16x32_bf16 v[192:195], a[160:163], a[112:115], v[192:195]
    v_add_u32 v24, s62, v24
    v_mul_f32 v32, s57, v128
    v_mul_f32 v33, s57, v129
    v_mul_f32 v34, s57, v130
    v_mfma_f32_16x16x32_bf16 v[208:211], a[160:163], a[116:119], v[208:211]
    v_mul_f32 v35, s57, v131
    v_mul_f32 v36, s57, v132
    v_mul_f32 v37, s57, v133
    ds_read_b64_tr_b16 a[160:161], v24 offset:0
    ds_read_b64_tr_b16 a[162:163], v24 offset:2048
    v_mfma_f32_16x16x32_bf16 v[196:199], a[164:167], a[112:115], v[196:199]
    v_add_u32 v25, s62, v25
    v_mul_f32 v38, s57, v134
    v_mul_f32 v39, s57, v135
    v_mul_f32 v40, s57, v136
    v_mfma_f32_16x16x32_bf16 v[212:215], a[164:167], a[116:119], v[212:215]
    v_mul_f32 v41, s57, v137
    v_mul_f32 v42, s57, v138
    v_mul_f32 v43, s57, v139
    ds_read_b64_tr_b16 a[164:165], v25 offset:0
    ds_read_b64_tr_b16 a[166:167], v25 offset:2048
    s_waitcnt lgkmcnt(12)
    v_mfma_f32_16x16x32_bf16 v[200:203], a[168:171], a[112:115], v[200:203]
    v_add_u32 v26, s62, v26
    v_mul_f32 v44, s57, v140
    v_mul_f32 v45, s57, v141
    v_mul_f32 v46, s57, v142
    v_mfma_f32_16x16x32_bf16 v[216:219], a[168:171], a[116:119], v[216:219]
    v_mul_f32 v47, s57, v143
    v_exp_f32 v32, v32
    v_exp_f32 v33, v33
    ds_read_b64_tr_b16 a[168:169], v26 offset:0
    ds_read_b64_tr_b16 a[170:171], v26 offset:2048
    v_mfma_f32_16x16x32_bf16 v[204:207], a[172:175], a[112:115], v[204:207]
    v_add_u32 v27, s62, v27
    v_exp_f32 v34, v34
    v_exp_f32 v35, v35
    v_exp_f32 v36, v36
    v_mfma_f32_16x16x32_bf16 v[220:223], a[172:175], a[116:119], v[220:223]
    v_exp_f32 v37, v37
    v_exp_f32 v38, v38
    v_exp_f32 v39, v39
    ds_read_b64_tr_b16 a[172:173], v27 offset:0
    ds_read_b64_tr_b16 a[174:175], v27 offset:2048
    s_waitcnt vmcnt(14)
    s_waitcnt lgkmcnt(12)
    v_mfma_f32_16x16x32_bf16 v[192:195], a[176:179], a[120:123], v[192:195]
    v_exp_f32 v40, v40
    v_exp_f32 v41, v41
    v_exp_f32 v42, v42
    v_mfma_f32_16x16x32_bf16 v[208:211], a[176:179], a[124:127], v[208:211]
    v_exp_f32 v43, v43
    v_exp_f32 v44, v44
    v_exp_f32 v45, v45
    ds_read_b64_tr_b16 a[176:177], v24 offset:8192
    ds_read_b64_tr_b16 a[178:179], v24 offset:10240
    v_mfma_f32_16x16x32_bf16 v[196:199], a[180:183], a[120:123], v[196:199]
    v_exp_f32 v46, v46
    v_exp_f32 v47, v47
    v_add_f32 v32, 1.0, v32
    v_mfma_f32_16x16x32_bf16 v[212:215], a[180:183], a[124:127], v[212:215]
    v_add_f32 v33, 1.0, v33
    v_add_f32 v34, 1.0, v34
    v_add_f32 v35, 1.0, v35
    ds_read_b64_tr_b16 a[180:181], v25 offset:8192
    ds_read_b64_tr_b16 a[182:183], v25 offset:10240
    s_waitcnt lgkmcnt(12)
    v_mfma_f32_16x16x32_bf16 v[200:203], a[184:187], a[120:123], v[200:203]
    v_add_f32 v36, 1.0, v36
    v_add_f32 v37, 1.0, v37
    v_add_f32 v38, 1.0, v38
    v_mfma_f32_16x16x32_bf16 v[216:219], a[184:187], a[124:127], v[216:219]
    v_add_f32 v39, 1.0, v39
    v_add_f32 v40, 1.0, v40
    v_add_f32 v41, 1.0, v41
    ds_read_b64_tr_b16 a[184:185], v26 offset:8192
    ds_read_b64_tr_b16 a[186:187], v26 offset:10240
    v_mfma_f32_16x16x32_bf16 v[204:207], a[188:191], a[120:123], v[204:207]
    s_cmp_ge_u32 s71, 0x20000
    s_cselect_b32 s52, s64, 0x8000
    s_add_u32 s71, s71, s52
    v_add_f32 v42, 1.0, v42
    v_add_f32 v43, 1.0, v43
    v_add_f32 v44, 1.0, v44
    v_mfma_f32_16x16x32_bf16 v[220:223], a[188:191], a[124:127], v[220:223]
    v_add_f32 v45, 1.0, v45
    v_add_f32 v46, 1.0, v46
    v_add_f32 v47, 1.0, v47
    ds_read_b64_tr_b16 a[188:189], v27 offset:8192
    ds_read_b64_tr_b16 a[190:191], v27 offset:10240
    s_waitcnt vmcnt(14)
    s_waitcnt lgkmcnt(12)
    v_mfma_f32_16x16x32_bf16 v[192:195], a[160:163], a[0:3], v[192:195]
    s_cmp_eq_u32 s63, 0x20000
    s_cselect_b32 s62, s64, 0x8000
    v_rcp_f32 v32, v32
    v_rcp_f32 v33, v33
    v_rcp_f32 v34, v34
    v_mfma_f32_16x16x32_bf16 v[208:211], a[160:163], a[4:7], v[208:211]
    v_rcp_f32 v35, v35
    v_rcp_f32 v36, v36
    v_rcp_f32 v37, v37
    ds_read_b64_tr_b16 a[160:161], v24 offset:16384
    ds_read_b64_tr_b16 a[162:163], v24 offset:18432
    v_mfma_f32_16x16x32_bf16 v[196:199], a[164:167], a[0:3], v[196:199]
    v_rcp_f32 v38, v38
    v_rcp_f32 v39, v39
    v_rcp_f32 v40, v40
    v_mfma_f32_16x16x32_bf16 v[212:215], a[164:167], a[4:7], v[212:215]
    v_rcp_f32 v41, v41
    v_rcp_f32 v42, v42
    v_rcp_f32 v43, v43
    ds_read_b64_tr_b16 a[164:165], v25 offset:16384
    ds_read_b64_tr_b16 a[166:167], v25 offset:18432
    s_waitcnt lgkmcnt(12)
    v_mfma_f32_16x16x32_bf16 v[200:203], a[168:171], a[0:3], v[200:203]
    s_add_u32 s63, s63, s62
    v_rcp_f32 v44, v44
    v_rcp_f32 v45, v45
    v_rcp_f32 v46, v46
    v_mfma_f32_16x16x32_bf16 v[216:219], a[168:171], a[4:7], v[216:219]
    v_rcp_f32 v47, v47
    v_mul_f32 v128, v128, v32
    v_mul_f32 v129, v129, v33
    ds_read_b64_tr_b16 a[168:169], v26 offset:16384
    ds_read_b64_tr_b16 a[170:171], v26 offset:18432
    v_mfma_f32_16x16x32_bf16 v[204:207], a[172:175], a[0:3], v[204:207]
    v_mul_f32 v130, v130, v34
    v_mul_f32 v131, v131, v35
    v_mul_f32 v132, v132, v36
    v_mfma_f32_16x16x32_bf16 v[220:223], a[172:175], a[4:7], v[220:223]
    v_mul_f32 v133, v133, v37
    v_mul_f32 v134, v134, v38
    v_mul_f32 v135, v135, v39
    ds_read_b64_tr_b16 a[172:173], v27 offset:16384
    ds_read_b64_tr_b16 a[174:175], v27 offset:18432
    s_waitcnt vmcnt(14)
    s_waitcnt lgkmcnt(12)
    v_mfma_f32_16x16x32_bf16 v[192:195], a[176:179], a[8:11], v[192:195]
    v_mul_f32 v136, v136, v40
    v_mul_f32 v137, v137, v41
    v_mul_f32 v138, v138, v42
    v_mfma_f32_16x16x32_bf16 v[208:211], a[176:179], a[12:15], v[208:211]
    v_mul_f32 v139, v139, v43
    v_mul_f32 v140, v140, v44
    v_mul_f32 v141, v141, v45
    ds_read_b64_tr_b16 a[176:177], v24 offset:24576
    ds_read_b64_tr_b16 a[178:179], v24 offset:26624
    v_mfma_f32_16x16x32_bf16 v[196:199], a[180:183], a[8:11], v[196:199]
    v_mul_f32 v142, v142, v46
    v_mul_f32 v143, v143, v47
    v_add_f32 v160, v160, v48
    v_mfma_f32_16x16x32_bf16 v[212:215], a[180:183], a[12:15], v[212:215]
    v_add_f32 v161, v161, v49
    v_add_f32 v162, v162, v50
    v_add_f32 v163, v163, v51
    ds_read_b64_tr_b16 a[180:181], v25 offset:24576
    ds_read_b64_tr_b16 a[182:183], v25 offset:26624
    s_waitcnt lgkmcnt(12)
    v_mfma_f32_16x16x32_bf16 v[200:203], a[184:187], a[8:11], v[200:203]
    v_add_f32 v164, v164, v52
    v_add_f32 v165, v165, v53
    v_add_f32 v166, v166, v54
    v_mfma_f32_16x16x32_bf16 v[216:219], a[184:187], a[12:15], v[216:219]
    v_add_f32 v167, v167, v55
    v_add_f32 v168, v168, v56
    v_add_f32 v169, v169, v57
    ds_read_b64_tr_b16 a[184:185], v26 offset:24576
    ds_read_b64_tr_b16 a[186:187], v26 offset:26624
    v_mfma_f32_16x16x32_bf16 v[204:207], a[188:191], a[8:11], v[204:207]
    v_add_f32 v170, v170, v58
    v_add_f32 v171, v171, v59
    v_add_f32 v172, v172, v60
    v_mfma_f32_16x16x32_bf16 v[220:223], a[188:191], a[12:15], v[220:223]
    v_add_f32 v173, v173, v61
    v_add_f32 v174, v174, v62
    v_add_f32 v175, v175, v63
    ds_read_b64_tr_b16 a[188:189], v27 offset:24576
    ds_read_b64_tr_b16 a[190:191], v27 offset:26624
    s_waitcnt vmcnt(2)
    s_barrier
    s_waitcnt lgkmcnt(12)
    v_mfma_f32_16x16x32_bf16 v[192:195], a[160:163], a[16:19], v[192:195]
    v_add_u32 v24, s62, v24
    v_mul_f32 v48, s57, v160
    v_mul_f32 v49, s57, v161
    v_mul_f32 v50, s57, v162
    v_mfma_f32_16x16x32_bf16 v[208:211], a[160:163], a[20:23], v[208:211]
    v_mul_f32 v51, s57, v163
    v_mul_f32 v52, s57, v164
    v_mul_f32 v53, s57, v165
    ds_read_b64_tr_b16 a[160:161], v24 offset:0
    ds_read_b64_tr_b16 a[162:163], v24 offset:2048
    v_mfma_f32_16x16x32_bf16 v[196:199], a[164:167], a[16:19], v[196:199]
    v_add_u32 v25, s62, v25
    v_mul_f32 v54, s57, v166
    v_mul_f32 v55, s57, v167
    v_mul_f32 v56, s57, v168
    v_mfma_f32_16x16x32_bf16 v[212:215], a[164:167], a[20:23], v[212:215]
    v_mul_f32 v57, s57, v169
    v_mul_f32 v58, s57, v170
    v_mul_f32 v59, s57, v171
    ds_read_b64_tr_b16 a[164:165], v25 offset:0
    ds_read_b64_tr_b16 a[166:167], v25 offset:2048
    s_waitcnt lgkmcnt(12)
    v_mfma_f32_16x16x32_bf16 v[200:203], a[168:171], a[16:19], v[200:203]
    v_add_u32 v26, s62, v26
    v_mul_f32 v60, s57, v172
    v_mul_f32 v61, s57, v173
    v_mul_f32 v62, s57, v174
    v_mfma_f32_16x16x32_bf16 v[216:219], a[168:171], a[20:23], v[216:219]
    v_mul_f32 v63, s57, v175
    v_exp_f32 v48, v48
    v_exp_f32 v49, v49
    ds_read_b64_tr_b16 a[168:169], v26 offset:0
    ds_read_b64_tr_b16 a[170:171], v26 offset:2048
    v_mfma_f32_16x16x32_bf16 v[204:207], a[172:175], a[16:19], v[204:207]
    v_add_u32 v27, s62, v27
    v_exp_f32 v50, v50
    v_exp_f32 v51, v51
    v_exp_f32 v52, v52
    v_mfma_f32_16x16x32_bf16 v[220:223], a[172:175], a[20:23], v[220:223]
    v_exp_f32 v53, v53
    v_exp_f32 v54, v54
    v_exp_f32 v55, v55
    ds_read_b64_tr_b16 a[172:173], v27 offset:0
    ds_read_b64_tr_b16 a[174:175], v27 offset:2048
    s_waitcnt vmcnt(2)
    s_waitcnt lgkmcnt(12)
    v_mfma_f32_16x16x32_bf16 v[192:195], a[176:179], a[24:27], v[192:195]
    v_exp_f32 v56, v56
    v_exp_f32 v57, v57
    v_exp_f32 v58, v58
    v_mfma_f32_16x16x32_bf16 v[208:211], a[176:179], a[28:31], v[208:211]
    v_exp_f32 v59, v59
    v_exp_f32 v60, v60
    v_exp_f32 v61, v61
    ds_read_b64_tr_b16 a[176:177], v24 offset:8192
    ds_read_b64_tr_b16 a[178:179], v24 offset:10240
    v_mfma_f32_16x16x32_bf16 v[196:199], a[180:183], a[24:27], v[196:199]
    v_exp_f32 v62, v62
    v_exp_f32 v63, v63
    v_add_f32 v48, 1.0, v48
    v_mfma_f32_16x16x32_bf16 v[212:215], a[180:183], a[28:31], v[212:215]
    v_add_f32 v49, 1.0, v49
    v_add_f32 v50, 1.0, v50
    v_add_f32 v51, 1.0, v51
    ds_read_b64_tr_b16 a[180:181], v25 offset:8192
    ds_read_b64_tr_b16 a[182:183], v25 offset:10240
    s_waitcnt lgkmcnt(12)
    v_mfma_f32_16x16x32_bf16 v[200:203], a[184:187], a[24:27], v[200:203]
    v_add_f32 v52, 1.0, v52
    v_add_f32 v53, 1.0, v53
    v_add_f32 v54, 1.0, v54
    v_mfma_f32_16x16x32_bf16 v[216:219], a[184:187], a[28:31], v[216:219]
    v_add_f32 v55, 1.0, v55
    v_add_f32 v56, 1.0, v56
    v_add_f32 v57, 1.0, v57
    ds_read_b64_tr_b16 a[184:185], v26 offset:8192
    ds_read_b64_tr_b16 a[186:187], v26 offset:10240
    v_mfma_f32_16x16x32_bf16 v[204:207], a[188:191], a[24:27], v[204:207]
    s_cmp_ge_u32 s71, 0x20000
    s_cselect_b32 s52, s64, 0x8000
    s_add_u32 s71, s71, s52
    v_add_f32 v58, 1.0, v58
    v_add_f32 v59, 1.0, v59
    v_add_f32 v60, 1.0, v60
    v_mfma_f32_16x16x32_bf16 v[220:223], a[188:191], a[28:31], v[220:223]
    v_add_f32 v61, 1.0, v61
    v_add_f32 v62, 1.0, v62
    v_add_f32 v63, 1.0, v63
    ds_read_b64_tr_b16 a[188:189], v27 offset:8192
    ds_read_b64_tr_b16 a[190:191], v27 offset:10240
    s_waitcnt vmcnt(2)
    s_waitcnt lgkmcnt(12)
    v_mfma_f32_16x16x32_bf16 v[192:195], a[160:163], a[32:35], v[192:195]
    s_cmp_eq_u32 s63, 0x20000
    s_cselect_b32 s62, s64, 0x8000
    v_rcp_f32 v48, v48
    v_rcp_f32 v49, v49
    v_rcp_f32 v50, v50
    v_mfma_f32_16x16x32_bf16 v[208:211], a[160:163], a[36:39], v[208:211]
    v_rcp_f32 v51, v51
    v_rcp_f32 v52, v52
    v_rcp_f32 v53, v53
    ds_read_b64_tr_b16 a[160:161], v24 offset:16384
    ds_read_b64_tr_b16 a[162:163], v24 offset:18432
    v_mfma_f32_16x16x32_bf16 v[196:199], a[164:167], a[32:35], v[196:199]
    v_rcp_f32 v54, v54
    v_rcp_f32 v55, v55
    v_rcp_f32 v56, v56
    v_mfma_f32_16x16x32_bf16 v[212:215], a[164:167], a[36:39], v[212:215]
    v_rcp_f32 v57, v57
    v_rcp_f32 v58, v58
    v_rcp_f32 v59, v59
    ds_read_b64_tr_b16 a[164:165], v25 offset:16384
    ds_read_b64_tr_b16 a[166:167], v25 offset:18432
    s_waitcnt lgkmcnt(12)
    v_mfma_f32_16x16x32_bf16 v[200:203], a[168:171], a[32:35], v[200:203]
    s_add_u32 s63, s63, s62
    v_rcp_f32 v60, v60
    v_rcp_f32 v61, v61
    v_rcp_f32 v62, v62
    v_mfma_f32_16x16x32_bf16 v[216:219], a[168:171], a[36:39], v[216:219]
    v_rcp_f32 v63, v63
    v_mul_f32 v160, v160, v48
    v_mul_f32 v161, v161, v49
    ds_read_b64_tr_b16 a[168:169], v26 offset:16384
    ds_read_b64_tr_b16 a[170:171], v26 offset:18432
    v_mfma_f32_16x16x32_bf16 v[204:207], a[172:175], a[32:35], v[204:207]
    v_mul_f32 v162, v162, v50
    v_mul_f32 v163, v163, v51
    v_mul_f32 v164, v164, v52
    v_mfma_f32_16x16x32_bf16 v[220:223], a[172:175], a[36:39], v[220:223]
    v_mul_f32 v165, v165, v53
    v_mul_f32 v166, v166, v54
    v_mul_f32 v167, v167, v55
    ds_read_b64_tr_b16 a[172:173], v27 offset:16384
    ds_read_b64_tr_b16 a[174:175], v27 offset:18432
    s_waitcnt vmcnt(2)
    s_waitcnt lgkmcnt(12)
    v_mfma_f32_16x16x32_bf16 v[192:195], a[176:179], a[40:43], v[192:195]
    v_mul_f32 v168, v168, v56
    v_mul_f32 v169, v169, v57
    v_mul_f32 v170, v170, v58
    v_mfma_f32_16x16x32_bf16 v[208:211], a[176:179], a[44:47], v[208:211]
    v_mul_f32 v171, v171, v59
    v_mul_f32 v172, v172, v60
    v_mul_f32 v173, v173, v61
    ds_read_b64_tr_b16 a[176:177], v24 offset:24576
    ds_read_b64_tr_b16 a[178:179], v24 offset:26624
    v_mfma_f32_16x16x32_bf16 v[196:199], a[180:183], a[40:43], v[196:199]
    v_mul_f32 v174, v174, v62
    v_mul_f32 v175, v175, v63
    v_lshlrev_b32 v64, 16, v96
    v_mfma_f32_16x16x32_bf16 v[212:215], a[180:183], a[44:47], v[212:215]
    v_and_b32 v65, 0xffff0000, v96
    v_lshlrev_b32 v66, 16, v97
    v_and_b32 v67, 0xffff0000, v97
    ds_read_b64_tr_b16 a[180:181], v25 offset:24576
    ds_read_b64_tr_b16 a[182:183], v25 offset:26624
    s_waitcnt lgkmcnt(12)
    v_mfma_f32_16x16x32_bf16 v[200:203], a[184:187], a[40:43], v[200:203]
    v_lshlrev_b32 v68, 16, v98
    v_and_b32 v69, 0xffff0000, v98
    v_lshlrev_b32 v70, 16, v99
    v_mfma_f32_16x16x32_bf16 v[216:219], a[184:187], a[44:47], v[216:219]
    v_and_b32 v71, 0xffff0000, v99
    v_lshlrev_b32 v72, 16, v100
    v_and_b32 v73, 0xffff0000, v100
    ds_read_b64_tr_b16 a[184:185], v26 offset:24576
    ds_read_b64_tr_b16 a[186:187], v26 offset:26624
    v_mfma_f32_16x16x32_bf16 v[204:207], a[188:191], a[40:43], v[204:207]
    v_lshlrev_b32 v74, 16, v101
    v_and_b32 v75, 0xffff0000, v101
    v_lshlrev_b32 v76, 16, v102
    v_mfma_f32_16x16x32_bf16 v[220:223], a[188:191], a[44:47], v[220:223]
    v_and_b32 v77, 0xffff0000, v102
    v_lshlrev_b32 v78, 16, v103
    v_and_b32 v79, 0xffff0000, v103
    ds_read_b64_tr_b16 a[188:189], v27 offset:24576
    ds_read_b64_tr_b16 a[190:191], v27 offset:26624
    s_waitcnt vmcnt(2)
    s_waitcnt lgkmcnt(12)
    v_mfma_f32_16x16x32_bf16 v[192:195], a[160:163], a[48:51], v[192:195]
    v_lshlrev_b32 v80, 16, v104
    v_and_b32 v81, 0xffff0000, v104
    v_lshlrev_b32 v82, 16, v105
    v_mfma_f32_16x16x32_bf16 v[208:211], a[160:163], a[52:55], v[208:211]
    v_and_b32 v83, 0xffff0000, v105
    v_lshlrev_b32 v84, 16, v106
    v_and_b32 v85, 0xffff0000, v106
    v_mfma_f32_16x16x32_bf16 v[196:199], a[164:167], a[48:51], v[196:199]
    v_lshlrev_b32 v86, 16, v107
    v_and_b32 v87, 0xffff0000, v107
    v_lshlrev_b32 v88, 16, v108
    v_mfma_f32_16x16x32_bf16 v[212:215], a[164:167], a[52:55], v[212:215]
    v_and_b32 v89, 0xffff0000, v108
    v_lshlrev_b32 v90, 16, v109
    v_and_b32 v91, 0xffff0000, v109
    s_waitcnt lgkmcnt(8)
    v_mfma_f32_16x16x32_bf16 v[200:203], a[168:171], a[48:51], v[200:203]
    v_lshlrev_b32 v92, 16, v110
    v_and_b32 v93, 0xffff0000, v110
    v_lshlrev_b32 v94, 16, v111
    v_mfma_f32_16x16x32_bf16 v[216:219], a[168:171], a[52:55], v[216:219]
    v_and_b32 v95, 0xffff0000, v111
    v_mfma_f32_16x16x32_bf16 v[204:207], a[172:175], a[48:51], v[204:207]
    v_mfma_f32_16x16x32_bf16 v[220:223], a[172:175], a[52:55], v[220:223]
    s_waitcnt vmcnt(0)
    s_waitcnt lgkmcnt(4)
    v_mfma_f32_16x16x32_bf16 v[192:195], a[176:179], a[56:59], v[192:195]
    v_mfma_f32_16x16x32_bf16 v[208:211], a[176:179], a[60:63], v[208:211]
    v_mfma_f32_16x16x32_bf16 v[196:199], a[180:183], a[56:59], v[196:199]
    v_mfma_f32_16x16x32_bf16 v[212:215], a[180:183], a[60:63], v[212:215]
    s_waitcnt lgkmcnt(0)
    v_mfma_f32_16x16x32_bf16 v[200:203], a[184:187], a[56:59], v[200:203]
    v_mfma_f32_16x16x32_bf16 v[216:219], a[184:187], a[60:63], v[216:219]
    v_mfma_f32_16x16x32_bf16 v[204:207], a[188:191], a[56:59], v[204:207]
    s_cmp_ge_u32 s71, 0x20000
    s_cselect_b32 s52, s64, 0x8000
    s_add_u32 s71, s71, s52
    v_mfma_f32_16x16x32_bf16 v[220:223], a[188:191], a[60:63], v[220:223]
    s_waitcnt vmcnt(0)
    s_nop 7
    v_pk_mul_f32 v[128:129], v[128:129], v[192:193]
    v_pk_mul_f32 v[130:131], v[130:131], v[194:195]
    v_pk_mul_f32 v[132:133], v[132:133], v[196:197]
    v_pk_mul_f32 v[134:135], v[134:135], v[198:199]
    v_pk_mul_f32 v[136:137], v[136:137], v[200:201]
    v_pk_mul_f32 v[138:139], v[138:139], v[202:203]
    v_pk_mul_f32 v[140:141], v[140:141], v[204:205]
    v_pk_mul_f32 v[142:143], v[142:143], v[206:207]
    s_nop 1
    v_permlane16_swap_b32 v128, v132
    v_permlane16_swap_b32 v129, v133
    v_permlane16_swap_b32 v130, v134
    v_permlane16_swap_b32 v131, v135
    v_permlane16_swap_b32 v136, v140
    v_permlane16_swap_b32 v137, v141
    v_permlane16_swap_b32 v138, v142
    v_permlane16_swap_b32 v139, v143
    v_pk_add_f32 v[128:129], v[128:129], v[64:65]
    v_pk_add_f32 v[130:131], v[130:131], v[66:67]
    v_pk_add_f32 v[132:133], v[132:133], v[68:69]
    v_pk_add_f32 v[134:135], v[134:135], v[70:71]
    v_pk_add_f32 v[136:137], v[136:137], v[72:73]
    v_pk_add_f32 v[138:139], v[138:139], v[74:75]
    v_pk_add_f32 v[140:141], v[140:141], v[76:77]
    v_pk_add_f32 v[142:143], v[142:143], v[78:79]
    v_cvt_pk_bf16_f32 v32, v128, v129
    v_cvt_pk_bf16_f32 v33, v130, v131
    v_cvt_pk_bf16_f32 v34, v132, v133
    v_cvt_pk_bf16_f32 v35, v134, v135
    v_cvt_pk_bf16_f32 v36, v136, v137
    v_cvt_pk_bf16_f32 v37, v138, v139
    v_cvt_pk_bf16_f32 v38, v140, v141
    v_cvt_pk_bf16_f32 v39, v142, v143
    buffer_store_dwordx4 v[32:35], v0, s[24:27], 0 offen offset:0
    buffer_store_dwordx4 v[36:39], v0, s[24:27], 0 offen offset:64
    v_pk_mul_f32 v[160:161], v[160:161], v[208:209]
    v_pk_mul_f32 v[162:163], v[162:163], v[210:211]
    v_pk_mul_f32 v[164:165], v[164:165], v[212:213]
    v_pk_mul_f32 v[166:167], v[166:167], v[214:215]
    v_pk_mul_f32 v[168:169], v[168:169], v[216:217]
    v_pk_mul_f32 v[170:171], v[170:171], v[218:219]
    v_pk_mul_f32 v[172:173], v[172:173], v[220:221]
    v_pk_mul_f32 v[174:175], v[174:175], v[222:223]
    s_nop 1
    v_permlane16_swap_b32 v160, v164
    v_permlane16_swap_b32 v161, v165
    v_permlane16_swap_b32 v162, v166
    v_permlane16_swap_b32 v163, v167
    v_permlane16_swap_b32 v168, v172
    v_permlane16_swap_b32 v169, v173
    v_permlane16_swap_b32 v170, v174
    v_permlane16_swap_b32 v171, v175
    v_pk_add_f32 v[160:161], v[160:161], v[80:81]
    v_pk_add_f32 v[162:163], v[162:163], v[82:83]
    v_pk_add_f32 v[164:165], v[164:165], v[84:85]
    v_pk_add_f32 v[166:167], v[166:167], v[86:87]
    v_pk_add_f32 v[168:169], v[168:169], v[88:89]
    v_pk_add_f32 v[170:171], v[170:171], v[90:91]
    v_pk_add_f32 v[172:173], v[172:173], v[92:93]
    v_pk_add_f32 v[174:175], v[174:175], v[94:95]
    v_cvt_pk_bf16_f32 v48, v160, v161
    v_cvt_pk_bf16_f32 v49, v162, v163
    v_cvt_pk_bf16_f32 v50, v164, v165
    v_cvt_pk_bf16_f32 v51, v166, v167
    v_cvt_pk_bf16_f32 v52, v168, v169
    v_cvt_pk_bf16_f32 v53, v170, v171
    v_cvt_pk_bf16_f32 v54, v172, v173
    v_cvt_pk_bf16_f32 v55, v174, v175
    buffer_store_dwordx4 v[48:51], v1, s[24:27], 0 offen offset:0
    buffer_store_dwordx4 v[52:55], v1, s[24:27], 0 offen offset:64
    s_branch L_endC
.p2align 6
L_loop2_0:
    s_waitcnt vmcnt(16)
    s_waitcnt lgkmcnt(12)
    v_mfma_f32_16x16x32_bf16 v[128:131], a[160:163], a[96:99], v[128:131]
    s_lshr_b32 s59, s31, s72
    s_mov_b32 m0, s71
    v_mfma_f32_16x16x32_bf16 v[160:163], a[160:163], a[100:103], v[160:163]
    s_and_b32 s59, s59, 255
    s_lshl_b32 s59, s59, 16
    v_mfma_f32_16x16x32_bf16 v[192:195], a[160:163], a[104:107], v[192:195]
    buffer_load_dwordx4 v13, s[16:19], s59 offen offset:0 lds
    v_mfma_f32_16x16x32_bf16 v[224:227], a[160:163], a[108:111], v[224:227]
    ds_read_b64_tr_b16 a[160:161], v4 offset:16384
    ds_read_b64_tr_b16 a[162:163], v4 offset:20480
    v_mfma_f32_16x16x32_bf16 v[132:135], a[164:167], a[96:99], v[132:135]
    s_bfe_u32 s40, s30, 0x80010
    v_mfma_f32_16x16x32_bf16 v[164:167], a[164:167], a[100:103], v[164:167]
    s_lshl_b32 s40, s40, 13
    v_mfma_f32_16x16x32_bf16 v[196:199], a[164:167], a[104:107], v[196:199]
    buffer_load_dwordx4 a[144:147], v21, s[12:15], s40 offen offset:0 sc1
    v_mfma_f32_16x16x32_bf16 v[228:231], a[164:167], a[108:111], v[228:231]
    ds_read_b64_tr_b16 a[164:165], v5 offset:16384
    ds_read_b64_tr_b16 a[166:167], v5 offset:20480
    s_waitcnt lgkmcnt(12)
    v_mfma_f32_16x16x32_bf16 v[136:139], a[168:171], a[96:99], v[136:139]
    v_mfma_f32_16x16x32_bf16 v[168:171], a[168:171], a[100:103], v[168:171]
    s_lshr_b32 s30, s51, s73
    v_mfma_f32_16x16x32_bf16 v[200:203], a[168:171], a[104:107], v[200:203]
    buffer_load_dwordx4 v14, s[16:19], s59 offen offset:1024 lds
    v_mfma_f32_16x16x32_bf16 v[232:235], a[168:171], a[108:111], v[232:235]
    ds_read_b64_tr_b16 a[168:169], v6 offset:16384
    ds_read_b64_tr_b16 a[170:171], v6 offset:20480
    v_mfma_f32_16x16x32_bf16 v[140:143], a[172:175], a[96:99], v[140:143]
    s_mov_b32 s51, s31
    v_mfma_f32_16x16x32_bf16 v[172:175], a[172:175], a[100:103], v[172:175]
    s_add_u32 s41, s41, 1
    v_mfma_f32_16x16x32_bf16 v[204:207], a[172:175], a[104:107], v[204:207]
    buffer_load_dwordx4 a[148:151], v21, s[12:15], s40 offen offset:1024 sc1
    v_mfma_f32_16x16x32_bf16 v[236:239], a[172:175], a[108:111], v[236:239]
    ds_read_b64_tr_b16 a[172:173], v7 offset:16384
    ds_read_b64_tr_b16 a[174:175], v7 offset:20480
    s_waitcnt lgkmcnt(12)
    v_mfma_f32_16x16x32_bf16 v[144:147], a[176:179], a[96:99], v[144:147]
    v_mfma_f32_16x16x32_bf16 v[176:179], a[176:179], a[100:103], v[176:179]
    v_readlane_b32 s31, v18, s41
    v_mfma_f32_16x16x32_bf16 v[208:211], a[176:179], a[104:107], v[208:211]
    buffer_load_dwordx4 v15, s[16:19], s59 offen offset:2048 lds
    v_mfma_f32_16x16x32_bf16 v[240:243], a[176:179], a[108:111], v[240:243]
    ds_read_b64_tr_b16 a[176:177], v8 offset:16384
    ds_read_b64_tr_b16 a[178:179], v8 offset:20480
    v_mfma_f32_16x16x32_bf16 v[148:151], a[180:183], a[96:99], v[148:151]
    s_cmp_eq_u32 s63, 0x20000
    s_cselect_b32 s62, s64, 0x8000
    v_mfma_f32_16x16x32_bf16 v[180:183], a[180:183], a[100:103], v[180:183]
    v_mfma_f32_16x16x32_bf16 v[212:215], a[180:183], a[104:107], v[212:215]
    buffer_load_dwordx4 a[152:155], v22, s[12:15], s40 offen offset:0 sc1
    v_mfma_f32_16x16x32_bf16 v[244:247], a[180:183], a[108:111], v[244:247]
    ds_read_b64_tr_b16 a[180:181], v9 offset:16384
    ds_read_b64_tr_b16 a[182:183], v9 offset:20480
    s_waitcnt lgkmcnt(12)
    v_mfma_f32_16x16x32_bf16 v[152:155], a[184:187], a[96:99], v[152:155]
    s_add_u32 s63, s63, s62
    v_mfma_f32_16x16x32_bf16 v[184:187], a[184:187], a[100:103], v[184:187]
    v_mfma_f32_16x16x32_bf16 v[216:219], a[184:187], a[104:107], v[216:219]
    buffer_load_dwordx4 v16, s[16:19], s59 offen offset:3072 lds
    v_mfma_f32_16x16x32_bf16 v[248:251], a[184:187], a[108:111], v[248:251]
    ds_read_b64_tr_b16 a[184:185], v10 offset:16384
    ds_read_b64_tr_b16 a[186:187], v10 offset:20480
    v_mfma_f32_16x16x32_bf16 v[156:159], a[188:191], a[96:99], v[156:159]
    v_mfma_f32_16x16x32_bf16 v[188:191], a[188:191], a[100:103], v[188:191]
    v_mfma_f32_16x16x32_bf16 v[220:223], a[188:191], a[104:107], v[220:223]
    buffer_load_dwordx4 a[156:159], v22, s[12:15], s40 offen offset:1024 sc1
    v_mfma_f32_16x16x32_bf16 v[252:255], a[188:191], a[108:111], v[252:255]
    ds_read_b64_tr_b16 a[188:189], v11 offset:16384
    ds_read_b64_tr_b16 a[190:191], v11 offset:20480
    s_waitcnt vmcnt(16)
    s_barrier
    s_waitcnt lgkmcnt(12)
    v_mfma_f32_16x16x32_bf16 v[128:131], a[160:163], a[112:115], v[128:131]
    s_add_u32 m0, s71, 4096
    v_add_u32 v4, s62, v4
    v_mfma_f32_16x16x32_bf16 v[160:163], a[160:163], a[116:119], v[160:163]
    s_add_u32 s59, s59, 32768
    v_mfma_f32_16x16x32_bf16 v[192:195], a[160:163], a[120:123], v[192:195]
    buffer_load_dwordx4 v13, s[16:19], s59 offen offset:0 lds
    v_mfma_f32_16x16x32_bf16 v[224:227], a[160:163], a[124:127], v[224:227]
    ds_read_b64_tr_b16 a[160:161], v4 offset:0
    ds_read_b64_tr_b16 a[162:163], v4 offset:4096
    v_mfma_f32_16x16x32_bf16 v[132:135], a[164:167], a[112:115], v[132:135]
    s_bfe_u32 s40, s30, 0x80000
    v_add_u32 v5, s62, v5
    v_mfma_f32_16x16x32_bf16 v[164:167], a[164:167], a[116:119], v[164:167]
    s_lshl_b32 s40, s40, 13
    v_mfma_f32_16x16x32_bf16 v[196:199], a[164:167], a[120:123], v[196:199]
    buffer_load_dwordx4 a[96:99], v21, s[12:15], s40 offen offset:0 sc1
    v_mfma_f32_16x16x32_bf16 v[228:231], a[164:167], a[124:127], v[228:231]
    ds_read_b64_tr_b16 a[164:165], v5 offset:0
    ds_read_b64_tr_b16 a[166:167], v5 offset:4096
    s_waitcnt lgkmcnt(12)
    v_mfma_f32_16x16x32_bf16 v[136:139], a[168:171], a[112:115], v[136:139]
    v_add_u32 v6, s62, v6
    v_mfma_f32_16x16x32_bf16 v[168:171], a[168:171], a[116:119], v[168:171]
    v_mfma_f32_16x16x32_bf16 v[200:203], a[168:171], a[120:123], v[200:203]
    buffer_load_dwordx4 v14, s[16:19], s59 offen offset:1024 lds
    v_mfma_f32_16x16x32_bf16 v[232:235], a[168:171], a[124:127], v[232:235]
    ds_read_b64_tr_b16 a[168:169], v6 offset:0
    ds_read_b64_tr_b16 a[170:171], v6 offset:4096
    v_mfma_f32_16x16x32_bf16 v[140:143], a[172:175], a[112:115], v[140:143]
    v_add_u32 v7, s62, v7
    v_mfma_f32_16x16x32_bf16 v[172:175], a[172:175], a[116:119], v[172:175]
    v_mfma_f32_16x16x32_bf16 v[204:207], a[172:175], a[120:123], v[204:207]
    buffer_load_dwordx4 a[100:103], v21, s[12:15], s40 offen offset:1024 sc1
    v_mfma_f32_16x16x32_bf16 v[236:239], a[172:175], a[124:127], v[236:239]
    ds_read_b64_tr_b16 a[172:173], v7 offset:0
    ds_read_b64_tr_b16 a[174:175], v7 offset:4096
    s_waitcnt lgkmcnt(12)
    v_mfma_f32_16x16x32_bf16 v[144:147], a[176:179], a[112:115], v[144:147]
    v_add_u32 v8, s62, v8
    v_mfma_f32_16x16x32_bf16 v[176:179], a[176:179], a[116:119], v[176:179]
    v_mfma_f32_16x16x32_bf16 v[208:211], a[176:179], a[120:123], v[208:211]
    buffer_load_dwordx4 v15, s[16:19], s59 offen offset:2048 lds
    v_mfma_f32_16x16x32_bf16 v[240:243], a[176:179], a[124:127], v[240:243]
    ds_read_b64_tr_b16 a[176:177], v8 offset:0
    ds_read_b64_tr_b16 a[178:179], v8 offset:4096
    v_mfma_f32_16x16x32_bf16 v[148:151], a[180:183], a[112:115], v[148:151]
    v_add_u32 v9, s62, v9
    v_mfma_f32_16x16x32_bf16 v[180:183], a[180:183], a[116:119], v[180:183]
    v_mfma_f32_16x16x32_bf16 v[212:215], a[180:183], a[120:123], v[212:215]
    buffer_load_dwordx4 a[104:107], v22, s[12:15], s40 offen offset:0 sc1
    v_mfma_f32_16x16x32_bf16 v[244:247], a[180:183], a[124:127], v[244:247]
    ds_read_b64_tr_b16 a[180:181], v9 offset:0
    ds_read_b64_tr_b16 a[182:183], v9 offset:4096
    s_waitcnt lgkmcnt(12)
    v_mfma_f32_16x16x32_bf16 v[152:155], a[184:187], a[112:115], v[152:155]
    v_add_u32 v10, s62, v10
    v_mfma_f32_16x16x32_bf16 v[184:187], a[184:187], a[116:119], v[184:187]
    s_cmp_ge_u32 s71, 0x20000
    s_cselect_b32 s52, s64, 0x8000
    v_mfma_f32_16x16x32_bf16 v[216:219], a[184:187], a[120:123], v[216:219]
    buffer_load_dwordx4 v16, s[16:19], s59 offen offset:3072 lds
    v_mfma_f32_16x16x32_bf16 v[248:251], a[184:187], a[124:127], v[248:251]
    ds_read_b64_tr_b16 a[184:185], v10 offset:0
    ds_read_b64_tr_b16 a[186:187], v10 offset:4096
    v_mfma_f32_16x16x32_bf16 v[156:159], a[188:191], a[112:115], v[156:159]
    v_add_u32 v11, s62, v11
    v_mfma_f32_16x16x32_bf16 v[188:191], a[188:191], a[116:119], v[188:191]
    s_add_u32 s71, s71, s52
    v_mfma_f32_16x16x32_bf16 v[220:223], a[188:191], a[120:123], v[220:223]
    buffer_load_dwordx4 a[108:111], v22, s[12:15], s40 offen offset:1024 sc1
    v_mfma_f32_16x16x32_bf16 v[252:255], a[188:191], a[124:127], v[252:255]
    ds_read_b64_tr_b16 a[188:189], v11 offset:0
    ds_read_b64_tr_b16 a[190:191], v11 offset:4096
    s_sub_u32 s48, s48, 1
    s_cmp_lg_u32 s48, 0
    s_cbranch_scc1 L_loop2_1
    s_setpc_b64 s[28:29]
L_loop2_1:
    s_waitcnt vmcnt(16)
    s_waitcnt lgkmcnt(12)
    v_mfma_f32_16x16x32_bf16 v[128:131], a[160:163], a[128:131], v[128:131]
    s_lshr_b32 s59, s31, s72
    s_mov_b32 m0, s71
    v_mfma_f32_16x16x32_bf16 v[160:163], a[160:163], a[132:135], v[160:163]
    s_and_b32 s59, s59, 255
    s_lshl_b32 s59, s59, 16
    v_mfma_f32_16x16x32_bf16 v[192:195], a[160:163], a[136:139], v[192:195]
    buffer_load_dwordx4 v13, s[16:19], s59 offen offset:0 lds
    v_mfma_f32_16x16x32_bf16 v[224:227], a[160:163], a[140:143], v[224:227]
    ds_read_b64_tr_b16 a[160:161], v4 offset:16384
    ds_read_b64_tr_b16 a[162:163], v4 offset:20480
    v_mfma_f32_16x16x32_bf16 v[132:135], a[164:167], a[128:131], v[132:135]
    s_bfe_u32 s40, s30, 0x80010
    v_mfma_f32_16x16x32_bf16 v[164:167], a[164:167], a[132:135], v[164:167]
    s_lshl_b32 s40, s40, 13
    v_mfma_f32_16x16x32_bf16 v[196:199], a[164:167], a[136:139], v[196:199]
    buffer_load_dwordx4 a[112:115], v21, s[12:15], s40 offen offset:0 sc1
    v_mfma_f32_16x16x32_bf16 v[228:231], a[164:167], a[140:143], v[228:231]
    ds_read_b64_tr_b16 a[164:165], v5 offset:16384
    ds_read_b64_tr_b16 a[166:167], v5 offset:20480
    s_waitcnt lgkmcnt(12)
    v_mfma_f32_16x16x32_bf16 v[136:139], a[168:171], a[128:131], v[136:139]
    v_mfma_f32_16x16x32_bf16 v[168:171], a[168:171], a[132:135], v[168:171]
    s_lshr_b32 s30, s51, s73
    v_mfma_f32_16x16x32_bf16 v[200:203], a[168:171], a[136:139], v[200:203]
    buffer_load_dwordx4 v14, s[16:19], s59 offen offset:1024 lds
    v_mfma_f32_16x16x32_bf16 v[232:235], a[168:171], a[140:143], v[232:235]
    ds_read_b64_tr_b16 a[168:169], v6 offset:16384
    ds_read_b64_tr_b16 a[170:171], v6 offset:20480
    v_mfma_f32_16x16x32_bf16 v[140:143], a[172:175], a[128:131], v[140:143]
    s_mov_b32 s51, s31
    v_mfma_f32_16x16x32_bf16 v[172:175], a[172:175], a[132:135], v[172:175]
    s_add_u32 s41, s41, 1
    v_mfma_f32_16x16x32_bf16 v[204:207], a[172:175], a[136:139], v[204:207]
    buffer_load_dwordx4 a[116:119], v21, s[12:15], s40 offen offset:1024 sc1
    v_mfma_f32_16x16x32_bf16 v[236:239], a[172:175], a[140:143], v[236:239]
    ds_read_b64_tr_b16 a[172:173], v7 offset:16384
    ds_read_b64_tr_b16 a[174:175], v7 offset:20480
    s_waitcnt lgkmcnt(12)
    v_mfma_f32_16x16x32_bf16 v[144:147], a[176:179], a[128:131], v[144:147]
    v_mfma_f32_16x16x32_bf16 v[176:179], a[176:179], a[132:135], v[176:179]
    v_readlane_b32 s31, v18, s41
    v_mfma_f32_16x16x32_bf16 v[208:211], a[176:179], a[136:139], v[208:211]
    buffer_load_dwordx4 v15, s[16:19], s59 offen offset:2048 lds
    v_mfma_f32_16x16x32_bf16 v[240:243], a[176:179], a[140:143], v[240:243]
    ds_read_b64_tr_b16 a[176:177], v8 offset:16384
    ds_read_b64_tr_b16 a[178:179], v8 offset:20480
    v_mfma_f32_16x16x32_bf16 v[148:151], a[180:183], a[128:131], v[148:151]
    s_cmp_eq_u32 s63, 0x20000
    s_cselect_b32 s62, s64, 0x8000
    v_mfma_f32_16x16x32_bf16 v[180:183], a[180:183], a[132:135], v[180:183]
    v_mfma_f32_16x16x32_bf16 v[212:215], a[180:183], a[136:139], v[212:215]
    buffer_load_dwordx4 a[120:123], v22, s[12:15], s40 offen offset:0 sc1
    v_mfma_f32_16x16x32_bf16 v[244:247], a[180:183], a[140:143], v[244:247]
    ds_read_b64_tr_b16 a[180:181], v9 offset:16384
    ds_read_b64_tr_b16 a[182:183], v9 offset:20480
    s_waitcnt lgkmcnt(12)
    v_mfma_f32_16x16x32_bf16 v[152:155], a[184:187], a[128:131], v[152:155]
    s_add_u32 s63, s63, s62
    v_mfma_f32_16x16x32_bf16 v[184:187], a[184:187], a[132:135], v[184:187]
    v_mfma_f32_16x16x32_bf16 v[216:219], a[184:187], a[136:139], v[216:219]
    buffer_load_dwordx4 v16, s[16:19], s59 offen offset:3072 lds
    v_mfma_f32_16x16x32_bf16 v[248:251], a[184:187], a[140:143], v[248:251]
    ds_read_b64_tr_b16 a[184:185], v10 offset:16384
    ds_read_b64_tr_b16 a[186:187], v10 offset:20480
    v_mfma_f32_16x16x32_bf16 v[156:159], a[188:191], a[128:131], v[156:159]
    v_mfma_f32_16x16x32_bf16 v[188:191], a[188:191], a[132:135], v[188:191]
    v_mfma_f32_16x16x32_bf16 v[220:223], a[188:191], a[136:139], v[220:223]
    buffer_load_dwordx4 a[124:127], v22, s[12:15], s40 offen offset:1024 sc1
    v_mfma_f32_16x16x32_bf16 v[252:255], a[188:191], a[140:143], v[252:255]
    ds_read_b64_tr_b16 a[188:189], v11 offset:16384
    ds_read_b64_tr_b16 a[190:191], v11 offset:20480
    s_waitcnt vmcnt(16)
    s_barrier
    s_waitcnt lgkmcnt(12)
    v_mfma_f32_16x16x32_bf16 v[128:131], a[160:163], a[144:147], v[128:131]
    s_add_u32 m0, s71, 4096
    v_add_u32 v4, s62, v4
    v_mfma_f32_16x16x32_bf16 v[160:163], a[160:163], a[148:151], v[160:163]
    s_add_u32 s59, s59, 32768
    v_mfma_f32_16x16x32_bf16 v[192:195], a[160:163], a[152:155], v[192:195]
    buffer_load_dwordx4 v13, s[16:19], s59 offen offset:0 lds
    v_mfma_f32_16x16x32_bf16 v[224:227], a[160:163], a[156:159], v[224:227]
    ds_read_b64_tr_b16 a[160:161], v4 offset:0
    ds_read_b64_tr_b16 a[162:163], v4 offset:4096
    v_mfma_f32_16x16x32_bf16 v[132:135], a[164:167], a[144:147], v[132:135]
    s_bfe_u32 s40, s30, 0x80000
    v_add_u32 v5, s62, v5
    v_mfma_f32_16x16x32_bf16 v[164:167], a[164:167], a[148:151], v[164:167]
    s_lshl_b32 s40, s40, 13
    v_mfma_f32_16x16x32_bf16 v[196:199], a[164:167], a[152:155], v[196:199]
    buffer_load_dwordx4 a[128:131], v21, s[12:15], s40 offen offset:0 sc1
    v_mfma_f32_16x16x32_bf16 v[228:231], a[164:167], a[156:159], v[228:231]
    ds_read_b64_tr_b16 a[164:165], v5 offset:0
    ds_read_b64_tr_b16 a[166:167], v5 offset:4096
    s_waitcnt lgkmcnt(12)
    v_mfma_f32_16x16x32_bf16 v[136:139], a[168:171], a[144:147], v[136:139]
    v_add_u32 v6, s62, v6
    v_mfma_f32_16x16x32_bf16 v[168:171], a[168:171], a[148:151], v[168:171]
    v_mfma_f32_16x16x32_bf16 v[200:203], a[168:171], a[152:155], v[200:203]
    buffer_load_dwordx4 v14, s[16:19], s59 offen offset:1024 lds
    v_mfma_f32_16x16x32_bf16 v[232:235], a[168:171], a[156:159], v[232:235]
    ds_read_b64_tr_b16 a[168:169], v6 offset:0
    ds_read_b64_tr_b16 a[170:171], v6 offset:4096
    v_mfma_f32_16x16x32_bf16 v[140:143], a[172:175], a[144:147], v[140:143]
    v_add_u32 v7, s62, v7
    v_mfma_f32_16x16x32_bf16 v[172:175], a[172:175], a[148:151], v[172:175]
    v_mfma_f32_16x16x32_bf16 v[204:207], a[172:175], a[152:155], v[204:207]
    buffer_load_dwordx4 a[132:135], v21, s[12:15], s40 offen offset:1024 sc1
    v_mfma_f32_16x16x32_bf16 v[236:239], a[172:175], a[156:159], v[236:239]
    ds_read_b64_tr_b16 a[172:173], v7 offset:0
    ds_read_b64_tr_b16 a[174:175], v7 offset:4096
    s_waitcnt lgkmcnt(12)
    v_mfma_f32_16x16x32_bf16 v[144:147], a[176:179], a[144:147], v[144:147]
    v_add_u32 v8, s62, v8
    v_mfma_f32_16x16x32_bf16 v[176:179], a[176:179], a[148:151], v[176:179]
    v_mfma_f32_16x16x32_bf16 v[208:211], a[176:179], a[152:155], v[208:211]
    buffer_load_dwordx4 v15, s[16:19], s59 offen offset:2048 lds
    v_mfma_f32_16x16x32_bf16 v[240:243], a[176:179], a[156:159], v[240:243]
    ds_read_b64_tr_b16 a[176:177], v8 offset:0
    ds_read_b64_tr_b16 a[178:179], v8 offset:4096
    v_mfma_f32_16x16x32_bf16 v[148:151], a[180:183], a[144:147], v[148:151]
    v_add_u32 v9, s62, v9
    v_mfma_f32_16x16x32_bf16 v[180:183], a[180:183], a[148:151], v[180:183]
    v_mfma_f32_16x16x32_bf16 v[212:215], a[180:183], a[152:155], v[212:215]
    buffer_load_dwordx4 a[136:139], v22, s[12:15], s40 offen offset:0 sc1
    v_mfma_f32_16x16x32_bf16 v[244:247], a[180:183], a[156:159], v[244:247]
    ds_read_b64_tr_b16 a[180:181], v9 offset:0
    ds_read_b64_tr_b16 a[182:183], v9 offset:4096
    s_waitcnt lgkmcnt(12)
    v_mfma_f32_16x16x32_bf16 v[152:155], a[184:187], a[144:147], v[152:155]
    v_add_u32 v10, s62, v10
    v_mfma_f32_16x16x32_bf16 v[184:187], a[184:187], a[148:151], v[184:187]
    s_cmp_ge_u32 s71, 0x20000
    s_cselect_b32 s52, s64, 0x8000
    v_mfma_f32_16x16x32_bf16 v[216:219], a[184:187], a[152:155], v[216:219]
    buffer_load_dwordx4 v16, s[16:19], s59 offen offset:3072 lds
    v_mfma_f32_16x16x32_bf16 v[248:251], a[184:187], a[156:159], v[248:251]
    ds_read_b64_tr_b16 a[184:185], v10 offset:0
    ds_read_b64_tr_b16 a[186:187], v10 offset:4096
    v_mfma_f32_16x16x32_bf16 v[156:159], a[188:191], a[144:147], v[156:159]
    v_add_u32 v11, s62, v11
    v_mfma_f32_16x16x32_bf16 v[188:191], a[188:191], a[148:151], v[188:191]
    s_add_u32 s71, s71, s52
    v_mfma_f32_16x16x32_bf16 v[220:223], a[188:191], a[152:155], v[220:223]
    buffer_load_dwordx4 a[140:143], v22, s[12:15], s40 offen offset:1024 sc1
    v_mfma_f32_16x16x32_bf16 v[252:255], a[188:191], a[156:159], v[252:255]
    ds_read_b64_tr_b16 a[188:189], v11 offset:0
    ds_read_b64_tr_b16 a[190:191], v11 offset:4096
    s_sub_u32 s48, s48, 1
    s_cmp_lg_u32 s48, 0
    s_cbranch_scc1 L_loop2_0
    s_setpc_b64 s[28:29]
L_endC:
L_done:
    s_endpgm
L_pollSTA:
    s_mov_b32 s48, 0x20000
L_pollSTAl:
    s_sleep 1
    buffer_load_dword v26, v25, s[44:47], s52 offen sc1
    s_waitcnt vmcnt(0)
    v_cmp_ne_u32 vcc, v3, v26
    s_sub_u32 s48, s48, 1
    s_nop 3
    s_cbranch_vccz L_pollSTAb
    s_cmp_lg_u32 s48, 0
    s_cbranch_scc1 L_pollSTAl
    s_branch L_pollSTAb
L_pollCSA:
    s_mov_b32 s48, 0x20000
L_pollCSAl:
    s_sleep 1
    buffer_load_dword v28, v27, s[44:47], s53 offen sc1
    s_waitcnt vmcnt(0)
    v_cmp_ne_u32 vcc, v3, v28
    s_sub_u32 s48, s48, 1
    s_nop 3
    s_cbranch_vccz L_pollCSAb
    s_cmp_lg_u32 s48, 0
    s_cbranch_scc1 L_pollCSAl
    s_branch L_pollCSAb
L_pollSTB:
    s_mov_b32 s48, 0x20000
L_pollSTBl:
    s_sleep 1
    buffer_load_dword v26, v25, s[44:47], s52 offen sc1
    s_waitcnt vmcnt(0)
    v_cmp_ne_u32 vcc, v3, v26
    s_sub_u32 s48, s48, 1
    s_nop 3
    s_cbranch_vccz L_pollSTBb
    s_cmp_lg_u32 s48, 0
    s_cbranch_scc1 L_pollSTBl
    s_branch L_pollSTBb
L_pollCSB:
    s_mov_b32 s48, 0x20000
L_pollCSBl:
    s_sleep 1
    buffer_load_dword v28, v27, s[44:47], s53 offen sc1
    s_waitcnt vmcnt(0)
    v_cmp_ne_u32 vcc, v3, v28
    s_sub_u32 s48, s48, 1
    s_nop 3
    s_cbranch_vccz L_pollCSBb
    s_cmp_lg_u32 s48, 0
    s_cbranch_scc1 L_pollCSBl
    s_branch L_pollCSBb
.section .rodata,"a"
.p2align 6
.amdhsa_kernel recurrent_scan__linear_attn_block__glu_gated_swiglu__prompt_kernel
  .amdhsa_next_free_vgpr 512
  .amdhsa_next_free_sgpr 102
  .amdhsa_accum_offset 256
  .amdhsa_group_segment_fixed_size 0
  .amdhsa_kernarg_size 80
  .amdhsa_user_sgpr_count 2
  .amdhsa_user_sgpr_kernarg_segment_ptr 1
  .amdhsa_system_sgpr_workgroup_id_x 1
  .amdhsa_float_denorm_mode_32 3
.end_amdhsa_kernel
.text
```
